```python
import torch

def _softmax(x, axis=-1):
    return torch.softmax(x, dim=axis)

def _gelu(x):
    return torch.nn.functional.gelu(x, approximate='tanh')

def _silu(x):
    return torch.nn.functional.silu(x)

def _sigmoid(x):
    return torch.sigmoid(x)

def _layernorm(x, axis=-1, eps=1e-05):
    m = x.mean(dim=axis, keepdim=True)
    v = x.var(dim=axis, keepdim=True, unbiased=False)
    return (x - m) / torch.sqrt(v + eps)

def _scatter_add(tgt, idx, src, axis=0):
    return tgt.clone().index_add_(axis, idx, src)

def _segment_sum(src, seg, n):
    out = torch.zeros((n,) + src.shape[1:], dtype=src.dtype)
    return out.index_add_(0, seg, src)

def _pad(x, pw):
    flat = tuple((v for pair in reversed(pw) for v in pair))
    return torch.nn.functional.pad(x, flat)
kernel_name = 'parallel_sum__ssm_conv_h3__mixer_gmlp__prompt'

def setup_inputs():

    _w = lambda a: (lambda t: t.to(torch.bfloat16) if t.is_floating_point() else t)(torch.as_tensor(a))

    def _A_setup():
        B, S, D = (1, 2048, 1024)
        ks = 4
        return {'q': _w((lambda *s: torch.randn(*s, dtype=torch.bfloat16) * 0.05)(B, S, D)), 'k': _w((lambda *s: torch.randn(*s, dtype=torch.bfloat16) * 0.8)(B, S, D)), 'v': _w((lambda *s: torch.randn(*s, dtype=torch.bfloat16) * 0.8)(B, S, D)), 'shift_k': _w((lambda *s: torch.randn(*s, dtype=torch.bfloat16) * 0.8)(D, ks) * 0.5), 'ssm_k': _w((lambda *s: torch.randn(*s, dtype=torch.bfloat16) * 3.2)(D, S) * (1.0 / S ** 0.5)), 'ssm_D': _w((lambda *s: torch.randn(*s, dtype=torch.bfloat16) * 0.8)(D))}
    _A_in = _A_setup()

    def _B_setup():
        B, S, D, F = (1, 2048, 1024, 3584)
        Fh = F // 2
        return {'x': _w((lambda *s: torch.randn(*s, dtype=torch.bfloat16) * 0.05)(B, S, D)), 'w_in': _w((lambda *s: torch.randn(*s, dtype=torch.bfloat16) * 0.4)(D, 2 * Fh)), 'w_sp': _w(0.01 * (lambda *s: torch.randn(*s, dtype=torch.bfloat16) * 0.4)(S, S)), 'b_sp': _w(1.0 + 0.01 * (lambda *s: torch.randn(*s, dtype=torch.bfloat16) * 0.05)(S)), 'w_out': _w((lambda *s: torch.randn(*s, dtype=torch.bfloat16) * 0.05)(Fh, D))}
    _B_in = _B_setup()
    return {'A_q': _A_in['q'], 'A_k': _A_in['k'], 'A_v': _A_in['v'], 'A_shift_k': _A_in['shift_k'], 'A_ssm_k': _A_in['ssm_k'], 'A_ssm_D': _A_in['ssm_D'], 'B_x': _B_in['x'], 'B_w_in': _B_in['w_in'], 'B_w_sp': _B_in['w_sp'], 'B_b_sp': _B_in['b_sp'], 'B_w_out': _B_in['w_out']}

def reference(A_q, A_k, A_v, A_shift_k, A_ssm_k, A_ssm_D, B_x, B_w_in, B_w_sp, B_b_sp, B_w_out):

    def _A_ref(q, k, v, shift_k, ssm_k, ssm_D):
        B, S, D = q.shape
        ks = shift_k.shape[-1]
        k_pad = _pad(k, ((0, 0), (ks - 1, 0), (0, 0)))
        k_shift = torch.zeros_like(k)
        for t in range(ks):
            k_shift = k_shift + k_pad[:, t:t + S, :] * shift_k[:, ks - 1 - t][None, None, :]
        kv = k_shift * v
        L = 2 * S
        kv_pad = _pad(kv, ((0, 0), (0, S), (0, 0)))
        kf_pad = _pad(ssm_k, ((0, 0), (0, S)))
        kv_f = (lambda x, axes=(-2, -1): torch.fft.rfft2(x.float(), dim=axes))(kv_pad[:, None, :, :], axes=(1, 2))
        kf_f = (lambda x, axes=(-2, -1): torch.fft.rfft2(x.float(), dim=axes))(kf_pad[:, None, :], axes=(1, 2))
        kf_f = (lambda x, *d: x.permute(*d))(kf_f, 1, 2, 0)
        y_f = kv_f * kf_f[None, :, :, :]
        y = (lambda x, s, axes=(-2, -1): torch.fft.irfft2(x, s=s, dim=axes).to(torch.bfloat16))(y_f, (1, L), axes=(1, 2))[:, 0, :S, :]
        y = y + kv * ssm_D[None, None, :]
        return q * y

    def _B_ref(x, w_in, w_sp, b_sp, w_out):
        B, S, D = x.shape
        F = w_in.shape[-1]
        Fh = F // 2
        z = _gelu(torch.einsum('bsd,df->bsf', x, w_in))
        z1 = z[..., :Fh].clone()
        z2 = _layernorm(z[..., Fh:], axis=-1)
        g = torch.einsum('ts,bsf->btf', w_sp, z2) + b_sp[None, :, None]
        return torch.einsum('bsf,fd->bsd', z1 * g, w_out)
    x = A_q
    xn = _layernorm(x, axis=-1)
    return x + _A_ref(xn, A_k, A_v, A_shift_k, A_ssm_k, A_ssm_D) + _B_ref(xn, B_w_in, B_w_sp, B_b_sp, B_w_out)
```

```asm
; @launch grid=(256,1,1) block=(256,1,1) lds=163840
.amdgcn_target "amdgcn-amd-amdhsa--gfx950"
.text
.globl parallel_sum__ssm_conv_h3__mixer_gmlp__prompt_kernel
.p2align 12
.p2align 8
.type parallel_sum__ssm_conv_h3__mixer_gmlp__prompt_kernel,@function
parallel_sum__ssm_conv_h3__mixer_gmlp__prompt_kernel:
  s_cmp_ge_u32 s2, 256
  s_cbranch_scc1 parallel_sum__ssm_conv_h3__mixer_gmlp__prompt_kernel_end
  s_load_dwordx2 s[8:9], s[0:1], 0
  s_load_dwordx2 s[12:13], s[0:1], 56
  s_memrealtime s[92:93]
  v_lshrrev_b32 v1, 6, v0
  v_and_b32 v0, 63, v0
  v_readfirstlane_b32 s3, v1
  v_and_b32 v1, 15, v0
  v_lshrrev_b32 v2, 4, v0
  s_and_b32 s4, s2, 7
  s_lshr_b32 s5, s2, 3
  s_getpc_b64 s[98:99]
parallel_sum__ssm_conv_h3__mixer_gmlp__prompt_kernel_pc:
  s_lshr_b32 s94, s2, 3
  s_mul_i32 s94, s94, 3072
  s_mul_i32 s95, s3, 768
  s_add_u32 s94, s94, s95
  v_mul_u32_u24 v254, 12, v0
  v_add_u32_e64 v254, s94, v254
  v_min_u32 v254, parallel_sum__ssm_conv_h3__mixer_gmlp__prompt_kernel_last-parallel_sum__ssm_conv_h3__mixer_gmlp__prompt_kernel_pc-8, v254
  v_and_b32_e64 v254, -4, v254
  global_load_dwordx2 v[254:255], v254, s[98:99]
  s_lshl_b32 s68, s3, 14
  s_add_u32 s68, s68, 98304
  v_lshlrev_b32_e64 v208, 4, v0
  s_cmp_lt_u32 s5, 4
  s_cbranch_scc1 parallel_sum__ssm_conv_h3__mixer_gmlp__prompt_kernel_helper
  s_sub_u32 s5, s5, 4
  s_mul_i32 s6, s5, 37
  s_lshr_b32 s6, s6, 8
  s_mul_i32 s7, s6, 7
  s_sub_u32 s7, s5, s7
  s_lshr_b32 s60, s4, 1
  s_lshl_b32 s60, s60, 2
  s_add_u32 s60, s60, s6
  s_and_b32 s61, s4, 1
  s_mul_i32 s61, s61, 7
  s_add_u32 s61, s61, s7
  s_lshl_b32 s63, s60, 7
  s_lshl_b32 s4, s3, 5
  s_add_u32 s63, s63, s4
  s_lshl_b32 s69, s3, 13
  s_xor_b32 s71, s6, s7
  s_and_b32 s4, s60, 4
  s_xor_b32 s71, s71, s4
  s_and_b32 s4, s2, 1
  s_mul_i32 s4, s4, 7
  s_xor_b32 s71, s71, s4
  s_mul_i32 s70, s71, 917504
  s_add_u32 s70, s70, 3584
  s_lshl_b32 s72, s71, 8
  s_mul_i32 s71, s71, 0x11111111
  s_xor_b32 s71, s71, 0x76543210
  s_lshl_b32 s4, s61, 8
  s_lshl_b32 s5, s3, 5
  v_lshrrev_b32 v3, 5, v0
  v_bfe_u32 v4, v0, 3, 2
  v_lshl_add_u32 v3, v3, 3, v4
  v_add_u32_e64 v3, s5, v3
  v_mul_u32_u24 v3, 7168, v3
  v_and_b32 v4, 7, v0
  v_lshlrev_b32 v5, 1, v2
  v_xor_b32 v4, v4, v5
  v_lshlrev_b32 v4, 4, v4
  v_add3_u32 v224, v3, v4, s4
  v_add_u32 v225, 113664, v224
  v_add_u32 v226, 26624, v224
  v_add_u32 v227, 140288, v224
  s_waitcnt lgkmcnt(0)
  s_and_b32 s9, s9, 0xffff
  s_mov_b32 s10, 0x400000
  s_mov_b32 s11, 0x20000
  s_and_b32 s13, s13, 0xffff
  s_mov_b32 s14, 0x700000
  s_mov_b32 s15, 0x20000
  s_add_u32 m0, s69, 0
  s_nop 0
  buffer_load_dwordx4 v224, s[12:15], s70 offen offset:0 lds
  buffer_load_dwordx4 v225, s[12:15], s70 offen offset:1024 lds
  buffer_load_dwordx4 v226, s[12:15], s70 offen offset:2048 lds
  buffer_load_dwordx4 v227, s[12:15], s70 offen offset:3072 lds
  s_add_u32 m0, s69, 3968
  s_nop 0
  buffer_load_dwordx4 v224, s[12:15], s70 offen offset:128 lds
  buffer_load_dwordx4 v225, s[12:15], s70 offen offset:1152 lds
  buffer_load_dwordx4 v226, s[12:15], s70 offen offset:2176 lds
  buffer_load_dwordx4 v227, s[12:15], s70 offen offset:3200 lds
  s_bfe_u32 s70, s71, 0x30004
  s_mul_i32 s70, s70, 917504
  s_add_u32 s70, s70, 3584
  s_load_dwordx2 s[16:17], s[0:1], 104
  s_load_dwordx2 s[56:57], s[0:1], 96
  s_load_dwordx2 s[20:21], s[0:1], 8
  s_load_dwordx2 s[24:25], s[0:1], 16
  s_load_dwordx2 s[28:29], s[0:1], 24
  s_load_dwordx2 s[32:33], s[0:1], 32
  s_load_dwordx2 s[36:37], s[0:1], 40
  s_load_dwordx2 s[40:41], s[0:1], 64
  s_load_dwordx2 s[44:45], s[0:1], 72
  s_load_dwordx2 s[48:49], s[0:1], 80
  s_load_dwordx2 s[52:53], s[0:1], 88
  v_add_u32_e64 v3, s63, v2
  v_mul_u32_u24 v3, 2048, v3
  v_xor_b32 v4, v2, v1
  v_lshlrev_b32 v4, 4, v4
  v_add_u32 v216, v3, v4
  v_xor_b32 v217, 64, v4
  v_add_u32 v3, 15360, v3
  v_add_u32_e64 v217, v217, v3
  v_xor_b32 v218, 128, v4
  v_add_u32 v3, 15360, v3
  v_add_u32_e64 v218, v218, v3
  v_xor_b32 v219, 192, v4
  v_add_u32 v3, 15360, v3
  v_add_u32 v219, v219, v3
  s_add_u32 m0, s68, 0
  s_add_u32 s73, s72, 8192
  buffer_load_dwordx4 v216, s[8:11], s72 offen offset:0 lds
  buffer_load_dwordx4 v217, s[8:11], s72 offen offset:1024 lds
  buffer_load_dwordx4 v218, s[8:11], s72 offen offset:2048 lds
  buffer_load_dwordx4 v219, s[8:11], s72 offen offset:3072 lds
  s_add_u32 m0, s68, 4096
  s_nop 0
  buffer_load_dwordx4 v216, s[8:11], s73 offen offset:0 lds
  buffer_load_dwordx4 v217, s[8:11], s73 offen offset:1024 lds
  buffer_load_dwordx4 v218, s[8:11], s73 offen offset:2048 lds
  buffer_load_dwordx4 v219, s[8:11], s73 offen offset:3072 lds
  s_bfe_u32 s72, s71, 0x30004
  s_lshl_b32 s72, s72, 8
  s_waitcnt lgkmcnt(0)
  s_and_b32 s17, s17, 0xffff
  s_mov_b32 s18, 0x10000000
  s_mov_b32 s19, 0x20000
  s_and_b32 s57, s57, 0xffff
  s_mov_b32 s58, 0x100
  s_mov_b32 s59, 0x20000
  s_and_b32 s21, s21, 0xffff
  s_mov_b32 s22, 0x400000
  s_mov_b32 s23, 0x20000
  s_and_b32 s25, s25, 0xffff
  s_mov_b32 s26, 0x400000
  s_mov_b32 s27, 0x20000
  s_and_b32 s29, s29, 0xffff
  s_mov_b32 s30, 0x2000
  s_mov_b32 s31, 0x20000
  s_and_b32 s33, s33, 0xffff
  s_mov_b32 s34, 0x400000
  s_mov_b32 s35, 0x20000
  s_and_b32 s37, s37, 0xffff
  s_mov_b32 s38, 0x800
  s_mov_b32 s39, 0x20000
  s_and_b32 s41, s41, 0xffff
  s_mov_b32 s42, 0x800000
  s_mov_b32 s43, 0x20000
  s_and_b32 s45, s45, 0xffff
  s_mov_b32 s46, 0x1000
  s_mov_b32 s47, 0x20000
  s_and_b32 s49, s49, 0xffff
  s_mov_b32 s50, 0x380000
  s_mov_b32 s51, 0x20000
  s_and_b32 s53, s53, 0xffff
  s_mov_b32 s54, 0x400000
  s_mov_b32 s55, 0x20000
  v_lshrrev_b32 v14, 5, v0
  v_min_u32 v14, 1, v14
  v_lshlrev_b32 v14, 30, v14
  v_lshl_add_u32 v14, v0, 2, v14
  s_lshl_b32 s83, s63, 3
  s_lshl_b32 s85, s60, 14
  s_lshl_b32 s5, s3, 12
  s_add_u32 s85, s85, s5
  s_add_u32 s85, s85, 65536
  s_lshl_b32 s5, s61, 6
  s_add_u32 s84, s85, s5
  s_lshl_b32 s4, s61, 6
  s_lshl_b32 s5, s60, 2
  s_add_u32 s5, s5, s3
  s_add_u32 s5, s5, s4
  s_lshl_b32 s86, s5, 13
  s_add_u32 s86, s86, 9437184
  s_add_u32 s87, s86, 4096
  s_lshl_b32 s88, s5, 7
  s_add_u32 s88, s88, 1048576
  s_add_u32 s4, s4, s3
  s_lshl_b32 s89, s4, 7
  s_add_u32 s89, s89, 1048576
  s_lshl_b32 s90, s4, 13
  s_add_u32 s90, s90, 9437184
  s_and_b32 s4, s2, 1
  s_mul_i32 s5, s4, 7
  s_sub_u32 s5, s61, s5
  s_lshl_b32 s5, s5, 2
  s_cmp_eq_u32 s4, 0
  s_cselect_b32 s0, 0x7654321, 0
  s_cselect_b32 s6, 0, 0xedcba98
  s_cselect_b32 s1, 0xfedcba98, 0
  s_cselect_b32 s7, 0, 0xf7654321
  s_or_b32 s0, s0, s6
  s_or_b32 s1, s1, s7
  s_sub_u32 s4, 28, s5
  s_lshl_b32 s6, s0, s4
  s_lshr_b32 s0, s0, s5
  s_or_b32 s0, s0, s6
  s_lshl_b32 s0, s0, 4
  s_sub_u32 s4, 32, s5
  s_lshl_b32 s6, s1, s4
  s_lshr_b32 s1, s1, s5
  s_or_b32 s1, s1, s6
  s_mul_i32 s4, s60, 0x11111111
  s_xor_b32 s0, s0, s4
  s_xor_b32 s1, s1, s4
  s_bfe_u32 s74, s0, 0x40004
  s_lshl_b32 s74, s74, 15
  s_lshl_b32 s82, s61, 9
  s_add_u32 s82, s82, 409600
  s_lshl_b32 s99, s61, 10
  s_add_u32 s99, s99, 417792
  s_mov_b32 s76, 0x7060500
  s_mov_b32 s77, 0x7060501
  s_mov_b32 s78, 0x7060502
  s_mov_b32 s79, 0x7060503
  s_mov_b32 s80, 1.0
  s_mov_b32 s81, 1.0
  s_and_b32 s4, s2, 7
  s_lshr_b32 s5, s2, 3
  s_lshr_b32 s95, s4, 1
  s_lshl_b32 s95, s95, 3
  s_lshr_b32 s6, s5, 2
  s_add_u32 s95, s95, s6
  s_and_b32 s7, s4, 1
  s_lshl_b32 s7, s7, 2
  s_and_b32 s6, s5, 3
  s_add_u32 s7, s7, s6
  s_xor_b32 s7, s7, 1
  s_lshl_b32 s96, s7, 8
  s_lshl_b32 s6, s3, 6
  s_add_u32 s96, s96, s6
  s_add_u32 s6, s95, 2
  s_and_b32 s6, s6, 7
  s_and_b32 s97, s95, 24
  s_add_u32 s97, s97, s6
  s_add_u32 s97, s97, s7
  s_cmp_ge_u32 s97, 28
  s_cselect_b32 s6, 28, 0
  s_sub_u32 s97, s97, s6
  s_cmp_ge_u32 s97, 14
  s_cselect_b32 s6, 14, 0
  s_sub_u32 s97, s97, s6
  v_xor_b32 v3, v1, v2
  v_lshlrev_b32_e64 v3, 4, v3
  v_lshl_add_u32 v3, v1, 8, v3
  v_xor_b32 v4, 0, v3
  v_add_u32 v220, s68, v4
  v_xor_b32 v4, 64, v3
  v_add_u32 v221, s68, v4
  v_xor_b32 v4, 128, v3
  v_add_u32_e64 v222, s68, v4
  v_xor_b32 v4, 192, v3
  v_add_u32 v223, s68, v4
  v_lshlrev_b32 v4, 2, v2
  v_bfe_u32 v6, v0, 2, 2
  v_add_u32_e64 v4, v4, v6
  v_bfe_u32 v6, v4, 1, 2
  v_lshlrev_b32_e64 v4, 7, v4
  v_lshl_add_u32 v4, v6, 5, v4
  v_and_b32_e64 v5, 3, v0
  v_lshl_add_u32 v228, v5, 3, v4
  v_xor_b32 v229, 32, v228
  v_xor_b32 v230, 64, v228
  v_xor_b32 v231, 96, v228
  v_add_u32 v232, 0x10000, v228
  v_add_u32 v233, 0x10000, v229
  v_add_u32 v234, 0x10000, v230
  v_add_u32 v235, 0x10000, v231
  v_lshlrev_b32_e64 v12, 10, v2
  v_lshl_add_u32 v12, v1, 4, v12
  v_mov_b32 v10, 0
  s_cmp_eq_u32 s3, 0
  s_cbranch_scc1 parallel_sum__ssm_conv_h3__mixer_gmlp__prompt_kernel_pg0
  s_cmp_eq_u32 s3, 1
  s_cbranch_scc1 parallel_sum__ssm_conv_h3__mixer_gmlp__prompt_kernel_pg1
  s_cmp_eq_u32 s3, 2
  s_cbranch_scc1 parallel_sum__ssm_conv_h3__mixer_gmlp__prompt_kernel_pg2
  s_branch parallel_sum__ssm_conv_h3__mixer_gmlp__prompt_kernel_pg3
parallel_sum__ssm_conv_h3__mixer_gmlp__prompt_kernel_pgback:
  s_add_u32 m0, s68, 8192
  s_add_u32 s73, s72, 8192
  buffer_load_dwordx4 v216, s[8:11], s72 offen offset:0 lds
  buffer_load_dwordx4 v217, s[8:11], s72 offen offset:1024 lds
  buffer_load_dwordx4 v218, s[8:11], s72 offen offset:2048 lds
  buffer_load_dwordx4 v219, s[8:11], s72 offen offset:3072 lds
  s_add_u32 m0, s68, 12288
  s_nop 0
  buffer_load_dwordx4 v216, s[8:11], s73 offen offset:0 lds
  buffer_load_dwordx4 v217, s[8:11], s73 offen offset:1024 lds
  buffer_load_dwordx4 v218, s[8:11], s73 offen offset:2048 lds
  buffer_load_dwordx4 v219, s[8:11], s73 offen offset:3072 lds
  s_bfe_u32 s72, s71, 0x30008
  s_lshl_b32 s72, s72, 8
  s_waitcnt vmcnt(16)
  s_barrier
  s_waitcnt vmcnt(8)
  ds_read_b128 a[0:3], v220 offset:0
  ds_read_b128 a[4:7], v220 offset:4096
  ds_read_b128 a[8:11], v221 offset:0
  ds_read_b128 a[12:15], v221 offset:4096
  ds_read_b128 a[16:19], v222 offset:0
  ds_read_b128 a[20:23], v222 offset:4096
  ds_read_b128 a[24:27], v223 offset:0
  ds_read_b128 a[28:31], v223 offset:4096
  ds_read_b64_tr_b16 v[144:145], v228 offset:0
  ds_read_b64_tr_b16 v[146:147], v228 offset:2048
  ds_read_b64_tr_b16 v[148:149], v229 offset:0
  ds_read_b64_tr_b16 v[150:151], v229 offset:2048
  ds_read_b64_tr_b16 v[152:153], v230 offset:0
  ds_read_b64_tr_b16 v[154:155], v230 offset:2048
  ds_read_b64_tr_b16 v[156:157], v231 offset:0
  ds_read_b64_tr_b16 v[158:159], v231 offset:2048
  ds_read_b64_tr_b16 v[160:161], v228 offset:4096
  ds_read_b64_tr_b16 v[162:163], v228 offset:6144
  ds_read_b64_tr_b16 v[164:165], v229 offset:4096
  ds_read_b64_tr_b16 v[166:167], v229 offset:6144
  ds_read_b64_tr_b16 v[168:169], v230 offset:4096
  ds_read_b64_tr_b16 v[170:171], v230 offset:6144
  ds_read_b64_tr_b16 v[172:173], v231 offset:4096
  ds_read_b64_tr_b16 v[174:175], v231 offset:6144
  s_waitcnt lgkmcnt(14)
  v_mfma_f32_16x16x32_bf16 v[16:19], a[0:3], v[144:147], 0
  s_add_u32 m0, s69, 32768
  ds_read_b64_tr_b16 v[176:177], v228 offset:8192
  buffer_load_dword v13, v10, s[56:59], 0 offen sc0 sc1
  v_mfma_f32_16x16x32_bf16 v[20:23], a[4:7], v[144:147], 0
  s_waitcnt lgkmcnt(13)
  ds_read_b64_tr_b16 v[178:179], v228 offset:10240
  buffer_load_dwordx4 v224, s[12:15], s70 offen offset:0 lds
  v_mfma_f32_16x16x32_bf16 v[24:27], a[0:3], v[148:151], 0
  ds_read_b64_tr_b16 v[180:181], v229 offset:8192
  buffer_load_dwordx4 v225, s[12:15], s70 offen offset:1024 lds
  v_mfma_f32_16x16x32_bf16 v[28:31], a[4:7], v[148:151], 0
  s_waitcnt lgkmcnt(13)
  ds_read_b64_tr_b16 v[182:183], v229 offset:10240
  buffer_load_dwordx4 v226, s[12:15], s70 offen offset:2048 lds
  v_mfma_f32_16x16x32_bf16 v[32:35], a[0:3], v[152:155], 0
  ds_read_b64_tr_b16 v[184:185], v230 offset:8192
  buffer_load_dwordx4 v227, s[12:15], s70 offen offset:3072 lds
  v_mfma_f32_16x16x32_bf16 v[36:39], a[4:7], v[152:155], 0
  s_waitcnt lgkmcnt(5)
  ds_read_b64_tr_b16 v[186:187], v230 offset:10240
  s_add_u32 m0, s69, 36736
  v_mfma_f32_16x16x32_bf16 v[40:43], a[0:3], v[156:159], 0
  ds_read_b64_tr_b16 v[188:189], v231 offset:8192
  ds_read_b64_tr_b16 v[190:191], v231 offset:10240
  v_mfma_f32_16x16x32_bf16 v[44:47], a[4:7], v[156:159], 0
  buffer_load_dwordx4 v224, s[12:15], s70 offen offset:128 lds
  ds_read_b64_tr_b16 v[192:193], v228 offset:12288
  v_mfma_f32_16x16x32_bf16 v[48:51], a[0:3], v[160:163], 0
  buffer_load_dwordx4 v225, s[12:15], s70 offen offset:1152 lds
  ds_read_b64_tr_b16 v[194:195], v228 offset:14336
  v_mfma_f32_16x16x32_bf16 v[52:55], a[4:7], v[160:163], 0
  buffer_load_dwordx4 v226, s[12:15], s70 offen offset:2176 lds
  ds_read_b64_tr_b16 v[196:197], v229 offset:12288
  v_mfma_f32_16x16x32_bf16 v[56:59], a[0:3], v[164:167], 0
  buffer_load_dwordx4 v227, s[12:15], s70 offen offset:3200 lds
  ds_read_b64_tr_b16 v[198:199], v229 offset:14336
  v_mfma_f32_16x16x32_bf16 v[60:63], a[4:7], v[164:167], 0
  s_bfe_u32 s70, s71, 0x30008
  ds_read_b64_tr_b16 v[200:201], v230 offset:12288
  ds_read_b64_tr_b16 v[202:203], v230 offset:14336
  v_mfma_f32_16x16x32_bf16 v[64:67], a[0:3], v[168:171], 0
  s_mul_i32 s70, s70, 917504
  ds_read_b64_tr_b16 v[204:205], v231 offset:12288
  ds_read_b64_tr_b16 v[206:207], v231 offset:14336
  v_mfma_f32_16x16x32_bf16 v[68:71], a[4:7], v[168:171], 0
  ds_read_b64_tr_b16 v[144:145], v228 offset:16384
  ds_read_b64_tr_b16 v[146:147], v228 offset:18432
  v_mfma_f32_16x16x32_bf16 v[72:75], a[0:3], v[172:175], 0
  s_add_u32 s70, s70, 3584
  ds_read_b64_tr_b16 v[148:149], v229 offset:16384
  ds_read_b64_tr_b16 v[150:151], v229 offset:18432
  v_mfma_f32_16x16x32_bf16 v[76:79], a[4:7], v[172:175], 0
  s_waitcnt lgkmcnt(9)
  s_add_u32 m0, s68, 0
  ds_read_b64_tr_b16 v[152:153], v230 offset:16384
  v_mfma_f32_16x16x32_bf16 v[16:19], a[8:11], v[176:179], v[16:19]
  s_add_u32 s73, s72, 8192
  ds_read_b64_tr_b16 v[154:155], v230 offset:18432
  ds_read_b64_tr_b16 v[156:157], v231 offset:16384
  v_mfma_f32_16x16x32_bf16 v[20:23], a[12:15], v[176:179], v[20:23]
  buffer_load_dwordx4 v216, s[8:11], s72 offen offset:0 lds
  ds_read_b64_tr_b16 v[158:159], v231 offset:18432
  v_mfma_f32_16x16x32_bf16 v[24:27], a[8:11], v[180:183], v[24:27]
  buffer_load_dwordx4 v217, s[8:11], s72 offen offset:1024 lds
  ds_read_b64_tr_b16 v[160:161], v228 offset:20480
  v_mfma_f32_16x16x32_bf16 v[28:31], a[12:15], v[180:183], v[28:31]
  ds_read_b64_tr_b16 v[162:163], v228 offset:22528
  ds_read_b64_tr_b16 v[164:165], v229 offset:20480
  v_mfma_f32_16x16x32_bf16 v[32:35], a[8:11], v[184:187], v[32:35]
  buffer_load_dwordx4 v218, s[8:11], s72 offen offset:2048 lds
  ds_read_b64_tr_b16 v[166:167], v229 offset:22528
  v_mfma_f32_16x16x32_bf16 v[36:39], a[12:15], v[184:187], v[36:39]
  buffer_load_dwordx4 v219, s[8:11], s72 offen offset:3072 lds
  ds_read_b64_tr_b16 v[168:169], v230 offset:20480
  v_mfma_f32_16x16x32_bf16 v[40:43], a[8:11], v[188:191], v[40:43]
  s_add_u32 m0, s68, 4096
  ds_read_b64_tr_b16 v[170:171], v230 offset:22528
  ds_read_b64_tr_b16 v[172:173], v231 offset:20480
  v_mfma_f32_16x16x32_bf16 v[44:47], a[12:15], v[188:191], v[44:47]
  buffer_load_dwordx4 v216, s[8:11], s73 offen offset:0 lds
  ds_read_b64_tr_b16 v[174:175], v231 offset:22528
  v_mfma_f32_16x16x32_bf16 v[48:51], a[8:11], v[192:195], v[48:51]
  buffer_load_dwordx4 v217, s[8:11], s73 offen offset:1024 lds
  ds_read_b64_tr_b16 v[176:177], v228 offset:24576
  v_mfma_f32_16x16x32_bf16 v[52:55], a[12:15], v[192:195], v[52:55]
  s_waitcnt lgkmcnt(6)
  buffer_load_dwordx4 v218, s[8:11], s73 offen offset:2048 lds
  ds_read_b64_tr_b16 v[178:179], v228 offset:26624
  v_mfma_f32_16x16x32_bf16 v[56:59], a[8:11], v[196:199], v[56:59]
  ds_read_b64_tr_b16 v[180:181], v229 offset:24576
  v_mfma_f32_16x16x32_bf16 v[60:63], a[12:15], v[196:199], v[60:63]
  buffer_load_dwordx4 v219, s[8:11], s73 offen offset:3072 lds
  v_mfma_f32_16x16x32_bf16 v[64:67], a[8:11], v[200:203], v[64:67]
  s_bfe_u32 s72, s71, 0x3000c
  ds_read_b64_tr_b16 v[182:183], v229 offset:26624
  v_mfma_f32_16x16x32_bf16 v[68:71], a[12:15], v[200:203], v[68:71]
  s_lshl_b32 s72, s72, 8
  ds_read_b64_tr_b16 v[184:185], v230 offset:24576
  v_mfma_f32_16x16x32_bf16 v[72:75], a[8:11], v[204:207], v[72:75]
  s_add_u32 m0, s69, 65536
  ds_read_b64_tr_b16 v[186:187], v230 offset:26624
  v_mfma_f32_16x16x32_bf16 v[76:79], a[12:15], v[204:207], v[76:79]
  buffer_load_dwordx4 v224, s[12:15], s70 offen offset:0 lds
  v_mfma_f32_16x16x32_bf16 v[16:19], a[16:19], v[144:147], v[16:19]
  ds_read_b64_tr_b16 v[188:189], v231 offset:24576
  v_mfma_f32_16x16x32_bf16 v[20:23], a[20:23], v[144:147], v[20:23]
  buffer_load_dwordx4 v225, s[12:15], s70 offen offset:1024 lds
  v_mfma_f32_16x16x32_bf16 v[24:27], a[16:19], v[148:151], v[24:27]
  buffer_load_dwordx4 v226, s[12:15], s70 offen offset:2048 lds
  v_mfma_f32_16x16x32_bf16 v[28:31], a[20:23], v[148:151], v[28:31]
  buffer_load_dwordx4 v227, s[12:15], s70 offen offset:3072 lds
  v_mfma_f32_16x16x32_bf16 v[32:35], a[16:19], v[152:155], v[32:35]
  s_add_u32 m0, s69, 69504
  ds_read_b64_tr_b16 v[190:191], v231 offset:26624
  v_mfma_f32_16x16x32_bf16 v[36:39], a[20:23], v[152:155], v[36:39]
  buffer_load_dwordx4 v224, s[12:15], s70 offen offset:128 lds
  v_mfma_f32_16x16x32_bf16 v[40:43], a[16:19], v[156:159], v[40:43]
  buffer_load_dwordx4 v225, s[12:15], s70 offen offset:1152 lds
  v_mfma_f32_16x16x32_bf16 v[44:47], a[20:23], v[156:159], v[44:47]
  ds_read_b64_tr_b16 v[192:193], v228 offset:28672
  v_mfma_f32_16x16x32_bf16 v[48:51], a[16:19], v[160:163], v[48:51]
  buffer_load_dwordx4 v226, s[12:15], s70 offen offset:2176 lds
  v_mfma_f32_16x16x32_bf16 v[52:55], a[20:23], v[160:163], v[52:55]
  s_waitcnt lgkmcnt(2)
  buffer_load_dwordx4 v227, s[12:15], s70 offen offset:3200 lds
  v_mfma_f32_16x16x32_bf16 v[56:59], a[16:19], v[164:167], v[56:59]
  s_bfe_u32 s70, s71, 0x3000c
  ds_read_b64_tr_b16 v[194:195], v228 offset:30720
  v_mfma_f32_16x16x32_bf16 v[60:63], a[20:23], v[164:167], v[60:63]
  s_mul_i32 s70, s70, 917504
  ds_read_b64_tr_b16 v[196:197], v229 offset:28672
  v_mfma_f32_16x16x32_bf16 v[64:67], a[16:19], v[168:171], v[64:67]
  s_add_u32 s70, s70, 3584
  ds_read_b64_tr_b16 v[198:199], v229 offset:30720
  v_mfma_f32_16x16x32_bf16 v[68:71], a[20:23], v[168:171], v[68:71]
  ds_read_b64_tr_b16 v[200:201], v230 offset:28672
  v_mfma_f32_16x16x32_bf16 v[72:75], a[16:19], v[172:175], v[72:75]
  ds_read_b64_tr_b16 v[202:203], v230 offset:30720
  v_mfma_f32_16x16x32_bf16 v[76:79], a[20:23], v[172:175], v[76:79]
  ds_read_b64_tr_b16 v[204:205], v231 offset:28672
  v_mfma_f32_16x16x32_bf16 v[16:19], a[24:27], v[176:179], v[16:19]
  ds_read_b64_tr_b16 v[206:207], v231 offset:30720
  v_mfma_f32_16x16x32_bf16 v[20:23], a[28:31], v[176:179], v[20:23]
  s_waitcnt vmcnt(29)
  ds_read_b128 a[32:35], v220 offset:8192
  v_mfma_f32_16x16x32_bf16 v[24:27], a[24:27], v[180:183], v[24:27]
  s_waitcnt vmcnt(25)
  ds_read_b128 a[36:39], v220 offset:12288
  ds_read_b128 a[40:43], v221 offset:8192
  v_mfma_f32_16x16x32_bf16 v[28:31], a[28:31], v[180:183], v[28:31]
  ds_read_b128 a[44:47], v221 offset:12288
  ds_read_b128 a[48:51], v222 offset:8192
  v_mfma_f32_16x16x32_bf16 v[32:35], a[24:27], v[184:187], v[32:35]
  ds_read_b128 a[52:55], v222 offset:12288
  ds_read_b128 a[56:59], v223 offset:8192
  v_mfma_f32_16x16x32_bf16 v[36:39], a[28:31], v[184:187], v[36:39]
  s_waitcnt lgkmcnt(8)
  ds_read_b128 a[60:63], v223 offset:12288
  v_mfma_f32_16x16x32_bf16 v[40:43], a[24:27], v[188:191], v[40:43]
  v_mfma_f32_16x16x32_bf16 v[44:47], a[28:31], v[188:191], v[44:47]
  v_mfma_f32_16x16x32_bf16 v[48:51], a[24:27], v[192:195], v[48:51]
  s_waitcnt vmcnt(16) lgkmcnt(5)
  s_barrier
  ds_read_b64_tr_b16 v[144:145], v228 offset:32768
  v_mfma_f32_16x16x32_bf16 v[52:55], a[28:31], v[192:195], v[52:55]
  s_add_u32 m0, s69, 0
  ds_read_b64_tr_b16 v[146:147], v228 offset:34816
  ds_read_b64_tr_b16 v[148:149], v229 offset:32768
  v_mfma_f32_16x16x32_bf16 v[56:59], a[24:27], v[196:199], v[56:59]
  s_branch parallel_sum__ssm_conv_h3__mixer_gmlp__prompt_kernel_ps0
parallel_sum__ssm_conv_h3__mixer_gmlp__prompt_kernel_pg0:
  s_branch parallel_sum__ssm_conv_h3__mixer_gmlp__prompt_kernel_pg4
parallel_sum__ssm_conv_h3__mixer_gmlp__prompt_kernel_ps0:
  ds_read_b64_tr_b16 v[150:151], v229 offset:34816
  ds_read_b64_tr_b16 v[152:153], v230 offset:32768
  v_mfma_f32_16x16x32_bf16 v[60:63], a[28:31], v[196:199], v[60:63]
  ds_read_b64_tr_b16 v[154:155], v230 offset:34816
  ds_read_b64_tr_b16 v[156:157], v231 offset:32768
  v_mfma_f32_16x16x32_bf16 v[64:67], a[24:27], v[200:203], v[64:67]
  ds_read_b64_tr_b16 v[158:159], v231 offset:34816
  ds_read_b64_tr_b16 v[160:161], v228 offset:36864
  v_mfma_f32_16x16x32_bf16 v[68:71], a[28:31], v[200:203], v[68:71]
  ds_read_b64_tr_b16 v[162:163], v228 offset:38912
  ds_read_b64_tr_b16 v[164:165], v229 offset:36864
  v_mfma_f32_16x16x32_bf16 v[72:75], a[24:27], v[204:207], v[72:75]
  ds_read_b64_tr_b16 v[166:167], v229 offset:38912
  ds_read_b64_tr_b16 v[168:169], v230 offset:36864
  v_mfma_f32_16x16x32_bf16 v[76:79], a[28:31], v[204:207], v[76:79]
  s_waitcnt lgkmcnt(10)
  buffer_load_dwordx4 v224, s[12:15], s70 offen offset:0 lds
  ds_read_b64_tr_b16 v[170:171], v230 offset:38912
  v_mfma_f32_16x16x32_bf16 v[16:19], a[32:35], v[144:147], v[16:19]
  ds_read_b64_tr_b16 v[172:173], v231 offset:36864
  buffer_load_dwordx4 v225, s[12:15], s70 offen offset:1024 lds
  v_mfma_f32_16x16x32_bf16 v[20:23], a[36:39], v[144:147], v[20:23]
  s_waitcnt lgkmcnt(8)
  ds_read_b64_tr_b16 v[174:175], v231 offset:38912
  ds_read_b64_tr_b16 v[176:177], v228 offset:40960
  v_mfma_f32_16x16x32_bf16 v[24:27], a[32:35], v[148:151], v[24:27]
  ds_read_b64_tr_b16 v[178:179], v228 offset:43008
  buffer_load_dwordx4 v226, s[12:15], s70 offen offset:2048 lds
  v_mfma_f32_16x16x32_bf16 v[28:31], a[36:39], v[148:151], v[28:31]
  ds_read_b64_tr_b16 v[180:181], v229 offset:40960
  ds_read_b64_tr_b16 v[182:183], v229 offset:43008
  v_mfma_f32_16x16x32_bf16 v[32:35], a[32:35], v[152:155], v[32:35]
  buffer_load_dwordx4 v227, s[12:15], s70 offen offset:3072 lds
  ds_read_b64_tr_b16 v[184:185], v230 offset:40960
  v_mfma_f32_16x16x32_bf16 v[36:39], a[36:39], v[152:155], v[36:39]
  s_waitcnt lgkmcnt(7)
  ds_read_b64_tr_b16 v[186:187], v230 offset:43008
  s_add_u32 m0, s69, 3968
  v_mfma_f32_16x16x32_bf16 v[40:43], a[32:35], v[156:159], v[40:43]
  ds_read_b64_tr_b16 v[188:189], v231 offset:40960
  ds_read_b64_tr_b16 v[190:191], v231 offset:43008
  v_mfma_f32_16x16x32_bf16 v[44:47], a[36:39], v[156:159], v[44:47]
  ds_read_b64_tr_b16 v[192:193], v228 offset:45056
  buffer_load_dwordx4 v224, s[12:15], s70 offen offset:128 lds
  v_mfma_f32_16x16x32_bf16 v[48:51], a[32:35], v[160:163], v[48:51]
  ds_read_b64_tr_b16 v[194:195], v228 offset:47104
  ds_read_b64_tr_b16 v[196:197], v229 offset:45056
  v_mfma_f32_16x16x32_bf16 v[52:55], a[36:39], v[160:163], v[52:55]
  ds_read_b64_tr_b16 v[198:199], v229 offset:47104
  ds_read_b64_tr_b16 v[200:201], v230 offset:45056
  v_mfma_f32_16x16x32_bf16 v[56:59], a[32:35], v[164:167], v[56:59]
  buffer_load_dwordx4 v225, s[12:15], s70 offen offset:1152 lds
  ds_read_b64_tr_b16 v[202:203], v230 offset:47104
  v_mfma_f32_16x16x32_bf16 v[60:63], a[36:39], v[164:167], v[60:63]
  ds_read_b64_tr_b16 v[204:205], v231 offset:45056
  ds_read_b64_tr_b16 v[206:207], v231 offset:47104
  v_mfma_f32_16x16x32_bf16 v[64:67], a[32:35], v[168:171], v[64:67]
  buffer_load_dwordx4 v226, s[12:15], s70 offen offset:2176 lds
  ds_read_b64_tr_b16 v[144:145], v228 offset:49152
  v_mfma_f32_16x16x32_bf16 v[68:71], a[36:39], v[168:171], v[68:71]
  s_waitcnt lgkmcnt(8)
  ds_read_b64_tr_b16 v[146:147], v228 offset:51200
  ds_read_b64_tr_b16 v[148:149], v229 offset:49152
  v_mfma_f32_16x16x32_bf16 v[72:75], a[32:35], v[172:175], v[72:75]
  ds_read_b64_tr_b16 v[150:151], v229 offset:51200
  ds_read_b64_tr_b16 v[152:153], v230 offset:49152
  v_mfma_f32_16x16x32_bf16 v[76:79], a[36:39], v[172:175], v[76:79]
  buffer_load_dwordx4 v227, s[12:15], s70 offen offset:3200 lds
  ds_read_b64_tr_b16 v[154:155], v230 offset:51200
  v_mfma_f32_16x16x32_bf16 v[16:19], a[40:43], v[176:179], v[16:19]
  ds_read_b64_tr_b16 v[156:157], v231 offset:49152
  v_mfma_f32_16x16x32_bf16 v[20:23], a[44:47], v[176:179], v[20:23]
  s_bfe_u32 s70, s71, 0x30010
  ds_read_b64_tr_b16 v[158:159], v231 offset:51200
  v_mfma_f32_16x16x32_bf16 v[24:27], a[40:43], v[180:183], v[24:27]
  ds_read_b64_tr_b16 v[160:161], v228 offset:53248
  v_mfma_f32_16x16x32_bf16 v[28:31], a[44:47], v[180:183], v[28:31]
  ds_read_b64_tr_b16 v[162:163], v228 offset:55296
  v_mfma_f32_16x16x32_bf16 v[32:35], a[40:43], v[184:187], v[32:35]
  s_mul_i32 s70, s70, 917504
  ds_read_b64_tr_b16 v[164:165], v229 offset:53248
  v_mfma_f32_16x16x32_bf16 v[36:39], a[44:47], v[184:187], v[36:39]
  ds_read_b64_tr_b16 v[166:167], v229 offset:55296
  v_mfma_f32_16x16x32_bf16 v[40:43], a[40:43], v[188:191], v[40:43]
  s_add_u32 s70, s70, 3584
  ds_read_b64_tr_b16 v[168:169], v230 offset:53248
  v_mfma_f32_16x16x32_bf16 v[44:47], a[44:47], v[188:191], v[44:47]
  s_waitcnt lgkmcnt(5)
  ds_read_b64_tr_b16 v[170:171], v230 offset:55296
  v_mfma_f32_16x16x32_bf16 v[48:51], a[40:43], v[192:195], v[48:51]
  ds_read_b64_tr_b16 v[172:173], v231 offset:53248
  v_mfma_f32_16x16x32_bf16 v[52:55], a[44:47], v[192:195], v[52:55]
  s_add_u32 m0, s68, 8192
  ds_read_b64_tr_b16 v[174:175], v231 offset:55296
  v_mfma_f32_16x16x32_bf16 v[56:59], a[40:43], v[196:199], v[56:59]
  ds_read_b64_tr_b16 v[176:177], v228 offset:57344
  v_mfma_f32_16x16x32_bf16 v[60:63], a[44:47], v[196:199], v[60:63]
  s_add_u32 s73, s72, 8192
  ds_read_b64_tr_b16 v[178:179], v228 offset:59392
  v_mfma_f32_16x16x32_bf16 v[64:67], a[40:43], v[200:203], v[64:67]
  ds_read_b64_tr_b16 v[180:181], v229 offset:57344
  v_mfma_f32_16x16x32_bf16 v[68:71], a[44:47], v[200:203], v[68:71]
  buffer_load_dwordx4 v216, s[8:11], s72 offen offset:0 lds
  v_mfma_f32_16x16x32_bf16 v[72:75], a[40:43], v[204:207], v[72:75]
  ds_read_b64_tr_b16 v[182:183], v229 offset:59392
  v_mfma_f32_16x16x32_bf16 v[76:79], a[44:47], v[204:207], v[76:79]
  ds_read_b64_tr_b16 v[184:185], v230 offset:57344
  v_mfma_f32_16x16x32_bf16 v[16:19], a[48:51], v[144:147], v[16:19]
  buffer_load_dwordx4 v217, s[8:11], s72 offen offset:1024 lds
  v_mfma_f32_16x16x32_bf16 v[20:23], a[52:55], v[144:147], v[20:23]
  ds_read_b64_tr_b16 v[186:187], v230 offset:59392
  v_mfma_f32_16x16x32_bf16 v[24:27], a[48:51], v[148:151], v[24:27]
  buffer_load_dwordx4 v218, s[8:11], s72 offen offset:2048 lds
  v_mfma_f32_16x16x32_bf16 v[28:31], a[52:55], v[148:151], v[28:31]
  ds_read_b64_tr_b16 v[188:189], v231 offset:57344
  v_mfma_f32_16x16x32_bf16 v[32:35], a[48:51], v[152:155], v[32:35]
  ds_read_b64_tr_b16 v[190:191], v231 offset:59392
  v_mfma_f32_16x16x32_bf16 v[36:39], a[52:55], v[152:155], v[36:39]
  buffer_load_dwordx4 v219, s[8:11], s72 offen offset:3072 lds
  v_mfma_f32_16x16x32_bf16 v[40:43], a[48:51], v[156:159], v[40:43]
  ds_read_b64_tr_b16 v[192:193], v228 offset:61440
  v_mfma_f32_16x16x32_bf16 v[44:47], a[52:55], v[156:159], v[44:47]
  s_waitcnt lgkmcnt(3)
  s_add_u32 m0, s68, 12288
  ds_read_b64_tr_b16 v[194:195], v228 offset:63488
  v_mfma_f32_16x16x32_bf16 v[48:51], a[48:51], v[160:163], v[48:51]
  ds_read_b64_tr_b16 v[196:197], v229 offset:61440
  v_mfma_f32_16x16x32_bf16 v[52:55], a[52:55], v[160:163], v[52:55]
  ds_read_b64_tr_b16 v[198:199], v229 offset:63488
  v_cmp_eq_u32 vcc, 0, v13
  s_cbranch_vccnz parallel_sum__ssm_conv_h3__mixer_gmlp__prompt_kernel_nonce_slow
parallel_sum__ssm_conv_h3__mixer_gmlp__prompt_kernel_nonce_ok:
  v_mfma_f32_16x16x32_bf16 v[56:59], a[48:51], v[164:167], v[56:59]
  buffer_load_dwordx4 v216, s[8:11], s73 offen offset:0 lds
  v_mfma_f32_16x16x32_bf16 v[60:63], a[52:55], v[164:167], v[60:63]
  ds_read_b64_tr_b16 v[200:201], v230 offset:61440
  v_readfirstlane_b32 s64, v13
  v_mfma_f32_16x16x32_bf16 v[64:67], a[48:51], v[168:171], v[64:67]
  buffer_load_dwordx4 v217, s[8:11], s73 offen offset:1024 lds
  v_mfma_f32_16x16x32_bf16 v[68:71], a[52:55], v[168:171], v[68:71]
  s_lshr_b32 s65, s64, 8
  ds_read_b64_tr_b16 v[202:203], v230 offset:63488
  s_lshr_b32 s66, s64, 16
  v_mfma_f32_16x16x32_bf16 v[72:75], a[48:51], v[172:175], v[72:75]
  s_lshr_b32 s67, s64, 24
  ds_read_b64_tr_b16 v[204:205], v231 offset:61440
  s_and_b32 s62, s64, 0xbfffbfff
  v_mfma_f32_16x16x32_bf16 v[76:79], a[52:55], v[172:175], v[76:79]
  ds_read_b64_tr_b16 v[206:207], v231 offset:63488
  v_lshlrev_b32_e64 v5, 6, v2
  v_mfma_f32_16x16x32_bf16 v[16:19], a[56:59], v[176:179], v[16:19]
  buffer_load_dwordx4 v218, s[8:11], s73 offen offset:2048 lds
  v_mfma_f32_16x16x32_bf16 v[20:23], a[60:63], v[176:179], v[20:23]
  s_waitcnt vmcnt(27)
  ds_read_b128 a[64:67], v220 offset:0
  v_and_b32 v6, 3, v1
  v_mfma_f32_16x16x32_bf16 v[24:27], a[56:59], v[180:183], v[24:27]
  s_waitcnt vmcnt(23)
  ds_read_b128 a[68:71], v220 offset:4096
  v_lshl_add_u32 v5, v6, 4, v5
  v_mfma_f32_16x16x32_bf16 v[28:31], a[60:63], v[180:183], v[28:31]
  ds_read_b128 a[72:75], v221 offset:0
  v_lshlrev_b32 v6, 5, v1
  v_mfma_f32_16x16x32_bf16 v[32:35], a[56:59], v[184:187], v[32:35]
  buffer_load_dwordx4 v219, s[8:11], s73 offen offset:3072 lds
  ds_read_b128 a[76:79], v221 offset:4096
  v_mfma_f32_16x16x32_bf16 v[36:39], a[60:63], v[184:187], v[36:39]
  s_waitcnt lgkmcnt(4)
  ds_read_b128 a[80:83], v222 offset:0
  s_bfe_u32 s72, s71, 0x30010
  v_mfma_f32_16x16x32_bf16 v[40:43], a[56:59], v[188:191], v[40:43]
  s_lshl_b32 s72, s72, 8
  ds_read_b128 a[84:87], v222 offset:4096
  v_lshrrev_b32_e64 v7, 2, v1
  v_mfma_f32_16x16x32_bf16 v[44:47], a[60:63], v[188:191], v[44:47]
  ds_read_b128 a[88:91], v223 offset:0
  v_lshlrev_b32_e64 v8, 6, v7
  v_mfma_f32_16x16x32_bf16 v[48:51], a[56:59], v[192:195], v[48:51]
  s_waitcnt vmcnt(16)
  s_barrier
  ds_read_b64_tr_b16 v[144:145], v232 offset:0
  v_mfma_f32_16x16x32_bf16 v[52:55], a[60:63], v[192:195], v[52:55]
  s_add_u32 m0, s69, 32768
  ds_read_b64_tr_b16 v[146:147], v232 offset:2048
  ds_read_b64_tr_b16 v[148:149], v233 offset:0
  v_bfe_u32 v9, v1, 1, 1
  v_mfma_f32_16x16x32_bf16 v[56:59], a[56:59], v[196:199], v[56:59]
  ds_read_b64_tr_b16 v[150:151], v233 offset:2048
  ds_read_b64_tr_b16 v[152:153], v234 offset:0
  v_lshl_add_u32 v8, v9, 4, v8
  v_mfma_f32_16x16x32_bf16 v[60:63], a[60:63], v[196:199], v[60:63]
  ds_read_b128 a[92:95], v223 offset:4096
  ds_read_b64_tr_b16 v[154:155], v234 offset:2048
  v_and_b32_e64 v9, 1, v1
  v_mfma_f32_16x16x32_bf16 v[64:67], a[56:59], v[200:203], v[64:67]
  ds_read_b64_tr_b16 v[156:157], v235 offset:0
  ds_read_b64_tr_b16 v[158:159], v235 offset:2048
  v_lshl_add_u32 v209, v9, 2, v8
  v_mfma_f32_16x16x32_bf16 v[68:71], a[60:63], v[200:203], v[68:71]
  ds_read_b64_tr_b16 v[160:161], v232 offset:4096
  ds_read_b64_tr_b16 v[162:163], v232 offset:6144
  v_mfma_f32_16x16x32_bf16 v[72:75], a[56:59], v[204:207], v[72:75]
  ds_read_b64_tr_b16 v[164:165], v233 offset:4096
  ds_read_b64_tr_b16 v[166:167], v233 offset:6144
  v_mfma_f32_16x16x32_bf16 v[76:79], a[60:63], v[204:207], v[76:79]
  s_waitcnt lgkmcnt(10)
  ds_read_b64_tr_b16 v[168:169], v234 offset:4096
  buffer_load_dwordx4 v224, s[12:15], s70 offen offset:0 lds
  v_mfma_f32_16x16x32_bf16 v[16:19], a[64:67], v[144:147], v[16:19]
  ds_read_b64_tr_b16 v[170:171], v234 offset:6144
  ds_read_b64_tr_b16 v[172:173], v235 offset:4096
  v_mfma_f32_16x16x32_bf16 v[20:23], a[68:71], v[144:147], v[20:23]
  s_waitcnt lgkmcnt(9)
  buffer_load_dwordx4 v225, s[12:15], s70 offen offset:1024 lds
  ds_read_b64_tr_b16 v[174:175], v235 offset:6144
  v_mfma_f32_16x16x32_bf16 v[24:27], a[64:67], v[148:151], v[24:27]
  ds_read_b64_tr_b16 v[176:177], v232 offset:8192
  ds_read_b64_tr_b16 v[178:179], v232 offset:10240
  v_mfma_f32_16x16x32_bf16 v[28:31], a[68:71], v[148:151], v[28:31]
  buffer_load_dwordx4 v226, s[12:15], s70 offen offset:2048 lds
  ds_read_b64_tr_b16 v[180:181], v233 offset:8192
  v_mfma_f32_16x16x32_bf16 v[32:35], a[64:67], v[152:155], v[32:35]
  ds_read_b64_tr_b16 v[182:183], v233 offset:10240
  buffer_load_dwordx4 v227, s[12:15], s70 offen offset:3072 lds
  v_mfma_f32_16x16x32_bf16 v[36:39], a[68:71], v[152:155], v[36:39]
  s_waitcnt lgkmcnt(7)
  ds_read_b64_tr_b16 v[184:185], v234 offset:8192
  s_add_u32 m0, s69, 36736
  v_mfma_f32_16x16x32_bf16 v[40:43], a[64:67], v[156:159], v[40:43]
  ds_read_b64_tr_b16 v[186:187], v234 offset:10240
  ds_read_b64_tr_b16 v[188:189], v235 offset:8192
  v_mfma_f32_16x16x32_bf16 v[44:47], a[68:71], v[156:159], v[44:47]
  ds_read_b64_tr_b16 v[190:191], v235 offset:10240
  ds_read_b64_tr_b16 v[192:193], v232 offset:12288
  v_mfma_f32_16x16x32_bf16 v[48:51], a[64:67], v[160:163], v[48:51]
  buffer_load_dwordx4 v224, s[12:15], s70 offen offset:128 lds
  ds_read_b64_tr_b16 v[194:195], v232 offset:14336
  v_mfma_f32_16x16x32_bf16 v[52:55], a[68:71], v[160:163], v[52:55]
  ds_read_b64_tr_b16 v[196:197], v233 offset:12288
  ds_read_b64_tr_b16 v[198:199], v233 offset:14336
  v_mfma_f32_16x16x32_bf16 v[56:59], a[64:67], v[164:167], v[56:59]
  buffer_load_dwordx4 v225, s[12:15], s70 offen offset:1152 lds
  ds_read_b64_tr_b16 v[200:201], v234 offset:12288
  v_mfma_f32_16x16x32_bf16 v[60:63], a[68:71], v[164:167], v[60:63]
  s_waitcnt lgkmcnt(8)
  ds_read_b64_tr_b16 v[202:203], v234 offset:14336
  ds_read_b64_tr_b16 v[204:205], v235 offset:12288
  v_mfma_f32_16x16x32_bf16 v[64:67], a[64:67], v[168:171], v[64:67]
  buffer_load_dwordx4 v226, s[12:15], s70 offen offset:2176 lds
  ds_read_b64_tr_b16 v[206:207], v235 offset:14336
  v_mfma_f32_16x16x32_bf16 v[68:71], a[68:71], v[168:171], v[68:71]
  ds_read_b64_tr_b16 v[144:145], v232 offset:16384
  ds_read_b64_tr_b16 v[146:147], v232 offset:18432
  v_mfma_f32_16x16x32_bf16 v[72:75], a[64:67], v[172:175], v[72:75]
  ds_read_b64_tr_b16 v[148:149], v233 offset:16384
  ds_read_b64_tr_b16 v[150:151], v233 offset:18432
  v_mfma_f32_16x16x32_bf16 v[76:79], a[68:71], v[172:175], v[76:79]
  buffer_load_dwordx4 v227, s[12:15], s70 offen offset:3200 lds
  ds_read_b64_tr_b16 v[152:153], v234 offset:16384
  v_mfma_f32_16x16x32_bf16 v[16:19], a[72:75], v[176:179], v[16:19]
  ds_read_b64_tr_b16 v[154:155], v234 offset:18432
  ds_read_b64_tr_b16 v[156:157], v235 offset:16384
  v_mfma_f32_16x16x32_bf16 v[20:23], a[76:79], v[176:179], v[20:23]
  s_bfe_u32 s70, s71, 0x30014
  ds_read_b64_tr_b16 v[158:159], v235 offset:18432
  v_mfma_f32_16x16x32_bf16 v[24:27], a[72:75], v[180:183], v[24:27]
  ds_read_b64_tr_b16 v[160:161], v232 offset:20480
  v_mfma_f32_16x16x32_bf16 v[28:31], a[76:79], v[180:183], v[28:31]
  s_waitcnt lgkmcnt(7)
  ds_read_b64_tr_b16 v[162:163], v232 offset:22528
  v_mfma_f32_16x16x32_bf16 v[32:35], a[72:75], v[184:187], v[32:35]
  s_mul_i32 s70, s70, 917504
  ds_read_b64_tr_b16 v[164:165], v233 offset:20480
  v_mfma_f32_16x16x32_bf16 v[36:39], a[76:79], v[184:187], v[36:39]
  ds_read_b64_tr_b16 v[166:167], v233 offset:22528
  v_mfma_f32_16x16x32_bf16 v[40:43], a[72:75], v[188:191], v[40:43]
  s_add_u32 s70, s70, 3584
  ds_read_b64_tr_b16 v[168:169], v234 offset:20480
  v_mfma_f32_16x16x32_bf16 v[44:47], a[76:79], v[188:191], v[44:47]
  ds_read_b64_tr_b16 v[170:171], v234 offset:22528
  v_mfma_f32_16x16x32_bf16 v[48:51], a[72:75], v[192:195], v[48:51]
  ds_read_b64_tr_b16 v[172:173], v235 offset:20480
  v_mfma_f32_16x16x32_bf16 v[52:55], a[76:79], v[192:195], v[52:55]
  s_add_u32 m0, s68, 0
  ds_read_b64_tr_b16 v[174:175], v235 offset:22528
  v_mfma_f32_16x16x32_bf16 v[56:59], a[72:75], v[196:199], v[56:59]
  ds_read_b64_tr_b16 v[176:177], v232 offset:24576
  v_mfma_f32_16x16x32_bf16 v[60:63], a[76:79], v[196:199], v[60:63]
  s_add_u32 s73, s72, 8192
  ds_read_b64_tr_b16 v[178:179], v232 offset:26624
  v_mfma_f32_16x16x32_bf16 v[64:67], a[72:75], v[200:203], v[64:67]
  ds_read_b64_tr_b16 v[180:181], v233 offset:24576
  v_mfma_f32_16x16x32_bf16 v[68:71], a[76:79], v[200:203], v[68:71]
  buffer_load_dwordx4 v216, s[8:11], s72 offen offset:0 lds
  v_mfma_f32_16x16x32_bf16 v[72:75], a[72:75], v[204:207], v[72:75]
  ds_read_b64_tr_b16 v[182:183], v233 offset:26624
  v_mfma_f32_16x16x32_bf16 v[76:79], a[76:79], v[204:207], v[76:79]
  ds_read_b64_tr_b16 v[184:185], v234 offset:24576
  v_mfma_f32_16x16x32_bf16 v[16:19], a[80:83], v[144:147], v[16:19]
  buffer_load_dwordx4 v217, s[8:11], s72 offen offset:1024 lds
  v_mfma_f32_16x16x32_bf16 v[20:23], a[84:87], v[144:147], v[20:23]
  s_waitcnt lgkmcnt(3)
  ds_read_b64_tr_b16 v[186:187], v234 offset:26624
  v_mfma_f32_16x16x32_bf16 v[24:27], a[80:83], v[148:151], v[24:27]
  buffer_load_dwordx4 v218, s[8:11], s72 offen offset:2048 lds
  v_mfma_f32_16x16x32_bf16 v[28:31], a[84:87], v[148:151], v[28:31]
  ds_read_b64_tr_b16 v[188:189], v235 offset:24576
  v_mfma_f32_16x16x32_bf16 v[32:35], a[80:83], v[152:155], v[32:35]
  ds_read_b64_tr_b16 v[190:191], v235 offset:26624
  v_mfma_f32_16x16x32_bf16 v[36:39], a[84:87], v[152:155], v[36:39]
  buffer_load_dwordx4 v219, s[8:11], s72 offen offset:3072 lds
  v_mfma_f32_16x16x32_bf16 v[40:43], a[80:83], v[156:159], v[40:43]
  ds_read_b64_tr_b16 v[192:193], v232 offset:28672
  v_mfma_f32_16x16x32_bf16 v[44:47], a[84:87], v[156:159], v[44:47]
  s_add_u32 m0, s68, 4096
  ds_read_b64_tr_b16 v[194:195], v232 offset:30720
  v_mfma_f32_16x16x32_bf16 v[48:51], a[80:83], v[160:163], v[48:51]
  ds_read_b64_tr_b16 v[196:197], v233 offset:28672
  v_mfma_f32_16x16x32_bf16 v[52:55], a[84:87], v[160:163], v[52:55]
  ds_read_b64_tr_b16 v[198:199], v233 offset:30720
  v_mfma_f32_16x16x32_bf16 v[56:59], a[80:83], v[164:167], v[56:59]
  buffer_load_dwordx4 v216, s[8:11], s73 offen offset:0 lds
  v_mfma_f32_16x16x32_bf16 v[60:63], a[84:87], v[164:167], v[60:63]
  ds_read_b64_tr_b16 v[200:201], v234 offset:28672
  v_mfma_f32_16x16x32_bf16 v[64:67], a[80:83], v[168:171], v[64:67]
  buffer_load_dwordx4 v217, s[8:11], s73 offen offset:1024 lds
  v_mfma_f32_16x16x32_bf16 v[68:71], a[84:87], v[168:171], v[68:71]
  ds_read_b64_tr_b16 v[202:203], v234 offset:30720
  v_mfma_f32_16x16x32_bf16 v[72:75], a[80:83], v[172:175], v[72:75]
  ds_read_b64_tr_b16 v[204:205], v235 offset:28672
  v_mfma_f32_16x16x32_bf16 v[76:79], a[84:87], v[172:175], v[76:79]
  ds_read_b64_tr_b16 v[206:207], v235 offset:30720
  v_mfma_f32_16x16x32_bf16 v[16:19], a[88:91], v[176:179], v[16:19]
  buffer_load_dwordx4 v218, s[8:11], s73 offen offset:2048 lds
  v_mfma_f32_16x16x32_bf16 v[20:23], a[92:95], v[176:179], v[20:23]
  s_waitcnt vmcnt(19) lgkmcnt(3)
  ds_read_b128 a[96:99], v220 offset:8192
  v_mfma_f32_16x16x32_bf16 v[24:27], a[88:91], v[180:183], v[24:27]
  s_waitcnt vmcnt(15)
  ds_read_b128 a[100:103], v220 offset:12288
  ds_read_b128 a[104:107], v221 offset:8192
  v_mfma_f32_16x16x32_bf16 v[28:31], a[92:95], v[180:183], v[28:31]
  buffer_load_dwordx4 v219, s[8:11], s73 offen offset:3072 lds
  ds_read_b128 a[108:111], v221 offset:12288
  v_mfma_f32_16x16x32_bf16 v[32:35], a[88:91], v[184:187], v[32:35]
  s_bfe_u32 s72, s71, 0x30014
  ds_read_b128 a[112:115], v222 offset:8192
  ds_read_b128 a[116:119], v222 offset:12288
  v_mfma_f32_16x16x32_bf16 v[36:39], a[92:95], v[184:187], v[36:39]
  ds_read_b128 a[120:123], v223 offset:8192
  ds_read_b128 a[124:127], v223 offset:12288
  v_mfma_f32_16x16x32_bf16 v[40:43], a[88:91], v[188:191], v[40:43]
  s_lshl_b32 s72, s72, 8
  v_mfma_f32_16x16x32_bf16 v[44:47], a[92:95], v[188:191], v[44:47]
  v_mfma_f32_16x16x32_bf16 v[48:51], a[88:91], v[192:195], v[48:51]
  s_waitcnt lgkmcnt(5)
  s_barrier
  ds_read_b64_tr_b16 v[144:145], v228 offset:0
  v_mfma_f32_16x16x32_bf16 v[52:55], a[92:95], v[192:195], v[52:55]
  s_add_u32 m0, s69, 65536
  ds_read_b64_tr_b16 v[146:147], v228 offset:2048
  ds_read_b64_tr_b16 v[148:149], v229 offset:0
  v_mfma_f32_16x16x32_bf16 v[56:59], a[88:91], v[196:199], v[56:59]
  ds_read_b64_tr_b16 v[150:151], v229 offset:2048
  ds_read_b64_tr_b16 v[152:153], v230 offset:0
  v_mfma_f32_16x16x32_bf16 v[60:63], a[92:95], v[196:199], v[60:63]
  ds_read_b64_tr_b16 v[154:155], v230 offset:2048
  ds_read_b64_tr_b16 v[156:157], v231 offset:0
  v_mfma_f32_16x16x32_bf16 v[64:67], a[88:91], v[200:203], v[64:67]
  ds_read_b64_tr_b16 v[158:159], v231 offset:2048
  ds_read_b64_tr_b16 v[160:161], v228 offset:4096
  v_mfma_f32_16x16x32_bf16 v[68:71], a[92:95], v[200:203], v[68:71]
  ds_read_b64_tr_b16 v[162:163], v228 offset:6144
  ds_read_b64_tr_b16 v[164:165], v229 offset:4096
  v_mfma_f32_16x16x32_bf16 v[72:75], a[88:91], v[204:207], v[72:75]
  ds_read_b64_tr_b16 v[166:167], v229 offset:6144
  ds_read_b64_tr_b16 v[168:169], v230 offset:4096
  v_mfma_f32_16x16x32_bf16 v[76:79], a[92:95], v[204:207], v[76:79]
  s_waitcnt lgkmcnt(10)
  buffer_load_dwordx4 v224, s[12:15], s70 offen offset:0 lds
  ds_read_b64_tr_b16 v[170:171], v230 offset:6144
  v_mfma_f32_16x16x32_bf16 v[16:19], a[96:99], v[144:147], v[16:19]
  ds_read_b64_tr_b16 v[172:173], v231 offset:4096
  buffer_load_dwordx4 v225, s[12:15], s70 offen offset:1024 lds
  v_mfma_f32_16x16x32_bf16 v[20:23], a[100:103], v[144:147], v[20:23]
  s_waitcnt lgkmcnt(8)
  ds_read_b64_tr_b16 v[174:175], v231 offset:6144
  ds_read_b64_tr_b16 v[176:177], v228 offset:8192
  v_mfma_f32_16x16x32_bf16 v[24:27], a[96:99], v[148:151], v[24:27]
  ds_read_b64_tr_b16 v[178:179], v228 offset:10240
  buffer_load_dwordx4 v226, s[12:15], s70 offen offset:2048 lds
  v_mfma_f32_16x16x32_bf16 v[28:31], a[100:103], v[148:151], v[28:31]
  ds_read_b64_tr_b16 v[180:181], v229 offset:8192
  ds_read_b64_tr_b16 v[182:183], v229 offset:10240
  v_mfma_f32_16x16x32_bf16 v[32:35], a[96:99], v[152:155], v[32:35]
  buffer_load_dwordx4 v227, s[12:15], s70 offen offset:3072 lds
  ds_read_b64_tr_b16 v[184:185], v230 offset:8192
  v_mfma_f32_16x16x32_bf16 v[36:39], a[100:103], v[152:155], v[36:39]
  s_waitcnt lgkmcnt(7)
  ds_read_b64_tr_b16 v[186:187], v230 offset:10240
  s_add_u32 m0, s69, 69504
  v_mfma_f32_16x16x32_bf16 v[40:43], a[96:99], v[156:159], v[40:43]
  ds_read_b64_tr_b16 v[188:189], v231 offset:8192
  ds_read_b64_tr_b16 v[190:191], v231 offset:10240
  v_mfma_f32_16x16x32_bf16 v[44:47], a[100:103], v[156:159], v[44:47]
  ds_read_b64_tr_b16 v[192:193], v228 offset:12288
  buffer_load_dwordx4 v224, s[12:15], s70 offen offset:128 lds
  v_mfma_f32_16x16x32_bf16 v[48:51], a[96:99], v[160:163], v[48:51]
  ds_read_b64_tr_b16 v[194:195], v228 offset:14336
  ds_read_b64_tr_b16 v[196:197], v229 offset:12288
  v_mfma_f32_16x16x32_bf16 v[52:55], a[100:103], v[160:163], v[52:55]
  ds_read_b64_tr_b16 v[198:199], v229 offset:14336
  ds_read_b64_tr_b16 v[200:201], v230 offset:12288
  v_mfma_f32_16x16x32_bf16 v[56:59], a[96:99], v[164:167], v[56:59]
  buffer_load_dwordx4 v225, s[12:15], s70 offen offset:1152 lds
  ds_read_b64_tr_b16 v[202:203], v230 offset:14336
  v_mfma_f32_16x16x32_bf16 v[60:63], a[100:103], v[164:167], v[60:63]
  ds_read_b64_tr_b16 v[204:205], v231 offset:12288
  ds_read_b64_tr_b16 v[206:207], v231 offset:14336
  v_mfma_f32_16x16x32_bf16 v[64:67], a[96:99], v[168:171], v[64:67]
  buffer_load_dwordx4 v226, s[12:15], s70 offen offset:2176 lds
  ds_read_b64_tr_b16 v[144:145], v228 offset:16384
  v_mfma_f32_16x16x32_bf16 v[68:71], a[100:103], v[168:171], v[68:71]
  s_waitcnt lgkmcnt(8)
  ds_read_b64_tr_b16 v[146:147], v228 offset:18432
  ds_read_b64_tr_b16 v[148:149], v229 offset:16384
  v_mfma_f32_16x16x32_bf16 v[72:75], a[96:99], v[172:175], v[72:75]
  ds_read_b64_tr_b16 v[150:151], v229 offset:18432
  ds_read_b64_tr_b16 v[152:153], v230 offset:16384
  v_mfma_f32_16x16x32_bf16 v[76:79], a[100:103], v[172:175], v[76:79]
  buffer_load_dwordx4 v227, s[12:15], s70 offen offset:3200 lds
  ds_read_b64_tr_b16 v[154:155], v230 offset:18432
  v_mfma_f32_16x16x32_bf16 v[16:19], a[104:107], v[176:179], v[16:19]
  ds_read_b64_tr_b16 v[156:157], v231 offset:16384
  v_mfma_f32_16x16x32_bf16 v[20:23], a[108:111], v[176:179], v[20:23]
  s_bfe_u32 s70, s71, 0x30018
  ds_read_b64_tr_b16 v[158:159], v231 offset:18432
  v_mfma_f32_16x16x32_bf16 v[24:27], a[104:107], v[180:183], v[24:27]
  ds_read_b64_tr_b16 v[160:161], v228 offset:20480
  v_mfma_f32_16x16x32_bf16 v[28:31], a[108:111], v[180:183], v[28:31]
  ds_read_b64_tr_b16 v[162:163], v228 offset:22528
  v_mfma_f32_16x16x32_bf16 v[32:35], a[104:107], v[184:187], v[32:35]
  s_mul_i32 s70, s70, 917504
  ds_read_b64_tr_b16 v[164:165], v229 offset:20480
  v_mfma_f32_16x16x32_bf16 v[36:39], a[108:111], v[184:187], v[36:39]
  ds_read_b64_tr_b16 v[166:167], v229 offset:22528
  v_mfma_f32_16x16x32_bf16 v[40:43], a[104:107], v[188:191], v[40:43]
  s_add_u32 s70, s70, 3584
  ds_read_b64_tr_b16 v[168:169], v230 offset:20480
  v_mfma_f32_16x16x32_bf16 v[44:47], a[108:111], v[188:191], v[44:47]
  s_waitcnt lgkmcnt(5)
  ds_read_b64_tr_b16 v[170:171], v230 offset:22528
  v_mfma_f32_16x16x32_bf16 v[48:51], a[104:107], v[192:195], v[48:51]
  ds_read_b64_tr_b16 v[172:173], v231 offset:20480
  v_mfma_f32_16x16x32_bf16 v[52:55], a[108:111], v[192:195], v[52:55]
  s_add_u32 m0, s68, 8192
  ds_read_b64_tr_b16 v[174:175], v231 offset:22528
  v_mfma_f32_16x16x32_bf16 v[56:59], a[104:107], v[196:199], v[56:59]
  ds_read_b64_tr_b16 v[176:177], v228 offset:24576
  v_mfma_f32_16x16x32_bf16 v[60:63], a[108:111], v[196:199], v[60:63]
  s_add_u32 s73, s72, 8192
  ds_read_b64_tr_b16 v[178:179], v228 offset:26624
  v_mfma_f32_16x16x32_bf16 v[64:67], a[104:107], v[200:203], v[64:67]
  ds_read_b64_tr_b16 v[180:181], v229 offset:24576
  v_mfma_f32_16x16x32_bf16 v[68:71], a[108:111], v[200:203], v[68:71]
  buffer_load_dwordx4 v216, s[8:11], s72 offen offset:0 lds
  v_mfma_f32_16x16x32_bf16 v[72:75], a[104:107], v[204:207], v[72:75]
  ds_read_b64_tr_b16 v[182:183], v229 offset:26624
  v_mfma_f32_16x16x32_bf16 v[76:79], a[108:111], v[204:207], v[76:79]
  ds_read_b64_tr_b16 v[184:185], v230 offset:24576
  v_mfma_f32_16x16x32_bf16 v[16:19], a[112:115], v[144:147], v[16:19]
  buffer_load_dwordx4 v217, s[8:11], s72 offen offset:1024 lds
  v_mfma_f32_16x16x32_bf16 v[20:23], a[116:119], v[144:147], v[20:23]
  ds_read_b64_tr_b16 v[186:187], v230 offset:26624
  v_mfma_f32_16x16x32_bf16 v[24:27], a[112:115], v[148:151], v[24:27]
  buffer_load_dwordx4 v218, s[8:11], s72 offen offset:2048 lds
  v_mfma_f32_16x16x32_bf16 v[28:31], a[116:119], v[148:151], v[28:31]
  ds_read_b64_tr_b16 v[188:189], v231 offset:24576
  v_mfma_f32_16x16x32_bf16 v[32:35], a[112:115], v[152:155], v[32:35]
  ds_read_b64_tr_b16 v[190:191], v231 offset:26624
  v_mfma_f32_16x16x32_bf16 v[36:39], a[116:119], v[152:155], v[36:39]
  buffer_load_dwordx4 v219, s[8:11], s72 offen offset:3072 lds
  v_mfma_f32_16x16x32_bf16 v[40:43], a[112:115], v[156:159], v[40:43]
  ds_read_b64_tr_b16 v[192:193], v228 offset:28672
  v_mfma_f32_16x16x32_bf16 v[44:47], a[116:119], v[156:159], v[44:47]
  s_waitcnt lgkmcnt(3)
  s_add_u32 m0, s68, 12288
  ds_read_b64_tr_b16 v[194:195], v228 offset:30720
  v_mfma_f32_16x16x32_bf16 v[48:51], a[112:115], v[160:163], v[48:51]
  ds_read_b64_tr_b16 v[196:197], v229 offset:28672
  v_mfma_f32_16x16x32_bf16 v[52:55], a[116:119], v[160:163], v[52:55]
  ds_read_b64_tr_b16 v[198:199], v229 offset:30720
  v_mfma_f32_16x16x32_bf16 v[56:59], a[112:115], v[164:167], v[56:59]
  buffer_load_dwordx4 v216, s[8:11], s73 offen offset:0 lds
  v_mfma_f32_16x16x32_bf16 v[60:63], a[116:119], v[164:167], v[60:63]
  ds_read_b64_tr_b16 v[200:201], v230 offset:28672
  v_mfma_f32_16x16x32_bf16 v[64:67], a[112:115], v[168:171], v[64:67]
  buffer_load_dwordx4 v217, s[8:11], s73 offen offset:1024 lds
  v_mfma_f32_16x16x32_bf16 v[68:71], a[116:119], v[168:171], v[68:71]
  ds_read_b64_tr_b16 v[202:203], v230 offset:30720
  v_mfma_f32_16x16x32_bf16 v[72:75], a[112:115], v[172:175], v[72:75]
  ds_read_b64_tr_b16 v[204:205], v231 offset:28672
  v_mfma_f32_16x16x32_bf16 v[76:79], a[116:119], v[172:175], v[76:79]
  ds_read_b64_tr_b16 v[206:207], v231 offset:30720
  v_mfma_f32_16x16x32_bf16 v[16:19], a[120:123], v[176:179], v[16:19]
  buffer_load_dwordx4 v218, s[8:11], s73 offen offset:2048 lds
  v_mfma_f32_16x16x32_bf16 v[20:23], a[124:127], v[176:179], v[20:23]
  s_waitcnt vmcnt(19)
  ds_read_b128 a[128:131], v220 offset:0
  buffer_load_dwordx4 v219, s[8:11], s73 offen offset:3072 lds
  v_mfma_f32_16x16x32_bf16 v[24:27], a[120:123], v[180:183], v[24:27]
  s_waitcnt vmcnt(16)
  ds_read_b128 a[132:135], v220 offset:4096
  ds_read_b128 a[136:139], v221 offset:0
  v_mfma_f32_16x16x32_bf16 v[28:31], a[124:127], v[180:183], v[28:31]
  ds_read_b128 a[140:143], v221 offset:4096
  ds_read_b128 a[144:147], v222 offset:0
  v_mfma_f32_16x16x32_bf16 v[32:35], a[120:123], v[184:187], v[32:35]
  s_bfe_u32 s72, s71, 0x30018
  ds_read_b128 a[148:151], v222 offset:4096
  ds_read_b128 a[152:155], v223 offset:0
  v_mfma_f32_16x16x32_bf16 v[36:39], a[124:127], v[184:187], v[36:39]
  s_waitcnt lgkmcnt(7)
  ds_read_b128 a[156:159], v223 offset:4096
  v_mfma_f32_16x16x32_bf16 v[40:43], a[120:123], v[188:191], v[40:43]
  s_lshl_b32 s72, s72, 8
  v_mfma_f32_16x16x32_bf16 v[44:47], a[124:127], v[188:191], v[44:47]
  v_mfma_f32_16x16x32_bf16 v[48:51], a[120:123], v[192:195], v[48:51]
  s_barrier
  ds_read_b64_tr_b16 v[144:145], v228 offset:32768
  v_mfma_f32_16x16x32_bf16 v[52:55], a[124:127], v[192:195], v[52:55]
  s_add_u32 m0, s69, 0
  ds_read_b64_tr_b16 v[146:147], v228 offset:34816
  ds_read_b64_tr_b16 v[148:149], v229 offset:32768
  v_mfma_f32_16x16x32_bf16 v[56:59], a[120:123], v[196:199], v[56:59]
  s_branch parallel_sum__ssm_conv_h3__mixer_gmlp__prompt_kernel_ps1
parallel_sum__ssm_conv_h3__mixer_gmlp__prompt_kernel_pg1:
  s_branch parallel_sum__ssm_conv_h3__mixer_gmlp__prompt_kernel_pg5
parallel_sum__ssm_conv_h3__mixer_gmlp__prompt_kernel_ps1:
  ds_read_b64_tr_b16 v[150:151], v229 offset:34816
  ds_read_b64_tr_b16 v[152:153], v230 offset:32768
  v_mfma_f32_16x16x32_bf16 v[60:63], a[124:127], v[196:199], v[60:63]
  ds_read_b64_tr_b16 v[154:155], v230 offset:34816
  ds_read_b64_tr_b16 v[156:157], v231 offset:32768
  v_mfma_f32_16x16x32_bf16 v[64:67], a[120:123], v[200:203], v[64:67]
  ds_read_b64_tr_b16 v[158:159], v231 offset:34816
  ds_read_b64_tr_b16 v[160:161], v228 offset:36864
  v_mfma_f32_16x16x32_bf16 v[68:71], a[124:127], v[200:203], v[68:71]
  ds_read_b64_tr_b16 v[162:163], v228 offset:38912
  ds_read_b64_tr_b16 v[164:165], v229 offset:36864
  v_mfma_f32_16x16x32_bf16 v[72:75], a[120:123], v[204:207], v[72:75]
  ds_read_b64_tr_b16 v[166:167], v229 offset:38912
  ds_read_b64_tr_b16 v[168:169], v230 offset:36864
  v_mfma_f32_16x16x32_bf16 v[76:79], a[124:127], v[204:207], v[76:79]
  s_waitcnt lgkmcnt(10)
  buffer_load_dwordx4 v224, s[12:15], s70 offen offset:0 lds
  ds_read_b64_tr_b16 v[170:171], v230 offset:38912
  v_mfma_f32_16x16x32_bf16 v[16:19], a[128:131], v[144:147], v[16:19]
  ds_read_b64_tr_b16 v[172:173], v231 offset:36864
  buffer_load_dwordx4 v225, s[12:15], s70 offen offset:1024 lds
  v_mfma_f32_16x16x32_bf16 v[20:23], a[132:135], v[144:147], v[20:23]
  s_waitcnt lgkmcnt(8)
  ds_read_b64_tr_b16 v[174:175], v231 offset:38912
  ds_read_b64_tr_b16 v[176:177], v228 offset:40960
  v_mfma_f32_16x16x32_bf16 v[24:27], a[128:131], v[148:151], v[24:27]
  ds_read_b64_tr_b16 v[178:179], v228 offset:43008
  buffer_load_dwordx4 v226, s[12:15], s70 offen offset:2048 lds
  v_mfma_f32_16x16x32_bf16 v[28:31], a[132:135], v[148:151], v[28:31]
  ds_read_b64_tr_b16 v[180:181], v229 offset:40960
  ds_read_b64_tr_b16 v[182:183], v229 offset:43008
  v_mfma_f32_16x16x32_bf16 v[32:35], a[128:131], v[152:155], v[32:35]
  buffer_load_dwordx4 v227, s[12:15], s70 offen offset:3072 lds
  ds_read_b64_tr_b16 v[184:185], v230 offset:40960
  v_mfma_f32_16x16x32_bf16 v[36:39], a[132:135], v[152:155], v[36:39]
  s_waitcnt lgkmcnt(7)
  ds_read_b64_tr_b16 v[186:187], v230 offset:43008
  s_add_u32 m0, s69, 3968
  v_mfma_f32_16x16x32_bf16 v[40:43], a[128:131], v[156:159], v[40:43]
  ds_read_b64_tr_b16 v[188:189], v231 offset:40960
  ds_read_b64_tr_b16 v[190:191], v231 offset:43008
  v_mfma_f32_16x16x32_bf16 v[44:47], a[132:135], v[156:159], v[44:47]
  ds_read_b64_tr_b16 v[192:193], v228 offset:45056
  buffer_load_dwordx4 v224, s[12:15], s70 offen offset:128 lds
  v_mfma_f32_16x16x32_bf16 v[48:51], a[128:131], v[160:163], v[48:51]
  ds_read_b64_tr_b16 v[194:195], v228 offset:47104
  ds_read_b64_tr_b16 v[196:197], v229 offset:45056
  v_mfma_f32_16x16x32_bf16 v[52:55], a[132:135], v[160:163], v[52:55]
  ds_read_b64_tr_b16 v[198:199], v229 offset:47104
  ds_read_b64_tr_b16 v[200:201], v230 offset:45056
  v_mfma_f32_16x16x32_bf16 v[56:59], a[128:131], v[164:167], v[56:59]
  buffer_load_dwordx4 v225, s[12:15], s70 offen offset:1152 lds
  ds_read_b64_tr_b16 v[202:203], v230 offset:47104
  v_mfma_f32_16x16x32_bf16 v[60:63], a[132:135], v[164:167], v[60:63]
  ds_read_b64_tr_b16 v[204:205], v231 offset:45056
  ds_read_b64_tr_b16 v[206:207], v231 offset:47104
  v_mfma_f32_16x16x32_bf16 v[64:67], a[128:131], v[168:171], v[64:67]
  buffer_load_dwordx4 v226, s[12:15], s70 offen offset:2176 lds
  ds_read_b64_tr_b16 v[144:145], v228 offset:49152
  v_mfma_f32_16x16x32_bf16 v[68:71], a[132:135], v[168:171], v[68:71]
  s_waitcnt lgkmcnt(8)
  ds_read_b64_tr_b16 v[146:147], v228 offset:51200
  ds_read_b64_tr_b16 v[148:149], v229 offset:49152
  v_mfma_f32_16x16x32_bf16 v[72:75], a[128:131], v[172:175], v[72:75]
  ds_read_b64_tr_b16 v[150:151], v229 offset:51200
  ds_read_b64_tr_b16 v[152:153], v230 offset:49152
  v_mfma_f32_16x16x32_bf16 v[76:79], a[132:135], v[172:175], v[76:79]
  buffer_load_dwordx4 v227, s[12:15], s70 offen offset:3200 lds
  ds_read_b64_tr_b16 v[154:155], v230 offset:51200
  v_mfma_f32_16x16x32_bf16 v[16:19], a[136:139], v[176:179], v[16:19]
  ds_read_b64_tr_b16 v[156:157], v231 offset:49152
  v_mfma_f32_16x16x32_bf16 v[20:23], a[140:143], v[176:179], v[20:23]
  s_bfe_u32 s70, s71, 0x3001c
  ds_read_b64_tr_b16 v[158:159], v231 offset:51200
  v_mfma_f32_16x16x32_bf16 v[24:27], a[136:139], v[180:183], v[24:27]
  ds_read_b64_tr_b16 v[160:161], v228 offset:53248
  v_mfma_f32_16x16x32_bf16 v[28:31], a[140:143], v[180:183], v[28:31]
  ds_read_b64_tr_b16 v[162:163], v228 offset:55296
  v_mfma_f32_16x16x32_bf16 v[32:35], a[136:139], v[184:187], v[32:35]
  s_mul_i32 s70, s70, 917504
  ds_read_b64_tr_b16 v[164:165], v229 offset:53248
  v_mfma_f32_16x16x32_bf16 v[36:39], a[140:143], v[184:187], v[36:39]
  ds_read_b64_tr_b16 v[166:167], v229 offset:55296
  v_mfma_f32_16x16x32_bf16 v[40:43], a[136:139], v[188:191], v[40:43]
  s_add_u32 s70, s70, 3584
  ds_read_b64_tr_b16 v[168:169], v230 offset:53248
  v_mfma_f32_16x16x32_bf16 v[44:47], a[140:143], v[188:191], v[44:47]
  s_waitcnt lgkmcnt(5)
  ds_read_b64_tr_b16 v[170:171], v230 offset:55296
  v_mfma_f32_16x16x32_bf16 v[48:51], a[136:139], v[192:195], v[48:51]
  ds_read_b64_tr_b16 v[172:173], v231 offset:53248
  v_mfma_f32_16x16x32_bf16 v[52:55], a[140:143], v[192:195], v[52:55]
  s_add_u32 m0, s68, 0
  ds_read_b64_tr_b16 v[174:175], v231 offset:55296
  v_mfma_f32_16x16x32_bf16 v[56:59], a[136:139], v[196:199], v[56:59]
  ds_read_b64_tr_b16 v[176:177], v228 offset:57344
  v_mfma_f32_16x16x32_bf16 v[60:63], a[140:143], v[196:199], v[60:63]
  s_add_u32 s73, s72, 8192
  ds_read_b64_tr_b16 v[178:179], v228 offset:59392
  v_mfma_f32_16x16x32_bf16 v[64:67], a[136:139], v[200:203], v[64:67]
  ds_read_b64_tr_b16 v[180:181], v229 offset:57344
  v_mfma_f32_16x16x32_bf16 v[68:71], a[140:143], v[200:203], v[68:71]
  buffer_load_dwordx4 v216, s[8:11], s72 offen offset:0 lds
  v_mfma_f32_16x16x32_bf16 v[72:75], a[136:139], v[204:207], v[72:75]
  ds_read_b64_tr_b16 v[182:183], v229 offset:59392
  v_mfma_f32_16x16x32_bf16 v[76:79], a[140:143], v[204:207], v[76:79]
  ds_read_b64_tr_b16 v[184:185], v230 offset:57344
  v_mfma_f32_16x16x32_bf16 v[16:19], a[144:147], v[144:147], v[16:19]
  buffer_load_dwordx4 v217, s[8:11], s72 offen offset:1024 lds
  v_mfma_f32_16x16x32_bf16 v[20:23], a[148:151], v[144:147], v[20:23]
  ds_read_b64_tr_b16 v[186:187], v230 offset:59392
  v_mfma_f32_16x16x32_bf16 v[24:27], a[144:147], v[148:151], v[24:27]
  buffer_load_dwordx4 v218, s[8:11], s72 offen offset:2048 lds
  v_mfma_f32_16x16x32_bf16 v[28:31], a[148:151], v[148:151], v[28:31]
  ds_read_b64_tr_b16 v[188:189], v231 offset:57344
  v_mfma_f32_16x16x32_bf16 v[32:35], a[144:147], v[152:155], v[32:35]
  ds_read_b64_tr_b16 v[190:191], v231 offset:59392
  v_mfma_f32_16x16x32_bf16 v[36:39], a[148:151], v[152:155], v[36:39]
  buffer_load_dwordx4 v219, s[8:11], s72 offen offset:3072 lds
  v_mfma_f32_16x16x32_bf16 v[40:43], a[144:147], v[156:159], v[40:43]
  ds_read_b64_tr_b16 v[192:193], v228 offset:61440
  v_mfma_f32_16x16x32_bf16 v[44:47], a[148:151], v[156:159], v[44:47]
  s_waitcnt lgkmcnt(3)
  s_add_u32 m0, s68, 4096
  ds_read_b64_tr_b16 v[194:195], v228 offset:63488
  v_mfma_f32_16x16x32_bf16 v[48:51], a[144:147], v[160:163], v[48:51]
  ds_read_b64_tr_b16 v[196:197], v229 offset:61440
  v_mfma_f32_16x16x32_bf16 v[52:55], a[148:151], v[160:163], v[52:55]
  ds_read_b64_tr_b16 v[198:199], v229 offset:63488
  v_mfma_f32_16x16x32_bf16 v[56:59], a[144:147], v[164:167], v[56:59]
  buffer_load_dwordx4 v216, s[8:11], s73 offen offset:0 lds
  v_mfma_f32_16x16x32_bf16 v[60:63], a[148:151], v[164:167], v[60:63]
  ds_read_b64_tr_b16 v[200:201], v230 offset:61440
  v_mfma_f32_16x16x32_bf16 v[64:67], a[144:147], v[168:171], v[64:67]
  buffer_load_dwordx4 v217, s[8:11], s73 offen offset:1024 lds
  v_mfma_f32_16x16x32_bf16 v[68:71], a[148:151], v[168:171], v[68:71]
  ds_read_b64_tr_b16 v[202:203], v230 offset:63488
  v_mfma_f32_16x16x32_bf16 v[72:75], a[144:147], v[172:175], v[72:75]
  ds_read_b64_tr_b16 v[204:205], v231 offset:61440
  v_mfma_f32_16x16x32_bf16 v[76:79], a[148:151], v[172:175], v[76:79]
  ds_read_b64_tr_b16 v[206:207], v231 offset:63488
  v_mfma_f32_16x16x32_bf16 v[16:19], a[152:155], v[176:179], v[16:19]
  buffer_load_dwordx4 v218, s[8:11], s73 offen offset:2048 lds
  v_mfma_f32_16x16x32_bf16 v[20:23], a[156:159], v[176:179], v[20:23]
  s_waitcnt vmcnt(19)
  ds_read_b128 a[160:163], v220 offset:8192
  buffer_load_dwordx4 v219, s[8:11], s73 offen offset:3072 lds
  v_mfma_f32_16x16x32_bf16 v[24:27], a[152:155], v[180:183], v[24:27]
  s_waitcnt vmcnt(16)
  ds_read_b128 a[164:167], v220 offset:12288
  ds_read_b128 a[168:171], v221 offset:8192
  v_mfma_f32_16x16x32_bf16 v[28:31], a[156:159], v[180:183], v[28:31]
  ds_read_b128 a[172:175], v221 offset:12288
  ds_read_b128 a[176:179], v222 offset:8192
  v_mfma_f32_16x16x32_bf16 v[32:35], a[152:155], v[184:187], v[32:35]
  s_bfe_u32 s72, s71, 0x3001c
  ds_read_b128 a[180:183], v222 offset:12288
  ds_read_b128 a[184:187], v223 offset:8192
  v_mfma_f32_16x16x32_bf16 v[36:39], a[156:159], v[184:187], v[36:39]
  s_waitcnt lgkmcnt(7)
  ds_read_b128 a[188:191], v223 offset:12288
  v_mfma_f32_16x16x32_bf16 v[40:43], a[152:155], v[188:191], v[40:43]
  s_lshl_b32 s72, s72, 8
  v_mfma_f32_16x16x32_bf16 v[44:47], a[156:159], v[188:191], v[44:47]
  v_mfma_f32_16x16x32_bf16 v[48:51], a[152:155], v[192:195], v[48:51]
  s_barrier
  ds_read_b64_tr_b16 v[144:145], v232 offset:0
  v_mfma_f32_16x16x32_bf16 v[52:55], a[156:159], v[192:195], v[52:55]
  s_add_u32 m0, s69, 32768
  ds_read_b64_tr_b16 v[146:147], v232 offset:2048
  ds_read_b64_tr_b16 v[148:149], v233 offset:0
  v_mfma_f32_16x16x32_bf16 v[56:59], a[152:155], v[196:199], v[56:59]
  ds_read_b64_tr_b16 v[150:151], v233 offset:2048
  ds_read_b64_tr_b16 v[152:153], v234 offset:0
  v_mfma_f32_16x16x32_bf16 v[60:63], a[156:159], v[196:199], v[60:63]
  ds_read_b64_tr_b16 v[154:155], v234 offset:2048
  ds_read_b64_tr_b16 v[156:157], v235 offset:0
  v_mfma_f32_16x16x32_bf16 v[64:67], a[152:155], v[200:203], v[64:67]
  ds_read_b64_tr_b16 v[158:159], v235 offset:2048
  ds_read_b64_tr_b16 v[160:161], v232 offset:4096
  v_mfma_f32_16x16x32_bf16 v[68:71], a[156:159], v[200:203], v[68:71]
  ds_read_b64_tr_b16 v[162:163], v232 offset:6144
  ds_read_b64_tr_b16 v[164:165], v233 offset:4096
  v_mfma_f32_16x16x32_bf16 v[72:75], a[152:155], v[204:207], v[72:75]
  ds_read_b64_tr_b16 v[166:167], v233 offset:6144
  ds_read_b64_tr_b16 v[168:169], v234 offset:4096
  v_mfma_f32_16x16x32_bf16 v[76:79], a[156:159], v[204:207], v[76:79]
  s_waitcnt lgkmcnt(10)
  buffer_load_dwordx4 v224, s[12:15], s70 offen offset:0 lds
  ds_read_b64_tr_b16 v[170:171], v234 offset:6144
  v_mfma_f32_16x16x32_bf16 v[16:19], a[160:163], v[144:147], v[16:19]
  ds_read_b64_tr_b16 v[172:173], v235 offset:4096
  ds_read_b64_tr_b16 v[174:175], v235 offset:6144
  v_mfma_f32_16x16x32_bf16 v[20:23], a[164:167], v[144:147], v[20:23]
  s_waitcnt lgkmcnt(9)
  buffer_load_dwordx4 v225, s[12:15], s70 offen offset:1024 lds
  ds_read_b64_tr_b16 v[176:177], v232 offset:8192
  v_mfma_f32_16x16x32_bf16 v[24:27], a[160:163], v[148:151], v[24:27]
  ds_read_b64_tr_b16 v[178:179], v232 offset:10240
  ds_read_b64_tr_b16 v[180:181], v233 offset:8192
  v_mfma_f32_16x16x32_bf16 v[28:31], a[164:167], v[148:151], v[28:31]
  buffer_load_dwordx4 v226, s[12:15], s70 offen offset:2048 lds
  ds_read_b64_tr_b16 v[182:183], v233 offset:10240
  v_mfma_f32_16x16x32_bf16 v[32:35], a[160:163], v[152:155], v[32:35]
  ds_read_b64_tr_b16 v[184:185], v234 offset:8192
  buffer_load_dwordx4 v227, s[12:15], s70 offen offset:3072 lds
  v_mfma_f32_16x16x32_bf16 v[36:39], a[164:167], v[152:155], v[36:39]
  s_waitcnt lgkmcnt(7)
  ds_read_b64_tr_b16 v[186:187], v234 offset:10240
  ds_read_b64_tr_b16 v[188:189], v235 offset:8192
  v_mfma_f32_16x16x32_bf16 v[40:43], a[160:163], v[156:159], v[40:43]
  s_add_u32 m0, s69, 36736
  ds_read_b64_tr_b16 v[190:191], v235 offset:10240
  ds_read_b64_tr_b16 v[192:193], v232 offset:12288
  v_mfma_f32_16x16x32_bf16 v[44:47], a[164:167], v[156:159], v[44:47]
  ds_read_b64_tr_b16 v[194:195], v232 offset:14336
  ds_read_b64_tr_b16 v[196:197], v233 offset:12288
  v_mfma_f32_16x16x32_bf16 v[48:51], a[160:163], v[160:163], v[48:51]
  ds_read_b64_tr_b16 v[198:199], v233 offset:14336
  ds_read_b64_tr_b16 v[200:201], v234 offset:12288
  v_mfma_f32_16x16x32_bf16 v[52:55], a[164:167], v[160:163], v[52:55]
  buffer_load_dwordx4 v224, s[12:15], s70 offen offset:128 lds
  ds_read_b64_tr_b16 v[202:203], v234 offset:14336
  v_mfma_f32_16x16x32_bf16 v[56:59], a[160:163], v[164:167], v[56:59]
  ds_read_b64_tr_b16 v[204:205], v235 offset:12288
  ds_read_b64_tr_b16 v[206:207], v235 offset:14336
  v_mfma_f32_16x16x32_bf16 v[60:63], a[164:167], v[164:167], v[60:63]
  buffer_load_dwordx4 v225, s[12:15], s70 offen offset:1152 lds
  ds_read_b64_tr_b16 v[144:145], v232 offset:16384
  v_mfma_f32_16x16x32_bf16 v[64:67], a[160:163], v[168:171], v[64:67]
  ds_read_b64_tr_b16 v[146:147], v232 offset:18432
  ds_read_b64_tr_b16 v[148:149], v233 offset:16384
  v_mfma_f32_16x16x32_bf16 v[68:71], a[164:167], v[168:171], v[68:71]
  s_waitcnt lgkmcnt(8)
  ds_read_b64_tr_b16 v[150:151], v233 offset:18432
  ds_read_b64_tr_b16 v[152:153], v234 offset:16384
  v_mfma_f32_16x16x32_bf16 v[72:75], a[160:163], v[172:175], v[72:75]
  buffer_load_dwordx4 v226, s[12:15], s70 offen offset:2176 lds
  v_mfma_f32_16x16x32_bf16 v[76:79], a[164:167], v[172:175], v[76:79]
  ds_read_b64_tr_b16 v[154:155], v234 offset:18432
  v_mfma_f32_16x16x32_bf16 v[16:19], a[168:171], v[176:179], v[16:19]
  ds_read_b64_tr_b16 v[156:157], v235 offset:16384
  v_mfma_f32_16x16x32_bf16 v[20:23], a[172:175], v[176:179], v[20:23]
  buffer_load_dwordx4 v227, s[12:15], s70 offen offset:3200 lds
  v_mfma_f32_16x16x32_bf16 v[24:27], a[168:171], v[180:183], v[24:27]
  ds_read_b64_tr_b16 v[158:159], v235 offset:18432
  v_mfma_f32_16x16x32_bf16 v[28:31], a[172:175], v[180:183], v[28:31]
  s_bfe_u32 s70, s71, 0x30000
  ds_read_b64_tr_b16 v[160:161], v232 offset:20480
  v_mfma_f32_16x16x32_bf16 v[32:35], a[168:171], v[184:187], v[32:35]
  ds_read_b64_tr_b16 v[162:163], v232 offset:22528
  v_mfma_f32_16x16x32_bf16 v[36:39], a[172:175], v[184:187], v[36:39]
  ds_read_b64_tr_b16 v[164:165], v233 offset:20480
  v_mfma_f32_16x16x32_bf16 v[40:43], a[168:171], v[188:191], v[40:43]
  s_mul_i32 s70, s70, 917504
  ds_read_b64_tr_b16 v[166:167], v233 offset:22528
  v_mfma_f32_16x16x32_bf16 v[44:47], a[172:175], v[188:191], v[44:47]
  ds_read_b64_tr_b16 v[168:169], v234 offset:20480
  v_mfma_f32_16x16x32_bf16 v[48:51], a[168:171], v[192:195], v[48:51]
  ds_read_b64_tr_b16 v[170:171], v234 offset:22528
  v_mfma_f32_16x16x32_bf16 v[52:55], a[172:175], v[192:195], v[52:55]
  s_waitcnt lgkmcnt(5)
  s_add_u32 m0, s68, 8192
  ds_read_b64_tr_b16 v[172:173], v235 offset:20480
  v_mfma_f32_16x16x32_bf16 v[56:59], a[168:171], v[196:199], v[56:59]
  ds_read_b64_tr_b16 v[174:175], v235 offset:22528
  v_mfma_f32_16x16x32_bf16 v[60:63], a[172:175], v[196:199], v[60:63]
  s_add_u32 s73, s72, 8192
  ds_read_b64_tr_b16 v[176:177], v232 offset:24576
  v_mfma_f32_16x16x32_bf16 v[64:67], a[168:171], v[200:203], v[64:67]
  ds_read_b64_tr_b16 v[178:179], v232 offset:26624
  v_mfma_f32_16x16x32_bf16 v[68:71], a[172:175], v[200:203], v[68:71]
  ds_read_b64_tr_b16 v[180:181], v233 offset:24576
  v_mfma_f32_16x16x32_bf16 v[72:75], a[168:171], v[204:207], v[72:75]
  buffer_load_dwordx4 v216, s[8:11], s72 offen offset:0 lds
  v_mfma_f32_16x16x32_bf16 v[76:79], a[172:175], v[204:207], v[76:79]
  ds_read_b64_tr_b16 v[182:183], v233 offset:26624
  v_mfma_f32_16x16x32_bf16 v[16:19], a[176:179], v[144:147], v[16:19]
  ds_read_b64_tr_b16 v[184:185], v234 offset:24576
  v_mfma_f32_16x16x32_bf16 v[20:23], a[180:183], v[144:147], v[20:23]
  buffer_load_dwordx4 v217, s[8:11], s72 offen offset:1024 lds
  v_mfma_f32_16x16x32_bf16 v[24:27], a[176:179], v[148:151], v[24:27]
  ds_read_b64_tr_b16 v[186:187], v234 offset:26624
  v_mfma_f32_16x16x32_bf16 v[28:31], a[180:183], v[148:151], v[28:31]
  buffer_load_dwordx4 v218, s[8:11], s72 offen offset:2048 lds
  v_mfma_f32_16x16x32_bf16 v[32:35], a[176:179], v[152:155], v[32:35]
  ds_read_b64_tr_b16 v[188:189], v235 offset:24576
  v_mfma_f32_16x16x32_bf16 v[36:39], a[180:183], v[152:155], v[36:39]
  ds_read_b64_tr_b16 v[190:191], v235 offset:26624
  v_mfma_f32_16x16x32_bf16 v[40:43], a[176:179], v[156:159], v[40:43]
  buffer_load_dwordx4 v219, s[8:11], s72 offen offset:3072 lds
  v_mfma_f32_16x16x32_bf16 v[44:47], a[180:183], v[156:159], v[44:47]
  s_waitcnt lgkmcnt(3)
  ds_read_b64_tr_b16 v[192:193], v232 offset:28672
  v_mfma_f32_16x16x32_bf16 v[48:51], a[176:179], v[160:163], v[48:51]
  ds_read_b64_tr_b16 v[194:195], v232 offset:30720
  v_mfma_f32_16x16x32_bf16 v[52:55], a[180:183], v[160:163], v[52:55]
  s_add_u32 m0, s68, 12288
  ds_read_b64_tr_b16 v[196:197], v233 offset:28672
  v_mfma_f32_16x16x32_bf16 v[56:59], a[176:179], v[164:167], v[56:59]
  ds_read_b64_tr_b16 v[198:199], v233 offset:30720
  v_mfma_f32_16x16x32_bf16 v[60:63], a[180:183], v[164:167], v[60:63]
  buffer_load_dwordx4 v216, s[8:11], s73 offen offset:0 lds
  v_mfma_f32_16x16x32_bf16 v[64:67], a[176:179], v[168:171], v[64:67]
  ds_read_b64_tr_b16 v[200:201], v234 offset:28672
  v_mfma_f32_16x16x32_bf16 v[68:71], a[180:183], v[168:171], v[68:71]
  ds_read_b64_tr_b16 v[202:203], v234 offset:30720
  v_mfma_f32_16x16x32_bf16 v[72:75], a[176:179], v[172:175], v[72:75]
  ds_read_b64_tr_b16 v[204:205], v235 offset:28672
  v_mfma_f32_16x16x32_bf16 v[76:79], a[180:183], v[172:175], v[76:79]
  buffer_load_dwordx4 v217, s[8:11], s73 offen offset:1024 lds
  v_mfma_f32_16x16x32_bf16 v[16:19], a[184:187], v[176:179], v[16:19]
  ds_read_b64_tr_b16 v[206:207], v235 offset:30720
  v_mfma_f32_16x16x32_bf16 v[20:23], a[188:191], v[176:179], v[20:23]
  s_waitcnt vmcnt(18)
  ds_read_b128 a[192:195], v220 offset:0
  buffer_load_dwordx4 v218, s[8:11], s73 offen offset:2048 lds
  v_mfma_f32_16x16x32_bf16 v[24:27], a[184:187], v[180:183], v[24:27]
  s_waitcnt vmcnt(15)
  ds_read_b128 a[196:199], v220 offset:4096
  ds_read_b128 a[200:203], v221 offset:0
  v_mfma_f32_16x16x32_bf16 v[28:31], a[188:191], v[180:183], v[28:31]
  s_waitcnt lgkmcnt(5)
  ds_read_b128 a[204:207], v221 offset:4096
  ds_read_b128 a[208:211], v222 offset:0
  v_mfma_f32_16x16x32_bf16 v[32:35], a[184:187], v[184:187], v[32:35]
  buffer_load_dwordx4 v219, s[8:11], s73 offen offset:3072 lds
  ds_read_b128 a[212:215], v222 offset:4096
  v_mfma_f32_16x16x32_bf16 v[36:39], a[188:191], v[184:187], v[36:39]
  ds_read_b128 a[216:219], v223 offset:0
  ds_read_b128 a[220:223], v223 offset:4096
  v_mfma_f32_16x16x32_bf16 v[40:43], a[184:187], v[188:191], v[40:43]
  s_lshl_b32 s72, s60, 8
  v_mfma_f32_16x16x32_bf16 v[44:47], a[188:191], v[188:191], v[44:47]
  v_mfma_f32_16x16x32_bf16 v[48:51], a[184:187], v[192:195], v[48:51]
  s_waitcnt lgkmcnt(5)
  s_barrier
  ds_read_b64_tr_b16 v[144:145], v228 offset:0
  v_mfma_f32_16x16x32_bf16 v[52:55], a[188:191], v[192:195], v[52:55]
  s_add_u32 m0, s69, 65536
  ds_read_b64_tr_b16 v[146:147], v228 offset:2048
  ds_read_b64_tr_b16 v[148:149], v229 offset:0
  v_add_u32_e64 v3, s63, v2
  v_mfma_f32_16x16x32_bf16 v[56:59], a[184:187], v[196:199], v[56:59]
  ds_read_b64_tr_b16 v[150:151], v229 offset:2048
  ds_read_b64_tr_b16 v[152:153], v230 offset:0
  v_mul_u32_u24 v3, 4096, v3
  v_mfma_f32_16x16x32_bf16 v[60:63], a[188:191], v[196:199], v[60:63]
  ds_read_b64_tr_b16 v[154:155], v230 offset:2048
  ds_read_b64_tr_b16 v[156:157], v231 offset:0
  v_xor_b32_e64 v4, v2, v1
  v_mfma_f32_16x16x32_bf16 v[64:67], a[184:187], v[200:203], v[64:67]
  ds_read_b64_tr_b16 v[158:159], v231 offset:2048
  ds_read_b64_tr_b16 v[160:161], v228 offset:4096
  v_lshlrev_b32_e64 v4, 4, v4
  v_mfma_f32_16x16x32_bf16 v[68:71], a[188:191], v[200:203], v[68:71]
  ds_read_b64_tr_b16 v[162:163], v228 offset:6144
  ds_read_b64_tr_b16 v[164:165], v229 offset:4096
  v_add_u32_e64 v216, v3, v4
  v_mfma_f32_16x16x32_bf16 v[72:75], a[184:187], v[204:207], v[72:75]
  ds_read_b64_tr_b16 v[166:167], v229 offset:6144
  ds_read_b64_tr_b16 v[168:169], v230 offset:4096
  v_xor_b32_e64 v217, 64, v4
  v_mfma_f32_16x16x32_bf16 v[76:79], a[188:191], v[204:207], v[76:79]
  s_waitcnt lgkmcnt(10)
  ds_read_b64_tr_b16 v[170:171], v230 offset:6144
  v_add_u32 v3, 31744, v3
  v_mfma_f32_16x16x32_bf16 v[16:19], a[192:195], v[144:147], v[16:19]
  ds_read_b64_tr_b16 v[172:173], v231 offset:4096
  v_add_u32 v217, v217, v3
  v_xor_b32 v218, 128, v4
  v_mfma_f32_16x16x32_bf16 v[20:23], a[196:199], v[144:147], v[20:23]
  s_waitcnt lgkmcnt(8)
  ds_read_b64_tr_b16 v[174:175], v231 offset:6144
  v_add_u32 v3, 31744, v3
  v_add_u32 v218, v218, v3
  v_mfma_f32_16x16x32_bf16 v[24:27], a[192:195], v[148:151], v[24:27]
  ds_read_b64_tr_b16 v[176:177], v228 offset:8192
  v_xor_b32 v219, 192, v4
  v_add_u32 v3, 31744, v3
  v_mfma_f32_16x16x32_bf16 v[28:31], a[196:199], v[148:151], v[28:31]
  ds_read_b64_tr_b16 v[178:179], v228 offset:10240
  buffer_load_dwordx4 v224, s[12:15], s70 offen offset:0 lds
  v_add_u32_e64 v219, v219, v3
  v_mfma_f32_16x16x32_bf16 v[32:35], a[192:195], v[152:155], v[32:35]
  buffer_load_dwordx4 v[252:255], v5, s[16:19], s83 offen sc1
  ds_read_b64_tr_b16 v[180:181], v229 offset:8192
  v_mfma_f32_16x16x32_bf16 v[36:39], a[196:199], v[152:155], v[36:39]
  s_waitcnt lgkmcnt(5)
  buffer_load_dwordx4 v[236:239], v6, s[16:19], s82 offen offset:0 sc1
  ds_read_b64_tr_b16 v[182:183], v229 offset:10240
  v_mfma_f32_16x16x32_bf16 v[40:43], a[192:195], v[156:159], v[40:43]
  buffer_load_dwordx4 v[240:243], v6, s[16:19], s82 offen offset:16 sc1
  ds_read_b64_tr_b16 v[184:185], v230 offset:8192
  v_mfma_f32_16x16x32_bf16 v[44:47], a[196:199], v[156:159], v[44:47]
  buffer_load_dwordx4 v225, s[12:15], s70 offen offset:1024 lds
  ds_read_b64_tr_b16 v[186:187], v230 offset:10240
  v_mfma_f32_16x16x32_bf16 v[48:51], a[192:195], v[160:163], v[48:51]
  ds_read_b64_tr_b16 v[188:189], v231 offset:8192
  ds_read_b64_tr_b16 v[190:191], v231 offset:10240
  v_mfma_f32_16x16x32_bf16 v[52:55], a[196:199], v[160:163], v[52:55]
  ds_read_b64_tr_b16 v[192:193], v228 offset:12288
  ds_read_b64_tr_b16 v[194:195], v228 offset:14336
  v_mfma_f32_16x16x32_bf16 v[56:59], a[192:195], v[164:167], v[56:59]
  ds_read_b64_tr_b16 v[196:197], v229 offset:12288
  buffer_load_dwordx4 v226, s[12:15], s70 offen offset:2048 lds
  v_mfma_f32_16x16x32_bf16 v[60:63], a[196:199], v[164:167], v[60:63]
  ds_read_b64_tr_b16 v[198:199], v229 offset:14336
  ds_read_b64_tr_b16 v[200:201], v230 offset:12288
  v_mfma_f32_16x16x32_bf16 v[64:67], a[192:195], v[168:171], v[64:67]
  ds_read_b64_tr_b16 v[202:203], v230 offset:14336
  ds_read_b64_tr_b16 v[204:205], v231 offset:12288
  v_mfma_f32_16x16x32_bf16 v[68:71], a[196:199], v[168:171], v[68:71]
  s_waitcnt lgkmcnt(9)
  ds_read_b64_tr_b16 v[206:207], v231 offset:14336
  ds_read_b64_tr_b16 v[144:145], v228 offset:16384
  v_mfma_f32_16x16x32_bf16 v[72:75], a[192:195], v[172:175], v[72:75]
  buffer_load_dwordx4 v227, s[12:15], s70 offen offset:3072 lds
  ds_read_b64_tr_b16 v[146:147], v228 offset:18432
  v_mfma_f32_16x16x32_bf16 v[76:79], a[196:199], v[172:175], v[76:79]
  ds_read_b64_tr_b16 v[148:149], v229 offset:16384
  v_mfma_f32_16x16x32_bf16 v[16:19], a[200:203], v[176:179], v[16:19]
  ds_read_b64_tr_b16 v[150:151], v229 offset:18432
  v_mfma_f32_16x16x32_bf16 v[20:23], a[204:207], v[176:179], v[20:23]
  ds_read_b64_tr_b16 v[152:153], v230 offset:16384
  v_mfma_f32_16x16x32_bf16 v[24:27], a[200:203], v[180:183], v[24:27]
  ds_read_b64_tr_b16 v[154:155], v230 offset:18432
  v_mfma_f32_16x16x32_bf16 v[28:31], a[204:207], v[180:183], v[28:31]
  s_add_u32 m0, s69, 69504
  ds_read_b64_tr_b16 v[156:157], v231 offset:16384
  v_mfma_f32_16x16x32_bf16 v[32:35], a[200:203], v[184:187], v[32:35]
  ds_read_b64_tr_b16 v[158:159], v231 offset:18432
  v_mfma_f32_16x16x32_bf16 v[36:39], a[204:207], v[184:187], v[36:39]
  s_waitcnt lgkmcnt(5)
  ds_read_b64_tr_b16 v[160:161], v228 offset:20480
  v_mfma_f32_16x16x32_bf16 v[40:43], a[200:203], v[188:191], v[40:43]
  ds_read_b64_tr_b16 v[162:163], v228 offset:22528
  v_mfma_f32_16x16x32_bf16 v[44:47], a[204:207], v[188:191], v[44:47]
  ds_read_b64_tr_b16 v[164:165], v229 offset:20480
  v_mfma_f32_16x16x32_bf16 v[48:51], a[200:203], v[192:195], v[48:51]
  ds_read_b64_tr_b16 v[166:167], v229 offset:22528
  v_mfma_f32_16x16x32_bf16 v[52:55], a[204:207], v[192:195], v[52:55]
  buffer_load_dwordx4 v224, s[12:15], s70 offen offset:128 lds
  v_mfma_f32_16x16x32_bf16 v[56:59], a[200:203], v[196:199], v[56:59]
  ds_read_b64_tr_b16 v[168:169], v230 offset:20480
  v_mfma_f32_16x16x32_bf16 v[60:63], a[204:207], v[196:199], v[60:63]
  ds_read_b64_tr_b16 v[170:171], v230 offset:22528
  v_mfma_f32_16x16x32_bf16 v[64:67], a[200:203], v[200:203], v[64:67]
  ds_read_b64_tr_b16 v[172:173], v231 offset:20480
  v_mfma_f32_16x16x32_bf16 v[68:71], a[204:207], v[200:203], v[68:71]
  ds_read_b64_tr_b16 v[174:175], v231 offset:22528
  v_mfma_f32_16x16x32_bf16 v[72:75], a[200:203], v[204:207], v[72:75]
  buffer_load_dwordx4 v225, s[12:15], s70 offen offset:1152 lds
  v_mfma_f32_16x16x32_bf16 v[76:79], a[204:207], v[204:207], v[76:79]
  ds_read_b64_tr_b16 v[176:177], v228 offset:24576
  v_mfma_f32_16x16x32_bf16 v[16:19], a[208:211], v[144:147], v[16:19]
  ds_read_b64_tr_b16 v[178:179], v228 offset:26624
  v_mfma_f32_16x16x32_bf16 v[20:23], a[212:215], v[144:147], v[20:23]
  s_waitcnt lgkmcnt(4)
  ds_read_b64_tr_b16 v[180:181], v229 offset:24576
  v_mfma_f32_16x16x32_bf16 v[24:27], a[208:211], v[148:151], v[24:27]
  ds_read_b64_tr_b16 v[182:183], v229 offset:26624
  v_mfma_f32_16x16x32_bf16 v[28:31], a[212:215], v[148:151], v[28:31]
  ds_read_b64_tr_b16 v[184:185], v230 offset:24576
  v_mfma_f32_16x16x32_bf16 v[32:35], a[208:211], v[152:155], v[32:35]
  buffer_load_dwordx4 v226, s[12:15], s70 offen offset:2176 lds
  v_mfma_f32_16x16x32_bf16 v[36:39], a[212:215], v[152:155], v[36:39]
  ds_read_b64_tr_b16 v[186:187], v230 offset:26624
  v_mfma_f32_16x16x32_bf16 v[40:43], a[208:211], v[156:159], v[40:43]
  ds_read_b64_tr_b16 v[188:189], v231 offset:24576
  v_mfma_f32_16x16x32_bf16 v[44:47], a[212:215], v[156:159], v[44:47]
  ds_read_b64_tr_b16 v[190:191], v231 offset:26624
  v_mfma_f32_16x16x32_bf16 v[48:51], a[208:211], v[160:163], v[48:51]
  ds_read_b64_tr_b16 v[192:193], v228 offset:28672
  v_mfma_f32_16x16x32_bf16 v[52:55], a[212:215], v[160:163], v[52:55]
  ds_read_b64_tr_b16 v[194:195], v228 offset:30720
  v_mfma_f32_16x16x32_bf16 v[56:59], a[208:211], v[164:167], v[56:59]
  buffer_load_dwordx4 v227, s[12:15], s70 offen offset:3200 lds
  v_mfma_f32_16x16x32_bf16 v[60:63], a[212:215], v[164:167], v[60:63]
  ds_read_b64_tr_b16 v[196:197], v229 offset:28672
  v_mfma_f32_16x16x32_bf16 v[64:67], a[208:211], v[168:171], v[64:67]
  ds_read_b64_tr_b16 v[198:199], v229 offset:30720
  v_mfma_f32_16x16x32_bf16 v[68:71], a[212:215], v[168:171], v[68:71]
  s_waitcnt lgkmcnt(4)
  ds_read_b64_tr_b16 v[200:201], v230 offset:28672
  v_mfma_f32_16x16x32_bf16 v[72:75], a[208:211], v[172:175], v[72:75]
  ds_read_b64_tr_b16 v[202:203], v230 offset:30720
  s_bfe_u32 s70, s71, 0x30004
  v_mfma_f32_16x16x32_bf16 v[76:79], a[212:215], v[172:175], v[76:79]
  ds_read_b64_tr_b16 v[204:205], v231 offset:28672
  v_mfma_f32_16x16x32_bf16 v[16:19], a[216:219], v[176:179], v[16:19]
  ds_read_b64_tr_b16 v[206:207], v231 offset:30720
  v_mfma_f32_16x16x32_bf16 v[20:23], a[220:223], v[176:179], v[20:23]
  s_waitcnt vmcnt(15)
  ds_read_b128 a[224:227], v220 offset:8192
  v_mfma_f32_16x16x32_bf16 v[24:27], a[216:219], v[180:183], v[24:27]
  s_waitcnt vmcnt(11)
  ds_read_b128 a[228:231], v220 offset:12288
  ds_read_b128 a[232:235], v221 offset:8192
  v_mfma_f32_16x16x32_bf16 v[28:31], a[220:223], v[180:183], v[28:31]
  s_mul_i32 s70, s70, 917504
  ds_read_b128 a[236:239], v221 offset:12288
  ds_read_b128 a[240:243], v222 offset:8192
  v_mfma_f32_16x16x32_bf16 v[32:35], a[216:219], v[184:187], v[32:35]
  ds_read_b128 a[244:247], v222 offset:12288
  ds_read_b128 a[248:251], v223 offset:8192
  v_mfma_f32_16x16x32_bf16 v[36:39], a[220:223], v[184:187], v[36:39]
  ds_read_b128 a[252:255], v223 offset:12288
  v_mfma_f32_16x16x32_bf16 v[40:43], a[216:219], v[188:191], v[40:43]
  v_mfma_f32_16x16x32_bf16 v[44:47], a[220:223], v[188:191], v[44:47]
  s_waitcnt lgkmcnt(7)
  v_mfma_f32_16x16x32_bf16 v[48:51], a[216:219], v[192:195], v[48:51]
  s_barrier
  ds_read_b64_tr_b16 v[144:145], v228 offset:32768
  v_mfma_f32_16x16x32_bf16 v[52:55], a[220:223], v[192:195], v[52:55]
  s_add_u32 m0, s69, 0
  ds_read_b64_tr_b16 v[146:147], v228 offset:34816
  ds_read_b64_tr_b16 v[148:149], v229 offset:32768
  v_mfma_f32_16x16x32_bf16 v[56:59], a[216:219], v[196:199], v[56:59]
  ds_read_b64_tr_b16 v[150:151], v229 offset:34816
  ds_read_b64_tr_b16 v[152:153], v230 offset:32768
  v_mfma_f32_16x16x32_bf16 v[60:63], a[220:223], v[196:199], v[60:63]
  ds_read_b64_tr_b16 v[154:155], v230 offset:34816
  ds_read_b64_tr_b16 v[156:157], v231 offset:32768
  v_mfma_f32_16x16x32_bf16 v[64:67], a[216:219], v[200:203], v[64:67]
  ds_read_b64_tr_b16 v[158:159], v231 offset:34816
  ds_read_b64_tr_b16 v[160:161], v228 offset:36864
  v_mfma_f32_16x16x32_bf16 v[68:71], a[220:223], v[200:203], v[68:71]
  ds_read_b64_tr_b16 v[162:163], v228 offset:38912
  ds_read_b64_tr_b16 v[164:165], v229 offset:36864
  v_mfma_f32_16x16x32_bf16 v[72:75], a[216:219], v[204:207], v[72:75]
  s_branch parallel_sum__ssm_conv_h3__mixer_gmlp__prompt_kernel_ps2
parallel_sum__ssm_conv_h3__mixer_gmlp__prompt_kernel_pg2:
  s_branch parallel_sum__ssm_conv_h3__mixer_gmlp__prompt_kernel_pg6
parallel_sum__ssm_conv_h3__mixer_gmlp__prompt_kernel_ps2:
  ds_read_b64_tr_b16 v[166:167], v229 offset:38912
  ds_read_b64_tr_b16 v[168:169], v230 offset:36864
  v_mfma_f32_16x16x32_bf16 v[76:79], a[220:223], v[204:207], v[76:79]
  s_waitcnt lgkmcnt(10)
  ds_read_b64_tr_b16 v[170:171], v230 offset:38912
  buffer_load_dwordx4 v224, s[12:15], s70 offen offset:0 lds
  v_mfma_f32_16x16x32_bf16 v[16:19], a[224:227], v[144:147], v[16:19]
  ds_read_b64_tr_b16 v[172:173], v231 offset:36864
  ds_read_b64_tr_b16 v[174:175], v231 offset:38912
  v_mfma_f32_16x16x32_bf16 v[20:23], a[228:231], v[144:147], v[20:23]
  s_waitcnt lgkmcnt(9)
  ds_read_b64_tr_b16 v[176:177], v228 offset:40960
  ds_read_b64_tr_b16 v[178:179], v228 offset:43008
  v_mfma_f32_16x16x32_bf16 v[24:27], a[224:227], v[148:151], v[24:27]
  ds_read_b64_tr_b16 v[180:181], v229 offset:40960
  ds_read_b64_tr_b16 v[182:183], v229 offset:43008
  v_mfma_f32_16x16x32_bf16 v[28:31], a[228:231], v[148:151], v[28:31]
  buffer_load_dwordx4 v225, s[12:15], s70 offen offset:1024 lds
  ds_read_b64_tr_b16 v[184:185], v230 offset:40960
  v_mfma_f32_16x16x32_bf16 v[32:35], a[224:227], v[152:155], v[32:35]
  s_waitcnt vmcnt(11)
  v_xor_b32 v3, s64, v252
  v_bitop3_b32 v3, v3, v253, s65 bitop3:0xf6
  v_mfma_f32_16x16x32_bf16 v[36:39], a[228:231], v[152:155], v[36:39]
  s_waitcnt lgkmcnt(7)
  ds_read_b64_tr_b16 v[186:187], v230 offset:43008
  v_bitop3_b32 v3, v3, v254, s66 bitop3:0xf6
  v_bitop3_b32 v3, v3, v255, s67 bitop3:0xf6
  v_mfma_f32_16x16x32_bf16 v[40:43], a[224:227], v[156:159], v[40:43]
  s_waitcnt vmcnt(10)
  v_bitop3_b32 v3, v3, v236, s64 bitop3:0xf6
  v_bitop3_b32 v3, v3, v237, s65 bitop3:0xf6
  v_mfma_f32_16x16x32_bf16 v[44:47], a[228:231], v[156:159], v[44:47]
  ds_read_b64_tr_b16 v[188:189], v231 offset:40960
  v_bitop3_b32 v3, v3, v238, s66 bitop3:0xf6
  v_mfma_f32_16x16x32_bf16 v[48:51], a[224:227], v[160:163], v[48:51]
  ds_read_b64_tr_b16 v[190:191], v231 offset:43008
  v_bitop3_b32 v3, v3, v239, s67 bitop3:0xf6
  v_mfma_f32_16x16x32_bf16 v[52:55], a[228:231], v[160:163], v[52:55]
  buffer_load_dwordx4 v226, s[12:15], s70 offen offset:2048 lds
  ds_read_b64_tr_b16 v[192:193], v228 offset:45056
  v_mfma_f32_16x16x32_bf16 v[56:59], a[224:227], v[164:167], v[56:59]
  s_waitcnt vmcnt(10)
  v_bitop3_b32 v3, v3, v240, s64 bitop3:0xf6
  v_bitop3_b32 v3, v3, v241, s65 bitop3:0xf6
  v_mfma_f32_16x16x32_bf16 v[60:63], a[228:231], v[164:167], v[60:63]
  ds_read_b64_tr_b16 v[194:195], v228 offset:47104
  v_bitop3_b32 v3, v3, v242, s66 bitop3:0xf6
  v_mfma_f32_16x16x32_bf16 v[64:67], a[224:227], v[168:171], v[64:67]
  ds_read_b64_tr_b16 v[196:197], v229 offset:45056
  v_bitop3_b32 v3, v3, v243, s67 bitop3:0xf6
  v_mfma_f32_16x16x32_bf16 v[68:71], a[228:231], v[168:171], v[68:71]
  s_waitcnt lgkmcnt(4)
  ds_read_b64_tr_b16 v[198:199], v229 offset:47104
  v_and_b32 v3, 0xff, v3
  v_mfma_f32_16x16x32_bf16 v[72:75], a[224:227], v[172:175], v[72:75]
  buffer_load_dwordx4 v227, s[12:15], s70 offen offset:3072 lds
  ds_read_b64_tr_b16 v[200:201], v230 offset:45056
  v_mfma_f32_16x16x32_bf16 v[76:79], a[228:231], v[172:175], v[76:79]
  s_add_u32 m0, s68, 0
  ds_read_b64_tr_b16 v[202:203], v230 offset:47104
  ds_read_b64_tr_b16 v[204:205], v231 offset:45056
  v_mfma_f32_16x16x32_bf16 v[16:19], a[232:235], v[176:179], v[16:19]
  s_add_u32 s73, s72, 16384
  ds_read_b64_tr_b16 v[206:207], v231 offset:47104
  v_cmp_ne_u32_e64 vcc, 0, v3
  s_cbranch_vccnz parallel_sum__ssm_conv_h3__mixer_gmlp__prompt_kernel_stat_slow
parallel_sum__ssm_conv_h3__mixer_gmlp__prompt_kernel_stat_ok:
  v_mfma_f32_16x16x32_bf16 v[20:23], a[236:239], v[176:179], v[20:23]
  buffer_load_dwordx4 v216, s[40:43], s72 offen offset:0 lds
  ds_read_b64_tr_b16 v[144:145], v228 offset:49152
  v_mfma_f32_16x16x32_bf16 v[24:27], a[232:235], v[180:183], v[24:27]
  buffer_load_dwordx4 v217, s[40:43], s72 offen offset:1024 lds
  ds_read_b64_tr_b16 v[146:147], v228 offset:51200
  v_mfma_f32_16x16x32_bf16 v[28:31], a[236:239], v[180:183], v[28:31]
  ds_read_b64_tr_b16 v[148:149], v229 offset:49152
  v_mov_b32_dpp v80, v252 row_newbcast:0 row_mask:0xf bank_mask:0xf
  v_mov_b32_dpp v81, v253 row_newbcast:0 row_mask:0xf bank_mask:0xf
  v_mfma_f32_16x16x32_bf16 v[32:35], a[232:235], v[184:187], v[32:35]
  ds_read_b64_tr_b16 v[150:151], v229 offset:51200
  v_mov_b32_dpp v82, v254 row_newbcast:0 row_mask:0xf bank_mask:0xf
  v_mov_b32_dpp v83, v255 row_newbcast:0 row_mask:0xf bank_mask:0xf
  v_mfma_f32_16x16x32_bf16 v[36:39], a[236:239], v[184:187], v[36:39]
  s_waitcnt lgkmcnt(5)
  buffer_load_dwordx4 v218, s[40:43], s72 offen offset:2048 lds
  ds_read_b64_tr_b16 v[152:153], v230 offset:49152
  v_mfma_f32_16x16x32_bf16 v[40:43], a[232:235], v[188:191], v[40:43]
  ds_read_b64_tr_b16 v[154:155], v230 offset:51200
  v_mov_b32_dpp v84, v252 row_newbcast:1 row_mask:0xf bank_mask:0xf
  v_mov_b32_dpp v85, v253 row_newbcast:1 row_mask:0xf bank_mask:0xf
  v_mfma_f32_16x16x32_bf16 v[44:47], a[236:239], v[188:191], v[44:47]
  buffer_load_dwordx4 v219, s[40:43], s72 offen offset:3072 lds
  ds_read_b64_tr_b16 v[156:157], v231 offset:49152
  v_mfma_f32_16x16x32_bf16 v[48:51], a[232:235], v[192:195], v[48:51]
  s_add_u32 m0, s69, 3968
  ds_read_b64_tr_b16 v[158:159], v231 offset:51200
  v_mov_b32_dpp v86, v254 row_newbcast:1 row_mask:0xf bank_mask:0xf
  v_mov_b32_dpp v87, v255 row_newbcast:1 row_mask:0xf bank_mask:0xf
  v_mfma_f32_16x16x32_bf16 v[52:55], a[236:239], v[192:195], v[52:55]
  buffer_load_dwordx4 v224, s[12:15], s70 offen offset:128 lds
  ds_read_b64_tr_b16 v[160:161], v228 offset:53248
  v_mfma_f32_16x16x32_bf16 v[56:59], a[232:235], v[196:199], v[56:59]
  ds_read_b64_tr_b16 v[162:163], v228 offset:55296
  v_mov_b32_dpp v88, v252 row_newbcast:2 row_mask:0xf bank_mask:0xf
  v_mov_b32_dpp v89, v253 row_newbcast:2 row_mask:0xf bank_mask:0xf
  v_mfma_f32_16x16x32_bf16 v[60:63], a[236:239], v[196:199], v[60:63]
  ds_read_b64_tr_b16 v[164:165], v229 offset:53248
  v_mov_b32_dpp v90, v254 row_newbcast:2 row_mask:0xf bank_mask:0xf
  v_mov_b32_dpp v91, v255 row_newbcast:2 row_mask:0xf bank_mask:0xf
  v_mfma_f32_16x16x32_bf16 v[64:67], a[232:235], v[200:203], v[64:67]
  ds_read_b64_tr_b16 v[166:167], v229 offset:55296
  v_mov_b32_dpp v92, v252 row_newbcast:3 row_mask:0xf bank_mask:0xf
  v_mfma_f32_16x16x32_bf16 v[68:71], a[236:239], v[200:203], v[68:71]
  s_waitcnt lgkmcnt(5)
  ds_read_b64_tr_b16 v[168:169], v230 offset:53248
  v_mov_b32_dpp v93, v253 row_newbcast:3 row_mask:0xf bank_mask:0xf
  v_mfma_f32_16x16x32_bf16 v[72:75], a[232:235], v[204:207], v[72:75]
  buffer_load_dwordx4 v225, s[12:15], s70 offen offset:1152 lds
  ds_read_b64_tr_b16 v[170:171], v230 offset:55296
  v_mfma_f32_16x16x32_bf16 v[76:79], a[236:239], v[204:207], v[76:79]
  ds_read_b64_tr_b16 v[172:173], v231 offset:53248
  v_mov_b32_dpp v94, v254 row_newbcast:3 row_mask:0xf bank_mask:0xf
  v_mov_b32_dpp v95, v255 row_newbcast:3 row_mask:0xf bank_mask:0xf
  v_mfma_f32_16x16x32_bf16 v[16:19], a[240:243], v[144:147], v[16:19]
  ds_read_b64_tr_b16 v[174:175], v231 offset:55296
  v_mul_f32_e64 v104, v82, v82
  v_mfma_f32_16x16x32_bf16 v[20:23], a[244:247], v[144:147], v[20:23]
  ds_read_b64_tr_b16 v[176:177], v228 offset:57344
  v_mul_f32 v96, 0xc0135761, v82
  v_mfma_f32_16x16x32_bf16 v[24:27], a[240:243], v[148:151], v[24:27]
  ds_read_b64_tr_b16 v[178:179], v228 offset:59392
  v_mul_f32_e64 v104, v104, v82
  v_mfma_f32_16x16x32_bf16 v[28:31], a[244:247], v[148:151], v[28:31]
  buffer_load_dwordx4 v226, s[12:15], s70 offen offset:2176 lds
  ds_read_b64_tr_b16 v[180:181], v229 offset:57344
  v_mfma_f32_16x16x32_bf16 v[32:35], a[240:243], v[152:155], v[32:35]
  ds_read_b64_tr_b16 v[182:183], v229 offset:59392
  v_mul_f32 v104, 0xbdd2d3e8, v104
  v_mul_f32_e64 v105, v83, v83
  v_mfma_f32_16x16x32_bf16 v[36:39], a[244:247], v[152:155], v[36:39]
  s_waitcnt lgkmcnt(5)
  ds_read_b64_tr_b16 v[184:185], v230 offset:57344
  v_mul_f32 v97, 0xc0135761, v83
  v_mfma_f32_16x16x32_bf16 v[40:43], a[240:243], v[156:159], v[40:43]
  ds_read_b64_tr_b16 v[186:187], v230 offset:59392
  v_mul_f32 v105, v105, v83
  v_mfma_f32_16x16x32_bf16 v[44:47], a[244:247], v[156:159], v[44:47]
  ds_read_b64_tr_b16 v[188:189], v231 offset:57344
  v_mul_f32 v105, 0xbdd2d3e8, v105
  v_mfma_f32_16x16x32_bf16 v[48:51], a[240:243], v[160:163], v[48:51]
  ds_read_b64_tr_b16 v[190:191], v231 offset:59392
  v_mul_f32_e64 v106, v86, v86
  v_mfma_f32_16x16x32_bf16 v[52:55], a[244:247], v[160:163], v[52:55]
  buffer_load_dwordx4 v227, s[12:15], s70 offen offset:3200 lds
  ds_read_b64_tr_b16 v[192:193], v228 offset:61440
  v_mfma_f32_16x16x32_bf16 v[56:59], a[240:243], v[164:167], v[56:59]
  ds_read_b64_tr_b16 v[194:195], v228 offset:63488
  v_mul_f32 v98, 0xc0135761, v86
  v_mul_f32_e64 v106, v106, v86
  v_mfma_f32_16x16x32_bf16 v[60:63], a[244:247], v[164:167], v[60:63]
  ds_read_b64_tr_b16 v[196:197], v229 offset:61440
  v_mul_f32 v106, 0xbdd2d3e8, v106
  v_mfma_f32_16x16x32_bf16 v[64:67], a[240:243], v[168:171], v[64:67]
  ds_read_b64_tr_b16 v[198:199], v229 offset:63488
  v_mul_f32_e64 v107, v87, v87
  v_mfma_f32_16x16x32_bf16 v[68:71], a[244:247], v[168:171], v[68:71]
  s_waitcnt lgkmcnt(5)
  ds_read_b64_tr_b16 v[200:201], v230 offset:61440
  v_mul_f32 v99, 0xc0135761, v87
  v_mfma_f32_16x16x32_bf16 v[72:75], a[240:243], v[172:175], v[72:75]
  s_bfe_u32 s70, s71, 0x30008
  ds_read_b64_tr_b16 v[202:203], v230 offset:63488
  v_mul_f32 v107, v107, v87
  v_mfma_f32_16x16x32_bf16 v[76:79], a[244:247], v[172:175], v[76:79]
  ds_read_b64_tr_b16 v[204:205], v231 offset:61440
  v_mul_f32 v107, 0xbdd2d3e8, v107
  v_mfma_f32_16x16x32_bf16 v[16:19], a[248:251], v[176:179], v[16:19]
  s_mul_i32 s70, s70, 917504
  ds_read_b64_tr_b16 v[206:207], v231 offset:63488
  v_mul_f32_e64 v108, v90, v90
  v_mfma_f32_16x16x32_bf16 v[20:23], a[252:255], v[176:179], v[20:23]
  s_add_u32 m0, s68, 4096
  v_mul_f32 v100, 0xc0135761, v90
  v_mul_f32_e64 v108, v108, v90
  v_mfma_f32_16x16x32_bf16 v[24:27], a[248:251], v[180:183], v[24:27]
  buffer_load_dwordx4 v216, s[40:43], s73 offen offset:0 lds
  v_mfma_f32_16x16x32_bf16 v[28:31], a[252:255], v[180:183], v[28:31]
  buffer_load_dwordx4 v217, s[40:43], s73 offen offset:1024 lds
  v_mul_f32 v108, 0xbdd2d3e8, v108
  v_mfma_f32_16x16x32_bf16 v[32:35], a[248:251], v[184:187], v[32:35]
  buffer_load_dwordx4 v218, s[40:43], s73 offen offset:2048 lds
  v_mul_f32_e64 v109, v91, v91
  v_mfma_f32_16x16x32_bf16 v[36:39], a[252:255], v[184:187], v[36:39]
  s_waitcnt lgkmcnt(1)
  buffer_load_dwordx4 v219, s[40:43], s73 offen offset:3072 lds
  v_mul_f32 v101, 0xc0135761, v91
  v_mfma_f32_16x16x32_bf16 v[40:43], a[248:251], v[188:191], v[40:43]
  s_bfe_u32 s72, s0, 0x40004
  v_mul_f32 v109, v109, v91
  v_mul_f32 v109, 0xbdd2d3e8, v109
  v_mfma_f32_16x16x32_bf16 v[44:47], a[252:255], v[188:191], v[44:47]
  s_lshl_b32 s72, s72, 8
  v_mul_f32 v110, v94, v94
  v_mul_f32 v102, 0xc0135761, v94
  v_mfma_f32_16x16x32_bf16 v[48:51], a[248:251], v[192:195], v[48:51]
  s_waitcnt vmcnt(16) lgkmcnt(0)
  s_barrier
  v_mfma_f32_16x16x32_bf16 v[52:55], a[252:255], v[192:195], v[52:55]
  s_add_u32 m0, s69, 32768
  v_mul_f32_e64 v110, v110, v94
  v_mul_f32 v110, 0xbdd2d3e8, v110
  v_mfma_f32_16x16x32_bf16 v[56:59], a[248:251], v[196:199], v[56:59]
  v_mul_f32_e64 v111, v95, v95
  v_mul_f32 v103, 0xc0135761, v95
  v_mfma_f32_16x16x32_bf16 v[60:63], a[252:255], v[196:199], v[60:63]
  v_mul_f32_e64 v111, v111, v95
  v_mul_f32 v111, 0xbdd2d3e8, v111
  v_mfma_f32_16x16x32_bf16 v[64:67], a[248:251], v[200:203], v[64:67]
  buffer_load_dwordx4 v224, s[12:15], s70 offen offset:0 lds
  v_mfma_f32_16x16x32_bf16 v[68:71], a[252:255], v[200:203], v[68:71]
  ds_read_b64_tr_b16 v[144:145], v232 offset:0
  v_mfma_f32_16x16x32_bf16 v[72:75], a[248:251], v[204:207], v[72:75]
  buffer_load_dwordx4 v225, s[12:15], s70 offen offset:1024 lds
  v_mfma_f32_16x16x32_bf16 v[76:79], a[252:255], v[204:207], v[76:79]
  v_pk_fma_f32 v[16:17], v[80:81], v[236:237], v[16:17] op_sel:[0,0,0] op_sel_hi:[1,0,1] neg_lo:[1,0,0] neg_hi:[1,0,0]
  v_pk_fma_f32 v[18:19], v[84:85], v[236:237], v[18:19] op_sel:[0,0,0] op_sel_hi:[1,0,1] neg_lo:[1,0,0] neg_hi:[1,0,0]
  v_pk_fma_f32 v[20:21], v[88:89], v[236:237], v[20:21] op_sel:[0,0,0] op_sel_hi:[1,0,1] neg_lo:[1,0,0] neg_hi:[1,0,0]
  v_pk_fma_f32 v[22:23], v[92:93], v[236:237], v[22:23] op_sel:[0,0,0] op_sel_hi:[1,0,1] neg_lo:[1,0,0] neg_hi:[1,0,0]
  buffer_load_dwordx4 v226, s[12:15], s70 offen offset:2048 lds
  v_pk_mul_f32 v[112:113], v[16:17], v[16:17]
  v_pk_mul_f32 v[114:115], v[18:19], v[18:19]
  v_pk_mul_f32 v[116:117], v[20:21], v[20:21]
  v_pk_mul_f32 v[118:119], v[22:23], v[22:23]
  buffer_load_dwordx4 v227, s[12:15], s70 offen offset:3072 lds
  v_pk_fma_f32 v[112:113], v[112:113], v[104:105], v[96:97]
  v_pk_fma_f32 v[114:115], v[114:115], v[106:107], v[98:99]
  v_pk_fma_f32 v[116:117], v[116:117], v[108:109], v[100:101]
  v_pk_fma_f32 v[118:119], v[118:119], v[110:111], v[102:103]
  s_add_u32 m0, s69, 36736
  v_pk_mul_f32 v[112:113], v[112:113], v[16:17]
  v_pk_mul_f32 v[114:115], v[114:115], v[18:19]
  v_pk_mul_f32 v[116:117], v[116:117], v[20:21]
  v_pk_mul_f32 v[118:119], v[118:119], v[22:23]
  buffer_load_dwordx4 v224, s[12:15], s70 offen offset:128 lds
  v_exp_f32 v112, v112
  v_exp_f32 v113, v113
  v_exp_f32 v114, v114
  v_exp_f32 v115, v115
  buffer_load_dwordx4 v225, s[12:15], s70 offen offset:1152 lds
  v_exp_f32_e64 v116, v116
  buffer_load_dwordx4 v226, s[12:15], s70 offen offset:2176 lds
  v_exp_f32_e64 v117, v117
  buffer_load_dwordx4 v227, s[12:15], s70 offen offset:3200 lds
  v_exp_f32_e64 v118, v118
  s_bfe_u32 s70, s71, 0x3000c
  v_exp_f32 v119, v119
  v_lshlrev_b32 v5, 10, v2
  v_lshl_add_u32 v5, v1, 2, v5
  s_mul_i32 s70, s70, 917504
  buffer_load_dword v6, v5, s[16:19], s84 offen sc1
  v_pk_add_f32 v[112:113], v[112:113], s[80:81]
  v_pk_add_f32 v[114:115], v[114:115], s[80:81]
  v_pk_add_f32 v[116:117], v[116:117], s[80:81]
  v_pk_add_f32 v[118:119], v[118:119], s[80:81]
  ds_read_b64_tr_b16 v[146:147], v232 offset:2048
  v_rcp_f32 v112, v112
  v_rcp_f32 v113, v113
  v_rcp_f32 v114, v114
  v_rcp_f32 v115, v115
  ds_read_b64_tr_b16 v[148:149], v233 offset:0
  v_rcp_f32 v116, v116
  v_rcp_f32 v117, v117
  v_rcp_f32 v118, v118
  v_rcp_f32 v119, v119
  ds_read_b64_tr_b16 v[150:151], v233 offset:2048
  v_pk_mul_f32 v[16:17], v[16:17], v[112:113]
  v_pk_mul_f32 v[18:19], v[18:19], v[114:115]
  v_pk_mul_f32 v[20:21], v[20:21], v[116:117]
  v_pk_mul_f32 v[22:23], v[22:23], v[118:119]
  ds_read_b64_tr_b16 v[152:153], v234 offset:0
  ds_read_b64_tr_b16 v[154:155], v234 offset:2048
  ds_read_b64_tr_b16 v[156:157], v235 offset:0
  ds_read_b64_tr_b16 v[158:159], v235 offset:2048
  v_pk_mul_f32 v[120:121], v[16:17], s[80:81]
  v_pk_mul_f32 v[124:125], v[18:19], s[80:81]
  v_pk_mul_f32 v[128:129], v[20:21], s[80:81]
  v_pk_mul_f32 v[132:133], v[22:23], s[80:81]
  s_add_u32 m0, s68, 8192
  v_pk_mul_f32 v[122:123], v[16:17], v[16:17]
  v_pk_mul_f32 v[126:127], v[18:19], v[18:19]
  v_pk_mul_f32 v[130:131], v[20:21], v[20:21]
  v_pk_mul_f32 v[134:135], v[22:23], v[22:23]
  s_add_u32 s73, s72, 16384
  v_pk_fma_f32 v[24:25], v[80:81], v[236:237], v[24:25] op_sel:[0,1,0] op_sel_hi:[1,1,1] neg_lo:[1,0,0] neg_hi:[1,0,0]
  v_pk_fma_f32 v[26:27], v[84:85], v[236:237], v[26:27] op_sel:[0,1,0] op_sel_hi:[1,1,1] neg_lo:[1,0,0] neg_hi:[1,0,0]
  v_pk_fma_f32 v[28:29], v[88:89], v[236:237], v[28:29] op_sel:[0,1,0] op_sel_hi:[1,1,1] neg_lo:[1,0,0] neg_hi:[1,0,0]
  v_pk_fma_f32 v[30:31], v[92:93], v[236:237], v[30:31] op_sel:[0,1,0] op_sel_hi:[1,1,1] neg_lo:[1,0,0] neg_hi:[1,0,0]
  buffer_load_dwordx4 v216, s[40:43], s72 offen offset:0 lds
  v_pk_mul_f32 v[112:113], v[24:25], v[24:25]
  v_pk_mul_f32 v[114:115], v[26:27], v[26:27]
  v_pk_mul_f32 v[116:117], v[28:29], v[28:29]
  v_pk_mul_f32 v[118:119], v[30:31], v[30:31]
  buffer_load_dwordx4 v217, s[40:43], s72 offen offset:1024 lds
  v_pk_fma_f32 v[112:113], v[112:113], v[104:105], v[96:97]
  buffer_load_dwordx4 v218, s[40:43], s72 offen offset:2048 lds
  v_pk_fma_f32 v[114:115], v[114:115], v[106:107], v[98:99]
  buffer_load_dwordx4 v219, s[40:43], s72 offen offset:3072 lds
  v_pk_fma_f32 v[116:117], v[116:117], v[108:109], v[100:101]
  v_pk_fma_f32 v[118:119], v[118:119], v[110:111], v[102:103]
  v_pk_mul_f32 v[112:113], v[112:113], v[24:25]
  v_pk_mul_f32 v[114:115], v[114:115], v[26:27]
  v_pk_mul_f32 v[116:117], v[116:117], v[28:29]
  v_pk_mul_f32 v[118:119], v[118:119], v[30:31]
  v_exp_f32 v112, v112
  v_exp_f32 v113, v113
  v_exp_f32 v114, v114
  v_exp_f32 v115, v115
  v_exp_f32 v116, v116
  v_exp_f32 v117, v117
  v_exp_f32 v118, v118
  v_exp_f32 v119, v119
  v_pk_add_f32 v[112:113], v[112:113], s[80:81]
  v_pk_add_f32 v[114:115], v[114:115], s[80:81]
  v_pk_add_f32 v[116:117], v[116:117], s[80:81]
  v_pk_add_f32 v[118:119], v[118:119], s[80:81]
  v_rcp_f32 v112, v112
  v_rcp_f32 v113, v113
  v_rcp_f32 v114, v114
  v_rcp_f32 v115, v115
  v_rcp_f32 v116, v116
  v_rcp_f32 v117, v117
  v_rcp_f32 v118, v118
  v_rcp_f32 v119, v119
  v_pk_mul_f32 v[24:25], v[24:25], v[112:113]
  v_pk_mul_f32 v[26:27], v[26:27], v[114:115]
  v_pk_mul_f32 v[28:29], v[28:29], v[116:117]
  v_pk_mul_f32 v[30:31], v[30:31], v[118:119]
  v_pk_add_f32 v[120:121], v[120:121], v[24:25]
  v_pk_add_f32 v[124:125], v[124:125], v[26:27]
  v_pk_add_f32 v[128:129], v[128:129], v[28:29]
  v_pk_add_f32 v[132:133], v[132:133], v[30:31]
  v_pk_fma_f32 v[122:123], v[24:25], v[24:25], v[122:123]
  v_pk_fma_f32 v[126:127], v[26:27], v[26:27], v[126:127]
  v_pk_fma_f32 v[130:131], v[28:29], v[28:29], v[130:131]
  v_pk_fma_f32 v[134:135], v[30:31], v[30:31], v[134:135]
  v_pk_fma_f32 v[32:33], v[80:81], v[238:239], v[32:33] op_sel:[0,0,0] op_sel_hi:[1,0,1] neg_lo:[1,0,0] neg_hi:[1,0,0]
  v_pk_fma_f32 v[34:35], v[84:85], v[238:239], v[34:35] op_sel:[0,0,0] op_sel_hi:[1,0,1] neg_lo:[1,0,0] neg_hi:[1,0,0]
  v_pk_fma_f32 v[36:37], v[88:89], v[238:239], v[36:37] op_sel:[0,0,0] op_sel_hi:[1,0,1] neg_lo:[1,0,0] neg_hi:[1,0,0]
  v_pk_fma_f32 v[38:39], v[92:93], v[238:239], v[38:39] op_sel:[0,0,0] op_sel_hi:[1,0,1] neg_lo:[1,0,0] neg_hi:[1,0,0]
  v_pk_mul_f32 v[112:113], v[32:33], v[32:33]
  v_pk_mul_f32 v[114:115], v[34:35], v[34:35]
  v_pk_mul_f32 v[116:117], v[36:37], v[36:37]
  v_pk_mul_f32 v[118:119], v[38:39], v[38:39]
  v_pk_fma_f32 v[112:113], v[112:113], v[104:105], v[96:97]
  v_pk_fma_f32 v[114:115], v[114:115], v[106:107], v[98:99]
  v_pk_fma_f32 v[116:117], v[116:117], v[108:109], v[100:101]
  v_pk_fma_f32 v[118:119], v[118:119], v[110:111], v[102:103]
  v_pk_mul_f32 v[112:113], v[112:113], v[32:33]
  v_pk_mul_f32 v[114:115], v[114:115], v[34:35]
  v_pk_mul_f32 v[116:117], v[116:117], v[36:37]
  v_pk_mul_f32 v[118:119], v[118:119], v[38:39]
  v_exp_f32 v112, v112
  v_exp_f32 v113, v113
  v_exp_f32 v114, v114
  v_exp_f32 v115, v115
  v_exp_f32 v116, v116
  v_exp_f32 v117, v117
  v_exp_f32 v118, v118
  v_exp_f32 v119, v119
  v_pk_add_f32 v[112:113], v[112:113], s[80:81]
  v_pk_add_f32 v[114:115], v[114:115], s[80:81]
  v_pk_add_f32 v[116:117], v[116:117], s[80:81]
  v_pk_add_f32 v[118:119], v[118:119], s[80:81]
  buffer_load_dword v214, v209, s[16:19], s83 offen offset:8 sc1
  v_rcp_f32 v112, v112
  v_rcp_f32 v113, v113
  v_rcp_f32 v114, v114
  v_rcp_f32 v115, v115
  v_rcp_f32 v116, v116
  v_rcp_f32 v117, v117
  v_rcp_f32 v118, v118
  v_rcp_f32 v119, v119
  v_pk_mul_f32 v[32:33], v[32:33], v[112:113]
  v_pk_mul_f32 v[34:35], v[34:35], v[114:115]
  v_pk_mul_f32 v[36:37], v[36:37], v[116:117]
  v_pk_mul_f32 v[38:39], v[38:39], v[118:119]
  buffer_load_dword v215, v209, s[16:19], s83 offen offset:40 sc1
  v_pk_add_f32 v[120:121], v[120:121], v[32:33]
  v_pk_add_f32 v[124:125], v[124:125], v[34:35]
  v_pk_add_f32 v[128:129], v[128:129], v[36:37]
  v_pk_add_f32 v[132:133], v[132:133], v[38:39]
  v_pk_fma_f32 v[122:123], v[32:33], v[32:33], v[122:123]
  v_pk_fma_f32 v[126:127], v[34:35], v[34:35], v[126:127]
  v_pk_fma_f32 v[130:131], v[36:37], v[36:37], v[130:131]
  v_pk_fma_f32 v[134:135], v[38:39], v[38:39], v[134:135]
  v_pk_fma_f32 v[40:41], v[80:81], v[238:239], v[40:41] op_sel:[0,1,0] op_sel_hi:[1,1,1] neg_lo:[1,0,0] neg_hi:[1,0,0]
  v_pk_fma_f32 v[42:43], v[84:85], v[238:239], v[42:43] op_sel:[0,1,0] op_sel_hi:[1,1,1] neg_lo:[1,0,0] neg_hi:[1,0,0]
  v_pk_fma_f32 v[44:45], v[88:89], v[238:239], v[44:45] op_sel:[0,1,0] op_sel_hi:[1,1,1] neg_lo:[1,0,0] neg_hi:[1,0,0]
  v_pk_fma_f32 v[46:47], v[92:93], v[238:239], v[46:47] op_sel:[0,1,0] op_sel_hi:[1,1,1] neg_lo:[1,0,0] neg_hi:[1,0,0]
  buffer_load_dword v212, v209, s[16:19], s83 offen offset:0 sc1
  v_pk_mul_f32 v[112:113], v[40:41], v[40:41]
  v_pk_mul_f32 v[114:115], v[42:43], v[42:43]
  v_pk_mul_f32 v[116:117], v[44:45], v[44:45]
  v_pk_mul_f32 v[118:119], v[46:47], v[46:47]
  v_pk_fma_f32 v[112:113], v[112:113], v[104:105], v[96:97]
  v_pk_fma_f32 v[114:115], v[114:115], v[106:107], v[98:99]
  v_pk_fma_f32 v[116:117], v[116:117], v[108:109], v[100:101]
  v_pk_fma_f32 v[118:119], v[118:119], v[110:111], v[102:103]
  v_pk_mul_f32 v[112:113], v[112:113], v[40:41]
  v_pk_mul_f32 v[114:115], v[114:115], v[42:43]
  v_pk_mul_f32 v[116:117], v[116:117], v[44:45]
  v_pk_mul_f32 v[118:119], v[118:119], v[46:47]
  buffer_load_dword v213, v209, s[16:19], s83 offen offset:32 sc1
  v_exp_f32 v112, v112
  v_exp_f32 v113, v113
  v_exp_f32 v114, v114
  v_exp_f32 v115, v115
  v_exp_f32 v116, v116
  v_exp_f32 v117, v117
  v_exp_f32 v118, v118
  v_exp_f32 v119, v119
  v_pk_add_f32 v[112:113], v[112:113], s[80:81]
  v_pk_add_f32 v[114:115], v[114:115], s[80:81]
  v_pk_add_f32 v[116:117], v[116:117], s[80:81]
  v_pk_add_f32 v[118:119], v[118:119], s[80:81]
  v_rcp_f32 v112, v112
  v_rcp_f32 v113, v113
  v_rcp_f32 v114, v114
  v_rcp_f32 v115, v115
  v_rcp_f32 v116, v116
  v_rcp_f32 v117, v117
  v_rcp_f32 v118, v118
  v_rcp_f32 v119, v119
  v_pk_mul_f32 v[40:41], v[40:41], v[112:113]
  v_pk_mul_f32 v[42:43], v[42:43], v[114:115]
  v_pk_mul_f32 v[44:45], v[44:45], v[116:117]
  v_pk_mul_f32 v[46:47], v[46:47], v[118:119]
  v_pk_add_f32 v[120:121], v[120:121], v[40:41]
  v_pk_add_f32 v[124:125], v[124:125], v[42:43]
  v_pk_add_f32 v[128:129], v[128:129], v[44:45]
  v_pk_add_f32 v[132:133], v[132:133], v[46:47]
  v_pk_fma_f32 v[122:123], v[40:41], v[40:41], v[122:123]
  v_pk_fma_f32 v[126:127], v[42:43], v[42:43], v[126:127]
  v_pk_fma_f32 v[130:131], v[44:45], v[44:45], v[130:131]
  v_pk_fma_f32 v[134:135], v[46:47], v[46:47], v[134:135]
  v_pk_fma_f32 v[48:49], v[80:81], v[240:241], v[48:49] op_sel:[0,0,0] op_sel_hi:[1,0,1] neg_lo:[1,0,0] neg_hi:[1,0,0]
  v_pk_fma_f32 v[50:51], v[84:85], v[240:241], v[50:51] op_sel:[0,0,0] op_sel_hi:[1,0,1] neg_lo:[1,0,0] neg_hi:[1,0,0]
  v_pk_fma_f32 v[52:53], v[88:89], v[240:241], v[52:53] op_sel:[0,0,0] op_sel_hi:[1,0,1] neg_lo:[1,0,0] neg_hi:[1,0,0]
  v_pk_fma_f32 v[54:55], v[92:93], v[240:241], v[54:55] op_sel:[0,0,0] op_sel_hi:[1,0,1] neg_lo:[1,0,0] neg_hi:[1,0,0]
  v_pk_mul_f32 v[112:113], v[48:49], v[48:49]
  v_pk_mul_f32 v[114:115], v[50:51], v[50:51]
  v_pk_mul_f32 v[116:117], v[52:53], v[52:53]
  v_pk_mul_f32 v[118:119], v[54:55], v[54:55]
  v_pk_fma_f32 v[112:113], v[112:113], v[104:105], v[96:97]
  v_pk_fma_f32 v[114:115], v[114:115], v[106:107], v[98:99]
  v_pk_fma_f32 v[116:117], v[116:117], v[108:109], v[100:101]
  v_pk_fma_f32 v[118:119], v[118:119], v[110:111], v[102:103]
  v_pk_mul_f32 v[112:113], v[112:113], v[48:49]
  v_pk_mul_f32 v[114:115], v[114:115], v[50:51]
  v_pk_mul_f32 v[116:117], v[116:117], v[52:53]
  v_pk_mul_f32 v[118:119], v[118:119], v[54:55]
  v_exp_f32 v112, v112
  v_exp_f32 v113, v113
  v_exp_f32 v114, v114
  v_exp_f32 v115, v115
  v_exp_f32 v116, v116
  v_exp_f32 v117, v117
  v_exp_f32 v118, v118
  v_exp_f32 v119, v119
  v_pk_add_f32 v[112:113], v[112:113], s[80:81]
  v_pk_add_f32 v[114:115], v[114:115], s[80:81]
  v_pk_add_f32 v[116:117], v[116:117], s[80:81]
  v_pk_add_f32 v[118:119], v[118:119], s[80:81]
  v_rcp_f32 v112, v112
  v_rcp_f32 v113, v113
  v_rcp_f32 v114, v114
  v_rcp_f32 v115, v115
  v_rcp_f32 v116, v116
  v_rcp_f32 v117, v117
  v_rcp_f32 v118, v118
  v_rcp_f32 v119, v119
  v_pk_mul_f32 v[48:49], v[48:49], v[112:113]
  v_pk_mul_f32 v[50:51], v[50:51], v[114:115]
  v_pk_mul_f32 v[52:53], v[52:53], v[116:117]
  v_pk_mul_f32 v[54:55], v[54:55], v[118:119]
  v_pk_add_f32 v[120:121], v[120:121], v[48:49]
  v_pk_add_f32 v[124:125], v[124:125], v[50:51]
  v_pk_add_f32 v[128:129], v[128:129], v[52:53]
  v_pk_add_f32 v[132:133], v[132:133], v[54:55]
  v_pk_fma_f32 v[122:123], v[48:49], v[48:49], v[122:123]
  v_pk_fma_f32 v[126:127], v[50:51], v[50:51], v[126:127]
  v_pk_fma_f32 v[130:131], v[52:53], v[52:53], v[130:131]
  v_pk_fma_f32 v[134:135], v[54:55], v[54:55], v[134:135]
  v_pk_fma_f32 v[56:57], v[80:81], v[240:241], v[56:57] op_sel:[0,1,0] op_sel_hi:[1,1,1] neg_lo:[1,0,0] neg_hi:[1,0,0]
  v_pk_fma_f32 v[58:59], v[84:85], v[240:241], v[58:59] op_sel:[0,1,0] op_sel_hi:[1,1,1] neg_lo:[1,0,0] neg_hi:[1,0,0]
  v_pk_fma_f32 v[60:61], v[88:89], v[240:241], v[60:61] op_sel:[0,1,0] op_sel_hi:[1,1,1] neg_lo:[1,0,0] neg_hi:[1,0,0]
  v_pk_fma_f32 v[62:63], v[92:93], v[240:241], v[62:63] op_sel:[0,1,0] op_sel_hi:[1,1,1] neg_lo:[1,0,0] neg_hi:[1,0,0]
  v_pk_mul_f32 v[112:113], v[56:57], v[56:57]
  v_pk_mul_f32 v[114:115], v[58:59], v[58:59]
  v_pk_mul_f32 v[116:117], v[60:61], v[60:61]
  v_pk_mul_f32 v[118:119], v[62:63], v[62:63]
  v_pk_fma_f32 v[112:113], v[112:113], v[104:105], v[96:97]
  v_pk_fma_f32 v[114:115], v[114:115], v[106:107], v[98:99]
  v_pk_fma_f32 v[116:117], v[116:117], v[108:109], v[100:101]
  v_pk_fma_f32 v[118:119], v[118:119], v[110:111], v[102:103]
  v_pk_mul_f32 v[112:113], v[112:113], v[56:57]
  v_pk_mul_f32 v[114:115], v[114:115], v[58:59]
  v_pk_mul_f32 v[116:117], v[116:117], v[60:61]
  v_pk_mul_f32 v[118:119], v[118:119], v[62:63]
  v_exp_f32 v112, v112
  v_exp_f32 v113, v113
  v_exp_f32 v114, v114
  v_exp_f32 v115, v115
  v_exp_f32 v116, v116
  v_exp_f32 v117, v117
  v_exp_f32 v118, v118
  v_exp_f32 v119, v119
  v_pk_add_f32 v[112:113], v[112:113], s[80:81]
  v_pk_add_f32 v[114:115], v[114:115], s[80:81]
  v_pk_add_f32 v[116:117], v[116:117], s[80:81]
  v_pk_add_f32 v[118:119], v[118:119], s[80:81]
  v_rcp_f32 v112, v112
  v_rcp_f32 v113, v113
  v_rcp_f32 v114, v114
  v_rcp_f32 v115, v115
  v_rcp_f32 v116, v116
  v_rcp_f32 v117, v117
  v_rcp_f32 v118, v118
  v_rcp_f32 v119, v119
  v_pk_mul_f32 v[56:57], v[56:57], v[112:113]
  v_pk_mul_f32 v[58:59], v[58:59], v[114:115]
  v_pk_mul_f32 v[60:61], v[60:61], v[116:117]
  v_pk_mul_f32 v[62:63], v[62:63], v[118:119]
  v_pk_add_f32 v[120:121], v[120:121], v[56:57]
  v_pk_add_f32 v[124:125], v[124:125], v[58:59]
  v_pk_add_f32 v[128:129], v[128:129], v[60:61]
  v_pk_add_f32 v[132:133], v[132:133], v[62:63]
  v_pk_fma_f32 v[122:123], v[56:57], v[56:57], v[122:123]
  v_pk_fma_f32 v[126:127], v[58:59], v[58:59], v[126:127]
  v_pk_fma_f32 v[130:131], v[60:61], v[60:61], v[130:131]
  v_pk_fma_f32 v[134:135], v[62:63], v[62:63], v[134:135]
  v_pk_fma_f32 v[64:65], v[80:81], v[242:243], v[64:65] op_sel:[0,0,0] op_sel_hi:[1,0,1] neg_lo:[1,0,0] neg_hi:[1,0,0]
  v_pk_fma_f32 v[66:67], v[84:85], v[242:243], v[66:67] op_sel:[0,0,0] op_sel_hi:[1,0,1] neg_lo:[1,0,0] neg_hi:[1,0,0]
  v_pk_fma_f32 v[68:69], v[88:89], v[242:243], v[68:69] op_sel:[0,0,0] op_sel_hi:[1,0,1] neg_lo:[1,0,0] neg_hi:[1,0,0]
  v_pk_fma_f32 v[70:71], v[92:93], v[242:243], v[70:71] op_sel:[0,0,0] op_sel_hi:[1,0,1] neg_lo:[1,0,0] neg_hi:[1,0,0]
  v_pk_mul_f32 v[112:113], v[64:65], v[64:65]
  v_pk_mul_f32 v[114:115], v[66:67], v[66:67]
  v_pk_mul_f32 v[116:117], v[68:69], v[68:69]
  v_pk_mul_f32 v[118:119], v[70:71], v[70:71]
  v_pk_fma_f32 v[112:113], v[112:113], v[104:105], v[96:97]
  v_pk_fma_f32 v[114:115], v[114:115], v[106:107], v[98:99]
  v_pk_fma_f32 v[116:117], v[116:117], v[108:109], v[100:101]
  v_pk_fma_f32 v[118:119], v[118:119], v[110:111], v[102:103]
  v_pk_mul_f32 v[112:113], v[112:113], v[64:65]
  v_pk_mul_f32 v[114:115], v[114:115], v[66:67]
  v_pk_mul_f32 v[116:117], v[116:117], v[68:69]
  v_pk_mul_f32 v[118:119], v[118:119], v[70:71]
  v_exp_f32 v112, v112
  v_exp_f32 v113, v113
  v_exp_f32 v114, v114
  v_exp_f32 v115, v115
  v_exp_f32 v116, v116
  v_exp_f32 v117, v117
  v_exp_f32 v118, v118
  v_exp_f32 v119, v119
  v_pk_add_f32 v[112:113], v[112:113], s[80:81]
  v_pk_add_f32 v[114:115], v[114:115], s[80:81]
  v_pk_add_f32 v[116:117], v[116:117], s[80:81]
  v_pk_add_f32 v[118:119], v[118:119], s[80:81]
  v_rcp_f32 v112, v112
  v_rcp_f32 v113, v113
  v_rcp_f32 v114, v114
  v_rcp_f32 v115, v115
  v_rcp_f32 v116, v116
  s_branch parallel_sum__ssm_conv_h3__mixer_gmlp__prompt_kernel_ps3
parallel_sum__ssm_conv_h3__mixer_gmlp__prompt_kernel_pg3:
  s_branch parallel_sum__ssm_conv_h3__mixer_gmlp__prompt_kernel_pg7
parallel_sum__ssm_conv_h3__mixer_gmlp__prompt_kernel_ps3:
  v_rcp_f32 v117, v117
  v_rcp_f32 v118, v118
  v_rcp_f32 v119, v119
  v_pk_mul_f32 v[64:65], v[64:65], v[112:113]
  v_pk_mul_f32 v[66:67], v[66:67], v[114:115]
  v_pk_mul_f32 v[68:69], v[68:69], v[116:117]
  v_pk_mul_f32 v[70:71], v[70:71], v[118:119]
  v_pk_add_f32 v[120:121], v[120:121], v[64:65]
  v_pk_add_f32 v[124:125], v[124:125], v[66:67]
  v_pk_add_f32 v[128:129], v[128:129], v[68:69]
  v_pk_add_f32 v[132:133], v[132:133], v[70:71]
  v_pk_fma_f32 v[122:123], v[64:65], v[64:65], v[122:123]
  v_pk_fma_f32 v[126:127], v[66:67], v[66:67], v[126:127]
  v_pk_fma_f32 v[130:131], v[68:69], v[68:69], v[130:131]
  v_pk_fma_f32 v[134:135], v[70:71], v[70:71], v[134:135]
  v_pk_fma_f32 v[72:73], v[80:81], v[242:243], v[72:73] op_sel:[0,1,0] op_sel_hi:[1,1,1] neg_lo:[1,0,0] neg_hi:[1,0,0]
  v_pk_fma_f32 v[74:75], v[84:85], v[242:243], v[74:75] op_sel:[0,1,0] op_sel_hi:[1,1,1] neg_lo:[1,0,0] neg_hi:[1,0,0]
  v_pk_fma_f32 v[76:77], v[88:89], v[242:243], v[76:77] op_sel:[0,1,0] op_sel_hi:[1,1,1] neg_lo:[1,0,0] neg_hi:[1,0,0]
  v_pk_fma_f32 v[78:79], v[92:93], v[242:243], v[78:79] op_sel:[0,1,0] op_sel_hi:[1,1,1] neg_lo:[1,0,0] neg_hi:[1,0,0]
  v_pk_mul_f32 v[112:113], v[72:73], v[72:73]
  v_pk_mul_f32 v[114:115], v[74:75], v[74:75]
  v_pk_mul_f32 v[116:117], v[76:77], v[76:77]
  v_pk_mul_f32 v[118:119], v[78:79], v[78:79]
  v_pk_fma_f32 v[112:113], v[112:113], v[104:105], v[96:97]
  v_pk_fma_f32 v[114:115], v[114:115], v[106:107], v[98:99]
  v_pk_fma_f32 v[116:117], v[116:117], v[108:109], v[100:101]
  v_pk_fma_f32 v[118:119], v[118:119], v[110:111], v[102:103]
  v_pk_mul_f32 v[112:113], v[112:113], v[72:73]
  v_pk_mul_f32 v[114:115], v[114:115], v[74:75]
  v_pk_mul_f32 v[116:117], v[116:117], v[76:77]
  v_pk_mul_f32 v[118:119], v[118:119], v[78:79]
  v_exp_f32 v112, v112
  v_exp_f32 v113, v113
  v_exp_f32 v114, v114
  v_exp_f32 v115, v115
  v_exp_f32 v116, v116
  v_exp_f32 v117, v117
  v_exp_f32 v118, v118
  v_exp_f32 v119, v119
  v_pk_add_f32 v[112:113], v[112:113], s[80:81]
  v_pk_add_f32 v[114:115], v[114:115], s[80:81]
  v_pk_add_f32 v[116:117], v[116:117], s[80:81]
  v_pk_add_f32 v[118:119], v[118:119], s[80:81]
  v_rcp_f32 v112, v112
  v_rcp_f32 v113, v113
  v_rcp_f32 v114, v114
  v_rcp_f32 v115, v115
  v_rcp_f32 v116, v116
  v_rcp_f32 v117, v117
  v_rcp_f32 v118, v118
  v_rcp_f32 v119, v119
  v_pk_mul_f32 v[72:73], v[72:73], v[112:113]
  v_pk_mul_f32 v[74:75], v[74:75], v[114:115]
  v_pk_mul_f32 v[76:77], v[76:77], v[116:117]
  v_pk_mul_f32 v[78:79], v[78:79], v[118:119]
  v_pk_add_f32 v[120:121], v[120:121], v[72:73]
  v_pk_add_f32 v[124:125], v[124:125], v[74:75]
  v_pk_add_f32 v[128:129], v[128:129], v[76:77]
  v_pk_add_f32 v[132:133], v[132:133], v[78:79]
  v_pk_fma_f32 v[122:123], v[72:73], v[72:73], v[122:123]
  v_pk_fma_f32 v[126:127], v[74:75], v[74:75], v[126:127]
  v_pk_fma_f32 v[130:131], v[76:77], v[76:77], v[130:131]
  v_pk_fma_f32 v[134:135], v[78:79], v[78:79], v[134:135]
  v_add_f32_dpp v120, v120, v120 row_ror:8 row_mask:0xf bank_mask:0x3
  v_add_f32_dpp v121, v121, v121 row_ror:8 row_mask:0xf bank_mask:0x3
  v_add_f32_dpp v122, v122, v122 row_ror:8 row_mask:0xf bank_mask:0x3
  v_add_f32_dpp v123, v123, v123 row_ror:8 row_mask:0xf bank_mask:0x3
  v_add_f32_dpp v124, v124, v124 row_ror:8 row_mask:0xf bank_mask:0x3
  v_add_f32_dpp v125, v125, v125 row_ror:8 row_mask:0xf bank_mask:0x3
  v_add_f32_dpp v126, v126, v126 row_ror:8 row_mask:0xf bank_mask:0x3
  v_add_f32_dpp v127, v127, v127 row_ror:8 row_mask:0xf bank_mask:0x3
  v_add_f32_dpp v120, v128, v128 row_ror:8 row_mask:0xf bank_mask:0xc
  v_add_f32_dpp v121, v129, v129 row_ror:8 row_mask:0xf bank_mask:0xc
  v_add_f32_dpp v122, v130, v130 row_ror:8 row_mask:0xf bank_mask:0xc
  v_add_f32_dpp v123, v131, v131 row_ror:8 row_mask:0xf bank_mask:0xc
  v_add_f32_dpp v124, v132, v132 row_ror:8 row_mask:0xf bank_mask:0xc
  v_add_f32_dpp v125, v133, v133 row_ror:8 row_mask:0xf bank_mask:0xc
  v_add_f32_dpp v126, v134, v134 row_ror:8 row_mask:0xf bank_mask:0xc
  v_add_f32_dpp v127, v135, v135 row_ror:8 row_mask:0xf bank_mask:0xc
  v_add_f32_dpp v120, v120, v120 row_half_mirror row_mask:0xf bank_mask:0x5
  v_add_f32_dpp v121, v121, v121 row_half_mirror row_mask:0xf bank_mask:0x5
  v_add_f32_dpp v122, v122, v122 row_half_mirror row_mask:0xf bank_mask:0x5
  v_add_f32_dpp v123, v123, v123 row_half_mirror row_mask:0xf bank_mask:0x5
  v_add_f32_dpp v120, v124, v124 row_half_mirror row_mask:0xf bank_mask:0xa
  v_add_f32_dpp v121, v125, v125 row_half_mirror row_mask:0xf bank_mask:0xa
  v_add_f32_dpp v122, v126, v126 row_half_mirror row_mask:0xf bank_mask:0xa
  v_add_f32_dpp v123, v127, v127 row_half_mirror row_mask:0xf bank_mask:0xa
  v_add_f32_dpp v120, v120, v120 quad_perm:[1,0,3,2] row_mask:0xf bank_mask:0xf
  v_add_f32_dpp v121, v121, v121 quad_perm:[1,0,3,2] row_mask:0xf bank_mask:0xf
  v_add_f32_dpp v122, v122, v122 quad_perm:[1,0,3,2] row_mask:0xf bank_mask:0xf
  v_add_f32_dpp v123, v123, v123 quad_perm:[1,0,3,2] row_mask:0xf bank_mask:0xf
  v_add_f32_dpp v120, v120, v120 quad_perm:[2,3,0,1] row_mask:0xf bank_mask:0xf
  v_add_f32_dpp v121, v121, v121 quad_perm:[2,3,0,1] row_mask:0xf bank_mask:0xf
  v_add_f32_dpp v122, v122, v122 quad_perm:[2,3,0,1] row_mask:0xf bank_mask:0xf
  v_add_f32_dpp v123, v123, v123 quad_perm:[2,3,0,1] row_mask:0xf bank_mask:0xf
  v_perm_b32 v120, v120, v13, s76
  v_perm_b32 v121, v121, v13, s77
  v_perm_b32 v122, v122, v13, s78
  v_perm_b32 v123, v123, v13, s79
  v_lshlrev_b32_e64 v3, 10, v2
  v_lshl_add_u32 v3, v1, 2, v3
  s_mov_b32 exec_lo, 0x11111111
  s_mov_b32 exec_hi, 0x11111111
  buffer_store_dwordx4 v[120:123], v3, s[16:19], s84 offen sc1
  s_mov_b64 exec, -1
  s_waitcnt lgkmcnt(6)
  v_mfma_f32_16x16x32_bf16 v[80:83], v[144:147], a[0:3], 0
  ds_read_b64_tr_b16 v[160:161], v232 offset:4096
  ds_read_b64_tr_b16 v[162:163], v232 offset:6144
  v_add_u32 v210, 0x10000, v208
  v_mfma_f32_16x16x32_bf16 v[84:87], v[144:147], a[4:7], 0
  s_waitcnt lgkmcnt(6)
  ds_read_b64_tr_b16 v[164:165], v233 offset:4096
  ds_read_b64_tr_b16 v[166:167], v233 offset:6144
  v_mfma_f32_16x16x32_bf16 v[88:91], v[148:151], a[0:3], 0
  ds_read_b64_tr_b16 v[168:169], v234 offset:4096
  ds_read_b64_tr_b16 v[170:171], v234 offset:6144
  v_mfma_f32_16x16x32_bf16 v[92:95], v[148:151], a[4:7], 0
  s_waitcnt lgkmcnt(8)
  ds_read_b64_tr_b16 v[172:173], v235 offset:4096
  ds_read_b64_tr_b16 v[174:175], v235 offset:6144
  v_mfma_f32_16x16x32_bf16 v[96:99], v[152:155], a[0:3], 0
  s_add_u32 m0, s68, 12288
  ds_read_b64_tr_b16 v[176:177], v232 offset:8192
  ds_read_b64_tr_b16 v[178:179], v232 offset:10240
  v_mfma_f32_16x16x32_bf16 v[100:103], v[152:155], a[4:7], 0
  s_waitcnt lgkmcnt(10)
  ds_read_b64_tr_b16 v[180:181], v233 offset:8192
  ds_read_b64_tr_b16 v[182:183], v233 offset:10240
  v_mfma_f32_16x16x32_bf16 v[104:107], v[156:159], a[0:3], 0
  ds_read_b64_tr_b16 v[184:185], v234 offset:8192
  ds_read_b64_tr_b16 v[186:187], v234 offset:10240
  v_mfma_f32_16x16x32_bf16 v[108:111], v[156:159], a[4:7], 0
  s_waitcnt lgkmcnt(10)
  ds_read_b64_tr_b16 v[188:189], v235 offset:8192
  ds_read_b64_tr_b16 v[190:191], v235 offset:10240
  v_mfma_f32_16x16x32_bf16 v[112:115], v[160:163], a[0:3], 0
  ds_read_b64_tr_b16 v[192:193], v232 offset:12288
  ds_read_b64_tr_b16 v[194:195], v232 offset:14336
  v_mfma_f32_16x16x32_bf16 v[116:119], v[160:163], a[4:7], 0
  buffer_load_dwordx4 v216, s[40:43], s73 offen offset:0 lds
  ds_read_b64_tr_b16 v[196:197], v233 offset:12288
  v_mfma_f32_16x16x32_bf16 v[120:123], v[164:167], a[0:3], 0
  ds_read_b64_tr_b16 v[198:199], v233 offset:14336
  v_mfma_f32_16x16x32_bf16 v[124:127], v[164:167], a[4:7], 0
  s_waitcnt lgkmcnt(8)
  ds_read_b64_tr_b16 v[200:201], v234 offset:12288
  v_mfma_f32_16x16x32_bf16 v[128:131], v[168:171], a[0:3], 0
  ds_read_b64_tr_b16 v[202:203], v234 offset:14336
  v_mfma_f32_16x16x32_bf16 v[132:135], v[168:171], a[4:7], 0
  buffer_load_dwordx4 v217, s[40:43], s73 offen offset:1024 lds
  v_mfma_f32_16x16x32_bf16 v[136:139], v[172:175], a[0:3], 0
  ds_read_b64_tr_b16 v[204:205], v235 offset:12288
  v_mfma_f32_16x16x32_bf16 v[140:143], v[172:175], a[4:7], 0
  ds_read_b64_tr_b16 v[206:207], v235 offset:14336
  v_mfma_f32_16x16x32_bf16 v[80:83], v[176:179], a[8:11], v[80:83]
  ds_read_b64_tr_b16 v[144:145], v232 offset:16384
  v_mfma_f32_16x16x32_bf16 v[84:87], v[176:179], a[12:15], v[84:87]
  buffer_load_dwordx4 v218, s[40:43], s73 offen offset:2048 lds
  v_mfma_f32_16x16x32_bf16 v[88:91], v[180:183], a[8:11], v[88:91]
  ds_read_b64_tr_b16 v[146:147], v232 offset:18432
  v_mfma_f32_16x16x32_bf16 v[92:95], v[180:183], a[12:15], v[92:95]
  s_waitcnt lgkmcnt(4)
  ds_read_b64_tr_b16 v[148:149], v233 offset:16384
  v_mfma_f32_16x16x32_bf16 v[96:99], v[184:187], a[8:11], v[96:99]
  ds_read_b64_tr_b16 v[150:151], v233 offset:18432
  v_mfma_f32_16x16x32_bf16 v[100:103], v[184:187], a[12:15], v[100:103]
  ds_read_b64_tr_b16 v[152:153], v234 offset:16384
  v_mfma_f32_16x16x32_bf16 v[104:107], v[188:191], a[8:11], v[104:107]
  buffer_load_dwordx4 v219, s[40:43], s73 offen offset:3072 lds
  v_mfma_f32_16x16x32_bf16 v[108:111], v[188:191], a[12:15], v[108:111]
  ds_read_b64_tr_b16 v[154:155], v234 offset:18432
  v_mfma_f32_16x16x32_bf16 v[112:115], v[192:195], a[8:11], v[112:115]
  ds_read_b64_tr_b16 v[156:157], v235 offset:16384
  s_bfe_u32 s72, s0, 0x40008
  v_mfma_f32_16x16x32_bf16 v[116:119], v[192:195], a[12:15], v[116:119]
  ds_read_b64_tr_b16 v[158:159], v235 offset:18432
  v_mfma_f32_16x16x32_bf16 v[120:123], v[196:199], a[8:11], v[120:123]
  ds_read_b64_tr_b16 v[160:161], v232 offset:20480
  v_mfma_f32_16x16x32_bf16 v[124:127], v[196:199], a[12:15], v[124:127]
  ds_read_b64_tr_b16 v[162:163], v232 offset:22528
  v_mfma_f32_16x16x32_bf16 v[128:131], v[200:203], a[8:11], v[128:131]
  ds_read_b64_tr_b16 v[164:165], v233 offset:20480
  s_lshl_b32 s72, s72, 8
  v_mfma_f32_16x16x32_bf16 v[132:135], v[200:203], a[12:15], v[132:135]
  s_waitcnt lgkmcnt(5)
  ds_read_b64_tr_b16 v[166:167], v233 offset:22528
  v_mfma_f32_16x16x32_bf16 v[136:139], v[204:207], a[8:11], v[136:139]
  ds_read_b64_tr_b16 v[168:169], v234 offset:20480
  v_mfma_f32_16x16x32_bf16 v[140:143], v[204:207], a[12:15], v[140:143]
  ds_read_b64_tr_b16 v[170:171], v234 offset:22528
  v_mfma_f32_16x16x32_bf16 v[80:83], v[144:147], a[16:19], v[80:83]
  ds_read_b64_tr_b16 v[172:173], v235 offset:20480
  v_mfma_f32_16x16x32_bf16 v[84:87], v[144:147], a[20:23], v[84:87]
  ds_read_b64_tr_b16 v[174:175], v235 offset:22528
  v_mfma_f32_16x16x32_bf16 v[88:91], v[148:151], a[16:19], v[88:91]
  ds_read_b64_tr_b16 v[176:177], v232 offset:24576
  v_mfma_f32_16x16x32_bf16 v[92:95], v[148:151], a[20:23], v[92:95]
  ds_read_b64_tr_b16 v[178:179], v232 offset:26624
  v_mfma_f32_16x16x32_bf16 v[96:99], v[152:155], a[16:19], v[96:99]
  ds_read_b64_tr_b16 v[180:181], v233 offset:24576
  v_mfma_f32_16x16x32_bf16 v[100:103], v[152:155], a[20:23], v[100:103]
  s_waitcnt lgkmcnt(5)
  ds_read_b64_tr_b16 v[182:183], v233 offset:26624
  v_mfma_f32_16x16x32_bf16 v[104:107], v[156:159], a[16:19], v[104:107]
  ds_read_b64_tr_b16 v[184:185], v234 offset:24576
  v_mfma_f32_16x16x32_bf16 v[108:111], v[156:159], a[20:23], v[108:111]
  ds_read_b64_tr_b16 v[186:187], v234 offset:26624
  v_mfma_f32_16x16x32_bf16 v[112:115], v[160:163], a[16:19], v[112:115]
  ds_read_b64_tr_b16 v[188:189], v235 offset:24576
  v_mfma_f32_16x16x32_bf16 v[116:119], v[160:163], a[20:23], v[116:119]
  ds_read_b64_tr_b16 v[190:191], v235 offset:26624
  v_mfma_f32_16x16x32_bf16 v[120:123], v[164:167], a[16:19], v[120:123]
  ds_read_b64_tr_b16 v[192:193], v232 offset:28672
  v_mfma_f32_16x16x32_bf16 v[124:127], v[164:167], a[20:23], v[124:127]
  ds_read_b64_tr_b16 v[194:195], v232 offset:30720
  v_mfma_f32_16x16x32_bf16 v[128:131], v[168:171], a[16:19], v[128:131]
  ds_read_b64_tr_b16 v[196:197], v233 offset:28672
  v_mfma_f32_16x16x32_bf16 v[132:135], v[168:171], a[20:23], v[132:135]
  s_waitcnt lgkmcnt(5)
  ds_read_b64_tr_b16 v[198:199], v233 offset:30720
  v_mfma_f32_16x16x32_bf16 v[136:139], v[172:175], a[16:19], v[136:139]
  ds_read_b64_tr_b16 v[200:201], v234 offset:28672
  v_mfma_f32_16x16x32_bf16 v[140:143], v[172:175], a[20:23], v[140:143]
  ds_read_b64_tr_b16 v[202:203], v234 offset:30720
  v_mfma_f32_16x16x32_bf16 v[80:83], v[176:179], a[24:27], v[80:83]
  ds_read_b64_tr_b16 v[204:205], v235 offset:28672
  v_mfma_f32_16x16x32_bf16 v[84:87], v[176:179], a[28:31], v[84:87]
  ds_read_b64_tr_b16 v[206:207], v235 offset:30720
  v_mfma_f32_16x16x32_bf16 v[88:91], v[180:183], a[24:27], v[88:91]
  v_mfma_f32_16x16x32_bf16 v[92:95], v[180:183], a[28:31], v[92:95]
  v_mfma_f32_16x16x32_bf16 v[96:99], v[184:187], a[24:27], v[96:99]
  v_mfma_f32_16x16x32_bf16 v[100:103], v[184:187], a[28:31], v[100:103]
  s_waitcnt lgkmcnt(2)
  v_mfma_f32_16x16x32_bf16 v[104:107], v[188:191], a[24:27], v[104:107]
  v_mfma_f32_16x16x32_bf16 v[108:111], v[188:191], a[28:31], v[108:111]
  v_mfma_f32_16x16x32_bf16 v[112:115], v[192:195], a[24:27], v[112:115]
  s_waitcnt vmcnt(26) lgkmcnt(0)
  s_barrier
  ds_read_b64_tr_b16 v[144:145], v228 offset:0
  v_mfma_f32_16x16x32_bf16 v[116:119], v[192:195], a[28:31], v[116:119]
  s_add_u32 m0, s69, 65536
  ds_read_b64_tr_b16 v[146:147], v228 offset:2048
  ds_read_b64_tr_b16 v[148:149], v229 offset:0
  v_mfma_f32_16x16x32_bf16 v[120:123], v[196:199], a[24:27], v[120:123]
  ds_read_b64_tr_b16 v[150:151], v229 offset:2048
  ds_read_b64_tr_b16 v[152:153], v230 offset:0
  v_mfma_f32_16x16x32_bf16 v[124:127], v[196:199], a[28:31], v[124:127]
  ds_read_b64_tr_b16 v[154:155], v230 offset:2048
  ds_read_b64_tr_b16 v[156:157], v231 offset:0
  v_mfma_f32_16x16x32_bf16 v[128:131], v[200:203], a[24:27], v[128:131]
  ds_read_b64_tr_b16 v[158:159], v231 offset:2048
  ds_read_b64_tr_b16 v[160:161], v228 offset:4096
  v_mfma_f32_16x16x32_bf16 v[132:135], v[200:203], a[28:31], v[132:135]
  ds_read_b64_tr_b16 v[162:163], v228 offset:6144
  ds_read_b64_tr_b16 v[164:165], v229 offset:4096
  v_mfma_f32_16x16x32_bf16 v[136:139], v[204:207], a[24:27], v[136:139]
  ds_read_b64_tr_b16 v[166:167], v229 offset:6144
  ds_read_b64_tr_b16 v[168:169], v230 offset:4096
  v_mfma_f32_16x16x32_bf16 v[140:143], v[204:207], a[28:31], v[140:143]
  s_waitcnt lgkmcnt(10)
  ds_read_b64_tr_b16 v[170:171], v230 offset:6144
  buffer_load_dwordx4 v224, s[12:15], s70 offen offset:0 lds
  v_mfma_f32_16x16x32_bf16 v[80:83], v[144:147], a[32:35], v[80:83]
  ds_read_b64_tr_b16 v[172:173], v231 offset:4096
  ds_read_b64_tr_b16 v[174:175], v231 offset:6144
  v_mfma_f32_16x16x32_bf16 v[84:87], v[144:147], a[36:39], v[84:87]
  s_waitcnt lgkmcnt(9)
  ds_read_b64_tr_b16 v[176:177], v228 offset:8192
  ds_read_b64_tr_b16 v[178:179], v228 offset:10240
  v_mfma_f32_16x16x32_bf16 v[88:91], v[148:151], a[32:35], v[88:91]
  buffer_load_dwordx4 v225, s[12:15], s70 offen offset:1024 lds
  ds_read_b64_tr_b16 v[180:181], v229 offset:8192
  v_mfma_f32_16x16x32_bf16 v[92:95], v[148:151], a[36:39], v[92:95]
  ds_read_b64_tr_b16 v[182:183], v229 offset:10240
  ds_read_b64_tr_b16 v[184:185], v230 offset:8192
  v_mfma_f32_16x16x32_bf16 v[96:99], v[152:155], a[32:35], v[96:99]
  buffer_load_dwordx4 v226, s[12:15], s70 offen offset:2048 lds
  ds_read_b64_tr_b16 v[186:187], v230 offset:10240
  v_mfma_f32_16x16x32_bf16 v[100:103], v[152:155], a[36:39], v[100:103]
  s_waitcnt lgkmcnt(8)
  ds_read_b64_tr_b16 v[188:189], v231 offset:8192
  ds_read_b64_tr_b16 v[190:191], v231 offset:10240
  v_mfma_f32_16x16x32_bf16 v[104:107], v[156:159], a[32:35], v[104:107]
  ds_read_b64_tr_b16 v[192:193], v228 offset:12288
  ds_read_b64_tr_b16 v[194:195], v228 offset:14336
  v_mfma_f32_16x16x32_bf16 v[108:111], v[156:159], a[36:39], v[108:111]
  buffer_load_dwordx4 v227, s[12:15], s70 offen offset:3072 lds
  ds_read_b64_tr_b16 v[196:197], v229 offset:12288
  v_mfma_f32_16x16x32_bf16 v[112:115], v[160:163], a[32:35], v[112:115]
  ds_read_b64_tr_b16 v[198:199], v229 offset:14336
  ds_read_b64_tr_b16 v[200:201], v230 offset:12288
  v_mfma_f32_16x16x32_bf16 v[116:119], v[160:163], a[36:39], v[116:119]
  ds_read_b64_tr_b16 v[202:203], v230 offset:14336
  ds_read_b64_tr_b16 v[204:205], v231 offset:12288
  v_mfma_f32_16x16x32_bf16 v[120:123], v[164:167], a[32:35], v[120:123]
  s_add_u32 m0, s69, 69504
  ds_read_b64_tr_b16 v[206:207], v231 offset:14336
  ds_read_b64_tr_b16 v[144:145], v228 offset:16384
  v_mfma_f32_16x16x32_bf16 v[124:127], v[164:167], a[36:39], v[124:127]
  ds_read_b64_tr_b16 v[146:147], v228 offset:18432
  ds_read_b64_tr_b16 v[148:149], v229 offset:16384
  v_mfma_f32_16x16x32_bf16 v[128:131], v[168:171], a[32:35], v[128:131]
  ds_read_b64_tr_b16 v[150:151], v229 offset:18432
  ds_read_b64_tr_b16 v[152:153], v230 offset:16384
  v_mfma_f32_16x16x32_bf16 v[132:135], v[168:171], a[36:39], v[132:135]
  s_waitcnt lgkmcnt(10)
  ds_read_b64_tr_b16 v[154:155], v230 offset:18432
  ds_read_b64_tr_b16 v[156:157], v231 offset:16384
  v_mfma_f32_16x16x32_bf16 v[136:139], v[172:175], a[32:35], v[136:139]
  buffer_load_dwordx4 v224, s[12:15], s70 offen offset:128 lds
  ds_read_b64_tr_b16 v[158:159], v231 offset:18432
  v_mfma_f32_16x16x32_bf16 v[140:143], v[172:175], a[36:39], v[140:143]
  ds_read_b64_tr_b16 v[160:161], v228 offset:20480
  ds_read_b64_tr_b16 v[162:163], v228 offset:22528
  v_mfma_f32_16x16x32_bf16 v[80:83], v[176:179], a[40:43], v[80:83]
  ds_read_b64_tr_b16 v[164:165], v229 offset:20480
  v_mfma_f32_16x16x32_bf16 v[84:87], v[176:179], a[44:47], v[84:87]
  buffer_load_dwordx4 v225, s[12:15], s70 offen offset:1152 lds
  v_mfma_f32_16x16x32_bf16 v[88:91], v[180:183], a[40:43], v[88:91]
  ds_read_b64_tr_b16 v[166:167], v229 offset:22528
  v_mfma_f32_16x16x32_bf16 v[92:95], v[180:183], a[44:47], v[92:95]
  ds_read_b128 a[0:3], v220 offset:0
  v_mfma_f32_16x16x32_bf16 v[96:99], v[184:187], a[40:43], v[96:99]
  ds_read_b128 a[8:11], v221 offset:0
  v_mfma_f32_16x16x32_bf16 v[100:103], v[184:187], a[44:47], v[100:103]
  ds_read_b128 a[16:19], v222 offset:0
  v_mfma_f32_16x16x32_bf16 v[104:107], v[188:191], a[40:43], v[104:107]
  buffer_load_dwordx4 v226, s[12:15], s70 offen offset:2176 lds
  v_mfma_f32_16x16x32_bf16 v[108:111], v[188:191], a[44:47], v[108:111]
  ds_read_b128 a[24:27], v223 offset:0
  v_mfma_f32_16x16x32_bf16 v[112:115], v[192:195], a[40:43], v[112:115]
  buffer_load_dwordx4 v227, s[12:15], s70 offen offset:3200 lds
  v_mfma_f32_16x16x32_bf16 v[116:119], v[192:195], a[44:47], v[116:119]
  s_waitcnt lgkmcnt(3)
  ds_read_b64_tr_b16 v[168:169], v230 offset:20480
  v_mfma_f32_16x16x32_bf16 v[120:123], v[196:199], a[40:43], v[120:123]
  ds_read_b64_tr_b16 v[170:171], v230 offset:22528
  v_mfma_f32_16x16x32_bf16 v[124:127], v[196:199], a[44:47], v[124:127]
  ds_read_b64_tr_b16 v[172:173], v231 offset:20480
  v_mfma_f32_16x16x32_bf16 v[128:131], v[200:203], a[40:43], v[128:131]
  s_bfe_u32 s70, s71, 0x30010
  ds_read_b64_tr_b16 v[174:175], v231 offset:22528
  v_mfma_f32_16x16x32_bf16 v[132:135], v[200:203], a[44:47], v[132:135]
  ds_read_b64_tr_b16 v[176:177], v228 offset:24576
  v_mfma_f32_16x16x32_bf16 v[136:139], v[204:207], a[40:43], v[136:139]
  ds_read_b64_tr_b16 v[178:179], v228 offset:26624
  v_mfma_f32_16x16x32_bf16 v[140:143], v[204:207], a[44:47], v[140:143]
  s_mul_i32 s70, s70, 917504
  ds_read_b64_tr_b16 v[180:181], v229 offset:24576
  v_mfma_f32_16x16x32_bf16 v[80:83], v[144:147], a[48:51], v[80:83]
  ds_read_b64_tr_b16 v[182:183], v229 offset:26624
  v_mfma_f32_16x16x32_bf16 v[84:87], v[144:147], a[52:55], v[84:87]
  ds_read_b64_tr_b16 v[184:185], v230 offset:24576
  v_mfma_f32_16x16x32_bf16 v[88:91], v[148:151], a[48:51], v[88:91]
  ds_read_b64_tr_b16 v[186:187], v230 offset:26624
  v_mfma_f32_16x16x32_bf16 v[92:95], v[148:151], a[52:55], v[92:95]
  s_waitcnt lgkmcnt(5)
  s_add_u32 m0, s68, 0
  ds_read_b64_tr_b16 v[188:189], v231 offset:24576
  v_mfma_f32_16x16x32_bf16 v[96:99], v[152:155], a[48:51], v[96:99]
  ds_read_b64_tr_b16 v[190:191], v231 offset:26624
  v_mfma_f32_16x16x32_bf16 v[100:103], v[152:155], a[52:55], v[100:103]
  ds_read_b64_tr_b16 v[192:193], v228 offset:28672
  v_mfma_f32_16x16x32_bf16 v[104:107], v[156:159], a[48:51], v[104:107]
  s_add_u32 s73, s72, 16384
  ds_read_b64_tr_b16 v[194:195], v228 offset:30720
  v_mfma_f32_16x16x32_bf16 v[108:111], v[156:159], a[52:55], v[108:111]
  ds_read_b64_tr_b16 v[196:197], v229 offset:28672
  v_mfma_f32_16x16x32_bf16 v[112:115], v[160:163], a[48:51], v[112:115]
  ds_read_b64_tr_b16 v[198:199], v229 offset:30720
  v_mfma_f32_16x16x32_bf16 v[116:119], v[160:163], a[52:55], v[116:119]
  ds_read_b64_tr_b16 v[200:201], v230 offset:28672
  v_mfma_f32_16x16x32_bf16 v[120:123], v[164:167], a[48:51], v[120:123]
  buffer_load_dwordx4 v216, s[40:43], s72 offen offset:0 lds
  v_mfma_f32_16x16x32_bf16 v[124:127], v[164:167], a[52:55], v[124:127]
  ds_read_b64_tr_b16 v[202:203], v230 offset:30720
  v_mfma_f32_16x16x32_bf16 v[128:131], v[168:171], a[48:51], v[128:131]
  ds_read_b64_tr_b16 v[204:205], v231 offset:28672
  v_mfma_f32_16x16x32_bf16 v[132:135], v[168:171], a[52:55], v[132:135]
  buffer_load_dwordx4 v217, s[40:43], s72 offen offset:1024 lds
  v_mfma_f32_16x16x32_bf16 v[136:139], v[172:175], a[48:51], v[136:139]
  buffer_load_dwordx4 v[236:239], v12, s[16:19], s85 offen offset:0 sc1
  v_mfma_f32_16x16x32_bf16 v[140:143], v[172:175], a[52:55], v[140:143]
  s_waitcnt lgkmcnt(2)
  buffer_load_dwordx4 v[240:243], v12, s[16:19], s85 offen offset:256 sc1
  v_mfma_f32_16x16x32_bf16 v[80:83], v[176:179], a[56:59], v[80:83]
  ds_read_b64_tr_b16 v[206:207], v231 offset:30720
  v_mfma_f32_16x16x32_bf16 v[84:87], v[176:179], a[60:63], v[84:87]
  buffer_load_dwordx4 v[244:247], v12, s[16:19], s85 offen offset:512 sc1
  v_mfma_f32_16x16x32_bf16 v[88:91], v[180:183], a[56:59], v[88:91]
  buffer_load_dwordx4 v[248:251], v12, s[16:19], s85 offen offset:768 sc1
  v_mfma_f32_16x16x32_bf16 v[92:95], v[180:183], a[60:63], v[92:95]
  buffer_load_dwordx4 v218, s[40:43], s72 offen offset:2048 lds
  v_mfma_f32_16x16x32_bf16 v[96:99], v[184:187], a[56:59], v[96:99]
  buffer_load_dwordx4 v219, s[40:43], s72 offen offset:3072 lds
  v_mfma_f32_16x16x32_bf16 v[100:103], v[184:187], a[60:63], v[100:103]
  v_mfma_f32_16x16x32_bf16 v[104:107], v[188:191], a[56:59], v[104:107]
  v_mfma_f32_16x16x32_bf16 v[108:111], v[188:191], a[60:63], v[108:111]
  v_mfma_f32_16x16x32_bf16 v[112:115], v[192:195], a[56:59], v[112:115]
  s_waitcnt vmcnt(30) lgkmcnt(0)
  s_barrier
  ds_read_b64_tr_b16 v[144:145], v228 offset:32768
  v_mfma_f32_16x16x32_bf16 v[116:119], v[192:195], a[60:63], v[116:119]
  s_add_u32 m0, s69, 0
  ds_read_b64_tr_b16 v[146:147], v228 offset:34816
  ds_read_b64_tr_b16 v[148:149], v229 offset:32768
  v_mfma_f32_16x16x32_bf16 v[120:123], v[196:199], a[56:59], v[120:123]
  ds_read_b64_tr_b16 v[150:151], v229 offset:34816
  ds_read_b64_tr_b16 v[152:153], v230 offset:32768
  v_mfma_f32_16x16x32_bf16 v[124:127], v[196:199], a[60:63], v[124:127]
  ds_read_b64_tr_b16 v[154:155], v230 offset:34816
  ds_read_b64_tr_b16 v[156:157], v231 offset:32768
  v_mfma_f32_16x16x32_bf16 v[128:131], v[200:203], a[56:59], v[128:131]
  ds_read_b64_tr_b16 v[158:159], v231 offset:34816
  ds_read_b64_tr_b16 v[160:161], v228 offset:36864
  v_mfma_f32_16x16x32_bf16 v[132:135], v[200:203], a[60:63], v[132:135]
  ds_read_b64_tr_b16 v[162:163], v228 offset:38912
  ds_read_b64_tr_b16 v[164:165], v229 offset:36864
  v_mfma_f32_16x16x32_bf16 v[136:139], v[204:207], a[56:59], v[136:139]
  ds_read_b64_tr_b16 v[166:167], v229 offset:38912
  ds_read_b64_tr_b16 v[168:169], v230 offset:36864
  v_mfma_f32_16x16x32_bf16 v[140:143], v[204:207], a[60:63], v[140:143]
  s_waitcnt lgkmcnt(10)
  buffer_load_dwordx4 v224, s[12:15], s70 offen offset:0 lds
  ds_read_b64_tr_b16 v[170:171], v230 offset:38912
  v_mfma_f32_16x16x32_bf16 v[80:83], v[144:147], a[64:67], v[80:83]
  ds_read_b64_tr_b16 v[172:173], v231 offset:36864
  ds_read_b64_tr_b16 v[174:175], v231 offset:38912
  v_mfma_f32_16x16x32_bf16 v[84:87], v[144:147], a[68:71], v[84:87]
  s_waitcnt lgkmcnt(9)
  buffer_load_dwordx4 v225, s[12:15], s70 offen offset:1024 lds
  ds_read_b64_tr_b16 v[176:177], v228 offset:40960
  v_mfma_f32_16x16x32_bf16 v[88:91], v[148:151], a[64:67], v[88:91]
  ds_read_b64_tr_b16 v[178:179], v228 offset:43008
  ds_read_b64_tr_b16 v[180:181], v229 offset:40960
  v_mfma_f32_16x16x32_bf16 v[92:95], v[148:151], a[68:71], v[92:95]
  buffer_load_dwordx4 v226, s[12:15], s70 offen offset:2048 lds
  ds_read_b64_tr_b16 v[182:183], v229 offset:43008
  v_mfma_f32_16x16x32_bf16 v[96:99], v[152:155], a[64:67], v[96:99]
  ds_read_b64_tr_b16 v[184:185], v230 offset:40960
  buffer_load_dwordx4 v227, s[12:15], s70 offen offset:3072 lds
  v_mfma_f32_16x16x32_bf16 v[100:103], v[152:155], a[68:71], v[100:103]
  s_waitcnt lgkmcnt(7)
  ds_read_b64_tr_b16 v[186:187], v230 offset:43008
  ds_read_b64_tr_b16 v[188:189], v231 offset:40960
  v_mfma_f32_16x16x32_bf16 v[104:107], v[156:159], a[64:67], v[104:107]
  s_add_u32 m0, s69, 3968
  ds_read_b64_tr_b16 v[190:191], v231 offset:43008
  ds_read_b64_tr_b16 v[192:193], v228 offset:45056
  v_mfma_f32_16x16x32_bf16 v[108:111], v[156:159], a[68:71], v[108:111]
  ds_read_b64_tr_b16 v[194:195], v228 offset:47104
  ds_read_b64_tr_b16 v[196:197], v229 offset:45056
  v_mfma_f32_16x16x32_bf16 v[112:115], v[160:163], a[64:67], v[112:115]
  ds_read_b64_tr_b16 v[198:199], v229 offset:47104
  ds_read_b64_tr_b16 v[200:201], v230 offset:45056
  v_mfma_f32_16x16x32_bf16 v[116:119], v[160:163], a[68:71], v[116:119]
  ds_read_b128 a[4:7], v220 offset:4096
  ds_read_b128 a[12:15], v221 offset:4096
  v_mfma_f32_16x16x32_bf16 v[120:123], v[164:167], a[64:67], v[120:123]
  buffer_load_dwordx4 v224, s[12:15], s70 offen offset:128 lds
  ds_read_b128 a[20:23], v222 offset:4096
  v_mfma_f32_16x16x32_bf16 v[124:127], v[164:167], a[68:71], v[124:127]
  buffer_load_dwordx4 v225, s[12:15], s70 offen offset:1152 lds
  ds_read_b64_tr_b16 v[202:203], v230 offset:47104
  v_mfma_f32_16x16x32_bf16 v[128:131], v[168:171], a[64:67], v[128:131]
  ds_read_b64_tr_b16 v[204:205], v231 offset:45056
  ds_read_b128 a[28:31], v223 offset:4096
  v_mfma_f32_16x16x32_bf16 v[132:135], v[168:171], a[68:71], v[132:135]
  s_waitcnt lgkmcnt(8)
  ds_read_b64_tr_b16 v[206:207], v231 offset:47104
  ds_read_b64_tr_b16 v[144:145], v228 offset:49152
  v_mfma_f32_16x16x32_bf16 v[136:139], v[172:175], a[64:67], v[136:139]
  buffer_load_dwordx4 v226, s[12:15], s70 offen offset:2176 lds
  ds_read_b64_tr_b16 v[146:147], v228 offset:51200
  v_mfma_f32_16x16x32_bf16 v[140:143], v[172:175], a[68:71], v[140:143]
  ds_read_b64_tr_b16 v[148:149], v229 offset:49152
  ds_read_b64_tr_b16 v[150:151], v229 offset:51200
  v_mfma_f32_16x16x32_bf16 v[80:83], v[176:179], a[72:75], v[80:83]
  ds_read_b64_tr_b16 v[152:153], v230 offset:49152
  ds_read_b64_tr_b16 v[154:155], v230 offset:51200
  v_mfma_f32_16x16x32_bf16 v[84:87], v[176:179], a[76:79], v[84:87]
  buffer_load_dwordx4 v227, s[12:15], s70 offen offset:3200 lds
  ds_read_b64_tr_b16 v[156:157], v231 offset:49152
  v_mfma_f32_16x16x32_bf16 v[88:91], v[180:183], a[72:75], v[88:91]
  ds_read_b64_tr_b16 v[158:159], v231 offset:51200
  ds_read_b64_tr_b16 v[160:161], v228 offset:53248
  v_mfma_f32_16x16x32_bf16 v[92:95], v[180:183], a[76:79], v[92:95]
  s_bfe_u32 s70, s71, 0x30014
  ds_read_b64_tr_b16 v[162:163], v228 offset:55296
  ds_read_b64_tr_b16 v[164:165], v229 offset:53248
  v_mfma_f32_16x16x32_bf16 v[96:99], v[184:187], a[72:75], v[96:99]
  ds_read_b64_tr_b16 v[166:167], v229 offset:55296
  v_mfma_f32_16x16x32_bf16 v[100:103], v[184:187], a[76:79], v[100:103]
  ds_read_b64_tr_b16 v[168:169], v230 offset:53248
  v_mfma_f32_16x16x32_bf16 v[104:107], v[188:191], a[72:75], v[104:107]
  s_mul_i32 s70, s70, 917504
  ds_read_b64_tr_b16 v[170:171], v230 offset:55296
  v_mfma_f32_16x16x32_bf16 v[108:111], v[188:191], a[76:79], v[108:111]
  ds_read_b64_tr_b16 v[172:173], v231 offset:53248
  v_mfma_f32_16x16x32_bf16 v[112:115], v[192:195], a[72:75], v[112:115]
  ds_read_b64_tr_b16 v[174:175], v231 offset:55296
  v_mfma_f32_16x16x32_bf16 v[116:119], v[192:195], a[76:79], v[116:119]
  s_waitcnt vmcnt(33) lgkmcnt(5)
  ds_read_b128 a[32:35], v220 offset:8192
  v_mfma_f32_16x16x32_bf16 v[120:123], v[196:199], a[72:75], v[120:123]
  ds_read_b128 a[40:43], v221 offset:8192
  s_add_u32 m0, s68, 4096
  v_mfma_f32_16x16x32_bf16 v[124:127], v[196:199], a[76:79], v[124:127]
  ds_read_b128 a[48:51], v222 offset:8192
  v_mfma_f32_16x16x32_bf16 v[128:131], v[200:203], a[72:75], v[128:131]
  buffer_load_dwordx4 v216, s[40:43], s73 offen offset:0 lds
  v_mfma_f32_16x16x32_bf16 v[132:135], v[200:203], a[76:79], v[132:135]
  ds_read_b128 a[56:59], v223 offset:8192
  v_mfma_f32_16x16x32_bf16 v[136:139], v[204:207], a[72:75], v[136:139]
  buffer_load_dwordx4 v217, s[40:43], s73 offen offset:1024 lds
  v_mfma_f32_16x16x32_bf16 v[140:143], v[204:207], a[76:79], v[140:143]
  ds_read_b64_tr_b16 v[176:177], v228 offset:57344
  v_mfma_f32_16x16x32_bf16 v[80:83], v[144:147], a[80:83], v[80:83]
  buffer_load_dwordx4 v218, s[40:43], s73 offen offset:2048 lds
  v_mfma_f32_16x16x32_bf16 v[84:87], v[144:147], a[84:87], v[84:87]
  ds_read_b64_tr_b16 v[178:179], v228 offset:59392
  v_mfma_f32_16x16x32_bf16 v[88:91], v[148:151], a[80:83], v[88:91]
  ds_read_b64_tr_b16 v[180:181], v229 offset:57344
  v_mfma_f32_16x16x32_bf16 v[92:95], v[148:151], a[84:87], v[92:95]
  ds_read_b64_tr_b16 v[182:183], v229 offset:59392
  v_mfma_f32_16x16x32_bf16 v[96:99], v[152:155], a[80:83], v[96:99]
  buffer_load_dwordx4 v219, s[40:43], s73 offen offset:3072 lds
  v_mfma_f32_16x16x32_bf16 v[100:103], v[152:155], a[84:87], v[100:103]
  ds_read_b64_tr_b16 v[184:185], v230 offset:57344
  s_bfe_u32 s72, s0, 0x4000c
  v_mfma_f32_16x16x32_bf16 v[104:107], v[156:159], a[80:83], v[104:107]
  ds_read_b64_tr_b16 v[186:187], v230 offset:59392
  s_lshl_b32 s72, s72, 8
  v_mfma_f32_16x16x32_bf16 v[108:111], v[156:159], a[84:87], v[108:111]
  ds_read_b64_tr_b16 v[188:189], v231 offset:57344
  v_mfma_f32_16x16x32_bf16 v[112:115], v[160:163], a[80:83], v[112:115]
  s_branch parallel_sum__ssm_conv_h3__mixer_gmlp__prompt_kernel_ps4
parallel_sum__ssm_conv_h3__mixer_gmlp__prompt_kernel_pg4:
  s_branch parallel_sum__ssm_conv_h3__mixer_gmlp__prompt_kernel_pg8
parallel_sum__ssm_conv_h3__mixer_gmlp__prompt_kernel_ps4:
  ds_read_b64_tr_b16 v[190:191], v231 offset:59392
  v_mfma_f32_16x16x32_bf16 v[116:119], v[160:163], a[84:87], v[116:119]
  s_waitcnt lgkmcnt(4)
  ds_read_b64_tr_b16 v[192:193], v228 offset:61440
  s_add_u32 m0, s68, 8192
  v_mfma_f32_16x16x32_bf16 v[120:123], v[164:167], a[80:83], v[120:123]
  ds_read_b64_tr_b16 v[194:195], v228 offset:63488
  v_mfma_f32_16x16x32_bf16 v[124:127], v[164:167], a[84:87], v[124:127]
  ds_read_b64_tr_b16 v[196:197], v229 offset:61440
  s_add_u32 s73, s72, 16384
  v_mfma_f32_16x16x32_bf16 v[128:131], v[168:171], a[80:83], v[128:131]
  ds_read_b64_tr_b16 v[198:199], v229 offset:63488
  v_mfma_f32_16x16x32_bf16 v[132:135], v[168:171], a[84:87], v[132:135]
  ds_read_b64_tr_b16 v[200:201], v230 offset:61440
  v_mfma_f32_16x16x32_bf16 v[136:139], v[172:175], a[80:83], v[136:139]
  ds_read_b64_tr_b16 v[202:203], v230 offset:63488
  v_mfma_f32_16x16x32_bf16 v[140:143], v[172:175], a[84:87], v[140:143]
  ds_read_b64_tr_b16 v[204:205], v231 offset:61440
  v_mfma_f32_16x16x32_bf16 v[80:83], v[176:179], a[88:91], v[80:83]
  ds_read_b64_tr_b16 v[206:207], v231 offset:63488
  v_mfma_f32_16x16x32_bf16 v[84:87], v[176:179], a[92:95], v[84:87]
  buffer_load_dwordx4 v216, s[40:43], s72 offen offset:0 lds
  v_mfma_f32_16x16x32_bf16 v[88:91], v[180:183], a[88:91], v[88:91]
  buffer_load_dwordx4 v217, s[40:43], s72 offen offset:1024 lds
  v_mfma_f32_16x16x32_bf16 v[92:95], v[180:183], a[92:95], v[92:95]
  s_waitcnt lgkmcnt(3)
  buffer_load_dwordx4 v218, s[40:43], s72 offen offset:2048 lds
  v_mfma_f32_16x16x32_bf16 v[96:99], v[184:187], a[88:91], v[96:99]
  s_waitcnt vmcnt(20)
  v_xor_b32 v7, s64, v236
  v_bitop3_b32 v7, v7, v237, s65 bitop3:0xf6
  v_bitop3_b32 v7, v7, v238, s66 bitop3:0xf6
  v_mfma_f32_16x16x32_bf16 v[100:103], v[184:187], a[92:95], v[100:103]
  buffer_load_dwordx4 v219, s[40:43], s72 offen offset:3072 lds
  v_bitop3_b32 v7, v7, v239, s67 bitop3:0xf6
  v_mfma_f32_16x16x32_bf16 v[104:107], v[188:191], a[88:91], v[104:107]
  s_waitcnt vmcnt(20)
  v_bitop3_b32 v7, v7, v240, s64 bitop3:0xf6
  v_bitop3_b32 v7, v7, v241, s65 bitop3:0xf6
  v_mfma_f32_16x16x32_bf16 v[108:111], v[188:191], a[92:95], v[108:111]
  v_bitop3_b32 v7, v7, v242, s66 bitop3:0xf6
  v_bitop3_b32 v7, v7, v243, s67 bitop3:0xf6
  v_mfma_f32_16x16x32_bf16 v[112:115], v[192:195], a[88:91], v[112:115]
  s_waitcnt lgkmcnt(0)
  s_barrier
  ds_read_b64_tr_b16 v[144:145], v232 offset:0
  v_mfma_f32_16x16x32_bf16 v[116:119], v[192:195], a[92:95], v[116:119]
  s_add_u32 m0, s69, 32768
  ds_read_b64_tr_b16 v[146:147], v232 offset:2048
  ds_read_b64_tr_b16 v[148:149], v233 offset:0
  v_mfma_f32_16x16x32_bf16 v[120:123], v[196:199], a[88:91], v[120:123]
  ds_read_b64_tr_b16 v[150:151], v233 offset:2048
  ds_read_b64_tr_b16 v[152:153], v234 offset:0
  v_mfma_f32_16x16x32_bf16 v[124:127], v[196:199], a[92:95], v[124:127]
  ds_read_b64_tr_b16 v[154:155], v234 offset:2048
  ds_read_b64_tr_b16 v[156:157], v235 offset:0
  v_mfma_f32_16x16x32_bf16 v[128:131], v[200:203], a[88:91], v[128:131]
  ds_read_b64_tr_b16 v[158:159], v235 offset:2048
  s_waitcnt vmcnt(19)
  v_bitop3_b32 v7, v7, v244, s64 bitop3:0xf6
  v_bitop3_b32 v7, v7, v245, s65 bitop3:0xf6
  v_mfma_f32_16x16x32_bf16 v[132:135], v[200:203], a[92:95], v[132:135]
  ds_read_b64_tr_b16 v[160:161], v232 offset:4096
  v_bitop3_b32 v7, v7, v246, s66 bitop3:0xf6
  v_bitop3_b32 v7, v7, v247, s67 bitop3:0xf6
  v_mfma_f32_16x16x32_bf16 v[136:139], v[204:207], a[88:91], v[136:139]
  ds_read_b64_tr_b16 v[162:163], v232 offset:6144
  ds_read_b64_tr_b16 v[164:165], v233 offset:4096
  v_mfma_f32_16x16x32_bf16 v[140:143], v[204:207], a[92:95], v[140:143]
  s_waitcnt lgkmcnt(8)
  ds_read_b64_tr_b16 v[166:167], v233 offset:6144
  s_waitcnt vmcnt(18)
  v_bitop3_b32 v7, v7, v248, s64 bitop3:0xf6
  v_mfma_f32_16x16x32_bf16 v[80:83], v[144:147], a[96:99], v[80:83]
  ds_read_b64_tr_b16 v[168:169], v234 offset:4096
  v_bitop3_b32 v7, v7, v249, s65 bitop3:0xf6
  v_bitop3_b32 v7, v7, v250, s66 bitop3:0xf6
  v_mfma_f32_16x16x32_bf16 v[84:87], v[144:147], a[100:103], v[84:87]
  s_waitcnt lgkmcnt(6)
  ds_read_b64_tr_b16 v[170:171], v234 offset:6144
  v_bitop3_b32 v7, v7, v251, s67 bitop3:0xf6
  v_and_b32 v7, 0xff, v7
  v_mfma_f32_16x16x32_bf16 v[88:91], v[148:151], a[96:99], v[88:91]
  ds_read_b64_tr_b16 v[172:173], v235 offset:4096
  v_cmp_ne_u32_e64 vcc, 0, v7
  s_cbranch_vccnz parallel_sum__ssm_conv_h3__mixer_gmlp__prompt_kernel_z2s_slow
parallel_sum__ssm_conv_h3__mixer_gmlp__prompt_kernel_z2s_ok:
  v_mfma_f32_16x16x32_bf16 v[92:95], v[148:151], a[100:103], v[92:95]
  ds_read_b64_tr_b16 v[174:175], v235 offset:6144
  v_add_f32 v236, v236, v240
  v_add_f32 v237, v237, v241
  v_mfma_f32_16x16x32_bf16 v[96:99], v[152:155], a[96:99], v[96:99]
  buffer_load_dwordx4 v224, s[12:15], s70 offen offset:0 lds
  ds_read_b64_tr_b16 v[176:177], v232 offset:8192
  v_mfma_f32_16x16x32_bf16 v[100:103], v[152:155], a[100:103], v[100:103]
  s_waitcnt lgkmcnt(5)
  ds_read_b64_tr_b16 v[178:179], v232 offset:10240
  v_add_f32 v238, v238, v242
  v_add_f32_e64 v239, v239, v243
  v_mfma_f32_16x16x32_bf16 v[104:107], v[156:159], a[96:99], v[104:107]
  ds_read_b64_tr_b16 v[180:181], v233 offset:8192
  v_add_f32 v244, v244, v248
  v_add_f32 v245, v245, v249
  v_mfma_f32_16x16x32_bf16 v[108:111], v[156:159], a[100:103], v[108:111]
  ds_read_b64_tr_b16 v[182:183], v233 offset:10240
  v_add_f32 v246, v246, v250
  v_add_f32 v247, v247, v251
  v_mfma_f32_16x16x32_bf16 v[112:115], v[160:163], a[96:99], v[112:115]
  buffer_load_dwordx4 v225, s[12:15], s70 offen offset:1024 lds
  ds_read_b64_tr_b16 v[184:185], v234 offset:8192
  v_mfma_f32_16x16x32_bf16 v[116:119], v[160:163], a[100:103], v[116:119]
  ds_read_b64_tr_b16 v[186:187], v234 offset:10240
  v_add_f32 v236, v236, v244
  v_add_f32 v237, v237, v245
  v_mfma_f32_16x16x32_bf16 v[120:123], v[164:167], a[96:99], v[120:123]
  ds_read_b64_tr_b16 v[188:189], v235 offset:8192
  v_add_f32 v238, v238, v246
  v_add_f32 v239, v239, v247
  v_mfma_f32_16x16x32_bf16 v[124:127], v[164:167], a[100:103], v[124:127]
  s_waitcnt lgkmcnt(5)
  buffer_load_dwordx4 v226, s[12:15], s70 offen offset:2048 lds
  ds_read_b64_tr_b16 v[190:191], v235 offset:10240
  v_mfma_f32_16x16x32_bf16 v[128:131], v[168:171], a[96:99], v[128:131]
  ds_read_b64_tr_b16 v[192:193], v232 offset:12288
  v_add_f32_dpp v236, v236, v236 row_ror:8 row_mask:0xf bank_mask:0xf
  v_add_f32_dpp v237, v237, v237 row_ror:8 row_mask:0xf bank_mask:0xf
  v_mfma_f32_16x16x32_bf16 v[132:135], v[168:171], a[100:103], v[132:135]
  ds_read_b64_tr_b16 v[194:195], v232 offset:14336
  v_add_f32_dpp v238, v238, v238 row_ror:8 row_mask:0xf bank_mask:0xf
  v_add_f32_dpp v239, v239, v239 row_ror:8 row_mask:0xf bank_mask:0xf
  v_mfma_f32_16x16x32_bf16 v[136:139], v[172:175], a[96:99], v[136:139]
  ds_read_b64_tr_b16 v[196:197], v233 offset:12288
  v_add_f32_dpp v236, v236, v236 row_ror:4 row_mask:0xf bank_mask:0xf
  v_add_f32_dpp v237, v237, v237 row_ror:4 row_mask:0xf bank_mask:0xf
  v_mfma_f32_16x16x32_bf16 v[140:143], v[172:175], a[100:103], v[140:143]
  buffer_load_dwordx4 v227, s[12:15], s70 offen offset:3072 lds
  ds_read_b64_tr_b16 v[198:199], v233 offset:14336
  v_mfma_f32_16x16x32_bf16 v[80:83], v[176:179], a[104:107], v[80:83]
  s_add_u32 m0, s69, 36736
  ds_read_b64_tr_b16 v[200:201], v234 offset:12288
  v_add_f32_dpp v238, v238, v238 row_ror:4 row_mask:0xf bank_mask:0xf
  v_add_f32_dpp v239, v239, v239 row_ror:4 row_mask:0xf bank_mask:0xf
  v_mfma_f32_16x16x32_bf16 v[84:87], v[176:179], a[108:111], v[84:87]
  s_waitcnt lgkmcnt(5)
  ds_read_b64_tr_b16 v[202:203], v234 offset:14336
  v_mul_f32 v236, 0x3a124925, v236
  v_mul_f32 v237, 0x3a124925, v237
  v_mfma_f32_16x16x32_bf16 v[88:91], v[180:183], a[104:107], v[88:91]
  ds_read_b64_tr_b16 v[204:205], v235 offset:12288
  v_mul_f32 v238, 0x3a124925, v238
  v_mul_f32 v239, 0x3a124925, v239
  v_mfma_f32_16x16x32_bf16 v[92:95], v[180:183], a[108:111], v[92:95]
  ds_read_b64_tr_b16 v[206:207], v235 offset:14336
  v_mul_f32 v7, v254, v254
  v_mul_f32 v8, v255, v255
  v_mfma_f32_16x16x32_bf16 v[96:99], v[184:187], a[104:107], v[96:99]
  ds_read_b64_tr_b16 v[144:145], v232 offset:16384
  v_fma_f32 v238, -v236, v236, v238
  v_fma_f32 v239, -v237, v237, v239
  v_mfma_f32_16x16x32_bf16 v[100:103], v[184:187], a[108:111], v[100:103]
  buffer_load_dwordx4 v224, s[12:15], s70 offen offset:128 lds
  ds_read_b64_tr_b16 v[146:147], v232 offset:18432
  v_mfma_f32_16x16x32_bf16 v[104:107], v[188:191], a[104:107], v[104:107]
  ds_read_b64_tr_b16 v[148:149], v233 offset:16384
  v_max_f32 v238, 0, v238
  v_max_f32 v239, 0, v239
  v_mfma_f32_16x16x32_bf16 v[108:111], v[188:191], a[108:111], v[108:111]
  s_waitcnt lgkmcnt(5)
  ds_read_b128 a[36:39], v220 offset:12288
  buffer_load_dwordx4 v225, s[12:15], s70 offen offset:1152 lds
  v_mul_f32 v7, v7, v238
  v_mfma_f32_16x16x32_bf16 v[112:115], v[192:195], a[104:107], v[112:115]
  ds_read_b64_tr_b16 v[150:151], v233 offset:18432
  v_mul_f32_e64 v8, v8, v239
  v_add_f32 v7, 0x3727c5ac, v7
  v_mfma_f32_16x16x32_bf16 v[116:119], v[192:195], a[108:111], v[116:119]
  ds_read_b64_tr_b16 v[152:153], v234 offset:16384
  ds_read_b128 a[44:47], v221 offset:12288
  v_add_f32 v8, 0x3727c5ac, v8
  v_mfma_f32_16x16x32_bf16 v[120:123], v[196:199], a[104:107], v[120:123]
  ds_read_b64_tr_b16 v[154:155], v234 offset:18432
  v_rsq_f32_e64 v7, v7
  v_mfma_f32_16x16x32_bf16 v[124:127], v[196:199], a[108:111], v[124:127]
  ds_read_b64_tr_b16 v[156:157], v235 offset:16384
  v_rsq_f32_e64 v8, v8
  v_mfma_f32_16x16x32_bf16 v[128:131], v[200:203], a[104:107], v[128:131]
  ds_read_b128 a[52:55], v222 offset:12288
  buffer_load_dwordx4 v226, s[12:15], s70 offen offset:2176 lds
  v_mul_f32_e64 v7, v7, v254
  v_mfma_f32_16x16x32_bf16 v[132:135], v[200:203], a[108:111], v[132:135]
  s_waitcnt lgkmcnt(6)
  ds_read_b64_tr_b16 v[158:159], v235 offset:18432
  v_mul_f32 v8, v8, v255
  v_mul_f32_e64 v9, v7, v236
  v_mfma_f32_16x16x32_bf16 v[136:139], v[204:207], a[104:107], v[136:139]
  ds_read_b64_tr_b16 v[160:161], v232 offset:20480
  ds_read_b128 a[60:63], v223 offset:12288
  v_mul_f32_e64 v10, v8, v237
  v_mfma_f32_16x16x32_bf16 v[140:143], v[204:207], a[108:111], v[140:143]
  ds_read_b64_tr_b16 v[162:163], v232 offset:22528
  buffer_load_dwordx4 v227, s[12:15], s70 offen offset:3200 lds
  v_mov_b32_dpp v244, v7 row_newbcast:0 row_mask:0xf bank_mask:0xf
  v_mfma_f32_16x16x32_bf16 v[80:83], v[144:147], a[112:115], v[80:83]
  s_bfe_u32 s70, s71, 0x30018
  ds_read_b64_tr_b16 v[164:165], v233 offset:20480
  v_mov_b32_dpp v245, v8 row_newbcast:0 row_mask:0xf bank_mask:0xf
  v_mov_b32_dpp v246, v7 row_newbcast:1 row_mask:0xf bank_mask:0xf
  v_mfma_f32_16x16x32_bf16 v[84:87], v[144:147], a[116:119], v[84:87]
  s_waitcnt lgkmcnt(6)
  ds_read_b64_tr_b16 v[166:167], v233 offset:22528
  v_mov_b32_dpp v247, v8 row_newbcast:1 row_mask:0xf bank_mask:0xf
  v_mov_b32_dpp v248, v7 row_newbcast:2 row_mask:0xf bank_mask:0xf
  v_mfma_f32_16x16x32_bf16 v[88:91], v[148:151], a[112:115], v[88:91]
  s_mul_i32 s70, s70, 917504
  ds_read_b64_tr_b16 v[168:169], v234 offset:20480
  v_mov_b32_dpp v249, v8 row_newbcast:2 row_mask:0xf bank_mask:0xf
  v_mov_b32_dpp v250, v7 row_newbcast:3 row_mask:0xf bank_mask:0xf
  v_mfma_f32_16x16x32_bf16 v[92:95], v[148:151], a[116:119], v[92:95]
  ds_read_b64_tr_b16 v[170:171], v234 offset:22528
  ds_read_b64_tr_b16 v[172:173], v235 offset:20480
  v_mov_b32_dpp v251, v8 row_newbcast:3 row_mask:0xf bank_mask:0xf
  v_mfma_f32_16x16x32_bf16 v[96:99], v[152:155], a[112:115], v[96:99]
  ds_read_b64_tr_b16 v[174:175], v235 offset:22528
  v_mov_b32_dpp v236, v9 row_newbcast:0 row_mask:0xf bank_mask:0xf
  v_mov_b32_dpp v237, v10 row_newbcast:0 row_mask:0xf bank_mask:0xf
  v_mfma_f32_16x16x32_bf16 v[100:103], v[152:155], a[116:119], v[100:103]
  s_waitcnt lgkmcnt(6)
  ds_read_b64_tr_b16 v[176:177], v232 offset:24576
  v_mov_b32_dpp v238, v9 row_newbcast:1 row_mask:0xf bank_mask:0xf
  v_mov_b32_dpp v239, v10 row_newbcast:1 row_mask:0xf bank_mask:0xf
  v_mfma_f32_16x16x32_bf16 v[104:107], v[156:159], a[112:115], v[104:107]
  s_add_u32 m0, s68, 12288
  ds_read_b64_tr_b16 v[178:179], v232 offset:26624
  v_mov_b32_dpp v240, v9 row_newbcast:2 row_mask:0xf bank_mask:0xf
  v_mov_b32_dpp v241, v10 row_newbcast:2 row_mask:0xf bank_mask:0xf
  v_mfma_f32_16x16x32_bf16 v[108:111], v[156:159], a[116:119], v[108:111]
  ds_read_b64_tr_b16 v[180:181], v233 offset:24576
  ds_read_b64_tr_b16 v[182:183], v233 offset:26624
  v_mov_b32_dpp v242, v9 row_newbcast:3 row_mask:0xf bank_mask:0xf
  v_mfma_f32_16x16x32_bf16 v[112:115], v[160:163], a[112:115], v[112:115]
  ds_read_b64_tr_b16 v[184:185], v234 offset:24576
  v_mov_b32_dpp v243, v10 row_newbcast:3 row_mask:0xf bank_mask:0xf
  v_fma_f32 v16, v16, v244, -v236
  v_mfma_f32_16x16x32_bf16 v[116:119], v[160:163], a[116:119], v[116:119]
  s_waitcnt lgkmcnt(6)
  ds_read_b64_tr_b16 v[186:187], v234 offset:26624
  v_fma_f32 v17, v17, v245, -v237
  v_fma_f32 v18, v18, v246, -v238
  v_mfma_f32_16x16x32_bf16 v[120:123], v[164:167], a[112:115], v[120:123]
  ds_read_b64_tr_b16 v[188:189], v235 offset:24576
  v_fma_f32 v19, v19, v247, -v239
  v_fma_f32 v20, v20, v248, -v240
  v_mfma_f32_16x16x32_bf16 v[124:127], v[164:167], a[116:119], v[124:127]
  ds_read_b64_tr_b16 v[190:191], v235 offset:26624
  buffer_load_dwordx4 v216, s[40:43], s73 offen offset:0 lds
  v_fma_f32 v21, v21, v249, -v241
  v_mfma_f32_16x16x32_bf16 v[128:131], v[168:171], a[112:115], v[128:131]
  ds_read_b64_tr_b16 v[192:193], v232 offset:28672
  ds_read_b64_tr_b16 v[194:195], v232 offset:30720
  v_fma_f32 v22, v22, v250, -v242
  v_mfma_f32_16x16x32_bf16 v[132:135], v[168:171], a[116:119], v[132:135]
  s_waitcnt lgkmcnt(6)
  ds_read_b64_tr_b16 v[196:197], v233 offset:28672
  v_fma_f32 v23, v23, v251, -v243
  v_cvt_pk_bf16_f32 v16, v16, v17
  v_mfma_f32_16x16x32_bf16 v[136:139], v[172:175], a[112:115], v[136:139]
  buffer_load_dwordx4 v217, s[40:43], s73 offen offset:1024 lds
  ds_read_b64_tr_b16 v[198:199], v233 offset:30720
  v_mfma_f32_16x16x32_bf16 v[140:143], v[172:175], a[116:119], v[140:143]
  ds_read_b64_tr_b16 v[200:201], v234 offset:28672
  v_cvt_pk_bf16_f32 v17, v18, v19
  v_cvt_pk_bf16_f32 v18, v20, v21
  v_mfma_f32_16x16x32_bf16 v[80:83], v[176:179], a[120:123], v[80:83]
  ds_read_b64_tr_b16 v[202:203], v234 offset:30720
  buffer_load_dwordx4 v218, s[40:43], s73 offen offset:2048 lds
  v_cvt_pk_bf16_f32 v19, v22, v23
  v_mfma_f32_16x16x32_bf16 v[84:87], v[176:179], a[124:127], v[84:87]
  buffer_store_dwordx4 v[16:19], v208, s[16:19], s86 offen offset:0 sc1
  ds_read_b64_tr_b16 v[204:205], v235 offset:28672
  v_mfma_f32_16x16x32_bf16 v[88:91], v[180:183], a[120:123], v[88:91]
  ds_read_b64_tr_b16 v[206:207], v235 offset:30720
  v_fma_f32 v24, v24, v244, -v236
  v_fma_f32 v25, v25, v245, -v237
  v_mfma_f32_16x16x32_bf16 v[92:95], v[180:183], a[124:127], v[92:95]
  s_waitcnt lgkmcnt(5)
  v_fma_f32 v26, v26, v246, -v238
  v_fma_f32 v27, v27, v247, -v239
  v_fma_f32 v28, v28, v248, -v240
  v_mfma_f32_16x16x32_bf16 v[96:99], v[184:187], a[120:123], v[96:99]
  buffer_load_dwordx4 v219, s[40:43], s73 offen offset:3072 lds
  v_fma_f32 v29, v29, v249, -v241
  v_mfma_f32_16x16x32_bf16 v[100:103], v[184:187], a[124:127], v[100:103]
  s_bfe_u32 s72, s0, 0x40010
  v_fma_f32 v30, v30, v250, -v242
  v_fma_f32 v31, v31, v251, -v243
  v_cvt_pk_bf16_f32 v24, v24, v25
  v_mfma_f32_16x16x32_bf16 v[104:107], v[188:191], a[120:123], v[104:107]
  s_lshl_b32 s72, s72, 8
  v_cvt_pk_bf16_f32 v25, v26, v27
  v_cvt_pk_bf16_f32 v26, v28, v29
  v_cvt_pk_bf16_f32 v27, v30, v31
  v_mfma_f32_16x16x32_bf16 v[108:111], v[188:191], a[124:127], v[108:111]
  buffer_store_dwordx4 v[24:27], v208, s[16:19], s86 offen offset:1024 sc1
  v_fma_f32 v32, v32, v244, -v236
  v_mfma_f32_16x16x32_bf16 v[112:115], v[192:195], a[120:123], v[112:115]
  s_waitcnt vmcnt(22) lgkmcnt(0)
  s_barrier
  ds_read_b64_tr_b16 v[144:145], v228 offset:0
  v_mfma_f32_16x16x32_bf16 v[116:119], v[192:195], a[124:127], v[116:119]
  s_add_u32 m0, s69, 65536
  ds_read_b64_tr_b16 v[146:147], v228 offset:2048
  ds_read_b64_tr_b16 v[148:149], v229 offset:0
  v_fma_f32 v33, v33, v245, -v237
  v_mfma_f32_16x16x32_bf16 v[120:123], v[196:199], a[120:123], v[120:123]
  ds_read_b64_tr_b16 v[150:151], v229 offset:2048
  ds_read_b64_tr_b16 v[152:153], v230 offset:0
  v_fma_f32 v34, v34, v246, -v238
  v_mfma_f32_16x16x32_bf16 v[124:127], v[196:199], a[124:127], v[124:127]
  ds_read_b64_tr_b16 v[154:155], v230 offset:2048
  ds_read_b64_tr_b16 v[156:157], v231 offset:0
  v_fma_f32 v35, v35, v247, -v239
  v_mfma_f32_16x16x32_bf16 v[128:131], v[200:203], a[120:123], v[128:131]
  ds_read_b64_tr_b16 v[158:159], v231 offset:2048
  ds_read_b64_tr_b16 v[160:161], v228 offset:4096
  v_fma_f32 v36, v36, v248, -v240
  v_mfma_f32_16x16x32_bf16 v[132:135], v[200:203], a[124:127], v[132:135]
  ds_read_b64_tr_b16 v[162:163], v228 offset:6144
  ds_read_b64_tr_b16 v[164:165], v229 offset:4096
  v_fma_f32 v37, v37, v249, -v241
  v_mfma_f32_16x16x32_bf16 v[136:139], v[204:207], a[120:123], v[136:139]
  ds_read_b64_tr_b16 v[166:167], v229 offset:6144
  v_fma_f32 v38, v38, v250, -v242
  v_fma_f32 v39, v39, v251, -v243
  v_mfma_f32_16x16x32_bf16 v[140:143], v[204:207], a[124:127], v[140:143]
  s_waitcnt lgkmcnt(9)
  ds_read_b64_tr_b16 v[168:169], v230 offset:4096
  buffer_load_dwordx4 v224, s[12:15], s70 offen offset:0 lds
  v_cvt_pk_bf16_f32 v32, v32, v33
  v_mfma_f32_16x16x32_bf16 v[80:83], v[144:147], a[128:131], v[80:83]
  ds_read_b64_tr_b16 v[170:171], v230 offset:6144
  v_cvt_pk_bf16_f32 v33, v34, v35
  v_cvt_pk_bf16_f32 v34, v36, v37
  v_mfma_f32_16x16x32_bf16 v[84:87], v[144:147], a[132:135], v[84:87]
  s_waitcnt lgkmcnt(7)
  ds_read_b64_tr_b16 v[172:173], v231 offset:4096
  ds_read_b64_tr_b16 v[174:175], v231 offset:6144
  v_cvt_pk_bf16_f32 v35, v38, v39
  v_mfma_f32_16x16x32_bf16 v[88:91], v[148:151], a[128:131], v[88:91]
  buffer_store_dwordx4 v[32:35], v208, s[16:19], s86 offen offset:2048 sc1
  ds_read_b64_tr_b16 v[176:177], v228 offset:8192
  v_mfma_f32_16x16x32_bf16 v[92:95], v[148:151], a[132:135], v[92:95]
  ds_read_b64_tr_b16 v[178:179], v228 offset:10240
  v_fma_f32 v40, v40, v244, -v236
  v_fma_f32 v41, v41, v245, -v237
  v_mfma_f32_16x16x32_bf16 v[96:99], v[152:155], a[128:131], v[96:99]
  buffer_load_dwordx4 v225, s[12:15], s70 offen offset:1024 lds
  ds_read_b64_tr_b16 v[180:181], v229 offset:8192
  v_mfma_f32_16x16x32_bf16 v[100:103], v[152:155], a[132:135], v[100:103]
  s_waitcnt lgkmcnt(6)
  ds_read_b64_tr_b16 v[182:183], v229 offset:10240
  v_fma_f32 v42, v42, v246, -v238
  v_fma_f32 v43, v43, v247, -v239
  v_mfma_f32_16x16x32_bf16 v[104:107], v[156:159], a[128:131], v[104:107]
  ds_read_b64_tr_b16 v[184:185], v230 offset:8192
  v_fma_f32 v44, v44, v248, -v240
  v_fma_f32 v45, v45, v249, -v241
  v_mfma_f32_16x16x32_bf16 v[108:111], v[156:159], a[132:135], v[108:111]
  buffer_load_dwordx4 v226, s[12:15], s70 offen offset:2048 lds
  ds_read_b64_tr_b16 v[186:187], v230 offset:10240
  v_mfma_f32_16x16x32_bf16 v[112:115], v[160:163], a[128:131], v[112:115]
  ds_read_b64_tr_b16 v[188:189], v231 offset:8192
  v_fma_f32 v46, v46, v250, -v242
  v_fma_f32 v47, v47, v251, -v243
  v_mfma_f32_16x16x32_bf16 v[116:119], v[160:163], a[132:135], v[116:119]
  buffer_load_dwordx4 v227, s[12:15], s70 offen offset:3072 lds
  ds_read_b64_tr_b16 v[190:191], v231 offset:10240
  v_mfma_f32_16x16x32_bf16 v[120:123], v[164:167], a[128:131], v[120:123]
  s_add_u32 m0, s69, 69504
  ds_read_b64_tr_b16 v[192:193], v228 offset:12288
  v_cvt_pk_bf16_f32 v40, v40, v41
  v_cvt_pk_bf16_f32 v41, v42, v43
  v_mfma_f32_16x16x32_bf16 v[124:127], v[164:167], a[132:135], v[124:127]
  s_waitcnt lgkmcnt(5)
  ds_read_b128 a[64:67], v220 offset:0
  v_cvt_pk_bf16_f32 v42, v44, v45
  v_cvt_pk_bf16_f32 v43, v46, v47
  v_mfma_f32_16x16x32_bf16 v[128:131], v[168:171], a[128:131], v[128:131]
  buffer_store_dwordx4 v[40:43], v208, s[16:19], s86 offen offset:3072 sc1
  ds_read_b64_tr_b16 v[194:195], v228 offset:14336
  v_mfma_f32_16x16x32_bf16 v[132:135], v[168:171], a[132:135], v[132:135]
  ds_read_b64_tr_b16 v[196:197], v229 offset:12288
  v_fma_f32 v48, v48, v244, -v236
  v_fma_f32 v49, v49, v245, -v237
  v_mfma_f32_16x16x32_bf16 v[136:139], v[172:175], a[128:131], v[136:139]
  ds_read_b128 a[72:75], v221 offset:0
  buffer_load_dwordx4 v224, s[12:15], s70 offen offset:128 lds
  v_fma_f32 v50, v50, v246, -v238
  v_mfma_f32_16x16x32_bf16 v[140:143], v[172:175], a[132:135], v[140:143]
  ds_read_b64_tr_b16 v[198:199], v229 offset:14336
  v_fma_f32 v51, v51, v247, -v239
  v_fma_f32 v52, v52, v248, -v240
  v_mfma_f32_16x16x32_bf16 v[80:83], v[176:179], a[136:139], v[80:83]
  ds_read_b64_tr_b16 v[200:201], v230 offset:12288
  buffer_load_dwordx4 v225, s[12:15], s70 offen offset:1152 lds
  v_fma_f32 v53, v53, v249, -v241
  v_mfma_f32_16x16x32_bf16 v[84:87], v[176:179], a[140:143], v[84:87]
  ds_read_b128 a[80:83], v222 offset:0
  ds_read_b64_tr_b16 v[202:203], v230 offset:14336
  v_fma_f32 v54, v54, v250, -v242
  v_mfma_f32_16x16x32_bf16 v[88:91], v[180:183], a[136:139], v[88:91]
  ds_read_b64_tr_b16 v[204:205], v231 offset:12288
  v_fma_f32 v55, v55, v251, -v243
  v_cvt_pk_bf16_f32 v48, v48, v49
  v_mfma_f32_16x16x32_bf16 v[92:95], v[180:183], a[140:143], v[92:95]
  s_waitcnt lgkmcnt(6)
  ds_read_b128 a[88:91], v223 offset:0
  ds_read_b64_tr_b16 v[206:207], v231 offset:14336
  v_cvt_pk_bf16_f32 v49, v50, v51
  v_mfma_f32_16x16x32_bf16 v[96:99], v[184:187], a[136:139], v[96:99]
  buffer_load_dwordx4 v226, s[12:15], s70 offen offset:2176 lds
  ds_read_b64_tr_b16 v[144:145], v228 offset:16384
  v_mfma_f32_16x16x32_bf16 v[100:103], v[184:187], a[140:143], v[100:103]
  ds_read_b64_tr_b16 v[146:147], v228 offset:18432
  v_cvt_pk_bf16_f32 v50, v52, v53
  v_cvt_pk_bf16_f32 v51, v54, v55
  v_mfma_f32_16x16x32_bf16 v[104:107], v[188:191], a[136:139], v[104:107]
  buffer_store_dwordx4 v[48:51], v208, s[16:19], s87 offen offset:0 sc1
  ds_read_b64_tr_b16 v[148:149], v229 offset:16384
  v_mfma_f32_16x16x32_bf16 v[108:111], v[188:191], a[140:143], v[108:111]
  ds_read_b64_tr_b16 v[150:151], v229 offset:18432
  v_fma_f32 v56, v56, v244, -v236
  v_fma_f32 v57, v57, v245, -v237
  v_mfma_f32_16x16x32_bf16 v[112:115], v[192:195], a[136:139], v[112:115]
  buffer_load_dwordx4 v227, s[12:15], s70 offen offset:3200 lds
  ds_read_b64_tr_b16 v[152:153], v230 offset:16384
  v_mfma_f32_16x16x32_bf16 v[116:119], v[192:195], a[140:143], v[116:119]
  s_waitcnt lgkmcnt(5)
  ds_read_b64_tr_b16 v[154:155], v230 offset:18432
  v_fma_f32 v58, v58, v246, -v238
  v_fma_f32 v59, v59, v247, -v239
  v_mfma_f32_16x16x32_bf16 v[120:123], v[196:199], a[136:139], v[120:123]
  s_bfe_u32 s70, s71, 0x3001c
  ds_read_b64_tr_b16 v[156:157], v231 offset:16384
  v_fma_f32 v60, v60, v248, -v240
  v_fma_f32 v61, v61, v249, -v241
  v_mfma_f32_16x16x32_bf16 v[124:127], v[196:199], a[140:143], v[124:127]
  s_mul_i32 s70, s70, 917504
  ds_read_b64_tr_b16 v[158:159], v231 offset:18432
  v_fma_f32 v62, v62, v250, -v242
  v_fma_f32 v63, v63, v251, -v243
  v_mfma_f32_16x16x32_bf16 v[128:131], v[200:203], a[136:139], v[128:131]
  s_add_u32 m0, s68, 0
  ds_read_b64_tr_b16 v[160:161], v228 offset:20480
  v_cvt_pk_bf16_f32 v56, v56, v57
  v_cvt_pk_bf16_f32 v57, v58, v59
  v_mfma_f32_16x16x32_bf16 v[132:135], v[200:203], a[140:143], v[132:135]
  s_waitcnt vmcnt(29)
  ds_read_b128 a[68:71], v220 offset:4096
  v_cvt_pk_bf16_f32 v58, v60, v61
  v_cvt_pk_bf16_f32 v59, v62, v63
  v_mfma_f32_16x16x32_bf16 v[136:139], v[204:207], a[136:139], v[136:139]
  s_add_u32 s73, s72, 16384
  ds_read_b64_tr_b16 v[162:163], v228 offset:22528
  buffer_store_dwordx4 v[56:59], v208, s[16:19], s87 offen offset:1024 sc1
  v_mfma_f32_16x16x32_bf16 v[140:143], v[204:207], a[140:143], v[140:143]
  s_waitcnt lgkmcnt(5)
  ds_read_b64_tr_b16 v[164:165], v229 offset:20480
  ds_read_b128 a[76:79], v221 offset:4096
  v_fma_f32 v64, v64, v244, -v236
  v_mfma_f32_16x16x32_bf16 v[80:83], v[144:147], a[144:147], v[80:83]
  ds_read_b64_tr_b16 v[166:167], v229 offset:22528
  v_fma_f32 v65, v65, v245, -v237
  v_fma_f32 v66, v66, v246, -v238
  v_mfma_f32_16x16x32_bf16 v[84:87], v[144:147], a[148:151], v[84:87]
  ds_read_b64_tr_b16 v[168:169], v230 offset:20480
  ds_read_b128 a[84:87], v222 offset:4096
  v_fma_f32 v67, v67, v247, -v239
  v_mfma_f32_16x16x32_bf16 v[88:91], v[148:151], a[144:147], v[88:91]
  ds_read_b64_tr_b16 v[170:171], v230 offset:22528
  v_fma_f32 v68, v68, v248, -v240
  v_fma_f32 v69, v69, v249, -v241
  v_mfma_f32_16x16x32_bf16 v[92:95], v[148:151], a[148:151], v[92:95]
  ds_read_b64_tr_b16 v[172:173], v231 offset:20480
  ds_read_b128 a[92:95], v223 offset:4096
  v_fma_f32 v70, v70, v250, -v242
  v_mfma_f32_16x16x32_bf16 v[96:99], v[152:155], a[144:147], v[96:99]
  ds_read_b64_tr_b16 v[174:175], v231 offset:22528
  buffer_load_dwordx4 v216, s[40:43], s72 offen offset:0 lds
  v_fma_f32 v71, v71, v251, -v243
  v_mfma_f32_16x16x32_bf16 v[100:103], v[152:155], a[148:151], v[100:103]
  s_waitcnt lgkmcnt(7)
  ds_read_b64_tr_b16 v[176:177], v228 offset:24576
  v_cvt_pk_bf16_f32 v64, v64, v65
  v_cvt_pk_bf16_f32 v65, v66, v67
  v_mfma_f32_16x16x32_bf16 v[104:107], v[156:159], a[144:147], v[104:107]
  ds_read_b64_tr_b16 v[178:179], v228 offset:26624
  v_cvt_pk_bf16_f32 v66, v68, v69
  v_cvt_pk_bf16_f32 v67, v70, v71
  v_mfma_f32_16x16x32_bf16 v[108:111], v[156:159], a[148:151], v[108:111]
  buffer_store_dwordx4 v[64:67], v208, s[16:19], s87 offen offset:2048 sc1
  ds_read_b64_tr_b16 v[180:181], v229 offset:24576
  v_mfma_f32_16x16x32_bf16 v[112:115], v[160:163], a[144:147], v[112:115]
  buffer_load_dwordx4 v217, s[40:43], s72 offen offset:1024 lds
  ds_read_b64_tr_b16 v[182:183], v229 offset:26624
  v_mfma_f32_16x16x32_bf16 v[116:119], v[160:163], a[148:151], v[116:119]
  s_waitcnt lgkmcnt(5)
  ds_read_b64_tr_b16 v[184:185], v230 offset:24576
  v_fma_f32 v72, v72, v244, -v236
  v_fma_f32 v73, v73, v245, -v237
  v_mfma_f32_16x16x32_bf16 v[120:123], v[164:167], a[144:147], v[120:123]
  buffer_load_dwordx4 v218, s[40:43], s72 offen offset:2048 lds
  ds_read_b64_tr_b16 v[186:187], v230 offset:26624
  v_mfma_f32_16x16x32_bf16 v[124:127], v[164:167], a[148:151], v[124:127]
  ds_read_b64_tr_b16 v[188:189], v231 offset:24576
  v_fma_f32 v74, v74, v246, -v238
  v_fma_f32 v75, v75, v247, -v239
  v_mfma_f32_16x16x32_bf16 v[128:131], v[168:171], a[144:147], v[128:131]
  ds_read_b64_tr_b16 v[190:191], v231 offset:26624
  v_fma_f32 v76, v76, v248, -v240
  v_fma_f32 v77, v77, v249, -v241
  v_mfma_f32_16x16x32_bf16 v[132:135], v[168:171], a[148:151], v[132:135]
  s_waitcnt lgkmcnt(5)
  buffer_load_dwordx4 v219, s[40:43], s72 offen offset:3072 lds
  ds_read_b64_tr_b16 v[192:193], v228 offset:28672
  v_mfma_f32_16x16x32_bf16 v[136:139], v[172:175], a[144:147], v[136:139]
  s_add_u32 m0, s68, 4096
  ds_read_b64_tr_b16 v[194:195], v228 offset:30720
  v_fma_f32 v78, v78, v250, -v242
  v_fma_f32 v79, v79, v251, -v243
  v_mfma_f32_16x16x32_bf16 v[140:143], v[172:175], a[148:151], v[140:143]
  ds_read_b64_tr_b16 v[196:197], v229 offset:28672
  v_cvt_pk_bf16_f32 v72, v72, v73
  v_cvt_pk_bf16_f32 v73, v74, v75
  v_mfma_f32_16x16x32_bf16 v[80:83], v[176:179], a[152:155], v[80:83]
  ds_read_b64_tr_b16 v[198:199], v229 offset:30720
  v_cvt_pk_bf16_f32 v74, v76, v77
  v_cvt_pk_bf16_f32 v75, v78, v79
  v_mfma_f32_16x16x32_bf16 v[84:87], v[176:179], a[156:159], v[84:87]
  s_waitcnt lgkmcnt(5)
  ds_read_b64_tr_b16 v[200:201], v230 offset:28672
  buffer_load_dwordx4 v216, s[40:43], s73 offen offset:0 lds
  v_mfma_f32_16x16x32_bf16 v[88:91], v[180:183], a[152:155], v[88:91]
  s_branch parallel_sum__ssm_conv_h3__mixer_gmlp__prompt_kernel_ps5
parallel_sum__ssm_conv_h3__mixer_gmlp__prompt_kernel_pg5:
  s_branch parallel_sum__ssm_conv_h3__mixer_gmlp__prompt_kernel_pg9
parallel_sum__ssm_conv_h3__mixer_gmlp__prompt_kernel_ps5:
  buffer_store_dwordx4 v[72:75], v208, s[16:19], s87 offen offset:3072 sc1
  ds_read_b64_tr_b16 v[202:203], v230 offset:30720
  v_mfma_f32_16x16x32_bf16 v[92:95], v[180:183], a[156:159], v[92:95]
  ds_read_b64_tr_b16 v[204:205], v231 offset:28672
  buffer_load_dwordx4 v217, s[40:43], s73 offen offset:1024 lds
  v_add_u32 v252, s90, v208
  v_mfma_f32_16x16x32_bf16 v[96:99], v[184:187], a[152:155], v[96:99]
  ds_read_b64_tr_b16 v[206:207], v231 offset:30720
  buffer_load_dwordx4 v218, s[40:43], s73 offen offset:2048 lds
  v_add_u32 v253, 4096, v252
  v_mfma_f32_16x16x32_bf16 v[100:103], v[184:187], a[156:159], v[100:103]
  s_waitcnt lgkmcnt(5)
  buffer_load_dwordx4 v219, s[40:43], s73 offen offset:3072 lds
  v_lshlrev_b32 v254, 9, v1
  v_mfma_f32_16x16x32_bf16 v[104:107], v[188:191], a[152:155], v[104:107]
  s_bfe_u32 s72, s0, 0x40014
  v_add_u32_e64 v9, s69, v208
  v_mfma_f32_16x16x32_bf16 v[108:111], v[188:191], a[156:159], v[108:111]
  s_lshl_b32 s72, s72, 8
  v_mfma_f32_16x16x32_bf16 v[112:115], v[192:195], a[152:155], v[112:115]
  s_waitcnt vmcnt(28) lgkmcnt(0)
  s_barrier
  ds_read_b64_tr_b16 v[144:145], v228 offset:32768
  v_mfma_f32_16x16x32_bf16 v[116:119], v[192:195], a[156:159], v[116:119]
  s_add_u32 m0, s69, 0
  ds_read_b64_tr_b16 v[146:147], v228 offset:34816
  ds_read_b64_tr_b16 v[148:149], v229 offset:32768
  v_mfma_f32_16x16x32_bf16 v[120:123], v[196:199], a[152:155], v[120:123]
  ds_read_b64_tr_b16 v[150:151], v229 offset:34816
  ds_read_b64_tr_b16 v[152:153], v230 offset:32768
  v_mfma_f32_16x16x32_bf16 v[124:127], v[196:199], a[156:159], v[124:127]
  ds_read_b64_tr_b16 v[154:155], v230 offset:34816
  ds_read_b64_tr_b16 v[156:157], v231 offset:32768
  v_mfma_f32_16x16x32_bf16 v[128:131], v[200:203], a[152:155], v[128:131]
  ds_read_b64_tr_b16 v[158:159], v231 offset:34816
  ds_read_b64_tr_b16 v[160:161], v228 offset:36864
  v_mfma_f32_16x16x32_bf16 v[132:135], v[200:203], a[156:159], v[132:135]
  ds_read_b64_tr_b16 v[162:163], v228 offset:38912
  ds_read_b64_tr_b16 v[164:165], v229 offset:36864
  v_mfma_f32_16x16x32_bf16 v[136:139], v[204:207], a[152:155], v[136:139]
  ds_read_b64_tr_b16 v[166:167], v229 offset:38912
  ds_read_b64_tr_b16 v[168:169], v230 offset:36864
  v_mfma_f32_16x16x32_bf16 v[140:143], v[204:207], a[156:159], v[140:143]
  s_waitcnt lgkmcnt(10)
  ds_read_b64_tr_b16 v[170:171], v230 offset:38912
  ds_read_b64_tr_b16 v[172:173], v231 offset:36864
  v_mfma_f32_16x16x32_bf16 v[80:83], v[144:147], a[160:163], v[80:83]
  buffer_load_dwordx4 v224, s[12:15], s70 offen offset:0 lds
  ds_read_b64_tr_b16 v[174:175], v231 offset:38912
  v_mfma_f32_16x16x32_bf16 v[84:87], v[144:147], a[164:167], v[84:87]
  s_waitcnt lgkmcnt(9)
  ds_read_b64_tr_b16 v[176:177], v228 offset:40960
  ds_read_b64_tr_b16 v[178:179], v228 offset:43008
  v_mfma_f32_16x16x32_bf16 v[88:91], v[148:151], a[160:163], v[88:91]
  ds_read_b64_tr_b16 v[180:181], v229 offset:40960
  buffer_load_dwordx4 v225, s[12:15], s70 offen offset:1024 lds
  v_mfma_f32_16x16x32_bf16 v[92:95], v[148:151], a[164:167], v[92:95]
  ds_read_b64_tr_b16 v[182:183], v229 offset:43008
  ds_read_b64_tr_b16 v[184:185], v230 offset:40960
  v_mfma_f32_16x16x32_bf16 v[96:99], v[152:155], a[160:163], v[96:99]
  ds_read_b64_tr_b16 v[186:187], v230 offset:43008
  ds_read_b64_tr_b16 v[188:189], v231 offset:40960
  v_mfma_f32_16x16x32_bf16 v[100:103], v[152:155], a[164:167], v[100:103]
  s_waitcnt lgkmcnt(8)
  buffer_load_dwordx4 v226, s[12:15], s70 offen offset:2048 lds
  ds_read_b64_tr_b16 v[190:191], v231 offset:43008
  v_mfma_f32_16x16x32_bf16 v[104:107], v[156:159], a[160:163], v[104:107]
  ds_read_b64_tr_b16 v[192:193], v228 offset:45056
  ds_read_b64_tr_b16 v[194:195], v228 offset:47104
  v_mfma_f32_16x16x32_bf16 v[108:111], v[156:159], a[164:167], v[108:111]
  ds_read_b64_tr_b16 v[196:197], v229 offset:45056
  ds_read_b64_tr_b16 v[198:199], v229 offset:47104
  v_mfma_f32_16x16x32_bf16 v[112:115], v[160:163], a[160:163], v[112:115]
  ds_read_b64_tr_b16 v[200:201], v230 offset:45056
  ds_read_b64_tr_b16 v[202:203], v230 offset:47104
  v_mfma_f32_16x16x32_bf16 v[116:119], v[160:163], a[164:167], v[116:119]
  buffer_load_dwordx4 v227, s[12:15], s70 offen offset:3072 lds
  ds_read_b64_tr_b16 v[204:205], v231 offset:45056
  v_mfma_f32_16x16x32_bf16 v[120:123], v[164:167], a[160:163], v[120:123]
  ds_read_b64_tr_b16 v[206:207], v231 offset:47104
  ds_read_b64_tr_b16 v[144:145], v228 offset:49152
  v_mfma_f32_16x16x32_bf16 v[124:127], v[164:167], a[164:167], v[124:127]
  ds_read_b64_tr_b16 v[146:147], v228 offset:51200
  ds_read_b64_tr_b16 v[148:149], v229 offset:49152
  v_mfma_f32_16x16x32_bf16 v[128:131], v[168:171], a[160:163], v[128:131]
  ds_read_b64_tr_b16 v[150:151], v229 offset:51200
  ds_read_b64_tr_b16 v[152:153], v230 offset:49152
  v_mfma_f32_16x16x32_bf16 v[132:135], v[168:171], a[164:167], v[132:135]
  s_waitcnt lgkmcnt(9)
  ds_read_b64_tr_b16 v[154:155], v230 offset:51200
  ds_read_b64_tr_b16 v[156:157], v231 offset:49152
  v_mfma_f32_16x16x32_bf16 v[136:139], v[172:175], a[160:163], v[136:139]
  s_add_u32 m0, s69, 3968
  ds_read_b64_tr_b16 v[158:159], v231 offset:51200
  ds_read_b64_tr_b16 v[160:161], v228 offset:53248
  v_mfma_f32_16x16x32_bf16 v[140:143], v[172:175], a[164:167], v[140:143]
  ds_read_b64_tr_b16 v[162:163], v228 offset:55296
  ds_read_b64_tr_b16 v[164:165], v229 offset:53248
  v_mfma_f32_16x16x32_bf16 v[80:83], v[176:179], a[168:171], v[80:83]
  ds_read_b64_tr_b16 v[166:167], v229 offset:55296
  ds_read_b64_tr_b16 v[168:169], v230 offset:53248
  v_mfma_f32_16x16x32_bf16 v[84:87], v[176:179], a[172:175], v[84:87]
  ds_read_b64_tr_b16 v[170:171], v230 offset:55296
  ds_read_b64_tr_b16 v[172:173], v231 offset:53248
  v_mfma_f32_16x16x32_bf16 v[88:91], v[180:183], a[168:171], v[88:91]
  buffer_load_dwordx4 v224, s[12:15], s70 offen offset:128 lds
  ds_read_b64_tr_b16 v[174:175], v231 offset:55296
  v_mfma_f32_16x16x32_bf16 v[92:95], v[180:183], a[172:175], v[92:95]
  ds_read_b128 a[96:99], v220 offset:8192
  ds_read_b128 a[104:107], v221 offset:8192
  v_mfma_f32_16x16x32_bf16 v[96:99], v[184:187], a[168:171], v[96:99]
  ds_read_b128 a[112:115], v222 offset:8192
  v_mfma_f32_16x16x32_bf16 v[100:103], v[184:187], a[172:175], v[100:103]
  ds_read_b128 a[120:123], v223 offset:8192
  v_mfma_f32_16x16x32_bf16 v[104:107], v[188:191], a[168:171], v[104:107]
  buffer_load_dwordx4 v225, s[12:15], s70 offen offset:1152 lds
  v_mfma_f32_16x16x32_bf16 v[108:111], v[188:191], a[172:175], v[108:111]
  ds_read_b64_tr_b16 v[176:177], v228 offset:57344
  v_mfma_f32_16x16x32_bf16 v[112:115], v[192:195], a[168:171], v[112:115]
  ds_read_b64_tr_b16 v[178:179], v228 offset:59392
  v_mfma_f32_16x16x32_bf16 v[116:119], v[192:195], a[172:175], v[116:119]
  ds_read_b64_tr_b16 v[180:181], v229 offset:57344
  v_mfma_f32_16x16x32_bf16 v[120:123], v[196:199], a[168:171], v[120:123]
  buffer_load_dwordx4 v226, s[12:15], s70 offen offset:2176 lds
  v_mfma_f32_16x16x32_bf16 v[124:127], v[196:199], a[172:175], v[124:127]
  s_waitcnt lgkmcnt(3)
  ds_read_b64_tr_b16 v[182:183], v229 offset:59392
  v_mfma_f32_16x16x32_bf16 v[128:131], v[200:203], a[168:171], v[128:131]
  ds_read_b64_tr_b16 v[184:185], v230 offset:57344
  v_mfma_f32_16x16x32_bf16 v[132:135], v[200:203], a[172:175], v[132:135]
  ds_read_b64_tr_b16 v[186:187], v230 offset:59392
  v_mfma_f32_16x16x32_bf16 v[136:139], v[204:207], a[168:171], v[136:139]
  buffer_load_dwordx4 v227, s[12:15], s70 offen offset:3200 lds
  v_mfma_f32_16x16x32_bf16 v[140:143], v[204:207], a[172:175], v[140:143]
  ds_read_b64_tr_b16 v[188:189], v231 offset:57344
  v_mfma_f32_16x16x32_bf16 v[80:83], v[144:147], a[176:179], v[80:83]
  ds_read_b64_tr_b16 v[190:191], v231 offset:59392
  v_mfma_f32_16x16x32_bf16 v[84:87], v[144:147], a[180:183], v[84:87]
  ds_read_b64_tr_b16 v[192:193], v228 offset:61440
  v_mfma_f32_16x16x32_bf16 v[88:91], v[148:151], a[176:179], v[88:91]
  ds_read_b64_tr_b16 v[194:195], v228 offset:63488
  v_mfma_f32_16x16x32_bf16 v[92:95], v[148:151], a[180:183], v[92:95]
  s_add_u32 m0, s68, 8192
  ds_read_b64_tr_b16 v[196:197], v229 offset:61440
  v_mfma_f32_16x16x32_bf16 v[96:99], v[152:155], a[176:179], v[96:99]
  ds_read_b64_tr_b16 v[198:199], v229 offset:63488
  v_mfma_f32_16x16x32_bf16 v[100:103], v[152:155], a[180:183], v[100:103]
  ds_read_b64_tr_b16 v[200:201], v230 offset:61440
  v_mfma_f32_16x16x32_bf16 v[104:107], v[156:159], a[176:179], v[104:107]
  s_add_u32 s73, s72, 16384
  ds_read_b64_tr_b16 v[202:203], v230 offset:63488
  v_mfma_f32_16x16x32_bf16 v[108:111], v[156:159], a[180:183], v[108:111]
  ds_read_b64_tr_b16 v[204:205], v231 offset:61440
  v_mfma_f32_16x16x32_bf16 v[112:115], v[160:163], a[176:179], v[112:115]
  ds_read_b64_tr_b16 v[206:207], v231 offset:63488
  v_mfma_f32_16x16x32_bf16 v[116:119], v[160:163], a[180:183], v[116:119]
  s_waitcnt vmcnt(31)
  ds_read_b128 a[100:103], v220 offset:12288
  ds_read_b128 a[108:111], v221 offset:12288
  v_mfma_f32_16x16x32_bf16 v[120:123], v[164:167], a[176:179], v[120:123]
  s_waitcnt vmcnt(11)
  buffer_store_dword v13, v14, s[16:19], s88 offen sc1
  v_mfma_f32_16x16x32_bf16 v[124:127], v[164:167], a[180:183], v[124:127]
  ds_read_b128 a[116:119], v222 offset:12288
  v_lshrrev_b32 v211, 2, v1
  v_and_b32_e64 v3, 3, v1
  v_lshl_add_u32 v211, v211, 3, v3
  v_add_u32 v211, s63, v211
  v_lshlrev_b32 v211, 1, v211
  v_mfma_f32_16x16x32_bf16 v[128:131], v[168:171], a[176:179], v[128:131]
  ds_read_b128 a[124:127], v223 offset:12288
  v_lshlrev_b32_e64 v10, 4, v1
  v_mfma_f32_16x16x32_bf16 v[132:135], v[168:171], a[180:183], v[132:135]
  buffer_load_dwordx4 v[236:239], v10, s[16:19], s99 offen offset:0 sc1
  buffer_load_dwordx4 v216, s[40:43], s72 offen offset:0 lds
  v_mfma_f32_16x16x32_bf16 v[136:139], v[172:175], a[176:179], v[136:139]
  buffer_load_dwordx4 v[240:243], v10, s[16:19], s99 offen offset:256 sc1
  v_mfma_f32_16x16x32_bf16 v[140:143], v[172:175], a[180:183], v[140:143]
  s_waitcnt lgkmcnt(2)
  buffer_load_dwordx4 v217, s[40:43], s72 offen offset:1024 lds
  v_mfma_f32_16x16x32_bf16 v[80:83], v[176:179], a[184:187], v[80:83]
  buffer_load_dwordx4 v[244:247], v10, s[16:19], s99 offen offset:512 sc1
  v_mfma_f32_16x16x32_bf16 v[84:87], v[176:179], a[188:191], v[84:87]
  buffer_load_dwordx4 v[248:251], v10, s[16:19], s99 offen offset:768 sc1
  v_mfma_f32_16x16x32_bf16 v[88:91], v[180:183], a[184:187], v[88:91]
  buffer_load_dwordx4 v218, s[40:43], s72 offen offset:2048 lds
  v_mfma_f32_16x16x32_bf16 v[92:95], v[180:183], a[188:191], v[92:95]
  v_mfma_f32_16x16x32_bf16 v[96:99], v[184:187], a[184:187], v[96:99]
  buffer_load_dwordx4 v219, s[40:43], s72 offen offset:3072 lds
  v_mfma_f32_16x16x32_bf16 v[100:103], v[184:187], a[188:191], v[100:103]
  v_mfma_f32_16x16x32_bf16 v[104:107], v[188:191], a[184:187], v[104:107]
  v_mfma_f32_16x16x32_bf16 v[108:111], v[188:191], a[188:191], v[108:111]
  v_mfma_f32_16x16x32_bf16 v[112:115], v[192:195], a[184:187], v[112:115]
  s_barrier
  ds_read_b64_tr_b16 v[144:145], v232 offset:0
  v_mfma_f32_16x16x32_bf16 v[116:119], v[192:195], a[188:191], v[116:119]
  s_waitcnt lgkmcnt(1)
  s_add_u32 m0, s68, 12288
  ds_read_b64_tr_b16 v[146:147], v232 offset:2048
  ds_read_b64_tr_b16 v[148:149], v233 offset:0
  v_mfma_f32_16x16x32_bf16 v[120:123], v[196:199], a[184:187], v[120:123]
  ds_read_b64_tr_b16 v[150:151], v233 offset:2048
  ds_read_b64_tr_b16 v[152:153], v234 offset:0
  v_mfma_f32_16x16x32_bf16 v[124:127], v[196:199], a[188:191], v[124:127]
  ds_read_b64_tr_b16 v[154:155], v234 offset:2048
  ds_read_b64_tr_b16 v[156:157], v235 offset:0
  v_mfma_f32_16x16x32_bf16 v[128:131], v[200:203], a[184:187], v[128:131]
  ds_write_b128 v9, v[16:19] offset:32768
  ds_read_b64_tr_b16 v[158:159], v235 offset:2048
  v_mfma_f32_16x16x32_bf16 v[132:135], v[200:203], a[188:191], v[132:135]
  ds_read_b64_tr_b16 v[160:161], v232 offset:4096
  ds_read_b64_tr_b16 v[162:163], v232 offset:6144
  v_mfma_f32_16x16x32_bf16 v[136:139], v[204:207], a[184:187], v[136:139]
  ds_write_b128 v9, v[24:27] offset:33792
  ds_read_b64_tr_b16 v[164:165], v233 offset:4096
  v_mfma_f32_16x16x32_bf16 v[140:143], v[204:207], a[188:191], v[140:143]
  s_waitcnt lgkmcnt(10)
  ds_write_b128 v9, v[32:35] offset:34816
  ds_read_b64_tr_b16 v[166:167], v233 offset:6144
  v_mfma_f32_16x16x32_bf16 v[80:83], v[144:147], a[192:195], v[80:83]
  ds_read_b64_tr_b16 v[168:169], v234 offset:4096
  ds_read_b64_tr_b16 v[170:171], v234 offset:6144
  v_mfma_f32_16x16x32_bf16 v[84:87], v[144:147], a[196:199], v[84:87]
  s_waitcnt lgkmcnt(10)
  ds_write_b128 v9, v[40:43] offset:35840
  ds_read_b128 a[128:131], v220 offset:0
  v_mfma_f32_16x16x32_bf16 v[88:91], v[148:151], a[192:195], v[88:91]
  buffer_load_dwordx4 v216, s[40:43], s73 offen offset:0 lds
  ds_read_b64_tr_b16 v[172:173], v235 offset:4096
  v_mfma_f32_16x16x32_bf16 v[92:95], v[148:151], a[196:199], v[92:95]
  ds_write_b128 v9, v[48:51] offset:36864
  ds_read_b64_tr_b16 v[174:175], v235 offset:6144
  v_mfma_f32_16x16x32_bf16 v[96:99], v[152:155], a[192:195], v[96:99]
  ds_read_b128 a[136:139], v221 offset:0
  ds_read_b64_tr_b16 v[176:177], v232 offset:8192
  v_mfma_f32_16x16x32_bf16 v[100:103], v[152:155], a[196:199], v[100:103]
  s_waitcnt lgkmcnt(9)
  buffer_load_dwordx4 v217, s[40:43], s73 offen offset:1024 lds
  ds_read_b64_tr_b16 v[178:179], v232 offset:10240
  v_mfma_f32_16x16x32_bf16 v[104:107], v[156:159], a[192:195], v[104:107]
  ds_write_b128 v9, v[56:59] offset:37888
  ds_read_b128 a[144:147], v222 offset:0
  v_mfma_f32_16x16x32_bf16 v[108:111], v[156:159], a[196:199], v[108:111]
  ds_read_b64_tr_b16 v[180:181], v233 offset:8192
  ds_read_b64_tr_b16 v[182:183], v233 offset:10240
  v_mfma_f32_16x16x32_bf16 v[112:115], v[160:163], a[192:195], v[112:115]
  ds_write_b128 v9, v[64:67] offset:38912
  ds_read_b128 a[152:155], v223 offset:0
  v_mfma_f32_16x16x32_bf16 v[116:119], v[160:163], a[196:199], v[116:119]
  buffer_load_dwordx4 v218, s[40:43], s73 offen offset:2048 lds
  ds_read_b64_tr_b16 v[184:185], v234 offset:8192
  v_mfma_f32_16x16x32_bf16 v[120:123], v[164:167], a[192:195], v[120:123]
  ds_write_b128 v9, v[72:75] offset:39936
  ds_read_b64_tr_b16 v[186:187], v234 offset:10240
  v_mfma_f32_16x16x32_bf16 v[124:127], v[164:167], a[196:199], v[124:127]
  s_waitcnt lgkmcnt(9)
  ds_read_b64_tr_b16 v[188:189], v235 offset:8192
  buffer_load_dwordx4 v219, s[40:43], s73 offen offset:3072 lds
  v_mfma_f32_16x16x32_bf16 v[128:131], v[168:171], a[192:195], v[128:131]
  s_bfe_u32 s72, s0, 0x40018
  ds_read_b64_tr_b16 v[190:191], v235 offset:10240
  ds_read_b64_tr_b16 v[192:193], v232 offset:12288
  v_mfma_f32_16x16x32_bf16 v[132:135], v[168:171], a[196:199], v[132:135]
  s_lshl_b32 s72, s72, 8
  ds_read_b64_tr_b16 v[194:195], v232 offset:14336
  ds_read_b64_tr_b16 v[196:197], v233 offset:12288
  v_mfma_f32_16x16x32_bf16 v[136:139], v[172:175], a[192:195], v[136:139]
  s_waitcnt lgkmcnt(8)
  s_add_u32 m0, s68, 0
  ds_read_b64_tr_b16 v[198:199], v233 offset:14336
  ds_read_b64_tr_b16 v[200:201], v234 offset:12288
  v_mfma_f32_16x16x32_bf16 v[140:143], v[172:175], a[196:199], v[140:143]
  ds_read_b64_tr_b16 v[202:203], v234 offset:14336
  ds_read_b64_tr_b16 v[204:205], v235 offset:12288
  v_mfma_f32_16x16x32_bf16 v[80:83], v[176:179], a[200:203], v[80:83]
  ds_read_b64_tr_b16 v[206:207], v235 offset:14336
  ds_read_b64_tr_b16 v[144:145], v232 offset:16384
  v_mfma_f32_16x16x32_bf16 v[84:87], v[176:179], a[204:207], v[84:87]
  s_add_u32 s73, s72, 16384
  ds_read_b64_tr_b16 v[146:147], v232 offset:18432
  ds_read_b64_tr_b16 v[148:149], v233 offset:16384
  v_mfma_f32_16x16x32_bf16 v[88:91], v[180:183], a[200:203], v[88:91]
  ds_read_b64_tr_b16 v[150:151], v233 offset:18432
  ds_read_b64_tr_b16 v[152:153], v234 offset:16384
  v_mfma_f32_16x16x32_bf16 v[92:95], v[180:183], a[204:207], v[92:95]
  s_waitcnt vmcnt(21) lgkmcnt(10)
  ds_read_b128 a[132:135], v220 offset:4096
  v_mfma_f32_16x16x32_bf16 v[96:99], v[184:187], a[200:203], v[96:99]
  ds_read_b128 a[140:143], v221 offset:4096
  ds_read_b64_tr_b16 v[154:155], v234 offset:18432
  v_mfma_f32_16x16x32_bf16 v[100:103], v[184:187], a[204:207], v[100:103]
  ds_read_b64_tr_b16 v[156:157], v235 offset:16384
  ds_read_b128 a[148:151], v222 offset:4096
  v_mfma_f32_16x16x32_bf16 v[104:107], v[188:191], a[200:203], v[104:107]
  buffer_load_dwordx4 v216, s[40:43], s72 offen offset:0 lds
  ds_read_b64_tr_b16 v[158:159], v235 offset:18432
  v_mfma_f32_16x16x32_bf16 v[108:111], v[188:191], a[204:207], v[108:111]
  ds_read_b64_tr_b16 v[160:161], v232 offset:20480
  ds_read_b128 a[156:159], v223 offset:4096
  v_mfma_f32_16x16x32_bf16 v[112:115], v[192:195], a[200:203], v[112:115]
  ds_read_b64_tr_b16 v[162:163], v232 offset:22528
  buffer_load_dwordx4 v217, s[40:43], s72 offen offset:1024 lds
  v_mfma_f32_16x16x32_bf16 v[116:119], v[192:195], a[204:207], v[116:119]
  s_waitcnt lgkmcnt(8)
  ds_read_b64_tr_b16 v[164:165], v233 offset:20480
  ds_read_b64_tr_b16 v[166:167], v233 offset:22528
  v_mfma_f32_16x16x32_bf16 v[120:123], v[196:199], a[200:203], v[120:123]
  buffer_load_dword v255, v254, s[16:19], s89 offen sc1
  ds_read_b64_tr_b16 v[168:169], v234 offset:20480
  v_mfma_f32_16x16x32_bf16 v[124:127], v[196:199], a[204:207], v[124:127]
  ds_read_b64_tr_b16 v[170:171], v234 offset:22528
  ds_read_b64_tr_b16 v[172:173], v235 offset:20480
  v_mfma_f32_16x16x32_bf16 v[128:131], v[200:203], a[200:203], v[128:131]
  buffer_load_dwordx4 v218, s[40:43], s72 offen offset:2048 lds
  ds_read_b64_tr_b16 v[174:175], v235 offset:22528
  v_mfma_f32_16x16x32_bf16 v[132:135], v[200:203], a[204:207], v[132:135]
  ds_read_b64_tr_b16 v[176:177], v232 offset:24576
  ds_read_b64_tr_b16 v[178:179], v232 offset:26624
  v_mfma_f32_16x16x32_bf16 v[136:139], v[204:207], a[200:203], v[136:139]
  ds_read_b64_tr_b16 v[180:181], v233 offset:24576
  ds_read_b64_tr_b16 v[182:183], v233 offset:26624
  v_mfma_f32_16x16x32_bf16 v[140:143], v[204:207], a[204:207], v[140:143]
  buffer_load_dwordx4 v219, s[40:43], s72 offen offset:3072 lds
  ds_read_b64_tr_b16 v[184:185], v234 offset:24576
  v_mfma_f32_16x16x32_bf16 v[80:83], v[144:147], a[208:211], v[80:83]
  ds_read_b64_tr_b16 v[186:187], v234 offset:26624
  ds_read_b64_tr_b16 v[188:189], v235 offset:24576
  v_mfma_f32_16x16x32_bf16 v[84:87], v[144:147], a[212:215], v[84:87]
  ds_read_b64_tr_b16 v[190:191], v235 offset:26624
  v_mfma_f32_16x16x32_bf16 v[88:91], v[148:151], a[208:211], v[88:91]
  ds_read_b64_tr_b16 v[192:193], v232 offset:28672
  v_mfma_f32_16x16x32_bf16 v[92:95], v[148:151], a[212:215], v[92:95]
  s_waitcnt lgkmcnt(7)
  s_add_u32 m0, s68, 4096
  ds_read_b64_tr_b16 v[194:195], v232 offset:30720
  v_mfma_f32_16x16x32_bf16 v[96:99], v[152:155], a[208:211], v[96:99]
  ds_read_b64_tr_b16 v[196:197], v233 offset:28672
  v_mfma_f32_16x16x32_bf16 v[100:103], v[152:155], a[212:215], v[100:103]
  ds_read_b64_tr_b16 v[198:199], v233 offset:30720
  v_mfma_f32_16x16x32_bf16 v[104:107], v[156:159], a[208:211], v[104:107]
  buffer_load_dwordx4 v216, s[40:43], s73 offen offset:0 lds
  v_mfma_f32_16x16x32_bf16 v[108:111], v[156:159], a[212:215], v[108:111]
  ds_read_b64_tr_b16 v[200:201], v234 offset:28672
  v_mfma_f32_16x16x32_bf16 v[112:115], v[160:163], a[208:211], v[112:115]
  ds_read_b64_tr_b16 v[202:203], v234 offset:30720
  v_mfma_f32_16x16x32_bf16 v[116:119], v[160:163], a[212:215], v[116:119]
  s_waitcnt vmcnt(10)
  ds_read_b128 a[160:163], v220 offset:8192
  v_mfma_f32_16x16x32_bf16 v[120:123], v[164:167], a[208:211], v[120:123]
  ds_read_b128 a[168:171], v221 offset:8192
  v_mfma_f32_16x16x32_bf16 v[124:127], v[164:167], a[212:215], v[124:127]
  buffer_load_dwordx4 v217, s[40:43], s73 offen offset:1024 lds
  v_mfma_f32_16x16x32_bf16 v[128:131], v[168:171], a[208:211], v[128:131]
  ds_read_b128 a[176:179], v222 offset:8192
  v_mfma_f32_16x16x32_bf16 v[132:135], v[168:171], a[212:215], v[132:135]
  buffer_load_dwordx4 v218, s[40:43], s73 offen offset:2048 lds
  v_mfma_f32_16x16x32_bf16 v[136:139], v[172:175], a[208:211], v[136:139]
  ds_read_b64_tr_b16 v[204:205], v235 offset:28672
  v_mfma_f32_16x16x32_bf16 v[140:143], v[172:175], a[212:215], v[140:143]
  ds_read_b128 a[184:187], v223 offset:8192
  v_mfma_f32_16x16x32_bf16 v[80:83], v[176:179], a[216:219], v[80:83]
  ds_read_b64_tr_b16 v[206:207], v235 offset:30720
  v_mfma_f32_16x16x32_bf16 v[84:87], v[176:179], a[220:223], v[84:87]
  s_waitcnt lgkmcnt(4)
  buffer_load_dwordx4 v219, s[40:43], s73 offen offset:3072 lds
  v_mfma_f32_16x16x32_bf16 v[88:91], v[180:183], a[216:219], v[88:91]
  s_bfe_u32 s72, s0, 0x4001c
  v_mfma_f32_16x16x32_bf16 v[92:95], v[180:183], a[220:223], v[92:95]
  v_mfma_f32_16x16x32_bf16 v[96:99], v[184:187], a[216:219], v[96:99]
  v_mfma_f32_16x16x32_bf16 v[100:103], v[184:187], a[220:223], v[100:103]
  s_lshl_b32 s72, s72, 8
  v_mfma_f32_16x16x32_bf16 v[104:107], v[188:191], a[216:219], v[104:107]
  v_mfma_f32_16x16x32_bf16 v[108:111], v[188:191], a[220:223], v[108:111]
  v_mfma_f32_16x16x32_bf16 v[112:115], v[192:195], a[216:219], v[112:115]
  s_waitcnt lgkmcnt(0)
  s_barrier
  ds_read_b64_tr_b16 v[144:145], v228 offset:0
  v_mfma_f32_16x16x32_bf16 v[116:119], v[192:195], a[220:223], v[116:119]
  ds_read_b64_tr_b16 v[146:147], v228 offset:2048
  ds_read_b64_tr_b16 v[148:149], v229 offset:0
  v_mfma_f32_16x16x32_bf16 v[120:123], v[196:199], a[216:219], v[120:123]
  ds_read_b64_tr_b16 v[150:151], v229 offset:2048
  ds_read_b64_tr_b16 v[152:153], v230 offset:0
  v_mfma_f32_16x16x32_bf16 v[124:127], v[196:199], a[220:223], v[124:127]
  ds_read_b64_tr_b16 v[154:155], v230 offset:2048
  ds_read_b64_tr_b16 v[156:157], v231 offset:0
  v_mfma_f32_16x16x32_bf16 v[128:131], v[200:203], a[216:219], v[128:131]
  s_waitcnt vmcnt(6)
  v_cmp_ne_u32_e64 vcc, s64, v255
  s_cbranch_vccnz parallel_sum__ssm_conv_h3__mixer_gmlp__prompt_kernel_zf_slow
parallel_sum__ssm_conv_h3__mixer_gmlp__prompt_kernel_zf_ok:
  ds_read_b64_tr_b16 v[158:159], v231 offset:2048
  v_mfma_f32_16x16x32_bf16 v[132:135], v[200:203], a[220:223], v[132:135]
  s_add_u32 m0, s69, 65536
  ds_read_b64_tr_b16 v[160:161], v228 offset:4096
  ds_read_b64_tr_b16 v[162:163], v228 offset:6144
  v_mfma_f32_16x16x32_bf16 v[136:139], v[204:207], a[216:219], v[136:139]
  buffer_load_dwordx4 v252, s[16:19], s74 offen offset:0 sc1 lds
  ds_read_b64_tr_b16 v[164:165], v229 offset:4096
  v_mfma_f32_16x16x32_bf16 v[140:143], v[204:207], a[220:223], v[140:143]
  s_waitcnt lgkmcnt(8)
  buffer_load_dwordx4 v252, s[16:19], s74 offen offset:1024 sc1 lds
  ds_read_b64_tr_b16 v[166:167], v229 offset:6144
  v_mfma_f32_16x16x32_bf16 v[80:83], v[144:147], a[224:227], v[80:83]
  ds_read_b64_tr_b16 v[168:169], v230 offset:4096
  ds_read_b64_tr_b16 v[170:171], v230 offset:6144
  v_mfma_f32_16x16x32_bf16 v[84:87], v[144:147], a[228:231], v[84:87]
  s_waitcnt lgkmcnt(7)
  buffer_load_dwordx4 v252, s[16:19], s74 offen offset:2048 sc1 lds
  ds_read_b64_tr_b16 v[172:173], v231 offset:4096
  v_mfma_f32_16x16x32_bf16 v[88:91], v[148:151], a[224:227], v[88:91]
  ds_read_b64_tr_b16 v[174:175], v231 offset:6144
  ds_read_b64_tr_b16 v[176:177], v228 offset:8192
  v_mfma_f32_16x16x32_bf16 v[92:95], v[148:151], a[228:231], v[92:95]
  ds_read_b64_tr_b16 v[178:179], v228 offset:10240
  ds_read_b64_tr_b16 v[180:181], v229 offset:8192
  v_mfma_f32_16x16x32_bf16 v[96:99], v[152:155], a[224:227], v[96:99]
  buffer_load_dwordx4 v252, s[16:19], s74 offen offset:3072 sc1 lds
  ds_read_b64_tr_b16 v[182:183], v229 offset:10240
  v_mfma_f32_16x16x32_bf16 v[100:103], v[152:155], a[228:231], v[100:103]
  s_waitcnt lgkmcnt(8)
  s_add_u32 m0, s68, 8192
  ds_read_b64_tr_b16 v[184:185], v230 offset:8192
  v_mfma_f32_16x16x32_bf16 v[104:107], v[156:159], a[224:227], v[104:107]
  s_add_u32 s73, s72, 16384
  ds_read_b64_tr_b16 v[186:187], v230 offset:10240
  ds_read_b64_tr_b16 v[188:189], v231 offset:8192
  v_mfma_f32_16x16x32_bf16 v[108:111], v[156:159], a[228:231], v[108:111]
  ds_read_b64_tr_b16 v[190:191], v231 offset:10240
  ds_read_b64_tr_b16 v[192:193], v228 offset:12288
  v_mfma_f32_16x16x32_bf16 v[112:115], v[160:163], a[224:227], v[112:115]
  ds_read_b64_tr_b16 v[194:195], v228 offset:14336
  ds_read_b64_tr_b16 v[196:197], v229 offset:12288
  v_mfma_f32_16x16x32_bf16 v[116:119], v[160:163], a[228:231], v[116:119]
  ds_read_b64_tr_b16 v[198:199], v229 offset:14336
  ds_read_b64_tr_b16 v[200:201], v230 offset:12288
  v_mfma_f32_16x16x32_bf16 v[120:123], v[164:167], a[224:227], v[120:123]
  ds_read_b64_tr_b16 v[202:203], v230 offset:14336
  ds_read_b64_tr_b16 v[204:205], v231 offset:12288
  v_mfma_f32_16x16x32_bf16 v[124:127], v[164:167], a[228:231], v[124:127]
  s_waitcnt lgkmcnt(10)
  ds_read_b64_tr_b16 v[206:207], v231 offset:14336
  ds_read_b64_tr_b16 v[144:145], v228 offset:16384
  v_mfma_f32_16x16x32_bf16 v[128:131], v[168:171], a[224:227], v[128:131]
  ds_read_b64_tr_b16 v[146:147], v228 offset:18432
  ds_read_b64_tr_b16 v[148:149], v229 offset:16384
  v_mfma_f32_16x16x32_bf16 v[132:135], v[168:171], a[228:231], v[132:135]
  buffer_load_dwordx4 v216, s[40:43], s72 offen offset:0 lds
  ds_read_b64_tr_b16 v[150:151], v229 offset:18432
  v_mfma_f32_16x16x32_bf16 v[136:139], v[172:175], a[224:227], v[136:139]
  buffer_load_dwordx4 v217, s[40:43], s72 offen offset:1024 lds
  ds_read_b64_tr_b16 v[152:153], v230 offset:16384
  v_mfma_f32_16x16x32_bf16 v[140:143], v[172:175], a[228:231], v[140:143]
  buffer_load_dwordx4 v218, s[40:43], s72 offen offset:2048 lds
  ds_read_b64_tr_b16 v[154:155], v230 offset:18432
  v_mfma_f32_16x16x32_bf16 v[80:83], v[176:179], a[232:235], v[80:83]
  buffer_load_dwordx4 v219, s[40:43], s72 offen offset:3072 lds
  ds_read_b64_tr_b16 v[156:157], v231 offset:16384
  v_mfma_f32_16x16x32_bf16 v[84:87], v[176:179], a[236:239], v[84:87]
  s_add_u32 m0, s69, 69632
  ds_read_b64_tr_b16 v[158:159], v231 offset:18432
  ds_read_b64_tr_b16 v[160:161], v228 offset:20480
  v_mfma_f32_16x16x32_bf16 v[88:91], v[180:183], a[232:235], v[88:91]
  buffer_load_dwordx4 v253, s[16:19], s74 offen offset:0 sc1 lds
  ds_read_b64_tr_b16 v[162:163], v228 offset:22528
  v_mfma_f32_16x16x32_bf16 v[92:95], v[180:183], a[236:239], v[92:95]
  s_waitcnt lgkmcnt(6)
  buffer_load_dwordx4 v253, s[16:19], s74 offen offset:1024 sc1 lds
  ds_read_b64_tr_b16 v[164:165], v229 offset:20480
  v_mfma_f32_16x16x32_bf16 v[96:99], v[184:187], a[232:235], v[96:99]
  buffer_load_dwordx4 v253, s[16:19], s74 offen offset:2048 sc1 lds
  ds_read_b64_tr_b16 v[166:167], v229 offset:22528
  v_mfma_f32_16x16x32_bf16 v[100:103], v[184:187], a[236:239], v[100:103]
  buffer_load_dwordx4 v253, s[16:19], s74 offen offset:3072 sc1 lds
  v_mfma_f32_16x16x32_bf16 v[104:107], v[188:191], a[232:235], v[104:107]
  s_bfe_u32 s74, s0, 0x40008
  ds_read_b64_tr_b16 v[168:169], v230 offset:20480
  v_mfma_f32_16x16x32_bf16 v[108:111], v[188:191], a[236:239], v[108:111]
  s_lshl_b32 s74, s74, 15
  ds_read_b64_tr_b16 v[170:171], v230 offset:22528
  v_mfma_f32_16x16x32_bf16 v[112:115], v[192:195], a[232:235], v[112:115]
  v_cvt_pk_bf16_f32 v3, -v212, -v212
  v_lshlrev_b32_e64 v8, 16, v3
  v_mfma_f32_16x16x32_bf16 v[116:119], v[192:195], a[236:239], v[116:119]
  v_sub_f32_e64 v8, -v212, v8
  v_cvt_pk_bf16_f32 v8, v8, v8
  v_mfma_f32_16x16x32_bf16 v[120:123], v[196:199], a[232:235], v[120:123]
  v_mov_b32 v4, 0
  v_mov_b32 v5, 0
  v_mfma_f32_16x16x32_bf16 v[124:127], v[196:199], a[236:239], v[124:127]
  ds_read_b64_tr_b16 v[172:173], v231 offset:20480
  v_mov_b32_dpp v4, v3 quad_perm:[0,1,2,3] row_mask:0x1 bank_mask:0xf
  v_mfma_f32_16x16x32_bf16 v[128:131], v[200:203], a[232:235], v[128:131]
  ds_read_b64_tr_b16 v[174:175], v231 offset:22528
  v_mov_b32_dpp v4, v8 quad_perm:[0,1,2,3] row_mask:0x2 bank_mask:0xf
  v_mfma_f32_16x16x32_bf16 v[132:135], v[200:203], a[236:239], v[132:135]
  ds_read_b64_tr_b16 v[176:177], v228 offset:24576
  v_cvt_pk_bf16_f32 v3, -v213, -v213
  v_mfma_f32_16x16x32_bf16 v[136:139], v[204:207], a[232:235], v[136:139]
  ds_read_b64_tr_b16 v[178:179], v228 offset:26624
  v_lshlrev_b32_e64 v8, 16, v3
  v_mfma_f32_16x16x32_bf16 v[140:143], v[204:207], a[236:239], v[140:143]
  ds_read_b64_tr_b16 v[180:181], v229 offset:24576
  v_sub_f32_e64 v8, -v213, v8
  v_mfma_f32_16x16x32_bf16 v[80:83], v[144:147], a[240:243], v[80:83]
  ds_read_b64_tr_b16 v[182:183], v229 offset:26624
  v_cvt_pk_bf16_f32 v8, v8, v8
  v_mfma_f32_16x16x32_bf16 v[84:87], v[144:147], a[244:247], v[84:87]
  ds_read_b64_tr_b16 v[184:185], v230 offset:24576
  v_mov_b32_e64 v6, 0
  v_mfma_f32_16x16x32_bf16 v[88:91], v[148:151], a[240:243], v[88:91]
  ds_read_b64_tr_b16 v[186:187], v230 offset:26624
  v_mov_b32_e64 v7, 0
  v_mfma_f32_16x16x32_bf16 v[92:95], v[148:151], a[244:247], v[92:95]
  s_waitcnt lgkmcnt(5)
  ds_read_b64_tr_b16 v[188:189], v231 offset:24576
  v_mov_b32_dpp v6, v3 quad_perm:[0,1,2,3] row_mask:0x1 bank_mask:0xf
  v_mfma_f32_16x16x32_bf16 v[96:99], v[152:155], a[240:243], v[96:99]
  ds_read_b64_tr_b16 v[190:191], v231 offset:26624
  v_mov_b32_dpp v6, v8 quad_perm:[0,1,2,3] row_mask:0x2 bank_mask:0xf
  v_mfma_f32_16x16x32_bf16 v[100:103], v[152:155], a[244:247], v[100:103]
  ds_read_b64_tr_b16 v[192:193], v228 offset:28672
  v_xor_b32 v3, s62, v237
  v_mfma_f32_16x16x32_bf16 v[104:107], v[156:159], a[240:243], v[104:107]
  ds_read_b64_tr_b16 v[194:195], v228 offset:30720
  v_bitop3_b32 v3, v3, v239, s62 bitop3:0xf6
  v_mfma_f32_16x16x32_bf16 v[108:111], v[156:159], a[244:247], v[108:111]
  ds_read_b64_tr_b16 v[196:197], v229 offset:28672
  v_bitop3_b32 v3, v3, v241, s62 bitop3:0xf6
  v_mfma_f32_16x16x32_bf16 v[112:115], v[160:163], a[240:243], v[112:115]
  ds_read_b64_tr_b16 v[198:199], v229 offset:30720
  v_bitop3_b32 v3, v3, v243, s62 bitop3:0xf6
  v_mfma_f32_16x16x32_bf16 v[116:119], v[160:163], a[244:247], v[116:119]
  s_branch parallel_sum__ssm_conv_h3__mixer_gmlp__prompt_kernel_ps6
parallel_sum__ssm_conv_h3__mixer_gmlp__prompt_kernel_pg6:
  s_branch parallel_sum__ssm_conv_h3__mixer_gmlp__prompt_kernel_pg10
parallel_sum__ssm_conv_h3__mixer_gmlp__prompt_kernel_ps6:
  ds_read_b64_tr_b16 v[200:201], v230 offset:28672
  v_bitop3_b32 v3, v3, v245, s62 bitop3:0xf6
  v_mfma_f32_16x16x32_bf16 v[120:123], v[164:167], a[240:243], v[120:123]
  ds_read_b64_tr_b16 v[202:203], v230 offset:30720
  v_bitop3_b32 v3, v3, v247, s62 bitop3:0xf6
  v_mfma_f32_16x16x32_bf16 v[124:127], v[164:167], a[244:247], v[124:127]
  ds_read_b64_tr_b16 v[204:205], v231 offset:28672
  v_bitop3_b32 v3, v3, v249, s62 bitop3:0xf6
  v_mfma_f32_16x16x32_bf16 v[128:131], v[168:171], a[240:243], v[128:131]
  ds_read_b64_tr_b16 v[206:207], v231 offset:30720
  v_bitop3_b32 v3, v3, v251, s62 bitop3:0xf6
  v_mfma_f32_16x16x32_bf16 v[132:135], v[168:171], a[244:247], v[132:135]
  v_cmp_ne_u32 vcc, 0, v3
  s_cbranch_vccnz parallel_sum__ssm_conv_h3__mixer_gmlp__prompt_kernel_cs1_slow
parallel_sum__ssm_conv_h3__mixer_gmlp__prompt_kernel_cs1_ok:
  v_mfma_f32_16x16x32_bf16 v[136:139], v[172:175], a[240:243], v[136:139]
  v_mfma_f32_16x16x32_bf16 v[140:143], v[172:175], a[244:247], v[140:143]
  s_waitcnt lgkmcnt(3)
  v_mfma_f32_16x16x32_bf16 v[80:83], v[176:179], a[248:251], v[80:83]
  v_mfma_f32_16x16x32_bf16 v[84:87], v[176:179], a[252:255], v[84:87]
  v_mfma_f32_16x16x32_bf16 v[88:91], v[180:183], a[248:251], v[88:91]
  v_mfma_f32_16x16x32_bf16 v[92:95], v[180:183], a[252:255], v[92:95]
  v_mfma_f32_16x16x32_bf16 v[96:99], v[184:187], a[248:251], v[96:99]
  v_mfma_f32_16x16x32_bf16 v[100:103], v[184:187], a[252:255], v[100:103]
  v_mfma_f32_16x16x32_bf16 v[104:107], v[188:191], a[248:251], v[104:107]
  v_mfma_f32_16x16x32_bf16 v[108:111], v[188:191], a[252:255], v[108:111]
  v_mfma_f32_16x16x32_bf16 v[112:115], v[192:195], a[248:251], v[112:115]
  s_waitcnt lgkmcnt(0)
  s_barrier
  v_mfma_f32_16x16x32_bf16 v[116:119], v[192:195], a[252:255], v[116:119]
  s_add_u32 m0, s69, 0
  ds_read_b128 v[144:147], v208 offset:32768
  v_mfma_f32_16x16x32_bf16 v[120:123], v[196:199], a[248:251], v[120:123]
  ds_read_b128 v[148:151], v208 offset:33792
  v_mfma_f32_16x16x32_bf16 v[124:127], v[196:199], a[252:255], v[124:127]
  buffer_load_dwordx4 v252, s[16:19], s74 offen offset:0 sc1 lds
  v_mfma_f32_16x16x32_bf16 v[128:131], v[200:203], a[248:251], v[128:131]
  ds_read_b128 v[152:155], v208 offset:34816
  v_mfma_f32_16x16x32_bf16 v[132:135], v[200:203], a[252:255], v[132:135]
  ds_read_b128 v[156:159], v208 offset:35840
  v_mfma_f32_16x16x32_bf16 v[136:139], v[204:207], a[248:251], v[136:139]
  buffer_load_dwordx4 v252, s[16:19], s74 offen offset:1024 sc1 lds
  v_mfma_f32_16x16x32_bf16 v[140:143], v[204:207], a[252:255], v[140:143]
  ds_read_b128 v[160:163], v208 offset:36864
  v_mfma_f32_16x16x16_bf16 v[80:83], v[236:237], v[4:5], v[80:83]
  ds_read_b128 v[164:167], v208 offset:37888
  v_mfma_f32_16x16x16_bf16 v[84:87], v[236:237], v[6:7], v[84:87]
  buffer_load_dwordx4 v252, s[16:19], s74 offen offset:2048 sc1 lds
  v_mfma_f32_16x16x16_bf16 v[88:91], v[238:239], v[4:5], v[88:91]
  ds_read_b128 v[168:171], v208 offset:38912
  v_mfma_f32_16x16x16_bf16 v[92:95], v[238:239], v[6:7], v[92:95]
  buffer_load_dwordx4 v252, s[16:19], s74 offen offset:3072 sc1 lds
  v_mfma_f32_16x16x16_bf16 v[96:99], v[240:241], v[4:5], v[96:99]
  ds_read_b128 v[172:175], v208 offset:39936
  v_mfma_f32_16x16x16_bf16 v[100:103], v[240:241], v[6:7], v[100:103]
  ds_read_b128 v[176:179], v208 offset:40960
  v_mfma_f32_16x16x16_bf16 v[104:107], v[242:243], v[4:5], v[104:107]
  s_add_u32 m0, s69, 4096
  ds_read_b128 v[180:183], v208 offset:41984
  v_mfma_f32_16x16x16_bf16 v[108:111], v[242:243], v[6:7], v[108:111]
  ds_read_b128 v[184:187], v208 offset:43008
  v_mfma_f32_16x16x16_bf16 v[112:115], v[244:245], v[4:5], v[112:115]
  ds_read_b128 v[188:191], v208 offset:44032
  v_mfma_f32_16x16x16_bf16 v[116:119], v[244:245], v[6:7], v[116:119]
  ds_read_b128 a[164:167], v220 offset:12288
  v_mfma_f32_16x16x16_bf16 v[120:123], v[246:247], v[4:5], v[120:123]
  ds_read_b128 a[172:175], v221 offset:12288
  v_mfma_f32_16x16x16_bf16 v[124:127], v[246:247], v[6:7], v[124:127]
  buffer_load_dwordx4 v253, s[16:19], s74 offen offset:0 sc1 lds
  v_mfma_f32_16x16x16_bf16 v[128:131], v[248:249], v[4:5], v[128:131]
  ds_read_b128 a[180:183], v222 offset:12288
  v_mfma_f32_16x16x16_bf16 v[132:135], v[248:249], v[6:7], v[132:135]
  buffer_load_dwordx4 v253, s[16:19], s74 offen offset:1024 sc1 lds
  v_mfma_f32_16x16x16_bf16 v[136:139], v[250:251], v[4:5], v[136:139]
  ds_read_b128 a[188:191], v223 offset:12288
  v_mfma_f32_16x16x16_bf16 v[140:143], v[250:251], v[6:7], v[140:143]
  s_waitcnt lgkmcnt(3)
  buffer_load_dwordx4 v253, s[16:19], s74 offen offset:2048 sc1 lds
  v_mfma_f32_16x16x32_bf16 v[16:19], v[144:147], a[0:3], 0
  s_lshl_b32 s4, s60, 1
  s_lshr_b32 s5, s3, 1
  s_add_u32 s4, s4, s5
  v_mfma_f32_16x16x32_bf16 v[20:23], v[144:147], a[4:7], 0
  buffer_load_dwordx4 v253, s[16:19], s74 offen offset:3072 sc1 lds
  v_mfma_f32_16x16x32_bf16 v[24:27], v[148:151], a[0:3], 0
  s_mul_i32 s88, s4, 4096
  s_lshl_b32 s5, s61, 8
  s_add_u32 s88, s88, s5
  v_mfma_f32_16x16x32_bf16 v[28:31], v[148:151], a[4:7], 0
  s_bfe_u32 s74, s0, 0x4000c
  s_and_b32 s6, s3, 1
  ds_read_b128 v[192:195], v208 offset:45056
  v_mfma_f32_16x16x32_bf16 v[32:35], v[152:155], a[0:3], 0
  s_lshl_b32 s5, s6, 7
  v_mul_f32 v226, v214, v214
  v_mul_f32 v227, v215, v215
  v_mfma_f32_16x16x32_bf16 v[36:39], v[152:155], a[4:7], 0
  s_add_u32 s88, s88, s5
  v_mul_f32 v224, 0xc0135761, v214
  v_mul_f32 v225, 0xc0135761, v215
  v_mfma_f32_16x16x32_bf16 v[40:43], v[156:159], a[0:3], 0
  s_lshl_b32 s74, s74, 15
  v_mul_f32 v226, v226, v214
  v_mul_f32 v227, v227, v215
  v_mfma_f32_16x16x32_bf16 v[44:47], v[156:159], a[4:7], 0
  s_add_u32 s88, s88, 1310720
  ds_read_b128 v[196:199], v208 offset:46080
  v_mul_f32 v226, 0xbdd2d3e8, v226
  v_mfma_f32_16x16x32_bf16 v[48:51], v[160:163], a[0:3], 0
  s_mul_i32 s4, s4, 14
  ds_read_b128 v[200:203], v208 offset:47104
  v_mul_f32 v227, 0xbdd2d3e8, v227
  v_mfma_f32_16x16x32_bf16 v[52:55], v[160:163], a[4:7], 0
  s_waitcnt vmcnt(24)
  ds_read_b128 a[192:195], v220 offset:0
  v_mul_f32_e64 v236, v80, v80
  v_mfma_f32_16x16x32_bf16 v[56:59], v[164:167], a[0:3], 0
  s_waitcnt lgkmcnt(3)
  s_add_u32 m0, s68, 12288
  ds_read_b128 a[200:203], v221 offset:0
  v_mfma_f32_16x16x32_bf16 v[60:63], v[164:167], a[4:7], 0
  s_add_u32 s4, s4, s61
  ds_read_b128 a[208:211], v222 offset:0
  v_mul_f32_e64 v237, v81, v81
  v_mfma_f32_16x16x32_bf16 v[64:67], v[168:171], a[0:3], 0
  buffer_load_dwordx4 v216, s[40:43], s73 offen offset:0 lds
  v_mfma_f32_16x16x32_bf16 v[68:71], v[168:171], a[4:7], 0
  s_lshl_b32 s4, s4, 14
  ds_read_b128 a[216:219], v223 offset:0
  v_mul_f32 v238, v82, v82
  v_mfma_f32_16x16x32_bf16 v[72:75], v[172:175], a[0:3], 0
  buffer_load_dwordx4 v217, s[40:43], s73 offen offset:1024 lds
  v_mfma_f32_16x16x32_bf16 v[76:79], v[172:175], a[4:7], 0
  buffer_load_dwordx4 v218, s[40:43], s73 offen offset:2048 lds
  v_mfma_f32_16x16x32_bf16 v[16:19], v[176:179], a[8:11], v[16:19]
  s_lshl_b32 s6, s6, 11
  ds_read_b128 v[204:207], v208 offset:48128
  v_mul_f32 v239, v83, v83
  v_mfma_f32_16x16x32_bf16 v[20:23], v[176:179], a[12:15], v[20:23]
  s_add_u32 s4, s4, s6
  ds_read_b128 v[144:147], v208 offset:49152
  v_fma_f32 v236, v236, v226, v224
  v_mfma_f32_16x16x32_bf16 v[24:27], v[180:183], a[8:11], v[24:27]
  buffer_load_dwordx4 v219, s[40:43], s73 offen offset:3072 lds
  v_mfma_f32_16x16x32_bf16 v[28:31], v[180:183], a[12:15], v[28:31]
  s_add_u32 s82, s4, 25165824
  ds_read_b128 v[148:151], v208 offset:50176
  v_fma_f32 v237, v237, v226, v224
  v_mfma_f32_16x16x32_bf16 v[32:35], v[184:187], a[8:11], v[32:35]
  s_bfe_u32 s72, s1, 0x40000
  ds_read_b128 v[152:155], v208 offset:51200
  v_fma_f32 v238, v238, v226, v224
  v_mfma_f32_16x16x32_bf16 v[36:39], v[184:187], a[12:15], v[36:39]
  ds_read_b128 v[156:159], v208 offset:52224
  v_fma_f32 v239, v239, v226, v224
  v_mfma_f32_16x16x32_bf16 v[40:43], v[188:191], a[8:11], v[40:43]
  s_lshl_b32 s72, s72, 8
  ds_read_b128 v[160:163], v208 offset:53248
  v_mul_f32_e64 v236, v236, v80
  v_mfma_f32_16x16x32_bf16 v[44:47], v[188:191], a[12:15], v[44:47]
  ds_read_b128 v[164:167], v208 offset:54272
  v_mul_f32_e64 v237, v237, v81
  v_mfma_f32_16x16x32_bf16 v[48:51], v[192:195], a[8:11], v[48:51]
  ds_read_b128 v[168:171], v208 offset:55296
  v_mul_f32_e64 v238, v238, v82
  v_mfma_f32_16x16x32_bf16 v[52:55], v[192:195], a[12:15], v[52:55]
  s_waitcnt lgkmcnt(5)
  s_add_u32 m0, s68, 0
  ds_read_b128 v[172:175], v208 offset:56320
  v_mfma_f32_16x16x32_bf16 v[56:59], v[196:199], a[8:11], v[56:59]
  ds_read_b128 v[176:179], v208 offset:57344
  v_mul_f32_e64 v239, v239, v83
  v_mfma_f32_16x16x32_bf16 v[60:63], v[196:199], a[12:15], v[60:63]
  s_add_u32 s73, s72, 16384
  ds_read_b128 v[180:183], v208 offset:58368
  v_mfma_f32_16x16x32_bf16 v[64:67], v[200:203], a[8:11], v[64:67]
  ds_read_b128 v[184:187], v208 offset:59392
  v_mfma_f32_16x16x32_bf16 v[68:71], v[200:203], a[12:15], v[68:71]
  ds_read_b128 v[188:191], v208 offset:60416
  v_mfma_f32_16x16x32_bf16 v[72:75], v[204:207], a[8:11], v[72:75]
  buffer_load_dwordx4 v216, s[40:43], s72 offen offset:0 lds
  v_mfma_f32_16x16x32_bf16 v[76:79], v[204:207], a[12:15], v[76:79]
  v_exp_f32_e64 v236, v236
  v_mfma_f32_16x16x32_bf16 v[16:19], v[144:147], a[16:19], v[16:19]
  buffer_load_dwordx4 v217, s[40:43], s72 offen offset:1024 lds
  v_mfma_f32_16x16x32_bf16 v[20:23], v[144:147], a[20:23], v[20:23]
  ds_read_b128 v[192:195], v208 offset:61440
  v_mfma_f32_16x16x32_bf16 v[24:27], v[148:151], a[16:19], v[24:27]
  ds_read_b128 v[196:199], v208 offset:62464
  v_mfma_f32_16x16x32_bf16 v[28:31], v[148:151], a[20:23], v[28:31]
  s_waitcnt lgkmcnt(2)
  buffer_load_dwordx4 v218, s[40:43], s72 offen offset:2048 lds
  v_mfma_f32_16x16x32_bf16 v[32:35], v[152:155], a[16:19], v[32:35]
  v_exp_f32 v237, v237
  v_mfma_f32_16x16x32_bf16 v[36:39], v[152:155], a[20:23], v[36:39]
  buffer_load_dwordx4 v219, s[40:43], s72 offen offset:3072 lds
  v_mfma_f32_16x16x32_bf16 v[40:43], v[156:159], a[16:19], v[40:43]
  ds_read_b128 v[200:203], v208 offset:63488
  v_mfma_f32_16x16x32_bf16 v[44:47], v[156:159], a[20:23], v[44:47]
  ds_read_b128 v[204:207], v208 offset:64512
  v_mfma_f32_16x16x32_bf16 v[48:51], v[160:163], a[16:19], v[48:51]
  s_lshl_b32 s4, s2, 2
  s_add_u32 s4, s4, s3
  s_lshl_b32 s71, s4, 12
  v_mfma_f32_16x16x32_bf16 v[52:55], v[160:163], a[20:23], v[52:55]
  s_mul_i32 s75, s4, 4096
  v_exp_f32 v238, v238
  v_mfma_f32_16x16x32_bf16 v[56:59], v[164:167], a[16:19], v[56:59]
  s_add_u32 s75, s75, 33554432
  v_exp_f32_e64 v239, v239
  v_mfma_f32_16x16x32_bf16 v[60:63], v[164:167], a[20:23], v[60:63]
  s_add_u32 s86, s71, 5242880
  v_add_f32 v236, 1.0, v236
  v_add_f32 v237, 1.0, v237
  v_mfma_f32_16x16x32_bf16 v[64:67], v[168:171], a[16:19], v[64:67]
  s_lshr_b32 s94, s4, 5
  v_add_f32 v238, 1.0, v238
  v_add_f32_e64 v239, 1.0, v239
  v_mfma_f32_16x16x32_bf16 v[68:71], v[168:171], a[20:23], v[68:71]
  s_mul_i32 s94, s94, 4096
  v_rcp_f32_e64 v236, v236
  v_mfma_f32_16x16x32_bf16 v[72:75], v[172:175], a[16:19], v[72:75]
  s_and_b32 s98, s4, 31
  v_rcp_f32 v237, v237
  v_mfma_f32_16x16x32_bf16 v[76:79], v[172:175], a[20:23], v[76:79]
  s_lshl_b32 s98, s98, 4
  v_rcp_f32 v238, v238
  v_mfma_f32_16x16x32_bf16 v[16:19], v[176:179], a[24:27], v[16:19]
  s_add_u32 s98, s98, s94
  v_rcp_f32 v239, v239
  v_mfma_f32_16x16x32_bf16 v[20:23], v[176:179], a[28:31], v[20:23]
  s_add_u32 s98, s98, 1835008
  v_mul_f32 v80, v80, v236
  v_mul_f32 v81, v81, v237
  v_mfma_f32_16x16x32_bf16 v[24:27], v[180:183], a[24:27], v[24:27]
  s_add_u32 s94, s94, 1572864
  v_mul_f32 v82, v82, v238
  v_mul_f32 v83, v83, v239
  v_mfma_f32_16x16x32_bf16 v[28:31], v[180:183], a[28:31], v[28:31]
  v_mul_f32 v236, v84, v84
  v_mul_f32 v237, v85, v85
  v_mfma_f32_16x16x32_bf16 v[32:35], v[184:187], a[24:27], v[32:35]
  v_mul_f32 v238, v86, v86
  v_mul_f32 v239, v87, v87
  v_mfma_f32_16x16x32_bf16 v[36:39], v[184:187], a[28:31], v[36:39]
  v_fma_f32 v236, v236, v227, v225
  v_fma_f32 v237, v237, v227, v225
  v_mfma_f32_16x16x32_bf16 v[40:43], v[188:191], a[24:27], v[40:43]
  v_mov_b32_e64 v9, 0
  v_fma_f32 v238, v238, v227, v225
  v_mfma_f32_16x16x32_bf16 v[44:47], v[188:191], a[28:31], v[44:47]
  s_waitcnt lgkmcnt(0)
  s_lshl_b32 s87, s95, 17
  v_fma_f32 v239, v239, v227, v225
  v_mfma_f32_16x16x32_bf16 v[48:51], v[192:195], a[24:27], v[48:51]
  s_waitcnt vmcnt(16)
  s_barrier
  v_mfma_f32_16x16x32_bf16 v[52:55], v[192:195], a[28:31], v[52:55]
  s_add_u32 m0, s69, 32768
  ds_read_b128 v[144:147], v210 offset:0
  v_mul_f32_e64 v236, v236, v84
  v_mfma_f32_16x16x32_bf16 v[56:59], v[196:199], a[24:27], v[56:59]
  s_mul_i32 s91, s95, 4096
  ds_read_b128 v[148:151], v210 offset:1024
  v_mul_f32_e64 v237, v237, v85
  v_mfma_f32_16x16x32_bf16 v[60:63], v[196:199], a[28:31], v[60:63]
  s_add_u32 s91, s91, 1310720
  ds_read_b128 v[152:155], v210 offset:2048
  v_mul_f32_e64 v238, v238, v86
  v_mfma_f32_16x16x32_bf16 v[64:67], v[200:203], a[24:27], v[64:67]
  s_lshr_b32 s99, s96, 6
  ds_read_b128 v[156:159], v210 offset:3072
  v_mul_f32 v239, v239, v87
  v_mfma_f32_16x16x32_bf16 v[68:71], v[200:203], a[28:31], v[68:71]
  buffer_load_dwordx4 v252, s[16:19], s74 offen offset:0 sc1 lds
  v_mfma_f32_16x16x32_bf16 v[72:75], v[204:207], a[24:27], v[72:75]
  s_mul_i32 s99, s99, 4096
  ds_read_b128 v[160:163], v210 offset:4096
  s_add_u32 s99, s99, 1835008
  v_mfma_f32_16x16x32_bf16 v[76:79], v[204:207], a[28:31], v[76:79]
  s_waitcnt lgkmcnt(4)
  ds_read_b128 v[164:167], v210 offset:5120
  s_lshl_b32 s100, s96, 11
  v_mfma_f32_16x16x32_bf16 v[16:19], v[144:147], a[32:35], v[16:19]
  buffer_load_dwordx4 v252, s[16:19], s74 offen offset:1024 sc1 lds
  v_mfma_f32_16x16x32_bf16 v[20:23], v[144:147], a[36:39], v[20:23]
  s_waitcnt lgkmcnt(3)
  ds_read_b128 v[168:171], v210 offset:6144
  s_lshl_b32 s5, s95, 7
  v_mfma_f32_16x16x32_bf16 v[24:27], v[148:151], a[32:35], v[24:27]
  s_add_u32 s100, s100, s5
  ds_read_b128 v[172:175], v210 offset:7168
  s_add_u32 s100, s100, 5242880
  v_mfma_f32_16x16x32_bf16 v[28:31], v[148:151], a[36:39], v[28:31]
  buffer_load_dwordx4 v252, s[16:19], s74 offen offset:2048 sc1 lds
  v_mfma_f32_16x16x32_bf16 v[32:35], v[152:155], a[32:35], v[32:35]
  s_lshl_b32 s60, s95, 1
  ds_read_b128 v[176:179], v210 offset:8192
  s_and_b32 s5, s3, 1
  v_mfma_f32_16x16x32_bf16 v[36:39], v[152:155], a[36:39], v[36:39]
  s_waitcnt lgkmcnt(3)
  ds_read_b128 v[180:183], v210 offset:9216
  s_add_u32 s60, s60, s5
  v_mfma_f32_16x16x32_bf16 v[40:43], v[156:159], a[32:35], v[40:43]
  s_lshl_b32 s60, s60, 8
  ds_read_b128 v[184:187], v210 offset:10240
  s_lshl_b32 s63, s3, 12
  v_mfma_f32_16x16x32_bf16 v[44:47], v[156:159], a[36:39], v[44:47]
  buffer_load_dwordx4 v252, s[16:19], s74 offen offset:3072 sc1 lds
  v_mfma_f32_16x16x32_bf16 v[48:51], v[160:163], a[32:35], v[48:51]
  s_lshl_b32 s90, s97, 14
  ds_read_b128 v[188:191], v210 offset:11264
  s_mul_i32 s4, s95, 229376
  v_mfma_f32_16x16x32_bf16 v[52:55], v[160:163], a[36:39], v[52:55]
  s_add_u32 s4, s4, s63
  ds_read_b128 v[192:195], v210 offset:12288
  s_add_u32 s4, s4, 25165824
  v_mfma_f32_16x16x32_bf16 v[56:59], v[164:167], a[32:35], v[56:59]
  s_add_u32 m0, s69, 36864
  ds_read_b128 v[196:199], v210 offset:13312
  v_add_u32 v12, s4, v208
  v_mfma_f32_16x16x32_bf16 v[60:63], v[164:167], a[36:39], v[60:63]
  s_waitcnt lgkmcnt(4)
  ds_read_b128 v[200:203], v210 offset:14336
  s_add_u32 s85, s68, 11808
  v_mfma_f32_16x16x32_bf16 v[64:67], v[168:171], a[32:35], v[64:67]
  s_lshl_b32 s84, s3, 13
  ds_read_b128 v[204:207], v210 offset:15360
  s_add_u32 s84, s84, 65536
  v_mfma_f32_16x16x32_bf16 v[68:71], v[168:171], a[36:39], v[68:71]
  ds_read_b128 v[144:147], v210 offset:16384
  v_add_u32_e64 v250, s85, v208
  v_mfma_f32_16x16x32_bf16 v[72:75], v[172:175], a[32:35], v[72:75]
  buffer_load_dwordx4 v253, s[16:19], s74 offen offset:0 sc1 lds
  v_mfma_f32_16x16x32_bf16 v[76:79], v[172:175], a[36:39], v[76:79]
  ds_read_b128 v[148:151], v210 offset:17408
  v_add_u32_e64 v251, s68, v208
  v_mfma_f32_16x16x32_bf16 v[16:19], v[176:179], a[40:43], v[16:19]
  s_and_b32 s5, s3, 1
  ds_read_b128 v[152:155], v210 offset:18432
  s_lshl_b32 s4, s5, 17
  v_mfma_f32_16x16x32_bf16 v[20:23], v[176:179], a[44:47], v[20:23]
  buffer_load_dwordx4 v253, s[16:19], s74 offen offset:1024 sc1 lds
  v_mfma_f32_16x16x32_bf16 v[24:27], v[180:183], a[40:43], v[24:27]
  s_andn2_b32 s6, s96, 127
  ds_read_b128 v[156:159], v210 offset:19456
  s_add_u32 s4, s4, s6
  v_mfma_f32_16x16x32_bf16 v[28:31], v[180:183], a[44:47], v[28:31]
  s_waitcnt lgkmcnt(3)
  ds_read_b128 a[196:199], v220 offset:4096
  v_lshrrev_b32_e64 v4, 3, v0
  v_mfma_f32_16x16x32_bf16 v[32:35], v[184:187], a[40:43], v[32:35]
  ds_read_b128 a[204:207], v221 offset:4096
  v_lshlrev_b32_e64 v4, 11, v4
  v_mfma_f32_16x16x32_bf16 v[36:39], v[184:187], a[44:47], v[36:39]
  ds_read_b128 a[212:215], v222 offset:4096
  v_and_b32_e64 v5, 7, v0
  v_mfma_f32_16x16x32_bf16 v[40:43], v[188:191], a[40:43], v[40:43]
  buffer_load_dwordx4 v253, s[16:19], s74 offen offset:2048 sc1 lds
  v_mfma_f32_16x16x32_bf16 v[44:47], v[188:191], a[44:47], v[44:47]
  ds_read_b128 a[220:223], v223 offset:4096
  v_lshlrev_b32_e64 v6, 1, v2
  v_mfma_f32_16x16x32_bf16 v[48:51], v[192:195], a[40:43], v[48:51]
  buffer_load_dwordx4 v253, s[16:19], s74 offen offset:3072 sc1 lds
  v_mfma_f32_16x16x32_bf16 v[52:55], v[192:195], a[44:47], v[52:55]
  ds_read_b128 v[160:163], v210 offset:20480
  v_xor_b32_e64 v6, v5, v6
  v_mfma_f32_16x16x32_bf16 v[56:59], v[196:199], a[40:43], v[56:59]
  ds_read_b128 v[164:167], v210 offset:21504
  v_lshlrev_b32_e64 v6, 4, v6
  v_mfma_f32_16x16x32_bf16 v[60:63], v[196:199], a[44:47], v[60:63]
  ds_read_b128 v[168:171], v210 offset:22528
  v_add3_u32 v244, v4, v6, s4
  v_mfma_f32_16x16x32_bf16 v[64:67], v[200:203], a[40:43], v[64:67]
  s_bfe_u32 s74, s0, 0x40010
  v_exp_f32_e64 v236, v236
  v_mfma_f32_16x16x32_bf16 v[68:71], v[200:203], a[44:47], v[68:71]
  ds_read_b128 v[172:175], v210 offset:23552
  v_add_u32 v245, 15360, v244
  v_mfma_f32_16x16x32_bf16 v[72:75], v[204:207], a[40:43], v[72:75]
  v_exp_f32_e64 v237, v237
  v_mfma_f32_16x16x32_bf16 v[76:79], v[204:207], a[44:47], v[76:79]
  s_lshl_b32 s74, s74, 15
  ds_read_b128 v[176:179], v210 offset:24576
  v_add_u32 v246, 30720, v244
  v_mfma_f32_16x16x32_bf16 v[16:19], v[144:147], a[48:51], v[16:19]
  v_exp_f32 v238, v238
  v_mfma_f32_16x16x32_bf16 v[20:23], v[144:147], a[52:55], v[20:23]
  s_waitcnt lgkmcnt(2)
  ds_read_b128 v[180:183], v210 offset:25600
  v_add_u32 v247, 46080, v244
  v_mfma_f32_16x16x32_bf16 v[24:27], v[148:151], a[48:51], v[24:27]
  v_exp_f32 v239, v239
  v_mfma_f32_16x16x32_bf16 v[28:31], v[148:151], a[52:55], v[28:31]
  s_add_u32 m0, s68, 4096
  ds_read_b128 v[184:187], v210 offset:26624
  v_add_f32_e64 v236, 1.0, v236
  v_mfma_f32_16x16x32_bf16 v[32:35], v[152:155], a[48:51], v[32:35]
  ds_read_b128 v[188:191], v210 offset:27648
  v_add_f32_e64 v237, 1.0, v237
  v_mfma_f32_16x16x32_bf16 v[36:39], v[152:155], a[52:55], v[36:39]
  ds_read_b128 v[192:195], v210 offset:28672
  v_add_f32_e64 v238, 1.0, v238
  v_mfma_f32_16x16x32_bf16 v[40:43], v[156:159], a[48:51], v[40:43]
  buffer_load_dwordx4 v216, s[40:43], s73 offen offset:0 lds
  v_mfma_f32_16x16x32_bf16 v[44:47], v[156:159], a[52:55], v[44:47]
  ds_read_b128 v[196:199], v210 offset:29696
  v_add_f32_e64 v239, 1.0, v239
  v_mfma_f32_16x16x32_bf16 v[48:51], v[160:163], a[48:51], v[48:51]
  ds_read_b128 v[200:203], v210 offset:30720
  v_lshlrev_b32_e64 v4, 2, v2
  v_mfma_f32_16x16x32_bf16 v[52:55], v[160:163], a[52:55], v[52:55]
  buffer_load_dwordx4 v217, s[40:43], s73 offen offset:1024 lds
  v_mfma_f32_16x16x32_bf16 v[56:59], v[164:167], a[48:51], v[56:59]
  ds_read_b128 v[204:207], v210 offset:31744
  v_bfe_u32 v6, v0, 2, 2
  v_mfma_f32_16x16x32_bf16 v[60:63], v[164:167], a[52:55], v[60:63]
  v_rcp_f32_e64 v236, v236
  v_mfma_f32_16x16x32_bf16 v[64:67], v[168:171], a[48:51], v[64:67]
  buffer_load_dwordx4 v218, s[40:43], s73 offen offset:2048 lds
  v_mfma_f32_16x16x32_bf16 v[68:71], v[168:171], a[52:55], v[68:71]
  s_waitcnt lgkmcnt(2)
  v_rcp_f32 v237, v237
  v_mfma_f32_16x16x32_bf16 v[72:75], v[172:175], a[48:51], v[72:75]
  v_rcp_f32_e64 v238, v238
  v_mfma_f32_16x16x32_bf16 v[76:79], v[172:175], a[52:55], v[76:79]
  buffer_load_dwordx4 v219, s[40:43], s73 offen offset:3072 lds
  v_mfma_f32_16x16x32_bf16 v[16:19], v[176:179], a[56:59], v[16:19]
  v_rcp_f32_e64 v239, v239
  v_mfma_f32_16x16x32_bf16 v[20:23], v[176:179], a[60:63], v[20:23]
  v_mul_f32 v84, v84, v236
  v_mul_f32 v85, v85, v237
  v_mfma_f32_16x16x32_bf16 v[24:27], v[180:183], a[56:59], v[24:27]
  s_bfe_u32 s72, s1, 0x40004
  v_mul_f32 v86, v86, v238
  v_mul_f32 v87, v87, v239
  v_mfma_f32_16x16x32_bf16 v[28:31], v[180:183], a[60:63], v[28:31]
  v_mul_f32 v236, v88, v88
  v_mul_f32 v237, v89, v89
  v_mfma_f32_16x16x32_bf16 v[32:35], v[184:187], a[56:59], v[32:35]
  v_mul_f32 v238, v90, v90
  v_mul_f32 v239, v91, v91
  v_mfma_f32_16x16x32_bf16 v[36:39], v[184:187], a[60:63], v[36:39]
  s_lshl_b32 s72, s72, 8
  v_fma_f32 v236, v236, v226, v224
  v_fma_f32 v237, v237, v226, v224
  v_mfma_f32_16x16x32_bf16 v[40:43], v[188:191], a[56:59], v[40:43]
  v_fma_f32 v238, v238, v226, v224
  v_fma_f32 v239, v239, v226, v224
  v_mfma_f32_16x16x32_bf16 v[44:47], v[188:191], a[60:63], v[44:47]
  v_mul_f32 v236, v236, v88
  v_mul_f32_e64 v237, v237, v89
  v_mfma_f32_16x16x32_bf16 v[48:51], v[192:195], a[56:59], v[48:51]
  s_waitcnt vmcnt(20) lgkmcnt(0)
  s_barrier
  v_mfma_f32_16x16x32_bf16 v[52:55], v[192:195], a[60:63], v[52:55]
  s_add_u32 m0, s69, 65536
  ds_read_b128 v[144:147], v208 offset:0
  v_mul_f32_e64 v238, v238, v90
  v_mfma_f32_16x16x32_bf16 v[56:59], v[196:199], a[56:59], v[56:59]
  ds_read_b128 v[148:151], v208 offset:1024
  v_mul_f32_e64 v239, v239, v91
  v_mfma_f32_16x16x32_bf16 v[60:63], v[196:199], a[60:63], v[60:63]
  ds_read_b128 v[152:155], v208 offset:2048
  v_add_u32_e64 v4, v4, v6
  v_mfma_f32_16x16x32_bf16 v[64:67], v[200:203], a[56:59], v[64:67]
  buffer_load_dwordx4 v252, s[16:19], s74 offen offset:0 sc1 lds
  v_mfma_f32_16x16x32_bf16 v[68:71], v[200:203], a[60:63], v[68:71]
  ds_read_b128 v[156:159], v208 offset:3072
  v_bfe_u32 v6, v4, 1, 2
  v_mfma_f32_16x16x32_bf16 v[72:75], v[204:207], a[56:59], v[72:75]
  ds_read_b128 v[160:163], v208 offset:4096
  v_lshlrev_b32_e64 v4, 7, v4
  v_mfma_f32_16x16x32_bf16 v[76:79], v[204:207], a[60:63], v[76:79]
  s_waitcnt lgkmcnt(4)
  buffer_load_dwordx4 v252, s[16:19], s74 offen offset:1024 sc1 lds
  v_mfma_f32_16x16x32_bf16 v[16:19], v[144:147], a[64:67], v[16:19]
  ds_read_b128 v[164:167], v208 offset:5120
  v_lshl_add_u32 v4, v6, 5, v4
  v_mfma_f32_16x16x32_bf16 v[20:23], v[144:147], a[68:71], v[20:23]
  s_waitcnt lgkmcnt(3)
  buffer_load_dwordx4 v252, s[16:19], s74 offen offset:2048 sc1 lds
  v_mfma_f32_16x16x32_bf16 v[24:27], v[148:151], a[64:67], v[24:27]
  ds_read_b128 v[168:171], v208 offset:6144
  v_and_b32_e64 v5, 3, v0
  v_mfma_f32_16x16x32_bf16 v[28:31], v[148:151], a[68:71], v[28:31]
  buffer_load_dwordx4 v252, s[16:19], s74 offen offset:3072 sc1 lds
  v_mfma_f32_16x16x32_bf16 v[32:35], v[152:155], a[64:67], v[32:35]
  ds_read_b128 v[172:175], v208 offset:7168
  v_lshl_add_u32 v4, v5, 3, v4
  v_mfma_f32_16x16x32_bf16 v[36:39], v[152:155], a[68:71], v[36:39]
  s_waitcnt lgkmcnt(3)
  ds_read_b128 v[176:179], v208 offset:8192
  v_add_u32 v240, s68, v4
  v_mfma_f32_16x16x32_bf16 v[40:43], v[156:159], a[64:67], v[40:43]
  s_add_u32 m0, s69, 69632
  ds_read_b128 v[180:183], v208 offset:9216
  v_xor_b32_e64 v241, 32, v240
  v_mfma_f32_16x16x32_bf16 v[44:47], v[156:159], a[68:71], v[44:47]
  ds_read_b128 v[184:187], v208 offset:10240
  v_xor_b32_e64 v242, 64, v240
  v_mfma_f32_16x16x32_bf16 v[48:51], v[160:163], a[64:67], v[48:51]
  ds_read_b128 v[188:191], v208 offset:11264
  v_xor_b32 v243, 96, v240
  v_mfma_f32_16x16x32_bf16 v[52:55], v[160:163], a[68:71], v[52:55]
  s_waitcnt lgkmcnt(5)
  ds_read_b128 a[224:227], v220 offset:8192
  s_sub_u32 s4, s63, s68
  v_mfma_f32_16x16x32_bf16 v[56:59], v[164:167], a[64:67], v[56:59]
  ds_read_b128 a[232:235], v221 offset:8192
  v_add_u32_e64 v232, s4, v240
  v_mfma_f32_16x16x32_bf16 v[60:63], v[164:167], a[68:71], v[60:63]
  buffer_load_dwordx4 v253, s[16:19], s74 offen offset:0 sc1 lds
  v_mfma_f32_16x16x32_bf16 v[64:67], v[168:171], a[64:67], v[64:67]
  ds_read_b128 a[240:243], v222 offset:8192
  v_add_u32_e64 v233, s4, v241
  v_mfma_f32_16x16x32_bf16 v[68:71], v[168:171], a[68:71], v[68:71]
  s_waitcnt lgkmcnt(4)
  buffer_load_dwordx4 v253, s[16:19], s74 offen offset:1024 sc1 lds
  v_mfma_f32_16x16x32_bf16 v[72:75], v[172:175], a[64:67], v[72:75]
  ds_read_b128 a[248:251], v223 offset:8192
  v_add_u32 v234, s4, v242
  v_mfma_f32_16x16x32_bf16 v[76:79], v[172:175], a[68:71], v[76:79]
  ds_read_b128 v[192:195], v208 offset:12288
  v_add_u32_e64 v235, s4, v243
  v_mfma_f32_16x16x32_bf16 v[16:19], v[176:179], a[72:75], v[16:19]
  buffer_load_dwordx4 v253, s[16:19], s74 offen offset:2048 sc1 lds
  v_mfma_f32_16x16x32_bf16 v[20:23], v[176:179], a[76:79], v[20:23]
  s_sub_u32 s4, s84, s68
  ds_read_b128 v[196:199], v208 offset:13312
  v_add_u32 v228, s4, v240
  v_mfma_f32_16x16x32_bf16 v[24:27], v[180:183], a[72:75], v[24:27]
  buffer_load_dwordx4 v253, s[16:19], s74 offen offset:3072 sc1 lds
  v_mfma_f32_16x16x32_bf16 v[28:31], v[180:183], a[76:79], v[28:31]
  s_bfe_u32 s74, s0, 0x40014
  ds_read_b128 v[200:203], v208 offset:14336
  v_add_u32_e64 v229, s4, v241
  v_mfma_f32_16x16x32_bf16 v[32:35], v[184:187], a[72:75], v[32:35]
  ds_read_b128 v[204:207], v208 offset:15360
  v_add_u32_e64 v230, s4, v242
  v_mfma_f32_16x16x32_bf16 v[36:39], v[184:187], a[76:79], v[36:39]
  s_waitcnt lgkmcnt(3)
  ds_read_b128 v[144:147], v208 offset:16384
  v_add_u32 v231, s4, v243
  v_mfma_f32_16x16x32_bf16 v[40:43], v[188:191], a[72:75], v[40:43]
  s_lshl_b32 s74, s74, 15
  ds_read_b128 v[148:151], v208 offset:17408
  s_mul_i32 s4, s5, 10240
  v_mfma_f32_16x16x32_bf16 v[44:47], v[188:191], a[76:79], v[44:47]
  ds_read_b128 v[152:155], v208 offset:18432
  v_add_u32 v248, s4, v208
  v_mfma_f32_16x16x32_bf16 v[48:51], v[192:195], a[72:75], v[48:51]
  s_mul_i32 s4, s5, 6144
  v_exp_f32_e64 v236, v236
  v_mfma_f32_16x16x32_bf16 v[52:55], v[192:195], a[76:79], v[52:55]
  s_waitcnt vmcnt(24) lgkmcnt(4)
  ds_read_b128 a[228:231], v220 offset:12288
  v_mfma_f32_16x16x32_bf16 v[56:59], v[196:199], a[72:75], v[56:59]
  s_add_u32 m0, s68, 8192
  ds_read_b128 a[236:239], v221 offset:12288
  v_add_u32 v249, s4, v208
  v_mfma_f32_16x16x32_bf16 v[60:63], v[196:199], a[76:79], v[60:63]
  s_add_u32 s73, s72, 16384
  ds_read_b128 a[244:247], v222 offset:12288
  v_lshlrev_b32_e64 v3, 5, v1
  v_mfma_f32_16x16x32_bf16 v[64:67], v[200:203], a[72:75], v[64:67]
  ds_read_b128 v[156:159], v208 offset:19456
  v_lshl_add_u32 v8, v2, 4, v3
  v_mfma_f32_16x16x32_bf16 v[68:71], v[200:203], a[76:79], v[68:71]
  s_waitcnt lgkmcnt(4)
  v_exp_f32 v237, v237
  v_mfma_f32_16x16x32_bf16 v[72:75], v[204:207], a[72:75], v[72:75]
  s_branch parallel_sum__ssm_conv_h3__mixer_gmlp__prompt_kernel_ps7
parallel_sum__ssm_conv_h3__mixer_gmlp__prompt_kernel_pg7:
  s_branch parallel_sum__ssm_conv_h3__mixer_gmlp__prompt_kernel_pg11
parallel_sum__ssm_conv_h3__mixer_gmlp__prompt_kernel_ps7:
  ds_read_b128 a[252:255], v223 offset:12288
  v_add_u32_e64 v8, s85, v8
  v_mfma_f32_16x16x32_bf16 v[76:79], v[204:207], a[76:79], v[76:79]
  ds_read_b128 v[160:163], v208 offset:20480
  v_lshl_add_u32 v3, v2, 3, v3
  v_mfma_f32_16x16x32_bf16 v[16:19], v[144:147], a[80:83], v[16:19]
  buffer_load_dwordx4 v216, s[40:43], s72 offen offset:0 lds
  v_mfma_f32_16x16x32_bf16 v[20:23], v[144:147], a[84:87], v[20:23]
  s_add_u32 s4, s68, 504
  v_exp_f32_e64 v238, v238
  v_mfma_f32_16x16x32_bf16 v[24:27], v[148:151], a[80:83], v[24:27]
  ds_read_b128 v[164:167], v208 offset:21504
  v_sub_u32_e64 v11, s4, v3
  v_mfma_f32_16x16x32_bf16 v[28:31], v[148:151], a[84:87], v[28:31]
  ds_read_b128 v[168:171], v208 offset:22528
  v_exp_f32_e64 v239, v239
  v_mfma_f32_16x16x32_bf16 v[32:35], v[152:155], a[80:83], v[32:35]
  buffer_load_dwordx4 v217, s[40:43], s72 offen offset:1024 lds
  v_mfma_f32_16x16x32_bf16 v[36:39], v[152:155], a[84:87], v[36:39]
  s_waitcnt lgkmcnt(2)
  ds_read_b128 v[172:175], v208 offset:23552
  v_add_f32 v236, 1.0, v236
  v_mfma_f32_16x16x32_bf16 v[40:43], v[156:159], a[80:83], v[40:43]
  buffer_load_dwordx4 v218, s[40:43], s72 offen offset:2048 lds
  v_mfma_f32_16x16x32_bf16 v[44:47], v[156:159], a[84:87], v[44:47]
  ds_read_b128 v[176:179], v208 offset:24576
  v_add_f32_e64 v237, 1.0, v237
  v_mfma_f32_16x16x32_bf16 v[48:51], v[160:163], a[80:83], v[48:51]
  buffer_load_dwordx4 v219, s[40:43], s72 offen offset:3072 lds
  v_mfma_f32_16x16x32_bf16 v[52:55], v[160:163], a[84:87], v[52:55]
  s_waitcnt lgkmcnt(2)
  ds_read_b128 v[180:183], v208 offset:25600
  v_add_f32 v238, 1.0, v238
  v_mfma_f32_16x16x32_bf16 v[56:59], v[164:167], a[80:83], v[56:59]
  s_add_u32 m0, s68, 12288
  ds_read_b128 v[184:187], v208 offset:26624
  v_add_f32_e64 v239, 1.0, v239
  v_mfma_f32_16x16x32_bf16 v[60:63], v[164:167], a[84:87], v[60:63]
  ds_read_b128 v[188:191], v208 offset:27648
  v_add_u32_e64 v3, s85, v3
  v_mfma_f32_16x16x32_bf16 v[64:67], v[168:171], a[80:83], v[64:67]
  ds_read_b128 v[192:195], v208 offset:28672
  v_rcp_f32_e64 v236, v236
  v_mfma_f32_16x16x32_bf16 v[68:71], v[168:171], a[84:87], v[68:71]
  s_waitcnt lgkmcnt(4)
  buffer_load_dwordx4 v216, s[40:43], s73 offen offset:0 lds
  v_mfma_f32_16x16x32_bf16 v[72:75], v[172:175], a[80:83], v[72:75]
  ds_read_b128 v[196:199], v208 offset:29696
  v_sub_u32 v4, 1807, v1
  v_mfma_f32_16x16x32_bf16 v[76:79], v[172:175], a[84:87], v[76:79]
  ds_read_b128 v[200:203], v208 offset:30720
  v_rcp_f32 v237, v237
  v_mfma_f32_16x16x32_bf16 v[16:19], v[176:179], a[88:91], v[16:19]
  buffer_load_dwordx4 v217, s[40:43], s73 offen offset:1024 lds
  v_mfma_f32_16x16x32_bf16 v[20:23], v[176:179], a[92:95], v[20:23]
  s_waitcnt lgkmcnt(3)
  ds_read_b128 v[204:207], v208 offset:31744
  v_lshrrev_b32 v4, 1, v4
  v_rcp_f32_e64 v238, v238
  v_mfma_f32_16x16x32_bf16 v[24:27], v[180:183], a[88:91], v[24:27]
  buffer_load_dwordx4 v218, s[40:43], s73 offen offset:2048 lds
  v_mfma_f32_16x16x32_bf16 v[28:31], v[180:183], a[92:95], v[28:31]
  v_rcp_f32_e64 v239, v239
  v_mfma_f32_16x16x32_bf16 v[32:35], v[184:187], a[88:91], v[32:35]
  buffer_load_dwordx4 v219, s[40:43], s73 offen offset:3072 lds
  v_mfma_f32_16x16x32_bf16 v[36:39], v[184:187], a[92:95], v[36:39]
  s_bfe_u32 s72, s1, 0x40008
  v_mul_f32 v88, v88, v236
  v_mul_f32 v89, v89, v237
  v_mfma_f32_16x16x32_bf16 v[40:43], v[188:191], a[88:91], v[40:43]
  s_lshl_b32 s72, s72, 8
  v_mul_f32 v90, v90, v238
  v_mul_f32_e64 v91, v91, v239
  v_mfma_f32_16x16x32_bf16 v[44:47], v[188:191], a[92:95], v[44:47]
  s_waitcnt lgkmcnt(0)
  v_mul_f32 v236, v92, v92
  v_mul_f32_e64 v237, v93, v93
  v_mfma_f32_16x16x32_bf16 v[48:51], v[192:195], a[88:91], v[48:51]
  s_waitcnt vmcnt(20)
  s_barrier
  v_mfma_f32_16x16x32_bf16 v[52:55], v[192:195], a[92:95], v[52:55]
  s_add_u32 m0, s69, 0
  ds_read_b128 v[144:147], v208 offset:32768
  v_mul_f32 v238, v94, v94
  v_mfma_f32_16x16x32_bf16 v[56:59], v[196:199], a[88:91], v[56:59]
  ds_read_b128 v[148:151], v208 offset:33792
  v_mul_f32_e64 v239, v95, v95
  v_mfma_f32_16x16x32_bf16 v[60:63], v[196:199], a[92:95], v[60:63]
  ds_read_b128 v[152:155], v208 offset:34816
  v_fma_f32 v236, v236, v227, v225
  v_mfma_f32_16x16x32_bf16 v[64:67], v[200:203], a[88:91], v[64:67]
  ds_read_b128 v[156:159], v208 offset:35840
  v_fma_f32 v237, v237, v227, v225
  v_mfma_f32_16x16x32_bf16 v[68:71], v[200:203], a[92:95], v[68:71]
  buffer_load_dwordx4 v252, s[16:19], s74 offen offset:0 sc1 lds
  v_mfma_f32_16x16x32_bf16 v[72:75], v[204:207], a[88:91], v[72:75]
  ds_read_b128 v[160:163], v208 offset:36864
  v_fma_f32 v238, v238, v227, v225
  v_mfma_f32_16x16x32_bf16 v[76:79], v[204:207], a[92:95], v[76:79]
  s_waitcnt lgkmcnt(4)
  ds_read_b128 v[164:167], v208 offset:37888
  v_fma_f32 v239, v239, v227, v225
  v_mfma_f32_16x16x32_bf16 v[16:19], v[144:147], a[96:99], v[16:19]
  buffer_load_dwordx4 v252, s[16:19], s74 offen offset:1024 sc1 lds
  v_mfma_f32_16x16x32_bf16 v[20:23], v[144:147], a[100:103], v[20:23]
  s_waitcnt lgkmcnt(3)
  ds_read_b128 v[168:171], v208 offset:38912
  v_mul_f32_e64 v236, v236, v92
  v_mfma_f32_16x16x32_bf16 v[24:27], v[148:151], a[96:99], v[24:27]
  ds_read_b128 v[172:175], v208 offset:39936
  v_mul_f32_e64 v237, v237, v93
  v_mfma_f32_16x16x32_bf16 v[28:31], v[148:151], a[100:103], v[28:31]
  buffer_load_dwordx4 v252, s[16:19], s74 offen offset:2048 sc1 lds
  v_mfma_f32_16x16x32_bf16 v[32:35], v[152:155], a[96:99], v[32:35]
  ds_read_b128 v[176:179], v208 offset:40960
  v_mul_f32_e64 v238, v238, v94
  v_mfma_f32_16x16x32_bf16 v[36:39], v[152:155], a[100:103], v[36:39]
  s_waitcnt lgkmcnt(3)
  ds_read_b128 v[180:183], v208 offset:41984
  v_mul_f32 v239, v239, v95
  v_mfma_f32_16x16x32_bf16 v[40:43], v[156:159], a[96:99], v[40:43]
  ds_read_b128 v[184:187], v208 offset:43008
  v_lshlrev_b32_e64 v4, 2, v4
  v_mfma_f32_16x16x32_bf16 v[44:47], v[156:159], a[100:103], v[44:47]
  buffer_load_dwordx4 v252, s[16:19], s74 offen offset:3072 sc1 lds
  v_mfma_f32_16x16x32_bf16 v[48:51], v[160:163], a[96:99], v[48:51]
  buffer_load_ushort v212, v211, s[44:47], 0 offen offset:0
  v_mfma_f32_16x16x32_bf16 v[52:55], v[160:163], a[100:103], v[52:55]
  ds_read_b128 v[188:191], v208 offset:44032
  v_lshl_add_u32 v4, v2, 4, v4
  v_mfma_f32_16x16x32_bf16 v[56:59], v[164:167], a[96:99], v[56:59]
  s_add_u32 m0, s69, 4096
  ds_read_b128 v[192:195], v208 offset:45056
  v_and_b32_e64 v5, 1, v1
  v_mfma_f32_16x16x32_bf16 v[60:63], v[164:167], a[100:103], v[60:63]
  s_waitcnt lgkmcnt(3)
  buffer_load_ushort v213, v211, s[44:47], 0 offen offset:8
  v_mfma_f32_16x16x32_bf16 v[64:67], v[168:171], a[96:99], v[64:67]
  ds_read_b128 v[196:199], v208 offset:46080
  v_mul_u32_u24 v5, 4160, v5
  v_mfma_f32_16x16x32_bf16 v[68:71], v[168:171], a[100:103], v[68:71]
  ds_read_b128 v[200:203], v208 offset:47104
  v_sub_u32 v4, v4, v5
  v_mfma_f32_16x16x32_bf16 v[72:75], v[172:175], a[96:99], v[72:75]
  buffer_load_dwordx4 v253, s[16:19], s74 offen offset:0 sc1 lds
  v_mfma_f32_16x16x32_bf16 v[76:79], v[172:175], a[100:103], v[76:79]
  s_add_u32 s4, s68, 3648
  v_exp_f32_e64 v236, v236
  v_mfma_f32_16x16x32_bf16 v[16:19], v[176:179], a[104:107], v[16:19]
  ds_read_b128 v[204:207], v208 offset:48128
  v_add_u32_e64 v4, s4, v4
  v_mfma_f32_16x16x32_bf16 v[20:23], v[176:179], a[108:111], v[20:23]
  buffer_load_dwordx4 v253, s[16:19], s74 offen offset:1024 sc1 lds
  v_mfma_f32_16x16x32_bf16 v[24:27], v[180:183], a[104:107], v[24:27]
  v_exp_f32_e64 v237, v237
  v_mfma_f32_16x16x32_bf16 v[28:31], v[180:183], a[108:111], v[28:31]
  s_waitcnt lgkmcnt(1)
  ds_read_b128 a[0:3], v220 offset:0
  v_subrev_u32 v5, 1024, v4
  v_mfma_f32_16x16x32_bf16 v[32:35], v[184:187], a[104:107], v[32:35]
  ds_read_b128 a[8:11], v221 offset:0
  v_subrev_u32 v6, 2048, v4
  v_mfma_f32_16x16x32_bf16 v[36:39], v[184:187], a[108:111], v[36:39]
  ds_read_b128 a[16:19], v222 offset:0
  v_subrev_u32 v7, 3072, v4
  v_mfma_f32_16x16x32_bf16 v[40:43], v[188:191], a[104:107], v[40:43]
  buffer_load_dwordx4 v253, s[16:19], s74 offen offset:2048 sc1 lds
  v_mfma_f32_16x16x32_bf16 v[44:47], v[188:191], a[108:111], v[44:47]
  ds_read_b128 v[144:147], v208 offset:49152
  v_mfma_f32_16x16x32_bf16 v[48:51], v[192:195], a[104:107], v[48:51]
  v_exp_f32 v238, v238
  v_mfma_f32_16x16x32_bf16 v[52:55], v[192:195], a[108:111], v[52:55]
  ds_read_b128 a[24:27], v223 offset:0
  v_mfma_f32_16x16x32_bf16 v[56:59], v[196:199], a[104:107], v[56:59]
  ds_read_b128 v[148:151], v208 offset:50176
  v_mfma_f32_16x16x32_bf16 v[60:63], v[196:199], a[108:111], v[60:63]
  buffer_load_dwordx4 v253, s[16:19], s74 offen offset:3072 sc1 lds
  v_exp_f32_e64 v239, v239
  v_mfma_f32_16x16x32_bf16 v[64:67], v[200:203], a[104:107], v[64:67]
  s_bfe_u32 s74, s0, 0x40018
  ds_read_b128 v[152:155], v208 offset:51200
  v_add_f32_e64 v236, 1.0, v236
  v_mfma_f32_16x16x32_bf16 v[68:71], v[200:203], a[108:111], v[68:71]
  s_waitcnt lgkmcnt(3)
  ds_read_b128 v[156:159], v208 offset:52224
  v_add_f32 v237, 1.0, v237
  v_mfma_f32_16x16x32_bf16 v[72:75], v[204:207], a[104:107], v[72:75]
  ds_read_b128 v[160:163], v208 offset:53248
  v_add_f32_e64 v238, 1.0, v238
  v_mfma_f32_16x16x32_bf16 v[76:79], v[204:207], a[108:111], v[76:79]
  s_lshl_b32 s74, s74, 15
  ds_read_b128 v[164:167], v208 offset:54272
  v_add_f32 v239, 1.0, v239
  v_mfma_f32_16x16x32_bf16 v[16:19], v[144:147], a[112:115], v[16:19]
  ds_read_b128 v[168:171], v208 offset:55296
  v_mfma_f32_16x16x32_bf16 v[20:23], v[144:147], a[116:119], v[20:23]
  s_waitcnt lgkmcnt(5)
  v_rcp_f32 v236, v236
  v_mfma_f32_16x16x32_bf16 v[24:27], v[148:151], a[112:115], v[24:27]
  ds_read_b128 v[172:175], v208 offset:56320
  v_mfma_f32_16x16x32_bf16 v[28:31], v[148:151], a[116:119], v[28:31]
  s_waitcnt lgkmcnt(4)
  s_add_u32 m0, s68, 0
  ds_read_b128 v[176:179], v208 offset:57344
  v_mfma_f32_16x16x32_bf16 v[32:35], v[152:155], a[112:115], v[32:35]
  v_rcp_f32_e64 v237, v237
  v_mfma_f32_16x16x32_bf16 v[36:39], v[152:155], a[116:119], v[36:39]
  v_rcp_f32_e64 v238, v238
  v_mfma_f32_16x16x32_bf16 v[40:43], v[156:159], a[112:115], v[40:43]
  s_add_u32 s73, s72, 16384
  ds_read_b128 v[180:183], v208 offset:58368
  v_mfma_f32_16x16x32_bf16 v[44:47], v[156:159], a[116:119], v[44:47]
  s_waitcnt lgkmcnt(3)
  ds_read_b128 v[184:187], v208 offset:59392
  v_mfma_f32_16x16x32_bf16 v[48:51], v[160:163], a[112:115], v[48:51]
  v_rcp_f32 v239, v239
  v_mfma_f32_16x16x32_bf16 v[52:55], v[160:163], a[116:119], v[52:55]
  ds_read_b128 v[188:191], v208 offset:60416
  v_mul_f32_e64 v92, v92, v236
  v_mfma_f32_16x16x32_bf16 v[56:59], v[164:167], a[112:115], v[56:59]
  buffer_load_dwordx4 v216, s[40:43], s72 offen offset:0 lds
  v_mfma_f32_16x16x32_bf16 v[60:63], v[164:167], a[116:119], v[60:63]
  ds_read_b128 v[192:195], v208 offset:61440
  v_mul_f32_e64 v93, v93, v237
  v_mfma_f32_16x16x32_bf16 v[64:67], v[168:171], a[112:115], v[64:67]
  ds_read_b128 v[196:199], v208 offset:62464
  v_mul_f32_e64 v94, v94, v238
  v_mfma_f32_16x16x32_bf16 v[68:71], v[168:171], a[116:119], v[68:71]
  s_waitcnt lgkmcnt(3)
  ds_read_b128 v[200:203], v208 offset:63488
  v_mul_f32 v95, v95, v239
  v_mfma_f32_16x16x32_bf16 v[72:75], v[172:175], a[112:115], v[72:75]
  buffer_load_dwordx4 v217, s[40:43], s72 offen offset:1024 lds
  v_mfma_f32_16x16x32_bf16 v[76:79], v[172:175], a[116:119], v[76:79]
  ds_read_b128 v[204:207], v208 offset:64512
  v_mul_f32_e64 v236, v96, v96
  v_mfma_f32_16x16x32_bf16 v[16:19], v[176:179], a[120:123], v[16:19]
  v_mul_f32 v237, v97, v97
  v_mul_f32 v238, v98, v98
  v_mfma_f32_16x16x32_bf16 v[20:23], v[176:179], a[124:127], v[20:23]
  buffer_load_dwordx4 v218, s[40:43], s72 offen offset:2048 lds
  v_mfma_f32_16x16x32_bf16 v[24:27], v[180:183], a[120:123], v[24:27]
  v_mul_f32_e64 v239, v99, v99
  v_fma_f32 v236, v236, v226, v224
  v_mfma_f32_16x16x32_bf16 v[28:31], v[180:183], a[124:127], v[28:31]
  v_fma_f32 v237, v237, v226, v224
  v_fma_f32 v238, v238, v226, v224
  v_mfma_f32_16x16x32_bf16 v[32:35], v[184:187], a[120:123], v[32:35]
  buffer_load_dwordx4 v219, s[40:43], s72 offen offset:3072 lds
  v_mfma_f32_16x16x32_bf16 v[36:39], v[184:187], a[124:127], v[36:39]
  s_waitcnt lgkmcnt(0)
  v_fma_f32 v239, v239, v226, v224
  v_mul_f32 v236, v236, v96
  v_mfma_f32_16x16x32_bf16 v[40:43], v[188:191], a[120:123], v[40:43]
  v_mul_f32 v237, v237, v97
  v_mul_f32 v238, v238, v98
  v_mfma_f32_16x16x32_bf16 v[44:47], v[188:191], a[124:127], v[44:47]
  v_mul_f32_e64 v239, v239, v99
  v_mfma_f32_16x16x32_bf16 v[48:51], v[192:195], a[120:123], v[48:51]
  s_waitcnt vmcnt(22)
  s_barrier
  v_mfma_f32_16x16x32_bf16 v[52:55], v[192:195], a[124:127], v[52:55]
  ds_read_b128 v[144:147], v210 offset:0
  s_add_u32 m0, s69, 32768
  v_mfma_f32_16x16x32_bf16 v[56:59], v[196:199], a[120:123], v[56:59]
  ds_read_b128 v[148:151], v210 offset:1024
  v_mfma_f32_16x16x32_bf16 v[60:63], v[196:199], a[124:127], v[60:63]
  ds_read_b128 v[152:155], v210 offset:2048
  v_mfma_f32_16x16x32_bf16 v[64:67], v[200:203], a[120:123], v[64:67]
  buffer_load_dwordx4 v252, s[16:19], s74 offen offset:0 sc1 lds
  v_mfma_f32_16x16x32_bf16 v[68:71], v[200:203], a[124:127], v[68:71]
  ds_read_b128 v[156:159], v210 offset:3072
  v_mfma_f32_16x16x32_bf16 v[72:75], v[204:207], a[120:123], v[72:75]
  ds_read_b128 v[160:163], v210 offset:4096
  v_mfma_f32_16x16x32_bf16 v[76:79], v[204:207], a[124:127], v[76:79]
  s_waitcnt lgkmcnt(4)
  buffer_load_dwordx4 v252, s[16:19], s74 offen offset:1024 sc1 lds
  v_mfma_f32_16x16x32_bf16 v[16:19], v[144:147], a[128:131], v[16:19]
  ds_read_b128 v[164:167], v210 offset:5120
  v_mfma_f32_16x16x32_bf16 v[20:23], v[144:147], a[132:135], v[20:23]
  s_waitcnt lgkmcnt(3)
  buffer_load_dwordx4 v252, s[16:19], s74 offen offset:2048 sc1 lds
  v_mfma_f32_16x16x32_bf16 v[24:27], v[148:151], a[128:131], v[24:27]
  ds_read_b128 v[168:171], v210 offset:6144
  v_mfma_f32_16x16x32_bf16 v[28:31], v[148:151], a[132:135], v[28:31]
  buffer_load_dwordx4 v252, s[16:19], s74 offen offset:3072 sc1 lds
  v_mfma_f32_16x16x32_bf16 v[32:35], v[152:155], a[128:131], v[32:35]
  ds_read_b128 v[172:175], v210 offset:7168
  v_mfma_f32_16x16x32_bf16 v[36:39], v[152:155], a[132:135], v[36:39]
  s_waitcnt lgkmcnt(3)
  ds_read_b128 v[176:179], v210 offset:8192
  v_mfma_f32_16x16x32_bf16 v[40:43], v[156:159], a[128:131], v[40:43]
  s_add_u32 m0, s69, 36864
  ds_read_b128 v[180:183], v210 offset:9216
  v_mfma_f32_16x16x32_bf16 v[44:47], v[156:159], a[132:135], v[44:47]
  ds_read_b128 v[184:187], v210 offset:10240
  v_mfma_f32_16x16x32_bf16 v[48:51], v[160:163], a[128:131], v[48:51]
  v_exp_f32 v236, v236
  v_mfma_f32_16x16x32_bf16 v[52:55], v[160:163], a[132:135], v[52:55]
  s_waitcnt lgkmcnt(4)
  ds_read_b128 a[4:7], v220 offset:4096
  v_mfma_f32_16x16x32_bf16 v[56:59], v[164:167], a[128:131], v[56:59]
  ds_read_b128 a[12:15], v221 offset:4096
  v_mfma_f32_16x16x32_bf16 v[60:63], v[164:167], a[132:135], v[60:63]
  buffer_load_dwordx4 v253, s[16:19], s74 offen offset:0 sc1 lds
  v_mfma_f32_16x16x32_bf16 v[64:67], v[168:171], a[128:131], v[64:67]
  ds_read_b128 a[20:23], v222 offset:4096
  v_mfma_f32_16x16x32_bf16 v[68:71], v[168:171], a[132:135], v[68:71]
  s_waitcnt lgkmcnt(3)
  buffer_load_dwordx4 v253, s[16:19], s74 offen offset:1024 sc1 lds
  v_mfma_f32_16x16x32_bf16 v[72:75], v[172:175], a[128:131], v[72:75]
  ds_read_b128 v[188:191], v210 offset:11264
  v_mfma_f32_16x16x32_bf16 v[76:79], v[172:175], a[132:135], v[76:79]
  ds_read_b128 a[28:31], v223 offset:4096
  v_mfma_f32_16x16x32_bf16 v[16:19], v[176:179], a[136:139], v[16:19]
  ds_read_b128 v[192:195], v210 offset:12288
  v_exp_f32_e64 v237, v237
  v_mfma_f32_16x16x32_bf16 v[20:23], v[176:179], a[140:143], v[20:23]
  buffer_load_dwordx4 v253, s[16:19], s74 offen offset:2048 sc1 lds
  v_mfma_f32_16x16x32_bf16 v[24:27], v[180:183], a[136:139], v[24:27]
  v_exp_f32_e64 v238, v238
  v_mfma_f32_16x16x32_bf16 v[28:31], v[180:183], a[140:143], v[28:31]
  ds_read_b128 v[196:199], v210 offset:13312
  v_mfma_f32_16x16x32_bf16 v[32:35], v[184:187], a[136:139], v[32:35]
  buffer_load_dwordx4 v253, s[16:19], s74 offen offset:3072 sc1 lds
  v_exp_f32_e64 v239, v239
  v_mfma_f32_16x16x32_bf16 v[36:39], v[184:187], a[140:143], v[36:39]
  s_waitcnt lgkmcnt(2)
  ds_read_b128 v[200:203], v210 offset:14336
  s_bfe_u32 s74, s0, 0x4001c
  v_mfma_f32_16x16x32_bf16 v[40:43], v[188:191], a[136:139], v[40:43]
  s_lshl_b32 s74, s74, 15
  ds_read_b128 v[204:207], v210 offset:15360
  v_add_f32_e64 v236, 1.0, v236
  v_mfma_f32_16x16x32_bf16 v[44:47], v[188:191], a[140:143], v[44:47]
  s_waitcnt lgkmcnt(3)
  ds_read_b128 v[144:147], v210 offset:16384
  v_add_f32 v237, 1.0, v237
  v_mfma_f32_16x16x32_bf16 v[48:51], v[192:195], a[136:139], v[48:51]
  ds_read_b128 v[148:151], v210 offset:17408
  v_add_f32_e64 v238, 1.0, v238
  v_mfma_f32_16x16x32_bf16 v[52:55], v[192:195], a[140:143], v[52:55]
  s_waitcnt vmcnt(26) lgkmcnt(4)
  ds_read_b128 a[32:35], v220 offset:8192
  v_mfma_f32_16x16x32_bf16 v[56:59], v[196:199], a[136:139], v[56:59]
  s_add_u32 m0, s68, 4096
  ds_read_b128 a[40:43], v221 offset:8192
  v_add_f32 v239, 1.0, v239
  v_mfma_f32_16x16x32_bf16 v[60:63], v[196:199], a[140:143], v[60:63]
  s_waitcnt lgkmcnt(5)
  ds_read_b128 v[152:155], v210 offset:18432
  v_mfma_f32_16x16x32_bf16 v[64:67], v[200:203], a[136:139], v[64:67]
  ds_read_b128 a[48:51], v222 offset:8192
  v_mfma_f32_16x16x32_bf16 v[68:71], v[200:203], a[140:143], v[68:71]
  s_waitcnt lgkmcnt(5)
  buffer_load_dwordx4 v216, s[40:43], s73 offen offset:0 lds
  v_mfma_f32_16x16x32_bf16 v[72:75], v[204:207], a[136:139], v[72:75]
  ds_read_b128 v[156:159], v210 offset:19456
  v_rcp_f32_e64 v236, v236
  v_mfma_f32_16x16x32_bf16 v[76:79], v[204:207], a[140:143], v[76:79]
  ds_read_b128 a[56:59], v223 offset:8192
  v_mfma_f32_16x16x32_bf16 v[16:19], v[144:147], a[144:147], v[16:19]
  buffer_load_dwordx4 v217, s[40:43], s73 offen offset:1024 lds
  v_rcp_f32_e64 v237, v237
  v_mfma_f32_16x16x32_bf16 v[20:23], v[144:147], a[148:151], v[20:23]
  s_waitcnt lgkmcnt(3)
  ds_read_b128 v[160:163], v210 offset:20480
  v_mfma_f32_16x16x32_bf16 v[24:27], v[148:151], a[144:147], v[24:27]
  buffer_load_dwordx4 v218, s[40:43], s73 offen offset:2048 lds
  v_rcp_f32 v238, v238
  v_mfma_f32_16x16x32_bf16 v[28:31], v[148:151], a[148:151], v[28:31]
  ds_read_b128 v[164:167], v210 offset:21504
  v_mfma_f32_16x16x32_bf16 v[32:35], v[152:155], a[144:147], v[32:35]
  ds_read_b128 v[168:171], v210 offset:22528
  v_rcp_f32_e64 v239, v239
  v_mfma_f32_16x16x32_bf16 v[36:39], v[152:155], a[148:151], v[36:39]
  s_waitcnt lgkmcnt(3)
  buffer_load_dwordx4 v219, s[40:43], s73 offen offset:3072 lds
  v_mfma_f32_16x16x32_bf16 v[40:43], v[156:159], a[144:147], v[40:43]
  s_bfe_u32 s72, s1, 0x4000c
  ds_read_b128 v[172:175], v210 offset:23552
  v_mul_f32 v96, v96, v236
  v_mfma_f32_16x16x32_bf16 v[44:47], v[156:159], a[148:151], v[44:47]
  s_waitcnt lgkmcnt(3)
  ds_read_b128 v[176:179], v210 offset:24576
  v_mul_f32 v97, v97, v237
  v_mfma_f32_16x16x32_bf16 v[48:51], v[160:163], a[144:147], v[48:51]
  s_lshl_b32 s72, s72, 8
  ds_read_b128 v[180:183], v210 offset:25600
  v_mul_f32 v98, v98, v238
  v_mfma_f32_16x16x32_bf16 v[52:55], v[160:163], a[148:151], v[52:55]
  s_waitcnt lgkmcnt(4)
  ds_read_b128 v[184:187], v210 offset:26624
  s_add_u32 m0, s68, 8192
  v_mfma_f32_16x16x32_bf16 v[56:59], v[164:167], a[144:147], v[56:59]
  ds_read_b128 v[188:191], v210 offset:27648
  v_mul_f32 v99, v99, v239
  v_mfma_f32_16x16x32_bf16 v[60:63], v[164:167], a[148:151], v[60:63]
  s_waitcnt lgkmcnt(5)
  ds_read_b128 v[192:195], v210 offset:28672
  s_add_u32 s73, s72, 16384
  v_mfma_f32_16x16x32_bf16 v[64:67], v[168:171], a[144:147], v[64:67]
  ds_read_b128 v[196:199], v210 offset:29696
  v_mul_f32 v236, v100, v100
  v_mfma_f32_16x16x32_bf16 v[68:71], v[168:171], a[148:151], v[68:71]
  s_waitcnt lgkmcnt(5)
  ds_read_b128 v[200:203], v210 offset:30720
  v_mul_f32 v237, v101, v101
  v_mfma_f32_16x16x32_bf16 v[72:75], v[172:175], a[144:147], v[72:75]
  ds_read_b128 v[204:207], v210 offset:31744
  v_mul_f32_e64 v238, v102, v102
  v_mfma_f32_16x16x32_bf16 v[76:79], v[172:175], a[148:151], v[76:79]
  buffer_load_dwordx4 v216, s[40:43], s72 offen offset:0 lds
  v_mfma_f32_16x16x32_bf16 v[16:19], v[176:179], a[152:155], v[16:19]
  buffer_load_dwordx4 v217, s[40:43], s72 offen offset:1024 lds
  v_mfma_f32_16x16x32_bf16 v[20:23], v[176:179], a[156:159], v[20:23]
  s_waitcnt lgkmcnt(3)
  v_mul_f32 v239, v103, v103
  v_fma_f32 v236, v236, v227, v225
  v_mfma_f32_16x16x32_bf16 v[24:27], v[180:183], a[152:155], v[24:27]
  v_fma_f32 v237, v237, v227, v225
  v_fma_f32 v238, v238, v227, v225
  v_mfma_f32_16x16x32_bf16 v[28:31], v[180:183], a[156:159], v[28:31]
  buffer_load_dwordx4 v218, s[40:43], s72 offen offset:2048 lds
  v_mfma_f32_16x16x32_bf16 v[32:35], v[184:187], a[152:155], v[32:35]
  v_fma_f32 v239, v239, v227, v225
  v_mul_f32_e64 v236, v236, v100
  v_mfma_f32_16x16x32_bf16 v[36:39], v[184:187], a[156:159], v[36:39]
  buffer_load_dwordx4 v219, s[40:43], s72 offen offset:3072 lds
  v_mfma_f32_16x16x32_bf16 v[40:43], v[188:191], a[152:155], v[40:43]
  v_mul_f32 v237, v237, v101
  v_mul_f32 v238, v238, v102
  v_mfma_f32_16x16x32_bf16 v[44:47], v[188:191], a[156:159], v[44:47]
  v_mul_f32_e64 v239, v239, v103
  v_mfma_f32_16x16x32_bf16 v[48:51], v[192:195], a[152:155], v[48:51]
  s_waitcnt vmcnt(20) lgkmcnt(0)
  s_barrier
  v_mfma_f32_16x16x32_bf16 v[52:55], v[192:195], a[156:159], v[52:55]
  ds_read_b128 v[144:147], v208 offset:0
  s_add_u32 m0, s69, 65536
  v_mfma_f32_16x16x32_bf16 v[56:59], v[196:199], a[152:155], v[56:59]
  ds_read_b128 v[148:151], v208 offset:1024
  v_mfma_f32_16x16x32_bf16 v[60:63], v[196:199], a[156:159], v[60:63]
  ds_read_b128 v[152:155], v208 offset:2048
  v_mfma_f32_16x16x32_bf16 v[64:67], v[200:203], a[152:155], v[64:67]
  ds_read_b128 v[156:159], v208 offset:3072
  v_mfma_f32_16x16x32_bf16 v[68:71], v[200:203], a[156:159], v[68:71]
  buffer_load_dwordx4 v252, s[16:19], s74 offen offset:0 sc1 lds
  v_mfma_f32_16x16x32_bf16 v[72:75], v[204:207], a[152:155], v[72:75]
  ds_read_b128 v[160:163], v208 offset:4096
  v_mfma_f32_16x16x32_bf16 v[76:79], v[204:207], a[156:159], v[76:79]
  s_waitcnt lgkmcnt(4)
  ds_read_b128 v[164:167], v208 offset:5120
  v_mfma_f32_16x16x32_bf16 v[16:19], v[144:147], a[160:163], v[16:19]
  buffer_load_dwordx4 v252, s[16:19], s74 offen offset:1024 sc1 lds
  v_mfma_f32_16x16x32_bf16 v[20:23], v[144:147], a[164:167], v[20:23]
  s_waitcnt lgkmcnt(3)
  ds_read_b128 v[168:171], v208 offset:6144
  v_mfma_f32_16x16x32_bf16 v[24:27], v[148:151], a[160:163], v[24:27]
  v_exp_f32_e64 v236, v236
  v_mfma_f32_16x16x32_bf16 v[28:31], v[148:151], a[164:167], v[28:31]
  buffer_load_dwordx4 v252, s[16:19], s74 offen offset:2048 sc1 lds
  v_mfma_f32_16x16x32_bf16 v[32:35], v[152:155], a[160:163], v[32:35]
  ds_read_b128 v[172:175], v208 offset:7168
  v_mfma_f32_16x16x32_bf16 v[36:39], v[152:155], a[164:167], v[36:39]
  s_waitcnt lgkmcnt(2)
  v_exp_f32 v237, v237
  v_mfma_f32_16x16x32_bf16 v[40:43], v[156:159], a[160:163], v[40:43]
  ds_read_b128 v[176:179], v208 offset:8192
  v_mfma_f32_16x16x32_bf16 v[44:47], v[156:159], a[164:167], v[44:47]
  buffer_load_dwordx4 v252, s[16:19], s74 offen offset:3072 sc1 lds
  v_mfma_f32_16x16x32_bf16 v[48:51], v[160:163], a[160:163], v[48:51]
  v_exp_f32_e64 v238, v238
  v_mfma_f32_16x16x32_bf16 v[52:55], v[160:163], a[164:167], v[52:55]
  ds_read_b128 v[180:183], v208 offset:9216
  v_mfma_f32_16x16x32_bf16 v[56:59], v[164:167], a[160:163], v[56:59]
  s_add_u32 m0, s69, 69632
  v_exp_f32_e64 v239, v239
  v_mfma_f32_16x16x32_bf16 v[60:63], v[164:167], a[164:167], v[60:63]
  s_waitcnt lgkmcnt(2)
  ds_read_b128 v[184:187], v208 offset:10240
  v_add_f32 v236, 1.0, v236
  v_mfma_f32_16x16x32_bf16 v[64:67], v[168:171], a[160:163], v[64:67]
  ds_read_b128 v[188:191], v208 offset:11264
  v_add_f32_e64 v237, 1.0, v237
  v_mfma_f32_16x16x32_bf16 v[68:71], v[168:171], a[164:167], v[68:71]
  ds_read_b128 v[192:195], v208 offset:12288
  v_add_f32_e64 v238, 1.0, v238
  v_mfma_f32_16x16x32_bf16 v[72:75], v[172:175], a[160:163], v[72:75]
  buffer_load_dwordx4 v253, s[16:19], s74 offen offset:0 sc1 lds
  v_mfma_f32_16x16x32_bf16 v[76:79], v[172:175], a[164:167], v[76:79]
  s_waitcnt lgkmcnt(3)
  ds_read_b128 v[196:199], v208 offset:13312
  v_add_f32 v239, 1.0, v239
  v_mfma_f32_16x16x32_bf16 v[16:19], v[176:179], a[168:171], v[16:19]
  ds_read_b128 v[200:203], v208 offset:14336
  v_mfma_f32_16x16x32_bf16 v[20:23], v[176:179], a[172:175], v[20:23]
  buffer_load_dwordx4 v253, s[16:19], s74 offen offset:1024 sc1 lds
  v_mfma_f32_16x16x32_bf16 v[24:27], v[180:183], a[168:171], v[24:27]
  v_rcp_f32_e64 v236, v236
  v_mfma_f32_16x16x32_bf16 v[28:31], v[180:183], a[172:175], v[28:31]
  s_waitcnt lgkmcnt(2)
  ds_read_b128 a[36:39], v220 offset:12288
  v_mfma_f32_16x16x32_bf16 v[32:35], v[184:187], a[168:171], v[32:35]
  ds_read_b128 a[44:47], v221 offset:12288
  v_mfma_f32_16x16x32_bf16 v[36:39], v[184:187], a[172:175], v[36:39]
  ds_read_b128 v[204:207], v208 offset:15360
  v_mfma_f32_16x16x32_bf16 v[40:43], v[188:191], a[168:171], v[40:43]
  ds_read_b128 a[52:55], v222 offset:12288
  v_mfma_f32_16x16x32_bf16 v[44:47], v[188:191], a[172:175], v[44:47]
  buffer_load_dwordx4 v253, s[16:19], s74 offen offset:2048 sc1 lds
  v_mfma_f32_16x16x32_bf16 v[48:51], v[192:195], a[168:171], v[48:51]
  ds_read_b128 v[144:147], v208 offset:16384
  v_rcp_f32 v237, v237
  v_mfma_f32_16x16x32_bf16 v[52:55], v[192:195], a[172:175], v[52:55]
  s_waitcnt lgkmcnt(4)
  ds_read_b128 a[60:63], v223 offset:12288
  v_mfma_f32_16x16x32_bf16 v[56:59], v[196:199], a[168:171], v[56:59]
  ds_read_b128 v[148:151], v208 offset:17408
  v_rcp_f32 v238, v238
  v_mfma_f32_16x16x32_bf16 v[60:63], v[196:199], a[172:175], v[60:63]
  buffer_load_dwordx4 v253, s[16:19], s74 offen offset:3072 sc1 lds
  v_mfma_f32_16x16x32_bf16 v[64:67], v[200:203], a[168:171], v[64:67]
  s_bfe_u32 s74, s1, 0x40000
  v_rcp_f32_e64 v239, v239
  v_mfma_f32_16x16x32_bf16 v[68:71], v[200:203], a[172:175], v[68:71]
  s_waitcnt lgkmcnt(3)
  ds_read_b128 v[152:155], v208 offset:18432
  v_mul_f32 v100, v100, v236
  v_mfma_f32_16x16x32_bf16 v[72:75], v[204:207], a[168:171], v[72:75]
  ds_read_b128 v[156:159], v208 offset:19456
  v_mul_f32_e64 v101, v101, v237
  v_mfma_f32_16x16x32_bf16 v[76:79], v[204:207], a[172:175], v[76:79]
  s_waitcnt lgkmcnt(3)
  ds_read_b128 v[160:163], v208 offset:20480
  s_lshl_b32 s74, s74, 15
  v_mfma_f32_16x16x32_bf16 v[16:19], v[144:147], a[176:179], v[16:19]
  v_mul_f32 v102, v102, v238
  v_lshlrev_b32 v212, 16, v212
  v_mfma_f32_16x16x32_bf16 v[20:23], v[144:147], a[180:183], v[20:23]
  s_waitcnt lgkmcnt(3)
  ds_read_b128 v[164:167], v208 offset:21504
  v_mul_f32 v103, v103, v239
  v_mfma_f32_16x16x32_bf16 v[24:27], v[148:151], a[176:179], v[24:27]
  ds_read_b128 v[168:171], v208 offset:22528
  v_mul_f32_e64 v236, v104, v104
  v_mfma_f32_16x16x32_bf16 v[28:31], v[148:151], a[180:183], v[28:31]
  s_waitcnt lgkmcnt(4)
  s_add_u32 m0, s68, 12288
  ds_read_b128 v[172:175], v208 offset:23552
  v_mfma_f32_16x16x32_bf16 v[32:35], v[152:155], a[176:179], v[32:35]
  v_lshlrev_b32 v213, 16, v213
  v_mul_f32_e64 v237, v105, v105
  v_mfma_f32_16x16x32_bf16 v[36:39], v[152:155], a[180:183], v[36:39]
  s_waitcnt lgkmcnt(3)
  ds_read_b128 v[176:179], v208 offset:24576
  v_mul_f32 v238, v106, v106
  v_mfma_f32_16x16x32_bf16 v[40:43], v[156:159], a[176:179], v[40:43]
  buffer_load_dwordx4 v216, s[40:43], s73 offen offset:0 lds
  v_mfma_f32_16x16x32_bf16 v[44:47], v[156:159], a[180:183], v[44:47]
  ds_read_b128 v[180:183], v208 offset:25600
  v_mul_f32_e64 v239, v107, v107
  v_mfma_f32_16x16x32_bf16 v[48:51], v[160:163], a[176:179], v[48:51]
  s_branch parallel_sum__ssm_conv_h3__mixer_gmlp__prompt_kernel_ps8
parallel_sum__ssm_conv_h3__mixer_gmlp__prompt_kernel_pg8:
  s_branch parallel_sum__ssm_conv_h3__mixer_gmlp__prompt_kernel_pg12
parallel_sum__ssm_conv_h3__mixer_gmlp__prompt_kernel_ps8:
  ds_read_b128 v[184:187], v208 offset:26624
  v_mul_f32_e64 v212, v212, v214
  v_mfma_f32_16x16x32_bf16 v[52:55], v[160:163], a[180:183], v[52:55]
  s_waitcnt lgkmcnt(3)
  buffer_load_dwordx4 v217, s[40:43], s73 offen offset:1024 lds
  v_mfma_f32_16x16x32_bf16 v[56:59], v[164:167], a[176:179], v[56:59]
  ds_read_b128 v[188:191], v208 offset:27648
  v_fma_f32 v236, v236, v226, v224
  v_mfma_f32_16x16x32_bf16 v[60:63], v[164:167], a[180:183], v[60:63]
  ds_read_b128 v[192:195], v208 offset:28672
  v_fma_f32 v237, v237, v226, v224
  v_mfma_f32_16x16x32_bf16 v[64:67], v[168:171], a[176:179], v[64:67]
  ds_read_b128 v[196:199], v208 offset:29696
  v_mul_f32 v213, v213, v215
  v_mfma_f32_16x16x32_bf16 v[68:71], v[168:171], a[180:183], v[68:71]
  buffer_load_dwordx4 v218, s[40:43], s73 offen offset:2048 lds
  v_mfma_f32_16x16x32_bf16 v[72:75], v[172:175], a[176:179], v[72:75]
  ds_read_b128 v[200:203], v208 offset:30720
  v_fma_f32 v238, v238, v226, v224
  v_mfma_f32_16x16x32_bf16 v[76:79], v[172:175], a[180:183], v[76:79]
  s_waitcnt lgkmcnt(4)
  ds_read_b128 v[204:207], v208 offset:31744
  v_fma_f32 v239, v239, v226, v224
  v_mfma_f32_16x16x32_bf16 v[16:19], v[176:179], a[184:187], v[16:19]
  buffer_load_dwordx4 v219, s[40:43], s73 offen offset:3072 lds
  v_mfma_f32_16x16x32_bf16 v[20:23], v[176:179], a[188:191], v[20:23]
  v_mul_f32 v236, v236, v104
  v_mul_f32_e64 v237, v237, v105
  v_mfma_f32_16x16x32_bf16 v[24:27], v[180:183], a[184:187], v[24:27]
  s_bfe_u32 s72, s1, 0x40010
  v_mul_f32 v238, v238, v106
  v_mul_f32 v239, v239, v107
  v_mfma_f32_16x16x32_bf16 v[28:31], v[180:183], a[188:191], v[28:31]
  v_exp_f32_e64 v236, v236
  v_mfma_f32_16x16x32_bf16 v[32:35], v[184:187], a[184:187], v[32:35]
  v_exp_f32_e64 v237, v237
  v_mfma_f32_16x16x32_bf16 v[36:39], v[184:187], a[188:191], v[36:39]
  s_waitcnt lgkmcnt(0)
  s_lshl_b32 s72, s72, 8
  v_mfma_f32_16x16x32_bf16 v[40:43], v[188:191], a[184:187], v[40:43]
  v_exp_f32_e64 v238, v238
  v_mfma_f32_16x16x32_bf16 v[44:47], v[188:191], a[188:191], v[44:47]
  v_exp_f32_e64 v239, v239
  v_mfma_f32_16x16x32_bf16 v[48:51], v[192:195], a[184:187], v[48:51]
  s_waitcnt vmcnt(20)
  s_barrier
  v_mfma_f32_16x16x32_bf16 v[52:55], v[192:195], a[188:191], v[52:55]
  s_add_u32 m0, s69, 0
  ds_read_b128 v[144:147], v208 offset:32768
  v_add_f32 v236, 1.0, v236
  v_mfma_f32_16x16x32_bf16 v[56:59], v[196:199], a[184:187], v[56:59]
  ds_read_b128 v[148:151], v208 offset:33792
  v_add_f32_e64 v237, 1.0, v237
  v_mfma_f32_16x16x32_bf16 v[60:63], v[196:199], a[188:191], v[60:63]
  ds_read_b128 v[152:155], v208 offset:34816
  v_add_f32_e64 v238, 1.0, v238
  v_mfma_f32_16x16x32_bf16 v[64:67], v[200:203], a[184:187], v[64:67]
  buffer_load_dwordx4 v252, s[16:19], s74 offen offset:0 sc1 lds
  v_mfma_f32_16x16x32_bf16 v[68:71], v[200:203], a[188:191], v[68:71]
  ds_read_b128 v[156:159], v208 offset:35840
  v_add_f32_e64 v239, 1.0, v239
  v_mfma_f32_16x16x32_bf16 v[72:75], v[204:207], a[184:187], v[72:75]
  ds_read_b128 v[160:163], v208 offset:36864
  v_mfma_f32_16x16x32_bf16 v[76:79], v[204:207], a[188:191], v[76:79]
  s_waitcnt lgkmcnt(4)
  buffer_load_dwordx4 v252, s[16:19], s74 offen offset:1024 sc1 lds
  v_mfma_f32_16x16x32_bf16 v[16:19], v[144:147], a[192:195], v[16:19]
  ds_read_b128 v[164:167], v208 offset:37888
  v_and_b32 v254, 31, v0
  v_mfma_f32_16x16x32_bf16 v[20:23], v[144:147], a[196:199], v[20:23]
  s_waitcnt lgkmcnt(3)
  buffer_load_dwordx4 v252, s[16:19], s74 offen offset:2048 sc1 lds
  v_mfma_f32_16x16x32_bf16 v[24:27], v[148:151], a[192:195], v[24:27]
  ds_read_b128 v[168:171], v208 offset:38912
  v_lshlrev_b32 v254, 4, v254
  v_mfma_f32_16x16x32_bf16 v[28:31], v[148:151], a[196:199], v[28:31]
  buffer_load_dwordx4 v252, s[16:19], s74 offen offset:3072 sc1 lds
  v_mfma_f32_16x16x32_bf16 v[32:35], v[152:155], a[192:195], v[32:35]
  ds_read_b128 v[172:175], v208 offset:39936
  v_mfma_f32_16x16x32_bf16 v[36:39], v[152:155], a[196:199], v[36:39]
  s_waitcnt lgkmcnt(3)
  ds_read_b128 v[176:179], v208 offset:40960
  v_mfma_f32_16x16x32_bf16 v[40:43], v[156:159], a[192:195], v[40:43]
  s_add_u32 m0, s69, 4096
  ds_read_b128 v[180:183], v208 offset:41984
  v_mfma_f32_16x16x32_bf16 v[44:47], v[156:159], a[196:199], v[44:47]
  ds_read_b128 v[184:187], v208 offset:43008
  v_mfma_f32_16x16x32_bf16 v[48:51], v[160:163], a[192:195], v[48:51]
  v_rcp_f32 v236, v236
  v_mfma_f32_16x16x32_bf16 v[52:55], v[160:163], a[196:199], v[52:55]
  s_waitcnt lgkmcnt(4)
  ds_read_b128 a[64:67], v220 offset:0
  v_mfma_f32_16x16x32_bf16 v[56:59], v[164:167], a[192:195], v[56:59]
  ds_read_b128 a[72:75], v221 offset:0
  v_mfma_f32_16x16x32_bf16 v[60:63], v[164:167], a[196:199], v[60:63]
  buffer_load_dwordx4 v253, s[16:19], s74 offen offset:0 sc1 lds
  v_mfma_f32_16x16x32_bf16 v[64:67], v[168:171], a[192:195], v[64:67]
  ds_read_b128 a[80:83], v222 offset:0
  v_mfma_f32_16x16x32_bf16 v[68:71], v[168:171], a[196:199], v[68:71]
  s_waitcnt lgkmcnt(3)
  buffer_load_dwordx4 v253, s[16:19], s74 offen offset:1024 sc1 lds
  v_mfma_f32_16x16x32_bf16 v[72:75], v[172:175], a[192:195], v[72:75]
  ds_read_b128 v[188:191], v208 offset:44032
  v_mfma_f32_16x16x32_bf16 v[76:79], v[172:175], a[196:199], v[76:79]
  ds_read_b128 a[88:91], v223 offset:0
  v_mfma_f32_16x16x32_bf16 v[16:19], v[176:179], a[200:203], v[16:19]
  ds_read_b128 v[192:195], v208 offset:45056
  v_rcp_f32_e64 v237, v237
  v_mfma_f32_16x16x32_bf16 v[20:23], v[176:179], a[204:207], v[20:23]
  buffer_load_dwordx4 v253, s[16:19], s74 offen offset:2048 sc1 lds
  v_mfma_f32_16x16x32_bf16 v[24:27], v[180:183], a[200:203], v[24:27]
  v_rcp_f32_e64 v238, v238
  v_mfma_f32_16x16x32_bf16 v[28:31], v[180:183], a[204:207], v[28:31]
  ds_read_b128 v[196:199], v208 offset:46080
  v_mfma_f32_16x16x32_bf16 v[32:35], v[184:187], a[200:203], v[32:35]
  buffer_load_dwordx4 v253, s[16:19], s74 offen offset:3072 sc1 lds
  v_rcp_f32_e64 v239, v239
  v_mfma_f32_16x16x32_bf16 v[36:39], v[184:187], a[204:207], v[36:39]
  s_waitcnt lgkmcnt(2)
  ds_read_b128 v[200:203], v208 offset:47104
  s_bfe_u32 s74, s1, 0x40004
  v_mfma_f32_16x16x32_bf16 v[40:43], v[188:191], a[200:203], v[40:43]
  s_lshl_b32 s74, s74, 15
  ds_read_b128 v[204:207], v208 offset:48128
  v_mul_f32_e64 v104, v104, v236
  v_mfma_f32_16x16x32_bf16 v[44:47], v[188:191], a[204:207], v[44:47]
  s_waitcnt lgkmcnt(3)
  ds_read_b128 v[144:147], v208 offset:49152
  v_mul_f32 v105, v105, v237
  v_mfma_f32_16x16x32_bf16 v[48:51], v[192:195], a[200:203], v[48:51]
  ds_read_b128 v[148:151], v208 offset:50176
  v_mul_f32_e64 v106, v106, v238
  v_mfma_f32_16x16x32_bf16 v[52:55], v[192:195], a[204:207], v[52:55]
  s_waitcnt vmcnt(24) lgkmcnt(4)
  ds_read_b128 a[68:71], v220 offset:4096
  v_mfma_f32_16x16x32_bf16 v[56:59], v[196:199], a[200:203], v[56:59]
  s_add_u32 m0, s68, 0
  ds_read_b128 a[76:79], v221 offset:4096
  v_mul_f32_e64 v107, v107, v239
  v_mfma_f32_16x16x32_bf16 v[60:63], v[196:199], a[204:207], v[60:63]
  s_waitcnt lgkmcnt(5)
  ds_read_b128 v[152:155], v208 offset:51200
  s_add_u32 s73, s72, 16384
  v_mfma_f32_16x16x32_bf16 v[64:67], v[200:203], a[200:203], v[64:67]
  ds_read_b128 a[84:87], v222 offset:4096
  v_mul_f32 v236, v108, v108
  v_mfma_f32_16x16x32_bf16 v[68:71], v[200:203], a[204:207], v[68:71]
  s_waitcnt lgkmcnt(5)
  ds_read_b128 v[156:159], v208 offset:52224
  v_mul_f32 v237, v109, v109
  v_mfma_f32_16x16x32_bf16 v[72:75], v[204:207], a[200:203], v[72:75]
  ds_read_b128 a[92:95], v223 offset:4096
  v_mul_f32_e64 v238, v110, v110
  v_mfma_f32_16x16x32_bf16 v[76:79], v[204:207], a[204:207], v[76:79]
  ds_read_b128 v[160:163], v208 offset:53248
  v_mul_f32_e64 v239, v111, v111
  v_mfma_f32_16x16x32_bf16 v[16:19], v[144:147], a[208:211], v[16:19]
  buffer_load_dwordx4 v216, s[40:43], s72 offen offset:0 lds
  v_mfma_f32_16x16x32_bf16 v[20:23], v[144:147], a[212:215], v[20:23]
  s_waitcnt lgkmcnt(4)
  ds_read_b128 v[164:167], v208 offset:54272
  v_fma_f32 v236, v236, v227, v225
  v_mfma_f32_16x16x32_bf16 v[24:27], v[148:151], a[208:211], v[24:27]
  buffer_load_dwordx4 v217, s[40:43], s72 offen offset:1024 lds
  v_mfma_f32_16x16x32_bf16 v[28:31], v[148:151], a[212:215], v[28:31]
  ds_read_b128 v[168:171], v208 offset:55296
  v_fma_f32 v237, v237, v227, v225
  v_mfma_f32_16x16x32_bf16 v[32:35], v[152:155], a[208:211], v[32:35]
  buffer_load_dwordx4 v218, s[40:43], s72 offen offset:2048 lds
  v_mfma_f32_16x16x32_bf16 v[36:39], v[152:155], a[212:215], v[36:39]
  s_waitcnt lgkmcnt(2)
  ds_read_b128 v[172:175], v208 offset:56320
  v_fma_f32 v238, v238, v227, v225
  v_mfma_f32_16x16x32_bf16 v[40:43], v[156:159], a[208:211], v[40:43]
  ds_read_b128 v[176:179], v208 offset:57344
  v_fma_f32 v239, v239, v227, v225
  v_mfma_f32_16x16x32_bf16 v[44:47], v[156:159], a[212:215], v[44:47]
  buffer_load_dwordx4 v219, s[40:43], s72 offen offset:3072 lds
  v_mfma_f32_16x16x32_bf16 v[48:51], v[160:163], a[208:211], v[48:51]
  ds_read_b128 v[180:183], v208 offset:58368
  v_mul_f32_e64 v236, v236, v108
  v_mfma_f32_16x16x32_bf16 v[52:55], v[160:163], a[212:215], v[52:55]
  s_waitcnt lgkmcnt(3)
  ds_read_b128 v[184:187], v208 offset:59392
  s_add_u32 m0, s68, 4096
  v_mfma_f32_16x16x32_bf16 v[56:59], v[164:167], a[208:211], v[56:59]
  ds_read_b128 v[188:191], v208 offset:60416
  v_mul_f32 v237, v237, v109
  v_mfma_f32_16x16x32_bf16 v[60:63], v[164:167], a[212:215], v[60:63]
  ds_read_b128 v[192:195], v208 offset:61440
  v_mul_f32_e64 v238, v238, v110
  v_mfma_f32_16x16x32_bf16 v[64:67], v[168:171], a[208:211], v[64:67]
  buffer_load_dwordx4 v216, s[40:43], s73 offen offset:0 lds
  v_mfma_f32_16x16x32_bf16 v[68:71], v[168:171], a[212:215], v[68:71]
  s_waitcnt lgkmcnt(4)
  ds_read_b128 v[196:199], v208 offset:62464
  v_mul_f32 v239, v239, v111
  v_mfma_f32_16x16x32_bf16 v[72:75], v[172:175], a[208:211], v[72:75]
  ds_read_b128 v[200:203], v208 offset:63488
  v_mfma_f32_16x16x32_bf16 v[76:79], v[172:175], a[212:215], v[76:79]
  buffer_load_dwordx4 v217, s[40:43], s73 offen offset:1024 lds
  v_mfma_f32_16x16x32_bf16 v[16:19], v[176:179], a[216:219], v[16:19]
  ds_read_b128 v[204:207], v208 offset:64512
  v_mfma_f32_16x16x32_bf16 v[20:23], v[176:179], a[220:223], v[20:23]
  s_waitcnt lgkmcnt(3)
  buffer_load_dwordx4 v218, s[40:43], s73 offen offset:2048 lds
  v_mfma_f32_16x16x32_bf16 v[24:27], v[180:183], a[216:219], v[24:27]
  buffer_load_dwordx4 v219, s[40:43], s73 offen offset:3072 lds
  v_mfma_f32_16x16x32_bf16 v[28:31], v[180:183], a[220:223], v[28:31]
  s_bfe_u32 s72, s1, 0x40014
  v_exp_f32 v236, v236
  v_mfma_f32_16x16x32_bf16 v[32:35], v[184:187], a[216:219], v[32:35]
  v_exp_f32_e64 v237, v237
  v_mfma_f32_16x16x32_bf16 v[36:39], v[184:187], a[220:223], v[36:39]
  s_lshl_b32 s72, s72, 8
  v_exp_f32 v238, v238
  v_mfma_f32_16x16x32_bf16 v[40:43], v[188:191], a[216:219], v[40:43]
  v_exp_f32_e64 v239, v239
  v_mfma_f32_16x16x32_bf16 v[44:47], v[188:191], a[220:223], v[44:47]
  v_add_f32 v236, 1.0, v236
  v_add_f32 v237, 1.0, v237
  v_mfma_f32_16x16x32_bf16 v[48:51], v[192:195], a[216:219], v[48:51]
  s_waitcnt vmcnt(20) lgkmcnt(0)
  s_barrier
  v_mfma_f32_16x16x32_bf16 v[52:55], v[192:195], a[220:223], v[52:55]
  s_add_u32 m0, s69, 32768
  ds_read_b128 v[144:147], v210 offset:0
  v_add_f32_e64 v238, 1.0, v238
  v_mfma_f32_16x16x32_bf16 v[56:59], v[196:199], a[216:219], v[56:59]
  ds_read_b128 v[148:151], v210 offset:1024
  v_add_f32_e64 v239, 1.0, v239
  v_mfma_f32_16x16x32_bf16 v[60:63], v[196:199], a[220:223], v[60:63]
  ds_read_b128 v[152:155], v210 offset:2048
  v_mfma_f32_16x16x32_bf16 v[64:67], v[200:203], a[216:219], v[64:67]
  ds_read_b128 v[156:159], v210 offset:3072
  v_mfma_f32_16x16x32_bf16 v[68:71], v[200:203], a[220:223], v[68:71]
  buffer_load_dwordx4 v252, s[16:19], s74 offen offset:0 sc1 lds
  v_mfma_f32_16x16x32_bf16 v[72:75], v[204:207], a[216:219], v[72:75]
  ds_read_b128 v[160:163], v210 offset:4096
  v_mfma_f32_16x16x32_bf16 v[76:79], v[204:207], a[220:223], v[76:79]
  s_waitcnt lgkmcnt(4)
  buffer_load_dword v255, v14, s[16:19], s98 offen sc1
  v_mfma_f32_16x16x32_bf16 v[16:19], v[144:147], a[224:227], v[16:19]
  ds_read_b128 v[164:167], v210 offset:5120
  v_mfma_f32_16x16x32_bf16 v[20:23], v[144:147], a[228:231], v[20:23]
  s_waitcnt lgkmcnt(3)
  buffer_load_dwordx4 v252, s[16:19], s74 offen offset:1024 sc1 lds
  v_mfma_f32_16x16x32_bf16 v[24:27], v[148:151], a[224:227], v[24:27]
  ds_read_b128 v[168:171], v210 offset:6144
  v_mfma_f32_16x16x32_bf16 v[28:31], v[148:151], a[228:231], v[28:31]
  buffer_load_dwordx4 v252, s[16:19], s74 offen offset:2048 sc1 lds
  v_mfma_f32_16x16x32_bf16 v[32:35], v[152:155], a[224:227], v[32:35]
  v_rcp_f32_e64 v236, v236
  v_mfma_f32_16x16x32_bf16 v[36:39], v[152:155], a[228:231], v[36:39]
  s_waitcnt lgkmcnt(2)
  ds_read_b128 v[172:175], v210 offset:7168
  v_mfma_f32_16x16x32_bf16 v[40:43], v[156:159], a[224:227], v[40:43]
  v_rcp_f32 v237, v237
  v_mfma_f32_16x16x32_bf16 v[44:47], v[156:159], a[228:231], v[44:47]
  ds_read_b128 v[176:179], v210 offset:8192
  v_mfma_f32_16x16x32_bf16 v[48:51], v[160:163], a[224:227], v[48:51]
  buffer_load_dwordx4 v252, s[16:19], s74 offen offset:3072 sc1 lds
  v_mfma_f32_16x16x32_bf16 v[52:55], v[160:163], a[228:231], v[52:55]
  s_waitcnt lgkmcnt(2)
  v_rcp_f32 v238, v238
  v_mfma_f32_16x16x32_bf16 v[56:59], v[164:167], a[224:227], v[56:59]
  ds_read_b128 v[180:183], v210 offset:9216
  s_add_u32 m0, s69, 36864
  v_mfma_f32_16x16x32_bf16 v[60:63], v[164:167], a[228:231], v[60:63]
  v_rcp_f32_e64 v239, v239
  v_mfma_f32_16x16x32_bf16 v[64:67], v[168:171], a[224:227], v[64:67]
  ds_read_b128 v[184:187], v210 offset:10240
  v_mul_f32_e64 v108, v108, v236
  v_mfma_f32_16x16x32_bf16 v[68:71], v[168:171], a[228:231], v[68:71]
  s_waitcnt lgkmcnt(2)
  ds_read_b128 v[188:191], v210 offset:11264
  v_mul_f32 v109, v109, v237
  v_mfma_f32_16x16x32_bf16 v[72:75], v[172:175], a[224:227], v[72:75]
  ds_read_b128 v[192:195], v210 offset:12288
  v_mul_f32_e64 v110, v110, v238
  v_mfma_f32_16x16x32_bf16 v[76:79], v[172:175], a[228:231], v[76:79]
  buffer_load_dwordx4 v253, s[16:19], s74 offen offset:0 sc1 lds
  v_mfma_f32_16x16x32_bf16 v[16:19], v[176:179], a[232:235], v[16:19]
  ds_read_b128 v[196:199], v210 offset:13312
  v_mul_f32_e64 v111, v111, v239
  v_mfma_f32_16x16x32_bf16 v[20:23], v[176:179], a[236:239], v[20:23]
  s_waitcnt lgkmcnt(4)
  buffer_load_dwordx4 v253, s[16:19], s74 offen offset:1024 sc1 lds
  v_mfma_f32_16x16x32_bf16 v[24:27], v[180:183], a[232:235], v[24:27]
  ds_read_b128 v[200:203], v210 offset:14336
  v_mul_f32 v236, v112, v112
  v_mfma_f32_16x16x32_bf16 v[28:31], v[180:183], a[236:239], v[28:31]
  s_waitcnt lgkmcnt(3)
  ds_read_b128 a[96:99], v220 offset:8192
  v_mul_f32 v237, v113, v113
  v_mfma_f32_16x16x32_bf16 v[32:35], v[184:187], a[232:235], v[32:35]
  ds_read_b128 a[104:107], v221 offset:8192
  v_mul_f32_e64 v238, v114, v114
  v_mfma_f32_16x16x32_bf16 v[36:39], v[184:187], a[236:239], v[36:39]
  ds_read_b128 v[204:207], v210 offset:15360
  v_mul_f32_e64 v239, v115, v115
  v_mfma_f32_16x16x32_bf16 v[40:43], v[188:191], a[232:235], v[40:43]
  ds_read_b128 a[112:115], v222 offset:8192
  v_fma_f32 v236, v236, v226, v224
  v_mfma_f32_16x16x32_bf16 v[44:47], v[188:191], a[236:239], v[44:47]
  s_waitcnt lgkmcnt(5)
  buffer_load_dwordx4 v253, s[16:19], s74 offen offset:2048 sc1 lds
  v_mfma_f32_16x16x32_bf16 v[48:51], v[192:195], a[232:235], v[48:51]
  ds_read_b128 v[144:147], v210 offset:16384
  v_fma_f32 v237, v237, v226, v224
  v_mfma_f32_16x16x32_bf16 v[52:55], v[192:195], a[236:239], v[52:55]
  ds_read_b128 a[120:123], v223 offset:8192
  v_fma_f32 v238, v238, v226, v224
  v_mfma_f32_16x16x32_bf16 v[56:59], v[196:199], a[232:235], v[56:59]
  ds_read_b128 v[148:151], v210 offset:17408
  v_fma_f32 v239, v239, v226, v224
  v_mfma_f32_16x16x32_bf16 v[60:63], v[196:199], a[236:239], v[60:63]
  s_waitcnt lgkmcnt(4)
  buffer_load_dwordx4 v253, s[16:19], s74 offen offset:3072 sc1 lds
  v_mfma_f32_16x16x32_bf16 v[64:67], v[200:203], a[232:235], v[64:67]
  s_bfe_u32 s74, s1, 0x40008
  ds_read_b128 v[152:155], v210 offset:18432
  v_mul_f32_e64 v236, v236, v112
  v_mfma_f32_16x16x32_bf16 v[68:71], v[200:203], a[236:239], v[68:71]
  ds_read_b128 v[156:159], v210 offset:19456
  v_mul_f32_e64 v237, v237, v113
  v_mfma_f32_16x16x32_bf16 v[72:75], v[204:207], a[232:235], v[72:75]
  ds_read_b128 v[160:163], v210 offset:20480
  v_mul_f32_e64 v238, v238, v114
  v_mfma_f32_16x16x32_bf16 v[76:79], v[204:207], a[236:239], v[76:79]
  s_waitcnt lgkmcnt(4)
  s_lshl_b32 s74, s74, 15
  ds_read_b128 v[164:167], v210 offset:21504
  v_mfma_f32_16x16x32_bf16 v[16:19], v[144:147], a[240:243], v[16:19]
  ds_read_b128 v[168:171], v210 offset:22528
  v_mul_f32_e64 v239, v239, v115
  v_mfma_f32_16x16x32_bf16 v[20:23], v[144:147], a[244:247], v[20:23]
  s_waitcnt lgkmcnt(5)
  ds_read_b128 v[172:175], v210 offset:23552
  v_mfma_f32_16x16x32_bf16 v[24:27], v[148:151], a[240:243], v[24:27]
  ds_read_b128 v[176:179], v210 offset:24576
  v_mfma_f32_16x16x32_bf16 v[28:31], v[148:151], a[244:247], v[28:31]
  s_waitcnt lgkmcnt(5)
  s_add_u32 m0, s68, 8192
  ds_read_b128 v[180:183], v210 offset:25600
  v_mfma_f32_16x16x32_bf16 v[32:35], v[152:155], a[240:243], v[32:35]
  ds_read_b128 v[184:187], v210 offset:26624
  v_mfma_f32_16x16x32_bf16 v[36:39], v[152:155], a[244:247], v[36:39]
  ds_read_b128 v[188:191], v210 offset:27648
  v_mfma_f32_16x16x32_bf16 v[40:43], v[156:159], a[240:243], v[40:43]
  s_add_u32 s73, s72, 16384
  ds_read_b128 v[192:195], v210 offset:28672
  v_mfma_f32_16x16x32_bf16 v[44:47], v[156:159], a[244:247], v[44:47]
  s_waitcnt lgkmcnt(5)
  ds_read_b128 v[196:199], v210 offset:29696
  v_mfma_f32_16x16x32_bf16 v[48:51], v[160:163], a[240:243], v[48:51]
  v_exp_f32 v236, v236
  v_mfma_f32_16x16x32_bf16 v[52:55], v[160:163], a[244:247], v[52:55]
  ds_read_b128 v[200:203], v210 offset:30720
  v_mfma_f32_16x16x32_bf16 v[56:59], v[164:167], a[240:243], v[56:59]
  buffer_load_dwordx4 v216, s[40:43], s72 offen offset:0 lds
  v_mfma_f32_16x16x32_bf16 v[60:63], v[164:167], a[244:247], v[60:63]
  ds_read_b128 v[204:207], v210 offset:31744
  v_mfma_f32_16x16x32_bf16 v[64:67], v[168:171], a[240:243], v[64:67]
  v_exp_f32_e64 v237, v237
  v_mfma_f32_16x16x32_bf16 v[68:71], v[168:171], a[244:247], v[68:71]
  buffer_load_dwordx4 v217, s[40:43], s72 offen offset:1024 lds
  v_mfma_f32_16x16x32_bf16 v[72:75], v[172:175], a[240:243], v[72:75]
  v_exp_f32_e64 v238, v238
  v_mfma_f32_16x16x32_bf16 v[76:79], v[172:175], a[244:247], v[76:79]
  s_waitcnt lgkmcnt(1)
  v_exp_f32 v239, v239
  v_mfma_f32_16x16x32_bf16 v[16:19], v[176:179], a[248:251], v[16:19]
  v_add_f32 v236, 1.0, v236
  v_add_f32 v237, 1.0, v237
  v_mfma_f32_16x16x32_bf16 v[20:23], v[176:179], a[252:255], v[20:23]
  buffer_load_dwordx4 v218, s[40:43], s72 offen offset:2048 lds
  v_mfma_f32_16x16x32_bf16 v[24:27], v[180:183], a[248:251], v[24:27]
  v_add_f32 v238, 1.0, v238
  v_add_f32 v239, 1.0, v239
  v_mfma_f32_16x16x32_bf16 v[28:31], v[180:183], a[252:255], v[28:31]
  v_rcp_f32_e64 v236, v236
  v_mfma_f32_16x16x32_bf16 v[32:35], v[184:187], a[248:251], v[32:35]
  buffer_load_dwordx4 v219, s[40:43], s72 offen offset:3072 lds
  v_mfma_f32_16x16x32_bf16 v[36:39], v[184:187], a[252:255], v[36:39]
  v_rcp_f32_e64 v237, v237
  v_mfma_f32_16x16x32_bf16 v[40:43], v[188:191], a[248:251], v[40:43]
  v_rcp_f32_e64 v238, v238
  v_mfma_f32_16x16x32_bf16 v[44:47], v[188:191], a[252:255], v[44:47]
  v_rcp_f32_e64 v239, v239
  v_mfma_f32_16x16x32_bf16 v[48:51], v[192:195], a[248:251], v[48:51]
  s_waitcnt vmcnt(21) lgkmcnt(0)
  s_barrier
  v_mfma_f32_16x16x32_bf16 v[52:55], v[192:195], a[252:255], v[52:55]
  s_add_u32 m0, s69, 65536
  ds_read_b128 v[144:147], v208 offset:0
  v_mul_f32_e64 v112, v112, v236
  v_mfma_f32_16x16x32_bf16 v[56:59], v[196:199], a[248:251], v[56:59]
  ds_read_b128 v[148:151], v208 offset:1024
  v_mul_f32_e64 v113, v113, v237
  v_mfma_f32_16x16x32_bf16 v[60:63], v[196:199], a[252:255], v[60:63]
  ds_read_b128 v[152:155], v208 offset:2048
  v_mul_f32_e64 v114, v114, v238
  v_mfma_f32_16x16x32_bf16 v[64:67], v[200:203], a[248:251], v[64:67]
  buffer_load_dwordx4 v252, s[16:19], s74 offen offset:0 sc1 lds
  v_mfma_f32_16x16x32_bf16 v[68:71], v[200:203], a[252:255], v[68:71]
  ds_read_b128 v[156:159], v208 offset:3072
  v_mul_f32_e64 v115, v115, v239
  v_mfma_f32_16x16x32_bf16 v[72:75], v[204:207], a[248:251], v[72:75]
  ds_read_b128 v[160:163], v208 offset:4096
  v_mul_f32_e64 v236, v116, v116
  v_mfma_f32_16x16x32_bf16 v[76:79], v[204:207], a[252:255], v[76:79]
  s_waitcnt lgkmcnt(4)
  buffer_load_dwordx4 v252, s[16:19], s74 offen offset:1024 sc1 lds
  v_mfma_f32_16x16x32_bf16 v[16:19], v[144:147], a[0:3], v[16:19]
  ds_read_b128 v[164:167], v208 offset:5120
  v_mul_f32 v237, v117, v117
  v_mfma_f32_16x16x32_bf16 v[20:23], v[144:147], a[4:7], v[20:23]
  s_waitcnt lgkmcnt(3)
  buffer_load_dwordx4 v252, s[16:19], s74 offen offset:2048 sc1 lds
  v_mfma_f32_16x16x32_bf16 v[24:27], v[148:151], a[0:3], v[24:27]
  ds_read_b128 v[168:171], v208 offset:6144
  v_mul_f32 v238, v118, v118
  v_mfma_f32_16x16x32_bf16 v[28:31], v[148:151], a[4:7], v[28:31]
  buffer_load_dwordx4 v252, s[16:19], s74 offen offset:3072 sc1 lds
  v_mfma_f32_16x16x32_bf16 v[32:35], v[152:155], a[0:3], v[32:35]
  ds_read_b128 v[172:175], v208 offset:7168
  v_mul_f32_e64 v239, v119, v119
  v_mfma_f32_16x16x32_bf16 v[36:39], v[152:155], a[4:7], v[36:39]
  s_waitcnt lgkmcnt(3)
  ds_read_b128 v[176:179], v208 offset:8192
  v_fma_f32 v236, v236, v227, v225
  v_mfma_f32_16x16x32_bf16 v[40:43], v[156:159], a[0:3], v[40:43]
  s_add_u32 m0, s69, 69632
  ds_read_b128 v[180:183], v208 offset:9216
  v_fma_f32 v237, v237, v227, v225
  v_mfma_f32_16x16x32_bf16 v[44:47], v[156:159], a[4:7], v[44:47]
  ds_read_b128 v[184:187], v208 offset:10240
  v_fma_f32 v238, v238, v227, v225
  v_mfma_f32_16x16x32_bf16 v[48:51], v[160:163], a[0:3], v[48:51]
  ds_read_b128 v[188:191], v208 offset:11264
  v_fma_f32 v239, v239, v227, v225
  v_mfma_f32_16x16x32_bf16 v[52:55], v[160:163], a[4:7], v[52:55]
  s_waitcnt lgkmcnt(5)
  ds_read_b128 a[100:103], v220 offset:12288
  v_mul_f32_e64 v236, v236, v116
  v_mfma_f32_16x16x32_bf16 v[56:59], v[164:167], a[0:3], v[56:59]
  ds_read_b128 a[108:111], v221 offset:12288
  v_mul_f32_e64 v237, v237, v117
  v_mfma_f32_16x16x32_bf16 v[60:63], v[164:167], a[4:7], v[60:63]
  buffer_load_dwordx4 v253, s[16:19], s74 offen offset:0 sc1 lds
  v_mfma_f32_16x16x32_bf16 v[64:67], v[168:171], a[0:3], v[64:67]
  ds_read_b128 a[116:119], v222 offset:12288
  v_mul_f32_e64 v238, v238, v118
  v_mfma_f32_16x16x32_bf16 v[68:71], v[168:171], a[4:7], v[68:71]
  s_waitcnt lgkmcnt(4)
  buffer_load_dwordx4 v253, s[16:19], s74 offen offset:1024 sc1 lds
  v_mfma_f32_16x16x32_bf16 v[72:75], v[172:175], a[0:3], v[72:75]
  ds_read_b128 a[124:127], v223 offset:12288
  v_mul_f32 v239, v239, v119
  v_mfma_f32_16x16x32_bf16 v[76:79], v[172:175], a[4:7], v[76:79]
  ds_read_b128 v[192:195], v208 offset:12288
  v_mfma_f32_16x16x32_bf16 v[16:19], v[176:179], a[8:11], v[16:19]
  buffer_load_dwordx4 v253, s[16:19], s74 offen offset:2048 sc1 lds
  v_mfma_f32_16x16x32_bf16 v[20:23], v[176:179], a[12:15], v[20:23]
  ds_read_b128 v[196:199], v208 offset:13312
  v_mfma_f32_16x16x32_bf16 v[24:27], v[180:183], a[8:11], v[24:27]
  buffer_load_dwordx4 v253, s[16:19], s74 offen offset:3072 sc1 lds
  v_mfma_f32_16x16x32_bf16 v[28:31], v[180:183], a[12:15], v[28:31]
  ds_read_b128 v[200:203], v208 offset:14336
  s_bfe_u32 s74, s1, 0x4000c
  v_mfma_f32_16x16x32_bf16 v[32:35], v[184:187], a[8:11], v[32:35]
  ds_read_b128 v[204:207], v208 offset:15360
  v_mfma_f32_16x16x32_bf16 v[36:39], v[184:187], a[12:15], v[36:39]
  s_waitcnt lgkmcnt(3)
  ds_read_b128 v[144:147], v208 offset:16384
  v_mfma_f32_16x16x32_bf16 v[40:43], v[188:191], a[8:11], v[40:43]
  s_lshl_b32 s74, s74, 15
  ds_read_b128 v[148:151], v208 offset:17408
  v_mfma_f32_16x16x32_bf16 v[44:47], v[188:191], a[12:15], v[44:47]
  ds_read_b128 v[152:155], v208 offset:18432
  v_mfma_f32_16x16x32_bf16 v[48:51], v[192:195], a[8:11], v[48:51]
  ds_read_b128 v[156:159], v208 offset:19456
  v_mfma_f32_16x16x32_bf16 v[52:55], v[192:195], a[12:15], v[52:55]
  s_waitcnt vmcnt(25) lgkmcnt(5)
  ds_read_b128 a[128:131], v220 offset:0
  v_mfma_f32_16x16x32_bf16 v[56:59], v[196:199], a[8:11], v[56:59]
  ds_read_b128 a[136:139], v221 offset:0
  s_add_u32 m0, s68, 12288
  v_mfma_f32_16x16x32_bf16 v[60:63], v[196:199], a[12:15], v[60:63]
  ds_read_b128 a[144:147], v222 offset:0
  v_mfma_f32_16x16x32_bf16 v[64:67], v[200:203], a[8:11], v[64:67]
  buffer_load_dwordx4 v216, s[40:43], s73 offen offset:0 lds
  v_mfma_f32_16x16x32_bf16 v[68:71], v[200:203], a[12:15], v[68:71]
  s_waitcnt lgkmcnt(4)
  ds_read_b128 a[152:155], v223 offset:0
  v_mfma_f32_16x16x32_bf16 v[72:75], v[204:207], a[8:11], v[72:75]
  buffer_load_dwordx4 v217, s[40:43], s73 offen offset:1024 lds
  v_mfma_f32_16x16x32_bf16 v[76:79], v[204:207], a[12:15], v[76:79]
  ds_read_b128 v[160:163], v208 offset:20480
  v_mfma_f32_16x16x32_bf16 v[16:19], v[144:147], a[16:19], v[16:19]
  buffer_load_dwordx4 v218, s[40:43], s73 offen offset:2048 lds
  v_mfma_f32_16x16x32_bf16 v[20:23], v[144:147], a[20:23], v[20:23]
  ds_read_b128 v[164:167], v208 offset:21504
  v_mfma_f32_16x16x32_bf16 v[24:27], v[148:151], a[16:19], v[24:27]
  ds_read_b128 v[168:171], v208 offset:22528
  v_mfma_f32_16x16x32_bf16 v[28:31], v[148:151], a[20:23], v[28:31]
  buffer_load_dwordx4 v219, s[40:43], s73 offen offset:3072 lds
  v_mfma_f32_16x16x32_bf16 v[32:35], v[152:155], a[16:19], v[32:35]
  ds_read_b128 v[172:175], v208 offset:23552
  s_bfe_u32 s72, s1, 0x40018
  v_mfma_f32_16x16x32_bf16 v[36:39], v[152:155], a[20:23], v[36:39]
  s_waitcnt lgkmcnt(3)
  v_exp_f32 v236, v236
  v_mfma_f32_16x16x32_bf16 v[40:43], v[156:159], a[16:19], v[40:43]
  ds_read_b128 v[176:179], v208 offset:24576
  s_lshl_b32 s72, s72, 8
  v_mfma_f32_16x16x32_bf16 v[44:47], v[156:159], a[20:23], v[44:47]
  v_exp_f32 v237, v237
  v_mfma_f32_16x16x32_bf16 v[48:51], v[160:163], a[16:19], v[48:51]
  ds_read_b128 v[180:183], v208 offset:25600
  v_mfma_f32_16x16x32_bf16 v[52:55], v[160:163], a[20:23], v[52:55]
  s_waitcnt lgkmcnt(3)
  v_exp_f32 v238, v238
  v_mfma_f32_16x16x32_bf16 v[56:59], v[164:167], a[16:19], v[56:59]
  ds_read_b128 v[184:187], v208 offset:26624
  s_add_u32 m0, s68, 0
  v_mfma_f32_16x16x32_bf16 v[60:63], v[164:167], a[20:23], v[60:63]
  ds_read_b128 v[188:191], v208 offset:27648
  s_add_u32 s73, s72, 16384
  v_mfma_f32_16x16x32_bf16 v[64:67], v[168:171], a[16:19], v[64:67]
  v_exp_f32 v239, v239
  v_mfma_f32_16x16x32_bf16 v[68:71], v[168:171], a[20:23], v[68:71]
  s_waitcnt lgkmcnt(3)
  ds_read_b128 v[192:195], v208 offset:28672
  v_add_f32 v236, 1.0, v236
  v_mfma_f32_16x16x32_bf16 v[72:75], v[172:175], a[16:19], v[72:75]
  ds_read_b128 v[196:199], v208 offset:29696
  v_add_f32_e64 v237, 1.0, v237
  v_mfma_f32_16x16x32_bf16 v[76:79], v[172:175], a[20:23], v[76:79]
  ds_read_b128 v[200:203], v208 offset:30720
  v_add_f32_e64 v238, 1.0, v238
  v_mfma_f32_16x16x32_bf16 v[16:19], v[176:179], a[24:27], v[16:19]
  ds_read_b128 v[204:207], v208 offset:31744
  v_add_f32_e64 v239, 1.0, v239
  v_mfma_f32_16x16x32_bf16 v[20:23], v[176:179], a[28:31], v[20:23]
  s_waitcnt lgkmcnt(4)
  buffer_load_dwordx4 v216, s[40:43], s72 offen offset:0 lds
  v_mfma_f32_16x16x32_bf16 v[24:27], v[180:183], a[24:27], v[24:27]
  buffer_load_dwordx4 v217, s[40:43], s72 offen offset:1024 lds
  v_mfma_f32_16x16x32_bf16 v[28:31], v[180:183], a[28:31], v[28:31]
  buffer_load_dwordx4 v218, s[40:43], s72 offen offset:2048 lds
  v_mfma_f32_16x16x32_bf16 v[32:35], v[184:187], a[24:27], v[32:35]
  v_rcp_f32 v236, v236
  v_mfma_f32_16x16x32_bf16 v[36:39], v[184:187], a[28:31], v[36:39]
  buffer_load_dwordx4 v219, s[40:43], s72 offen offset:3072 lds
  v_mfma_f32_16x16x32_bf16 v[40:43], v[188:191], a[24:27], v[40:43]
  v_rcp_f32_e64 v237, v237
  v_mfma_f32_16x16x32_bf16 v[44:47], v[188:191], a[28:31], v[44:47]
  s_branch parallel_sum__ssm_conv_h3__mixer_gmlp__prompt_kernel_ps9
parallel_sum__ssm_conv_h3__mixer_gmlp__prompt_kernel_pg9:
  s_branch parallel_sum__ssm_conv_h3__mixer_gmlp__prompt_kernel_pg13
parallel_sum__ssm_conv_h3__mixer_gmlp__prompt_kernel_ps9:
  s_waitcnt lgkmcnt(0)
  v_rcp_f32 v238, v238
  v_mfma_f32_16x16x32_bf16 v[48:51], v[192:195], a[24:27], v[48:51]
  s_waitcnt vmcnt(20)
  s_barrier
  v_mfma_f32_16x16x32_bf16 v[52:55], v[192:195], a[28:31], v[52:55]
  ds_read_b128 v[144:147], v208 offset:32768
  s_add_u32 m0, s69, 0
  v_mfma_f32_16x16x32_bf16 v[56:59], v[196:199], a[24:27], v[56:59]
  ds_read_b128 v[148:151], v208 offset:33792
  v_mfma_f32_16x16x32_bf16 v[60:63], v[196:199], a[28:31], v[60:63]
  ds_read_b128 v[152:155], v208 offset:34816
  v_mfma_f32_16x16x32_bf16 v[64:67], v[200:203], a[24:27], v[64:67]
  v_rcp_f32 v239, v239
  v_mfma_f32_16x16x32_bf16 v[68:71], v[200:203], a[28:31], v[68:71]
  ds_read_b128 v[156:159], v208 offset:35840
  v_mul_f32_e64 v116, v116, v236
  v_mfma_f32_16x16x32_bf16 v[72:75], v[204:207], a[24:27], v[72:75]
  buffer_load_dwordx4 v252, s[16:19], s74 offen offset:0 sc1 lds
  v_mfma_f32_16x16x32_bf16 v[76:79], v[204:207], a[28:31], v[76:79]
  s_waitcnt lgkmcnt(3)
  ds_read_b128 v[160:163], v208 offset:36864
  v_mul_f32 v117, v117, v237
  v_mfma_f32_16x16x32_bf16 v[16:19], v[144:147], a[32:35], v[16:19]
  ds_read_b128 v[164:167], v208 offset:37888
  v_mul_f32_e64 v118, v118, v238
  v_mfma_f32_16x16x32_bf16 v[20:23], v[144:147], a[36:39], v[20:23]
  s_waitcnt lgkmcnt(3)
  buffer_load_dwordx4 v252, s[16:19], s74 offen offset:1024 sc1 lds
  v_mfma_f32_16x16x32_bf16 v[24:27], v[148:151], a[32:35], v[24:27]
  ds_read_b128 v[168:171], v208 offset:38912
  v_mul_f32 v119, v119, v239
  v_mfma_f32_16x16x32_bf16 v[28:31], v[148:151], a[36:39], v[28:31]
  buffer_load_dwordx4 v252, s[16:19], s74 offen offset:2048 sc1 lds
  v_mfma_f32_16x16x32_bf16 v[32:35], v[152:155], a[32:35], v[32:35]
  ds_read_b128 v[172:175], v208 offset:39936
  v_mul_f32_e64 v236, v120, v120
  v_mfma_f32_16x16x32_bf16 v[36:39], v[152:155], a[36:39], v[36:39]
  s_waitcnt lgkmcnt(3)
  ds_read_b128 v[176:179], v208 offset:40960
  v_mul_f32 v237, v121, v121
  v_mfma_f32_16x16x32_bf16 v[40:43], v[156:159], a[32:35], v[40:43]
  ds_read_b128 v[180:183], v208 offset:41984
  v_mul_f32_e64 v238, v122, v122
  v_mfma_f32_16x16x32_bf16 v[44:47], v[156:159], a[36:39], v[44:47]
  buffer_load_dwordx4 v252, s[16:19], s74 offen offset:3072 sc1 lds
  v_mfma_f32_16x16x32_bf16 v[48:51], v[160:163], a[32:35], v[48:51]
  ds_read_b128 v[184:187], v208 offset:43008
  v_mul_f32_e64 v239, v123, v123
  v_mfma_f32_16x16x32_bf16 v[52:55], v[160:163], a[36:39], v[52:55]
  s_waitcnt lgkmcnt(4)
  ds_read_b128 v[188:191], v208 offset:44032
  v_fma_f32 v236, v236, v226, v224
  v_mfma_f32_16x16x32_bf16 v[56:59], v[164:167], a[32:35], v[56:59]
  s_add_u32 m0, s69, 4096
  ds_read_b128 v[192:195], v208 offset:45056
  v_fma_f32 v237, v237, v226, v224
  v_mfma_f32_16x16x32_bf16 v[60:63], v[164:167], a[36:39], v[60:63]
  ds_read_b128 v[196:199], v208 offset:46080
  v_fma_f32 v238, v238, v226, v224
  v_mfma_f32_16x16x32_bf16 v[64:67], v[168:171], a[32:35], v[64:67]
  ds_read_b128 v[200:203], v208 offset:47104
  v_fma_f32 v239, v239, v226, v224
  v_mfma_f32_16x16x32_bf16 v[68:71], v[168:171], a[36:39], v[68:71]
  s_waitcnt lgkmcnt(5)
  ds_read_b128 v[204:207], v208 offset:48128
  v_mul_f32_e64 v236, v236, v120
  v_mfma_f32_16x16x32_bf16 v[72:75], v[172:175], a[32:35], v[72:75]
  buffer_load_dwordx4 v253, s[16:19], s74 offen offset:0 sc1 lds
  v_mfma_f32_16x16x32_bf16 v[76:79], v[172:175], a[36:39], v[76:79]
  ds_read_b128 v[144:147], v208 offset:49152
  v_mul_f32_e64 v237, v237, v121
  v_mfma_f32_16x16x32_bf16 v[16:19], v[176:179], a[40:43], v[16:19]
  ds_read_b128 v[148:151], v208 offset:50176
  v_mul_f32_e64 v238, v238, v122
  v_mfma_f32_16x16x32_bf16 v[20:23], v[176:179], a[44:47], v[20:23]
  buffer_load_dwordx4 v253, s[16:19], s74 offen offset:1024 sc1 lds
  v_mfma_f32_16x16x32_bf16 v[24:27], v[180:183], a[40:43], v[24:27]
  ds_read_b128 v[152:155], v208 offset:51200
  v_mul_f32_e64 v239, v239, v123
  v_mfma_f32_16x16x32_bf16 v[28:31], v[180:183], a[44:47], v[28:31]
  s_waitcnt lgkmcnt(3)
  ds_read_b128 a[132:135], v220 offset:4096
  v_mfma_f32_16x16x32_bf16 v[32:35], v[184:187], a[40:43], v[32:35]
  ds_read_b128 a[140:143], v221 offset:4096
  v_mfma_f32_16x16x32_bf16 v[36:39], v[184:187], a[44:47], v[36:39]
  ds_read_b128 a[148:151], v222 offset:4096
  v_mfma_f32_16x16x32_bf16 v[40:43], v[188:191], a[40:43], v[40:43]
  buffer_load_dwordx4 v253, s[16:19], s74 offen offset:2048 sc1 lds
  v_mfma_f32_16x16x32_bf16 v[44:47], v[188:191], a[44:47], v[44:47]
  ds_read_b128 a[156:159], v223 offset:4096
  v_mfma_f32_16x16x32_bf16 v[48:51], v[192:195], a[40:43], v[48:51]
  buffer_load_dwordx4 v253, s[16:19], s74 offen offset:3072 sc1 lds
  v_mfma_f32_16x16x32_bf16 v[52:55], v[192:195], a[44:47], v[52:55]
  ds_read_b128 v[156:159], v208 offset:52224
  v_mfma_f32_16x16x32_bf16 v[56:59], v[196:199], a[40:43], v[56:59]
  v_exp_f32 v236, v236
  v_mfma_f32_16x16x32_bf16 v[60:63], v[196:199], a[44:47], v[60:63]
  ds_read_b128 v[160:163], v208 offset:53248
  v_mfma_f32_16x16x32_bf16 v[64:67], v[200:203], a[40:43], v[64:67]
  s_bfe_u32 s74, s1, 0x40010
  v_exp_f32_e64 v237, v237
  v_mfma_f32_16x16x32_bf16 v[68:71], v[200:203], a[44:47], v[68:71]
  ds_read_b128 v[164:167], v208 offset:54272
  v_mfma_f32_16x16x32_bf16 v[72:75], v[204:207], a[40:43], v[72:75]
  v_exp_f32_e64 v238, v238
  v_mfma_f32_16x16x32_bf16 v[76:79], v[204:207], a[44:47], v[76:79]
  s_waitcnt lgkmcnt(2)
  s_lshl_b32 s74, s74, 15
  ds_read_b128 v[168:171], v208 offset:55296
  v_mfma_f32_16x16x32_bf16 v[16:19], v[144:147], a[48:51], v[16:19]
  v_exp_f32_e64 v239, v239
  v_mfma_f32_16x16x32_bf16 v[20:23], v[144:147], a[52:55], v[20:23]
  ds_read_b128 v[172:175], v208 offset:56320
  v_add_f32_e64 v236, 1.0, v236
  v_mfma_f32_16x16x32_bf16 v[24:27], v[148:151], a[48:51], v[24:27]
  ds_read_b128 v[176:179], v208 offset:57344
  v_add_f32_e64 v237, 1.0, v237
  v_mfma_f32_16x16x32_bf16 v[28:31], v[148:151], a[52:55], v[28:31]
  s_add_u32 m0, s68, 4096
  ds_read_b128 v[180:183], v208 offset:58368
  v_add_f32_e64 v238, 1.0, v238
  v_mfma_f32_16x16x32_bf16 v[32:35], v[152:155], a[48:51], v[32:35]
  ds_read_b128 v[184:187], v208 offset:59392
  v_add_f32_e64 v239, 1.0, v239
  v_mfma_f32_16x16x32_bf16 v[36:39], v[152:155], a[52:55], v[36:39]
  ds_read_b128 v[188:191], v208 offset:60416
  v_mfma_f32_16x16x32_bf16 v[40:43], v[156:159], a[48:51], v[40:43]
  buffer_load_dwordx4 v216, s[40:43], s73 offen offset:0 lds
  v_mfma_f32_16x16x32_bf16 v[44:47], v[156:159], a[52:55], v[44:47]
  s_waitcnt lgkmcnt(4)
  ds_read_b128 v[192:195], v208 offset:61440
  v_mfma_f32_16x16x32_bf16 v[48:51], v[160:163], a[48:51], v[48:51]
  ds_read_b128 v[196:199], v208 offset:62464
  v_mfma_f32_16x16x32_bf16 v[52:55], v[160:163], a[52:55], v[52:55]
  buffer_load_dwordx4 v217, s[40:43], s73 offen offset:1024 lds
  v_mfma_f32_16x16x32_bf16 v[56:59], v[164:167], a[48:51], v[56:59]
  v_rcp_f32 v236, v236
  v_mfma_f32_16x16x32_bf16 v[60:63], v[164:167], a[52:55], v[60:63]
  ds_read_b128 v[200:203], v208 offset:63488
  v_mfma_f32_16x16x32_bf16 v[64:67], v[168:171], a[48:51], v[64:67]
  buffer_load_dwordx4 v218, s[40:43], s73 offen offset:2048 lds
  v_mfma_f32_16x16x32_bf16 v[68:71], v[168:171], a[52:55], v[68:71]
  ds_read_b128 v[204:207], v208 offset:64512
  v_mfma_f32_16x16x32_bf16 v[72:75], v[172:175], a[48:51], v[72:75]
  v_rcp_f32_e64 v237, v237
  v_mfma_f32_16x16x32_bf16 v[76:79], v[172:175], a[52:55], v[76:79]
  s_waitcnt lgkmcnt(2)
  buffer_load_dwordx4 v219, s[40:43], s73 offen offset:3072 lds
  v_mfma_f32_16x16x32_bf16 v[16:19], v[176:179], a[56:59], v[16:19]
  v_rcp_f32 v238, v238
  v_mfma_f32_16x16x32_bf16 v[20:23], v[176:179], a[60:63], v[20:23]
  v_rcp_f32_e64 v239, v239
  v_mfma_f32_16x16x32_bf16 v[24:27], v[180:183], a[56:59], v[24:27]
  s_bfe_u32 s72, s1, 0x4001c
  v_mul_f32 v120, v120, v236
  v_mul_f32 v121, v121, v237
  v_mfma_f32_16x16x32_bf16 v[28:31], v[180:183], a[60:63], v[28:31]
  v_mul_f32 v122, v122, v238
  v_mul_f32 v123, v123, v239
  v_mfma_f32_16x16x32_bf16 v[32:35], v[184:187], a[56:59], v[32:35]
  v_mul_f32 v236, v124, v124
  v_mul_f32 v237, v125, v125
  v_mfma_f32_16x16x32_bf16 v[36:39], v[184:187], a[60:63], v[36:39]
  s_lshl_b32 s72, s72, 8
  v_mul_f32 v238, v126, v126
  v_mul_f32_e64 v239, v127, v127
  v_mfma_f32_16x16x32_bf16 v[40:43], v[188:191], a[56:59], v[40:43]
  v_fma_f32 v236, v236, v227, v225
  v_fma_f32 v237, v237, v227, v225
  v_mfma_f32_16x16x32_bf16 v[44:47], v[188:191], a[60:63], v[44:47]
  v_fma_f32 v238, v238, v227, v225
  v_fma_f32 v239, v239, v227, v225
  v_mfma_f32_16x16x32_bf16 v[48:51], v[192:195], a[56:59], v[48:51]
  s_waitcnt vmcnt(20) lgkmcnt(0)
  s_barrier
  v_mfma_f32_16x16x32_bf16 v[52:55], v[192:195], a[60:63], v[52:55]
  s_add_u32 m0, s69, 32768
  ds_read_b128 v[144:147], v210 offset:0
  v_mul_f32_e64 v236, v236, v124
  v_mfma_f32_16x16x32_bf16 v[56:59], v[196:199], a[56:59], v[56:59]
  ds_read_b128 v[148:151], v210 offset:1024
  v_mul_f32_e64 v237, v237, v125
  v_mfma_f32_16x16x32_bf16 v[60:63], v[196:199], a[60:63], v[60:63]
  ds_read_b128 v[152:155], v210 offset:2048
  v_mul_f32_e64 v238, v238, v126
  v_mfma_f32_16x16x32_bf16 v[64:67], v[200:203], a[56:59], v[64:67]
  buffer_load_dwordx4 v252, s[16:19], s74 offen offset:0 sc1 lds
  v_mfma_f32_16x16x32_bf16 v[68:71], v[200:203], a[60:63], v[68:71]
  ds_read_b128 v[156:159], v210 offset:3072
  v_mul_f32_e64 v239, v239, v127
  v_mfma_f32_16x16x32_bf16 v[72:75], v[204:207], a[56:59], v[72:75]
  ds_read_b128 v[160:163], v210 offset:4096
  v_mfma_f32_16x16x32_bf16 v[76:79], v[204:207], a[60:63], v[76:79]
  s_waitcnt lgkmcnt(4)
  buffer_load_dwordx4 v252, s[16:19], s74 offen offset:1024 sc1 lds
  v_mfma_f32_16x16x32_bf16 v[16:19], v[144:147], a[64:67], v[16:19]
  ds_read_b128 v[164:167], v210 offset:5120
  v_mfma_f32_16x16x32_bf16 v[20:23], v[144:147], a[68:71], v[20:23]
  s_waitcnt lgkmcnt(3)
  buffer_load_dwordx4 v252, s[16:19], s74 offen offset:2048 sc1 lds
  v_mfma_f32_16x16x32_bf16 v[24:27], v[148:151], a[64:67], v[24:27]
  ds_read_b128 v[168:171], v210 offset:6144
  v_mfma_f32_16x16x32_bf16 v[28:31], v[148:151], a[68:71], v[28:31]
  buffer_load_dwordx4 v252, s[16:19], s74 offen offset:3072 sc1 lds
  v_mfma_f32_16x16x32_bf16 v[32:35], v[152:155], a[64:67], v[32:35]
  ds_read_b128 v[172:175], v210 offset:7168
  v_mfma_f32_16x16x32_bf16 v[36:39], v[152:155], a[68:71], v[36:39]
  s_waitcnt lgkmcnt(3)
  ds_read_b128 v[176:179], v210 offset:8192
  v_mfma_f32_16x16x32_bf16 v[40:43], v[156:159], a[64:67], v[40:43]
  s_add_u32 m0, s69, 36864
  ds_read_b128 v[180:183], v210 offset:9216
  v_mfma_f32_16x16x32_bf16 v[44:47], v[156:159], a[68:71], v[44:47]
  ds_read_b128 v[184:187], v210 offset:10240
  v_mfma_f32_16x16x32_bf16 v[48:51], v[160:163], a[64:67], v[48:51]
  ds_read_b128 v[188:191], v210 offset:11264
  v_mfma_f32_16x16x32_bf16 v[52:55], v[160:163], a[68:71], v[52:55]
  s_waitcnt lgkmcnt(5)
  ds_read_b128 a[160:163], v220 offset:8192
  v_mfma_f32_16x16x32_bf16 v[56:59], v[164:167], a[64:67], v[56:59]
  ds_read_b128 a[168:171], v221 offset:8192
  v_mfma_f32_16x16x32_bf16 v[60:63], v[164:167], a[68:71], v[60:63]
  buffer_load_dwordx4 v253, s[16:19], s74 offen offset:0 sc1 lds
  v_mfma_f32_16x16x32_bf16 v[64:67], v[168:171], a[64:67], v[64:67]
  ds_read_b128 a[176:179], v222 offset:8192
  v_mfma_f32_16x16x32_bf16 v[68:71], v[168:171], a[68:71], v[68:71]
  s_waitcnt lgkmcnt(4)
  buffer_load_dwordx4 v253, s[16:19], s74 offen offset:1024 sc1 lds
  v_mfma_f32_16x16x32_bf16 v[72:75], v[172:175], a[64:67], v[72:75]
  ds_read_b128 a[184:187], v223 offset:8192
  v_mfma_f32_16x16x32_bf16 v[76:79], v[172:175], a[68:71], v[76:79]
  ds_read_b128 v[192:195], v210 offset:12288
  v_mfma_f32_16x16x32_bf16 v[16:19], v[176:179], a[72:75], v[16:19]
  buffer_load_dwordx4 v253, s[16:19], s74 offen offset:2048 sc1 lds
  v_mfma_f32_16x16x32_bf16 v[20:23], v[176:179], a[76:79], v[20:23]
  ds_read_b128 v[196:199], v210 offset:13312
  v_mfma_f32_16x16x32_bf16 v[24:27], v[180:183], a[72:75], v[24:27]
  buffer_load_dwordx4 v253, s[16:19], s74 offen offset:3072 sc1 lds
  v_mfma_f32_16x16x32_bf16 v[28:31], v[180:183], a[76:79], v[28:31]
  ds_read_b128 v[200:203], v210 offset:14336
  s_bfe_u32 s74, s1, 0x40014
  v_mfma_f32_16x16x32_bf16 v[32:35], v[184:187], a[72:75], v[32:35]
  ds_read_b128 v[204:207], v210 offset:15360
  v_mfma_f32_16x16x32_bf16 v[36:39], v[184:187], a[76:79], v[36:39]
  s_waitcnt lgkmcnt(3)
  v_exp_f32_e64 v236, v236
  v_mfma_f32_16x16x32_bf16 v[40:43], v[188:191], a[72:75], v[40:43]
  ds_read_b128 v[144:147], v210 offset:16384
  s_lshl_b32 s74, s74, 15
  v_mfma_f32_16x16x32_bf16 v[44:47], v[188:191], a[76:79], v[44:47]
  v_exp_f32 v237, v237
  v_mfma_f32_16x16x32_bf16 v[48:51], v[192:195], a[72:75], v[48:51]
  ds_read_b128 v[148:151], v210 offset:17408
  v_mfma_f32_16x16x32_bf16 v[52:55], v[192:195], a[76:79], v[52:55]
  s_waitcnt vmcnt(24) lgkmcnt(3)
  ds_read_b128 a[164:167], v220 offset:12288
  v_mfma_f32_16x16x32_bf16 v[56:59], v[196:199], a[72:75], v[56:59]
  s_add_u32 m0, s68, 8192
  v_exp_f32 v238, v238
  v_mfma_f32_16x16x32_bf16 v[60:63], v[196:199], a[76:79], v[60:63]
  ds_read_b128 a[172:175], v221 offset:12288
  s_add_u32 s73, s72, 16384
  v_mfma_f32_16x16x32_bf16 v[64:67], v[200:203], a[72:75], v[64:67]
  ds_read_b128 v[152:155], v210 offset:18432
  v_mfma_f32_16x16x32_bf16 v[68:71], v[200:203], a[76:79], v[68:71]
  s_waitcnt lgkmcnt(4)
  ds_read_b128 a[180:183], v222 offset:12288
  v_exp_f32 v239, v239
  v_mfma_f32_16x16x32_bf16 v[72:75], v[204:207], a[72:75], v[72:75]
  ds_read_b128 v[156:159], v210 offset:19456
  v_add_f32_e64 v236, 1.0, v236
  v_mfma_f32_16x16x32_bf16 v[76:79], v[204:207], a[76:79], v[76:79]
  ds_read_b128 a[188:191], v223 offset:12288
  v_add_f32_e64 v237, 1.0, v237
  v_mfma_f32_16x16x32_bf16 v[16:19], v[144:147], a[80:83], v[16:19]
  ds_read_b128 v[160:163], v210 offset:20480
  v_add_f32_e64 v238, 1.0, v238
  v_mfma_f32_16x16x32_bf16 v[20:23], v[144:147], a[84:87], v[20:23]
  s_waitcnt lgkmcnt(5)
  buffer_load_dwordx4 v216, s[40:43], s72 offen offset:0 lds
  v_mfma_f32_16x16x32_bf16 v[24:27], v[148:151], a[80:83], v[24:27]
  ds_read_b128 v[164:167], v210 offset:21504
  v_add_f32 v239, 1.0, v239
  v_mfma_f32_16x16x32_bf16 v[28:31], v[148:151], a[84:87], v[28:31]
  s_waitcnt lgkmcnt(4)
  buffer_load_dwordx4 v217, s[40:43], s72 offen offset:1024 lds
  v_mfma_f32_16x16x32_bf16 v[32:35], v[152:155], a[80:83], v[32:35]
  ds_read_b128 v[168:171], v210 offset:22528
  v_mfma_f32_16x16x32_bf16 v[36:39], v[152:155], a[84:87], v[36:39]
  s_waitcnt lgkmcnt(3)
  buffer_load_dwordx4 v218, s[40:43], s72 offen offset:2048 lds
  v_mfma_f32_16x16x32_bf16 v[40:43], v[156:159], a[80:83], v[40:43]
  ds_read_b128 v[172:175], v210 offset:23552
  v_mfma_f32_16x16x32_bf16 v[44:47], v[156:159], a[84:87], v[44:47]
  s_waitcnt lgkmcnt(3)
  ds_read_b128 v[176:179], v210 offset:24576
  v_rcp_f32 v236, v236
  v_mfma_f32_16x16x32_bf16 v[48:51], v[160:163], a[80:83], v[48:51]
  buffer_load_dwordx4 v219, s[40:43], s72 offen offset:3072 lds
  v_mfma_f32_16x16x32_bf16 v[52:55], v[160:163], a[84:87], v[52:55]
  s_waitcnt lgkmcnt(3)
  ds_read_b128 v[180:183], v210 offset:25600
  v_rcp_f32 v237, v237
  v_mfma_f32_16x16x32_bf16 v[56:59], v[164:167], a[80:83], v[56:59]
  s_add_u32 m0, s68, 12288
  ds_read_b128 v[184:187], v210 offset:26624
  v_rcp_f32_e64 v238, v238
  v_mfma_f32_16x16x32_bf16 v[60:63], v[164:167], a[84:87], v[60:63]
  s_waitcnt lgkmcnt(4)
  ds_read_b128 v[188:191], v210 offset:27648
  v_mfma_f32_16x16x32_bf16 v[64:67], v[168:171], a[80:83], v[64:67]
  ds_read_b128 v[192:195], v210 offset:28672
  v_rcp_f32 v239, v239
  v_mfma_f32_16x16x32_bf16 v[68:71], v[168:171], a[84:87], v[68:71]
  s_waitcnt lgkmcnt(4)
  buffer_load_dwordx4 v216, s[40:43], s73 offen offset:0 lds
  v_mfma_f32_16x16x32_bf16 v[72:75], v[172:175], a[80:83], v[72:75]
  ds_read_b128 v[196:199], v210 offset:29696
  v_mul_f32 v124, v124, v236
  v_mfma_f32_16x16x32_bf16 v[76:79], v[172:175], a[84:87], v[76:79]
  ds_read_b128 v[200:203], v210 offset:30720
  v_mul_f32_e64 v125, v125, v237
  v_mfma_f32_16x16x32_bf16 v[16:19], v[176:179], a[88:91], v[16:19]
  ds_read_b128 v[204:207], v210 offset:31744
  v_mul_f32_e64 v126, v126, v238
  v_mfma_f32_16x16x32_bf16 v[20:23], v[176:179], a[92:95], v[20:23]
  s_waitcnt lgkmcnt(4)
  buffer_load_dwordx4 v217, s[40:43], s73 offen offset:1024 lds
  v_mfma_f32_16x16x32_bf16 v[24:27], v[180:183], a[88:91], v[24:27]
  buffer_load_dwordx4 v218, s[40:43], s73 offen offset:2048 lds
  v_mfma_f32_16x16x32_bf16 v[28:31], v[180:183], a[92:95], v[28:31]
  v_mul_f32 v127, v127, v239
  v_mul_f32_e64 v236, v128, v128
  v_mfma_f32_16x16x32_bf16 v[32:35], v[184:187], a[88:91], v[32:35]
  buffer_load_dwordx4 v219, s[40:43], s73 offen offset:3072 lds
  v_mfma_f32_16x16x32_bf16 v[36:39], v[184:187], a[92:95], v[36:39]
  s_lshl_b32 s72, s97, 18
  v_mul_f32 v237, v129, v129
  v_mul_f32_e64 v238, v130, v130
  v_mfma_f32_16x16x32_bf16 v[40:43], v[188:191], a[88:91], v[40:43]
  v_mul_f32_e64 v239, v131, v131
  v_fma_f32 v236, v236, v226, v224
  v_mfma_f32_16x16x32_bf16 v[44:47], v[188:191], a[92:95], v[44:47]
  s_waitcnt lgkmcnt(0)
  v_fma_f32 v237, v237, v226, v224
  v_fma_f32 v238, v238, v226, v224
  v_mfma_f32_16x16x32_bf16 v[48:51], v[192:195], a[88:91], v[48:51]
  s_waitcnt vmcnt(20)
  s_barrier
  v_mfma_f32_16x16x32_bf16 v[52:55], v[192:195], a[92:95], v[52:55]
  s_add_u32 m0, s69, 65536
  ds_read_b128 v[144:147], v208 offset:0
  v_fma_f32 v239, v239, v226, v224
  v_mfma_f32_16x16x32_bf16 v[56:59], v[196:199], a[88:91], v[56:59]
  ds_read_b128 v[148:151], v208 offset:1024
  v_mul_f32 v236, v236, v128
  v_mfma_f32_16x16x32_bf16 v[60:63], v[196:199], a[92:95], v[60:63]
  ds_read_b128 v[152:155], v208 offset:2048
  v_mul_f32_e64 v237, v237, v129
  v_mfma_f32_16x16x32_bf16 v[64:67], v[200:203], a[88:91], v[64:67]
  ds_read_b128 v[156:159], v208 offset:3072
  v_mul_f32_e64 v238, v238, v130
  v_mfma_f32_16x16x32_bf16 v[68:71], v[200:203], a[92:95], v[68:71]
  buffer_load_dwordx4 v252, s[16:19], s74 offen offset:0 sc1 lds
  v_mfma_f32_16x16x32_bf16 v[72:75], v[204:207], a[88:91], v[72:75]
  ds_read_b128 v[160:163], v208 offset:4096
  v_mul_f32_e64 v239, v239, v131
  v_mfma_f32_16x16x32_bf16 v[76:79], v[204:207], a[92:95], v[76:79]
  s_waitcnt lgkmcnt(4)
  ds_read_b128 v[164:167], v208 offset:5120
  v_mfma_f32_16x16x32_bf16 v[16:19], v[144:147], a[96:99], v[16:19]
  buffer_load_dwordx4 v252, s[16:19], s74 offen offset:1024 sc1 lds
  v_mfma_f32_16x16x32_bf16 v[20:23], v[144:147], a[100:103], v[20:23]
  s_waitcnt lgkmcnt(3)
  ds_read_b128 v[168:171], v208 offset:6144
  v_mfma_f32_16x16x32_bf16 v[24:27], v[148:151], a[96:99], v[24:27]
  ds_read_b128 v[172:175], v208 offset:7168
  v_mfma_f32_16x16x32_bf16 v[28:31], v[148:151], a[100:103], v[28:31]
  buffer_load_dwordx4 v252, s[16:19], s74 offen offset:2048 sc1 lds
  v_mfma_f32_16x16x32_bf16 v[32:35], v[152:155], a[96:99], v[32:35]
  ds_read_b128 v[176:179], v208 offset:8192
  v_mfma_f32_16x16x32_bf16 v[36:39], v[152:155], a[100:103], v[36:39]
  s_waitcnt lgkmcnt(3)
  ds_read_b128 v[180:183], v208 offset:9216
  v_mfma_f32_16x16x32_bf16 v[40:43], v[156:159], a[96:99], v[40:43]
  ds_read_b128 v[184:187], v208 offset:10240
  v_mfma_f32_16x16x32_bf16 v[44:47], v[156:159], a[100:103], v[44:47]
  buffer_load_dwordx4 v252, s[16:19], s74 offen offset:3072 sc1 lds
  v_mfma_f32_16x16x32_bf16 v[48:51], v[160:163], a[96:99], v[48:51]
  ds_read_b128 v[188:191], v208 offset:11264
  v_mfma_f32_16x16x32_bf16 v[52:55], v[160:163], a[100:103], v[52:55]
  v_exp_f32 v236, v236
  v_mfma_f32_16x16x32_bf16 v[56:59], v[164:167], a[96:99], v[56:59]
  s_add_u32 m0, s69, 69632
  ds_read_b128 v[192:195], v208 offset:12288
  v_mfma_f32_16x16x32_bf16 v[60:63], v[164:167], a[100:103], v[60:63]
  s_waitcnt lgkmcnt(3)
  v_exp_f32 v237, v237
  v_mfma_f32_16x16x32_bf16 v[64:67], v[168:171], a[96:99], v[64:67]
  ds_read_b128 v[196:199], v208 offset:13312
  v_mfma_f32_16x16x32_bf16 v[68:71], v[168:171], a[100:103], v[68:71]
  v_exp_f32_e64 v238, v238
  v_mfma_f32_16x16x32_bf16 v[72:75], v[172:175], a[96:99], v[72:75]
  buffer_load_dwordx4 v253, s[16:19], s74 offen offset:0 sc1 lds
  v_mfma_f32_16x16x32_bf16 v[76:79], v[172:175], a[100:103], v[76:79]
  ds_read_b128 v[200:203], v208 offset:14336
  v_mfma_f32_16x16x32_bf16 v[16:19], v[176:179], a[104:107], v[16:19]
  v_exp_f32_e64 v239, v239
  v_mfma_f32_16x16x32_bf16 v[20:23], v[176:179], a[108:111], v[20:23]
  buffer_load_dwordx4 v253, s[16:19], s74 offen offset:1024 sc1 lds
  v_mfma_f32_16x16x32_bf16 v[24:27], v[180:183], a[104:107], v[24:27]
  ds_read_b128 v[204:207], v208 offset:15360
  v_add_f32_e64 v236, 1.0, v236
  v_mfma_f32_16x16x32_bf16 v[28:31], v[180:183], a[108:111], v[28:31]
  s_waitcnt lgkmcnt(2)
  ds_read_b128 a[192:195], v220 offset:0
  v_add_f32 v237, 1.0, v237
  v_mfma_f32_16x16x32_bf16 v[32:35], v[184:187], a[104:107], v[32:35]
  ds_read_b128 a[200:203], v221 offset:0
  v_add_f32_e64 v238, 1.0, v238
  v_mfma_f32_16x16x32_bf16 v[36:39], v[184:187], a[108:111], v[36:39]
  ds_read_b128 a[208:211], v222 offset:0
  v_add_f32_e64 v239, 1.0, v239
  v_mfma_f32_16x16x32_bf16 v[40:43], v[188:191], a[104:107], v[40:43]
  buffer_load_dwordx4 v253, s[16:19], s74 offen offset:2048 sc1 lds
  v_mfma_f32_16x16x32_bf16 v[44:47], v[188:191], a[108:111], v[44:47]
  ds_read_b128 v[144:147], v208 offset:16384
  v_mfma_f32_16x16x32_bf16 v[48:51], v[192:195], a[104:107], v[48:51]
  ds_read_b128 a[216:219], v223 offset:0
  v_mfma_f32_16x16x32_bf16 v[52:55], v[192:195], a[108:111], v[52:55]
  ds_read_b128 v[148:151], v208 offset:17408
  v_mfma_f32_16x16x32_bf16 v[56:59], v[196:199], a[104:107], v[56:59]
  buffer_load_dwordx4 v253, s[16:19], s74 offen offset:3072 sc1 lds
  v_mfma_f32_16x16x32_bf16 v[60:63], v[196:199], a[108:111], v[60:63]
  s_waitcnt lgkmcnt(3)
  ds_read_b128 v[152:155], v208 offset:18432
  v_mfma_f32_16x16x32_bf16 v[64:67], v[200:203], a[104:107], v[64:67]
  ds_read_b128 v[156:159], v208 offset:19456
  s_bfe_u32 s74, s1, 0x40018
  v_mfma_f32_16x16x32_bf16 v[68:71], v[200:203], a[108:111], v[68:71]
  v_rcp_f32 v236, v236
  v_mfma_f32_16x16x32_bf16 v[72:75], v[204:207], a[104:107], v[72:75]
  ds_read_b128 v[160:163], v208 offset:20480
  v_mfma_f32_16x16x32_bf16 v[76:79], v[204:207], a[108:111], v[76:79]
  s_waitcnt lgkmcnt(3)
  s_lshl_b32 s74, s74, 15
  ds_read_b128 v[164:167], v208 offset:21504
  v_mfma_f32_16x16x32_bf16 v[16:19], v[144:147], a[112:115], v[16:19]
  v_rcp_f32_e64 v237, v237
  v_mfma_f32_16x16x32_bf16 v[20:23], v[144:147], a[116:119], v[20:23]
  v_rcp_f32_e64 v238, v238
  v_mfma_f32_16x16x32_bf16 v[24:27], v[148:151], a[112:115], v[24:27]
  ds_read_b128 v[168:171], v208 offset:22528
  v_mfma_f32_16x16x32_bf16 v[28:31], v[148:151], a[116:119], v[28:31]
  s_waitcnt lgkmcnt(3)
  s_add_u32 m0, s68, 0
  ds_read_b128 v[172:175], v208 offset:23552
  v_mfma_f32_16x16x32_bf16 v[32:35], v[152:155], a[112:115], v[32:35]
  v_rcp_f32_e64 v239, v239
  v_mfma_f32_16x16x32_bf16 v[36:39], v[152:155], a[116:119], v[36:39]
  ds_read_b128 v[176:179], v208 offset:24576
  v_mul_f32_e64 v128, v128, v236
  v_mfma_f32_16x16x32_bf16 v[40:43], v[156:159], a[112:115], v[40:43]
  s_add_u32 s73, s72, 0x10000
  ds_read_b128 v[180:183], v208 offset:25600
  v_mul_f32_e64 v129, v129, v237
  v_mfma_f32_16x16x32_bf16 v[44:47], v[156:159], a[116:119], v[44:47]
  s_waitcnt lgkmcnt(4)
  ds_read_b128 v[184:187], v208 offset:26624
  v_mul_f32 v130, v130, v238
  v_mfma_f32_16x16x32_bf16 v[48:51], v[160:163], a[112:115], v[48:51]
  ds_read_b128 v[188:191], v208 offset:27648
  v_mul_f32_e64 v131, v131, v239
  v_mfma_f32_16x16x32_bf16 v[52:55], v[160:163], a[116:119], v[52:55]
  ds_read_b128 v[192:195], v208 offset:28672
  v_mul_f32_e64 v236, v132, v132
  v_mfma_f32_16x16x32_bf16 v[56:59], v[164:167], a[112:115], v[56:59]
  buffer_load_dwordx4 v244, s[48:51], s72 offen offset:0 lds
  v_mfma_f32_16x16x32_bf16 v[60:63], v[164:167], a[116:119], v[60:63]
  s_waitcnt lgkmcnt(4)
  ds_read_b128 v[196:199], v208 offset:29696
  v_mul_f32 v237, v133, v133
  v_mfma_f32_16x16x32_bf16 v[64:67], v[168:171], a[112:115], v[64:67]
  ds_read_b128 v[200:203], v208 offset:30720
  v_mul_f32_e64 v238, v134, v134
  v_mfma_f32_16x16x32_bf16 v[68:71], v[168:171], a[116:119], v[68:71]
  buffer_load_dwordx4 v245, s[48:51], s72 offen offset:1024 lds
  v_mfma_f32_16x16x32_bf16 v[72:75], v[172:175], a[112:115], v[72:75]
  ds_read_b128 v[204:207], v208 offset:31744
  v_mul_f32_e64 v239, v135, v135
  v_mfma_f32_16x16x32_bf16 v[76:79], v[172:175], a[116:119], v[76:79]
  v_fma_f32 v236, v236, v227, v225
  v_fma_f32 v237, v237, v227, v225
  v_mfma_f32_16x16x32_bf16 v[16:19], v[176:179], a[120:123], v[16:19]
  v_fma_f32 v238, v238, v227, v225
  v_fma_f32 v239, v239, v227, v225
  v_mfma_f32_16x16x32_bf16 v[20:23], v[176:179], a[124:127], v[20:23]
  s_waitcnt lgkmcnt(2)
  buffer_load_dwordx4 v246, s[48:51], s72 offen offset:2048 lds
  v_mfma_f32_16x16x32_bf16 v[24:27], v[180:183], a[120:123], v[24:27]
  v_mul_f32 v236, v236, v132
  v_mul_f32_e64 v237, v237, v133
  v_mfma_f32_16x16x32_bf16 v[28:31], v[180:183], a[124:127], v[28:31]
  v_mul_f32 v238, v238, v134
  v_mul_f32 v239, v239, v135
  v_mfma_f32_16x16x32_bf16 v[32:35], v[184:187], a[120:123], v[32:35]
  buffer_load_dwordx4 v247, s[48:51], s72 offen offset:3072 lds
  v_mfma_f32_16x16x32_bf16 v[36:39], v[184:187], a[124:127], v[36:39]
  v_exp_f32_e64 v236, v236
  v_mfma_f32_16x16x32_bf16 v[40:43], v[188:191], a[120:123], v[40:43]
  v_exp_f32_e64 v237, v237
  v_mfma_f32_16x16x32_bf16 v[44:47], v[188:191], a[124:127], v[44:47]
  v_exp_f32_e64 v238, v238
  v_mfma_f32_16x16x32_bf16 v[48:51], v[192:195], a[120:123], v[48:51]
  s_waitcnt vmcnt(20) lgkmcnt(0)
  s_barrier
  v_mfma_f32_16x16x32_bf16 v[52:55], v[192:195], a[124:127], v[52:55]
  ds_read_b128 v[144:147], v208 offset:32768
  s_add_u32 m0, s69, 0
  v_mfma_f32_16x16x32_bf16 v[56:59], v[196:199], a[120:123], v[56:59]
  ds_read_b128 v[148:151], v208 offset:33792
  v_mfma_f32_16x16x32_bf16 v[60:63], v[196:199], a[124:127], v[60:63]
  ds_read_b128 v[152:155], v208 offset:34816
  v_mfma_f32_16x16x32_bf16 v[64:67], v[200:203], a[120:123], v[64:67]
  buffer_load_dwordx4 v252, s[16:19], s74 offen offset:0 sc1 lds
  v_mfma_f32_16x16x32_bf16 v[68:71], v[200:203], a[124:127], v[68:71]
  ds_read_b128 v[156:159], v208 offset:35840
  v_mfma_f32_16x16x32_bf16 v[72:75], v[204:207], a[120:123], v[72:75]
  ds_read_b128 v[160:163], v208 offset:36864
  v_mfma_f32_16x16x32_bf16 v[76:79], v[204:207], a[124:127], v[76:79]
  s_waitcnt lgkmcnt(4)
  buffer_load_dwordx4 v252, s[16:19], s74 offen offset:1024 sc1 lds
  v_mfma_f32_16x16x32_bf16 v[16:19], v[144:147], a[128:131], v[16:19]
  ds_read_b128 v[164:167], v208 offset:37888
  v_mfma_f32_16x16x32_bf16 v[20:23], v[144:147], a[132:135], v[20:23]
  s_waitcnt lgkmcnt(3)
  buffer_load_dwordx4 v252, s[16:19], s74 offen offset:2048 sc1 lds
  v_mfma_f32_16x16x32_bf16 v[24:27], v[148:151], a[128:131], v[24:27]
  ds_read_b128 v[168:171], v208 offset:38912
  v_mfma_f32_16x16x32_bf16 v[28:31], v[148:151], a[132:135], v[28:31]
  buffer_load_dwordx4 v252, s[16:19], s74 offen offset:3072 sc1 lds
  v_mfma_f32_16x16x32_bf16 v[32:35], v[152:155], a[128:131], v[32:35]
  ds_read_b128 v[172:175], v208 offset:39936
  v_mfma_f32_16x16x32_bf16 v[36:39], v[152:155], a[132:135], v[36:39]
  s_waitcnt lgkmcnt(3)
  ds_read_b128 v[176:179], v208 offset:40960
  v_mfma_f32_16x16x32_bf16 v[40:43], v[156:159], a[128:131], v[40:43]
  s_add_u32 m0, s69, 4096
  ds_read_b128 v[180:183], v208 offset:41984
  v_mfma_f32_16x16x32_bf16 v[44:47], v[156:159], a[132:135], v[44:47]
  ds_read_b128 v[184:187], v208 offset:43008
  v_mfma_f32_16x16x32_bf16 v[48:51], v[160:163], a[128:131], v[48:51]
  v_exp_f32_e64 v239, v239
  v_mfma_f32_16x16x32_bf16 v[52:55], v[160:163], a[132:135], v[52:55]
  s_waitcnt lgkmcnt(4)
  ds_read_b128 a[196:199], v220 offset:4096
  v_add_f32 v236, 1.0, v236
  v_mfma_f32_16x16x32_bf16 v[56:59], v[164:167], a[128:131], v[56:59]
  s_branch parallel_sum__ssm_conv_h3__mixer_gmlp__prompt_kernel_ps10
parallel_sum__ssm_conv_h3__mixer_gmlp__prompt_kernel_pg10:
  s_branch parallel_sum__ssm_conv_h3__mixer_gmlp__prompt_kernel_pg14
parallel_sum__ssm_conv_h3__mixer_gmlp__prompt_kernel_ps10:
  ds_read_b128 a[204:207], v221 offset:4096
  v_add_f32_e64 v237, 1.0, v237
  v_mfma_f32_16x16x32_bf16 v[60:63], v[164:167], a[132:135], v[60:63]
  buffer_load_dwordx4 v253, s[16:19], s74 offen offset:0 sc1 lds
  v_mfma_f32_16x16x32_bf16 v[64:67], v[168:171], a[128:131], v[64:67]
  ds_read_b128 a[212:215], v222 offset:4096
  v_add_f32_e64 v238, 1.0, v238
  v_mfma_f32_16x16x32_bf16 v[68:71], v[168:171], a[132:135], v[68:71]
  s_waitcnt lgkmcnt(3)
  buffer_load_dwordx4 v253, s[16:19], s74 offen offset:1024 sc1 lds
  v_mfma_f32_16x16x32_bf16 v[72:75], v[172:175], a[128:131], v[72:75]
  ds_read_b128 v[188:191], v208 offset:44032
  v_add_f32 v239, 1.0, v239
  v_mfma_f32_16x16x32_bf16 v[76:79], v[172:175], a[132:135], v[76:79]
  ds_read_b128 a[220:223], v223 offset:4096
  v_mfma_f32_16x16x32_bf16 v[16:19], v[176:179], a[136:139], v[16:19]
  ds_read_b128 v[192:195], v208 offset:45056
  v_mfma_f32_16x16x32_bf16 v[20:23], v[176:179], a[140:143], v[20:23]
  buffer_load_dwordx4 v253, s[16:19], s74 offen offset:2048 sc1 lds
  v_mfma_f32_16x16x32_bf16 v[24:27], v[180:183], a[136:139], v[24:27]
  ds_read_b128 v[196:199], v208 offset:46080
  v_mfma_f32_16x16x32_bf16 v[28:31], v[180:183], a[140:143], v[28:31]
  buffer_load_dwordx4 v253, s[16:19], s74 offen offset:3072 sc1 lds
  v_mfma_f32_16x16x32_bf16 v[32:35], v[184:187], a[136:139], v[32:35]
  ds_read_b128 v[200:203], v208 offset:47104
  s_bfe_u32 s74, s1, 0x4001c
  v_mfma_f32_16x16x32_bf16 v[36:39], v[184:187], a[140:143], v[36:39]
  s_waitcnt lgkmcnt(3)
  ds_read_b128 v[204:207], v208 offset:48128
  v_mfma_f32_16x16x32_bf16 v[40:43], v[188:191], a[136:139], v[40:43]
  s_lshl_b32 s74, s74, 15
  v_rcp_f32_e64 v236, v236
  v_mfma_f32_16x16x32_bf16 v[44:47], v[188:191], a[140:143], v[44:47]
  s_waitcnt lgkmcnt(3)
  ds_read_b128 v[144:147], v208 offset:49152
  v_mfma_f32_16x16x32_bf16 v[48:51], v[192:195], a[136:139], v[48:51]
  ds_read_b128 v[148:151], v208 offset:50176
  v_rcp_f32 v237, v237
  v_mfma_f32_16x16x32_bf16 v[52:55], v[192:195], a[140:143], v[52:55]
  s_waitcnt vmcnt(24) lgkmcnt(4)
  ds_read_b128 a[224:227], v220 offset:8192
  v_mfma_f32_16x16x32_bf16 v[56:59], v[196:199], a[136:139], v[56:59]
  ds_read_b128 a[232:235], v221 offset:8192
  s_add_u32 m0, s68, 4096
  v_mfma_f32_16x16x32_bf16 v[60:63], v[196:199], a[140:143], v[60:63]
  s_waitcnt lgkmcnt(4)
  ds_read_b128 v[152:155], v208 offset:51200
  v_rcp_f32_e64 v238, v238
  v_mfma_f32_16x16x32_bf16 v[64:67], v[200:203], a[136:139], v[64:67]
  ds_read_b128 a[240:243], v222 offset:8192
  v_mfma_f32_16x16x32_bf16 v[68:71], v[200:203], a[140:143], v[68:71]
  buffer_load_dwordx4 v244, s[48:51], s73 offen offset:0 lds
  v_mfma_f32_16x16x32_bf16 v[72:75], v[204:207], a[136:139], v[72:75]
  ds_read_b128 v[156:159], v208 offset:52224
  v_rcp_f32_e64 v239, v239
  v_mfma_f32_16x16x32_bf16 v[76:79], v[204:207], a[140:143], v[76:79]
  s_waitcnt lgkmcnt(4)
  ds_read_b128 a[248:251], v223 offset:8192
  v_mul_f32 v132, v132, v236
  v_mfma_f32_16x16x32_bf16 v[16:19], v[144:147], a[144:147], v[16:19]
  buffer_load_dwordx4 v245, s[48:51], s73 offen offset:1024 lds
  v_mfma_f32_16x16x32_bf16 v[20:23], v[144:147], a[148:151], v[20:23]
  ds_read_b128 v[160:163], v208 offset:53248
  v_mul_f32_e64 v133, v133, v237
  v_mfma_f32_16x16x32_bf16 v[24:27], v[148:151], a[144:147], v[24:27]
  buffer_load_dwordx4 v246, s[48:51], s73 offen offset:2048 lds
  v_mfma_f32_16x16x32_bf16 v[28:31], v[148:151], a[148:151], v[28:31]
  s_waitcnt lgkmcnt(3)
  ds_read_b128 v[164:167], v208 offset:54272
  v_mul_f32 v134, v134, v238
  v_mfma_f32_16x16x32_bf16 v[32:35], v[152:155], a[144:147], v[32:35]
  ds_read_b128 v[168:171], v208 offset:55296
  v_mul_f32_e64 v135, v135, v239
  v_mfma_f32_16x16x32_bf16 v[36:39], v[152:155], a[148:151], v[36:39]
  s_waitcnt lgkmcnt(3)
  buffer_load_dwordx4 v247, s[48:51], s73 offen offset:3072 lds
  v_mfma_f32_16x16x32_bf16 v[40:43], v[156:159], a[144:147], v[40:43]
  s_add_u32 s72, s72, 0x40000
  ds_read_b128 v[172:175], v208 offset:56320
  v_mul_f32 v236, v136, v136
  v_mfma_f32_16x16x32_bf16 v[44:47], v[156:159], a[148:151], v[44:47]
  s_waitcnt lgkmcnt(3)
  ds_read_b128 v[176:179], v208 offset:57344
  v_mul_f32 v237, v137, v137
  v_mfma_f32_16x16x32_bf16 v[48:51], v[160:163], a[144:147], v[48:51]
  s_cmp_eq_u32 s72, 0x380000
  s_cselect_b32 s72, 0, s72
  ds_read_b128 v[180:183], v208 offset:58368
  v_mfma_f32_16x16x32_bf16 v[52:55], v[160:163], a[148:151], v[52:55]
  s_waitcnt lgkmcnt(4)
  ds_read_b128 v[184:187], v208 offset:59392
  s_add_u32 m0, s68, 8192
  v_mfma_f32_16x16x32_bf16 v[56:59], v[164:167], a[144:147], v[56:59]
  ds_read_b128 v[188:191], v208 offset:60416
  v_mul_f32_e64 v238, v138, v138
  v_mfma_f32_16x16x32_bf16 v[60:63], v[164:167], a[148:151], v[60:63]
  s_waitcnt lgkmcnt(5)
  ds_read_b128 v[192:195], v208 offset:61440
  s_add_u32 s73, s72, 0x10000
  v_mfma_f32_16x16x32_bf16 v[64:67], v[168:171], a[144:147], v[64:67]
  ds_read_b128 v[196:199], v208 offset:62464
  v_mul_f32 v239, v139, v139
  v_mfma_f32_16x16x32_bf16 v[68:71], v[168:171], a[148:151], v[68:71]
  s_waitcnt lgkmcnt(5)
  ds_read_b128 v[200:203], v208 offset:63488
  v_fma_f32 v236, v236, v226, v224
  v_mfma_f32_16x16x32_bf16 v[72:75], v[172:175], a[144:147], v[72:75]
  ds_read_b128 v[204:207], v208 offset:64512
  v_fma_f32 v237, v237, v226, v224
  v_mfma_f32_16x16x32_bf16 v[76:79], v[172:175], a[148:151], v[76:79]
  buffer_load_dwordx4 v244, s[48:51], s72 offen offset:0 lds
  v_mfma_f32_16x16x32_bf16 v[16:19], v[176:179], a[152:155], v[16:19]
  buffer_load_dwordx4 v245, s[48:51], s72 offen offset:1024 lds
  v_mfma_f32_16x16x32_bf16 v[20:23], v[176:179], a[156:159], v[20:23]
  s_waitcnt lgkmcnt(3)
  v_fma_f32 v238, v238, v226, v224
  v_fma_f32 v239, v239, v226, v224
  v_mfma_f32_16x16x32_bf16 v[24:27], v[180:183], a[152:155], v[24:27]
  v_mul_f32 v236, v236, v136
  v_mul_f32 v237, v237, v137
  v_mfma_f32_16x16x32_bf16 v[28:31], v[180:183], a[156:159], v[28:31]
  buffer_load_dwordx4 v246, s[48:51], s72 offen offset:2048 lds
  v_mfma_f32_16x16x32_bf16 v[32:35], v[184:187], a[152:155], v[32:35]
  v_mul_f32 v238, v238, v138
  v_mul_f32 v239, v239, v139
  v_mfma_f32_16x16x32_bf16 v[36:39], v[184:187], a[156:159], v[36:39]
  buffer_load_dwordx4 v247, s[48:51], s72 offen offset:3072 lds
  v_mfma_f32_16x16x32_bf16 v[40:43], v[188:191], a[152:155], v[40:43]
  v_exp_f32_e64 v236, v236
  v_mfma_f32_16x16x32_bf16 v[44:47], v[188:191], a[156:159], v[44:47]
  v_exp_f32_e64 v237, v237
  v_mfma_f32_16x16x32_bf16 v[48:51], v[192:195], a[152:155], v[48:51]
  s_waitcnt vmcnt(20) lgkmcnt(0)
  s_barrier
  v_mfma_f32_16x16x32_bf16 v[52:55], v[192:195], a[156:159], v[52:55]
  ds_read_b128 v[144:147], v210 offset:0
  s_add_u32 m0, s69, 32768
  v_mfma_f32_16x16x32_bf16 v[56:59], v[196:199], a[152:155], v[56:59]
  ds_read_b128 v[148:151], v210 offset:1024
  v_mfma_f32_16x16x32_bf16 v[60:63], v[196:199], a[156:159], v[60:63]
  ds_read_b128 v[152:155], v210 offset:2048
  v_mfma_f32_16x16x32_bf16 v[64:67], v[200:203], a[152:155], v[64:67]
  ds_read_b128 v[156:159], v210 offset:3072
  v_mfma_f32_16x16x32_bf16 v[68:71], v[200:203], a[156:159], v[68:71]
  buffer_load_dwordx4 v252, s[16:19], s74 offen offset:0 sc1 lds
  v_mfma_f32_16x16x32_bf16 v[72:75], v[204:207], a[152:155], v[72:75]
  ds_read_b128 v[160:163], v210 offset:4096
  v_mfma_f32_16x16x32_bf16 v[76:79], v[204:207], a[156:159], v[76:79]
  s_waitcnt lgkmcnt(4)
  ds_read_b128 v[164:167], v210 offset:5120
  v_mfma_f32_16x16x32_bf16 v[16:19], v[144:147], a[160:163], v[16:19]
  v_exp_f32 v238, v238
  v_mfma_f32_16x16x32_bf16 v[20:23], v[144:147], a[164:167], v[20:23]
  s_waitcnt lgkmcnt(3)
  buffer_load_dwordx4 v252, s[16:19], s74 offen offset:1024 sc1 lds
  v_mfma_f32_16x16x32_bf16 v[24:27], v[148:151], a[160:163], v[24:27]
  ds_read_b128 v[168:171], v210 offset:6144
  v_mfma_f32_16x16x32_bf16 v[28:31], v[148:151], a[164:167], v[28:31]
  v_exp_f32 v239, v239
  v_mfma_f32_16x16x32_bf16 v[32:35], v[152:155], a[160:163], v[32:35]
  ds_read_b128 v[172:175], v210 offset:7168
  v_add_f32_e64 v236, 1.0, v236
  v_mfma_f32_16x16x32_bf16 v[36:39], v[152:155], a[164:167], v[36:39]
  s_waitcnt lgkmcnt(2)
  buffer_load_dwordx4 v252, s[16:19], s74 offen offset:2048 sc1 lds
  v_mfma_f32_16x16x32_bf16 v[40:43], v[156:159], a[160:163], v[40:43]
  ds_read_b128 v[176:179], v210 offset:8192
  v_add_f32 v237, 1.0, v237
  v_mfma_f32_16x16x32_bf16 v[44:47], v[156:159], a[164:167], v[44:47]
  ds_read_b128 v[180:183], v210 offset:9216
  v_add_f32_e64 v238, 1.0, v238
  v_mfma_f32_16x16x32_bf16 v[48:51], v[160:163], a[160:163], v[48:51]
  ds_read_b128 v[184:187], v210 offset:10240
  v_add_f32_e64 v239, 1.0, v239
  v_mfma_f32_16x16x32_bf16 v[52:55], v[160:163], a[164:167], v[52:55]
  buffer_load_dwordx4 v252, s[16:19], s74 offen offset:3072 sc1 lds
  v_mfma_f32_16x16x32_bf16 v[56:59], v[164:167], a[160:163], v[56:59]
  ds_read_b128 v[188:191], v210 offset:11264
  v_mfma_f32_16x16x32_bf16 v[60:63], v[164:167], a[164:167], v[60:63]
  s_waitcnt lgkmcnt(4)
  ds_read_b128 v[192:195], v210 offset:12288
  v_rcp_f32 v236, v236
  v_mfma_f32_16x16x32_bf16 v[64:67], v[168:171], a[160:163], v[64:67]
  ds_read_b128 v[196:199], v210 offset:13312
  v_rcp_f32_e64 v237, v237
  v_mfma_f32_16x16x32_bf16 v[68:71], v[168:171], a[164:167], v[68:71]
  ds_read_b128 v[200:203], v210 offset:14336
  v_rcp_f32_e64 v238, v238
  v_mfma_f32_16x16x32_bf16 v[72:75], v[172:175], a[160:163], v[72:75]
  s_add_u32 m0, s69, 36864
  ds_read_b128 v[204:207], v210 offset:15360
  v_rcp_f32_e64 v239, v239
  v_mfma_f32_16x16x32_bf16 v[76:79], v[172:175], a[164:167], v[76:79]
  s_waitcnt lgkmcnt(5)
  ds_read_b128 v[144:147], v210 offset:16384
  v_mul_f32 v136, v136, v236
  v_mfma_f32_16x16x32_bf16 v[16:19], v[176:179], a[168:171], v[16:19]
  ds_read_b128 v[148:151], v210 offset:17408
  v_mul_f32_e64 v137, v137, v237
  v_mfma_f32_16x16x32_bf16 v[20:23], v[176:179], a[172:175], v[20:23]
  ds_read_b128 v[152:155], v210 offset:18432
  v_mul_f32_e64 v138, v138, v238
  v_mfma_f32_16x16x32_bf16 v[24:27], v[180:183], a[168:171], v[24:27]
  buffer_load_dwordx4 v253, s[16:19], s74 offen offset:0 sc1 lds
  v_mfma_f32_16x16x32_bf16 v[28:31], v[180:183], a[172:175], v[28:31]
  ds_read_b128 a[228:231], v220 offset:12288
  v_mul_f32_e64 v139, v139, v239
  v_mfma_f32_16x16x32_bf16 v[32:35], v[184:187], a[168:171], v[32:35]
  ds_read_b128 a[236:239], v221 offset:12288
  v_mul_f32_e64 v236, v140, v140
  v_mfma_f32_16x16x32_bf16 v[36:39], v[184:187], a[172:175], v[36:39]
  s_waitcnt lgkmcnt(4)
  ds_read_b128 a[244:247], v222 offset:12288
  v_mul_f32 v237, v141, v141
  v_mfma_f32_16x16x32_bf16 v[40:43], v[188:191], a[168:171], v[40:43]
  buffer_load_dwordx4 v253, s[16:19], s74 offen offset:1024 sc1 lds
  v_mfma_f32_16x16x32_bf16 v[44:47], v[188:191], a[172:175], v[44:47]
  ds_read_b128 a[252:255], v223 offset:12288
  v_mul_f32_e64 v238, v142, v142
  v_mfma_f32_16x16x32_bf16 v[48:51], v[192:195], a[168:171], v[48:51]
  ds_read_b128 v[156:159], v210 offset:19456
  v_mul_f32_e64 v239, v143, v143
  v_mfma_f32_16x16x32_bf16 v[52:55], v[192:195], a[172:175], v[52:55]
  ds_read_b128 v[160:163], v210 offset:20480
  v_fma_f32 v236, v236, v227, v225
  v_mfma_f32_16x16x32_bf16 v[56:59], v[196:199], a[168:171], v[56:59]
  buffer_load_dwordx4 v253, s[16:19], s74 offen offset:2048 sc1 lds
  v_mfma_f32_16x16x32_bf16 v[60:63], v[196:199], a[172:175], v[60:63]
  ds_read_b128 v[164:167], v210 offset:21504
  v_fma_f32 v237, v237, v227, v225
  v_mfma_f32_16x16x32_bf16 v[64:67], v[200:203], a[168:171], v[64:67]
  ds_read_b128 v[168:171], v210 offset:22528
  v_fma_f32 v238, v238, v227, v225
  v_mfma_f32_16x16x32_bf16 v[68:71], v[200:203], a[172:175], v[68:71]
  ds_read_b128 v[172:175], v210 offset:23552
  v_fma_f32 v239, v239, v227, v225
  v_mfma_f32_16x16x32_bf16 v[72:75], v[204:207], a[168:171], v[72:75]
  buffer_load_dwordx4 v253, s[16:19], s74 offen offset:3072 sc1 lds
  v_mfma_f32_16x16x32_bf16 v[76:79], v[204:207], a[172:175], v[76:79]
  ds_read_b128 v[176:179], v210 offset:24576
  v_mul_f32_e64 v236, v236, v140
  v_mfma_f32_16x16x32_bf16 v[16:19], v[144:147], a[176:179], v[16:19]
  ds_read_b128 v[180:183], v210 offset:25600
  v_mul_f32_e64 v237, v237, v141
  v_mfma_f32_16x16x32_bf16 v[20:23], v[144:147], a[180:183], v[20:23]
  s_waitcnt lgkmcnt(4)
  ds_read_b128 v[184:187], v210 offset:26624
  v_mul_f32 v238, v238, v142
  v_mfma_f32_16x16x32_bf16 v[24:27], v[148:151], a[176:179], v[24:27]
  ds_read_b128 v[188:191], v210 offset:27648
  v_mul_f32_e64 v239, v239, v143
  v_mfma_f32_16x16x32_bf16 v[28:31], v[148:151], a[180:183], v[28:31]
  s_add_u32 m0, s68, 12288
  ds_read_b128 v[192:195], v210 offset:28672
  v_mfma_f32_16x16x32_bf16 v[32:35], v[152:155], a[176:179], v[32:35]
  ds_read_b128 v[196:199], v210 offset:29696
  v_mfma_f32_16x16x32_bf16 v[36:39], v[152:155], a[180:183], v[36:39]
  ds_read_b128 v[200:203], v210 offset:30720
  v_mfma_f32_16x16x32_bf16 v[40:43], v[156:159], a[176:179], v[40:43]
  buffer_load_dword v255, v254, s[16:19], s94 offen sc1
  v_mfma_f32_16x16x32_bf16 v[44:47], v[156:159], a[180:183], v[44:47]
  buffer_load_dwordx4 v244, s[48:51], s73 offen offset:0 lds
  v_mfma_f32_16x16x32_bf16 v[48:51], v[160:163], a[176:179], v[48:51]
  ds_read_b128 v[204:207], v210 offset:31744
  v_mfma_f32_16x16x32_bf16 v[52:55], v[160:163], a[180:183], v[52:55]
  s_waitcnt vmcnt(26)
  ds_read_b64_tr_b16 a[0:1], v240 offset:0
  ds_read_b64_tr_b16 a[2:3], v240 offset:2048
  v_mfma_f32_16x16x32_bf16 v[56:59], v[164:167], a[176:179], v[56:59]
  ds_read_b64_tr_b16 a[4:5], v241 offset:0
  v_mfma_f32_16x16x32_bf16 v[60:63], v[164:167], a[180:183], v[60:63]
  s_waitcnt lgkmcnt(4)
  buffer_load_dwordx4 v245, s[48:51], s73 offen offset:1024 lds
  v_mfma_f32_16x16x32_bf16 v[64:67], v[168:171], a[176:179], v[64:67]
  ds_read_b64_tr_b16 a[6:7], v241 offset:2048
  v_mfma_f32_16x16x32_bf16 v[68:71], v[168:171], a[180:183], v[68:71]
  ds_read_b64_tr_b16 a[8:9], v242 offset:0
  v_mfma_f32_16x16x32_bf16 v[72:75], v[172:175], a[176:179], v[72:75]
  ds_read_b64_tr_b16 a[10:11], v242 offset:2048
  v_mfma_f32_16x16x32_bf16 v[76:79], v[172:175], a[180:183], v[76:79]
  buffer_load_dwordx4 v246, s[48:51], s73 offen offset:2048 lds
  v_mfma_f32_16x16x32_bf16 v[16:19], v[176:179], a[184:187], v[16:19]
  ds_read_b64_tr_b16 a[12:13], v243 offset:0
  v_mfma_f32_16x16x32_bf16 v[20:23], v[176:179], a[188:191], v[20:23]
  ds_read_b64_tr_b16 a[14:15], v243 offset:2048
  v_mfma_f32_16x16x32_bf16 v[24:27], v[180:183], a[184:187], v[24:27]
  v_exp_f32_e64 v236, v236
  v_mfma_f32_16x16x32_bf16 v[28:31], v[180:183], a[188:191], v[28:31]
  buffer_load_dwordx4 v247, s[48:51], s73 offen offset:3072 lds
  v_mfma_f32_16x16x32_bf16 v[32:35], v[184:187], a[184:187], v[32:35]
  s_add_u32 s72, s72, 0x40000
  v_exp_f32_e64 v237, v237
  v_mfma_f32_16x16x32_bf16 v[36:39], v[184:187], a[188:191], v[36:39]
  s_cmp_eq_u32 s72, 0x380000
  s_cselect_b32 s72, 0, s72
  v_mfma_f32_16x16x32_bf16 v[40:43], v[188:191], a[184:187], v[40:43]
  v_exp_f32 v238, v238
  v_mfma_f32_16x16x32_bf16 v[44:47], v[188:191], a[188:191], v[44:47]
  v_exp_f32_e64 v239, v239
  v_mfma_f32_16x16x32_bf16 v[48:51], v[192:195], a[184:187], v[48:51]
  s_waitcnt vmcnt(21) lgkmcnt(0)
  s_barrier
  ds_read_b128 v[144:147], v208 offset:0
  v_mfma_f32_16x16x32_bf16 v[52:55], v[192:195], a[188:191], v[52:55]
  s_add_u32 m0, s84, 0
  ds_read_b128 v[148:151], v208 offset:1024
  v_add_f32 v236, 1.0, v236
  v_mfma_f32_16x16x32_bf16 v[56:59], v[196:199], a[184:187], v[56:59]
  s_add_u32 s73, s72, 0x10000
  ds_read_b128 v[152:155], v208 offset:2048
  v_add_f32_e64 v237, 1.0, v237
  v_mfma_f32_16x16x32_bf16 v[60:63], v[196:199], a[188:191], v[60:63]
  buffer_load_dwordx4 v244, s[48:51], s72 offen offset:0 lds
  ds_read_b128 v[156:159], v208 offset:3072
  v_mfma_f32_16x16x32_bf16 v[64:67], v[200:203], a[184:187], v[64:67]
  ds_read_b128 v[160:163], v208 offset:4096
  v_add_f32_e64 v238, 1.0, v238
  v_mfma_f32_16x16x32_bf16 v[68:71], v[200:203], a[188:191], v[68:71]
  ds_read_b128 v[164:167], v208 offset:5120
  v_add_f32_e64 v239, 1.0, v239
  v_mfma_f32_16x16x32_bf16 v[72:75], v[204:207], a[184:187], v[72:75]
  buffer_load_dwordx4 v245, s[48:51], s72 offen offset:1024 lds
  ds_read_b128 v[168:171], v208 offset:6144
  v_mfma_f32_16x16x32_bf16 v[76:79], v[204:207], a[188:191], v[76:79]
  s_waitcnt lgkmcnt(5)
  ds_read_b128 v[172:175], v208 offset:7168
  ds_read_b128 v[176:179], v208 offset:8192
  v_mfma_f32_16x16x32_bf16 v[16:19], v[144:147], a[192:195], v[16:19]
  ds_read_b128 v[180:183], v208 offset:9216
  v_rcp_f32 v236, v236
  v_mfma_f32_16x16x32_bf16 v[20:23], v[144:147], a[196:199], v[20:23]
  ds_read_b128 v[184:187], v208 offset:10240
  v_rcp_f32_e64 v237, v237
  v_mfma_f32_16x16x32_bf16 v[24:27], v[148:151], a[192:195], v[24:27]
  buffer_load_dwordx4 v246, s[48:51], s72 offen offset:2048 lds
  ds_read_b128 v[188:191], v208 offset:11264
  v_mfma_f32_16x16x32_bf16 v[28:31], v[148:151], a[196:199], v[28:31]
  s_waitcnt lgkmcnt(6)
  ds_read_b128 v[192:195], v208 offset:12288
  v_rcp_f32 v238, v238
  v_mfma_f32_16x16x32_bf16 v[32:35], v[152:155], a[192:195], v[32:35]
  ds_read_b128 v[196:199], v208 offset:13312
  v_rcp_f32_e64 v239, v239
  v_mfma_f32_16x16x32_bf16 v[36:39], v[152:155], a[196:199], v[36:39]
  buffer_load_dwordx4 v247, s[48:51], s72 offen offset:3072 lds
  ds_read_b128 v[200:203], v208 offset:14336
  v_mfma_f32_16x16x32_bf16 v[40:43], v[156:159], a[192:195], v[40:43]
  s_add_u32 m0, s84, 4096
  ds_read_b128 v[204:207], v208 offset:15360
  v_mul_f32 v140, v140, v236
  v_mul_f32 v141, v141, v237
  v_mfma_f32_16x16x32_bf16 v[44:47], v[156:159], a[196:199], v[44:47]
  ds_read_b128 v[144:147], v208 offset:16384
  v_mul_f32 v142, v142, v238
  v_mul_f32 v143, v143, v239
  v_mfma_f32_16x16x32_bf16 v[48:51], v[160:163], a[192:195], v[48:51]
  buffer_load_dwordx4 v244, s[48:51], s73 offen offset:0 lds
  ds_read_b128 v[148:151], v208 offset:17408
  v_mfma_f32_16x16x32_bf16 v[52:55], v[160:163], a[196:199], v[52:55]
  ds_read_b128 v[152:155], v208 offset:18432
  v_mov_b32 v236, 0
  v_mov_b32 v237, 0
  v_mfma_f32_16x16x32_bf16 v[56:59], v[164:167], a[192:195], v[56:59]
  ds_read_b128 v[156:159], v208 offset:19456
  v_mov_b32_e64 v238, 0
  v_mfma_f32_16x16x32_bf16 v[60:63], v[164:167], a[196:199], v[60:63]
  s_waitcnt lgkmcnt(5)
  buffer_load_dwordx4 v245, s[48:51], s73 offen offset:1024 lds
  ds_read_b128 v[160:163], v208 offset:20480
  v_mfma_f32_16x16x32_bf16 v[64:67], v[168:171], a[192:195], v[64:67]
  ds_read_b128 v[164:167], v208 offset:21504
  v_mov_b32 v239, 0
  v_mfma_f32_16x16x32_bf16 v[68:71], v[168:171], a[196:199], v[68:71]
  v_mfma_f32_16x16x32_bf16 v[72:75], v[172:175], a[192:195], v[72:75]
  ds_read_b128 v[168:171], v208 offset:22528
  v_mfma_f32_16x16x32_bf16 v[76:79], v[172:175], a[196:199], v[76:79]
  buffer_load_dwordx4 v246, s[48:51], s73 offen offset:2048 lds
  v_mfma_f32_16x16x32_bf16 v[16:19], v[176:179], a[200:203], v[16:19]
  ds_read_b128 v[172:175], v208 offset:23552
  v_mfma_f32_16x16x32_bf16 v[20:23], v[176:179], a[204:207], v[20:23]
  v_mfma_f32_16x16x32_bf16 v[24:27], v[180:183], a[200:203], v[24:27]
  ds_read_b128 v[176:179], v208 offset:24576
  v_mfma_f32_16x16x32_bf16 v[28:31], v[180:183], a[204:207], v[28:31]
  buffer_load_dwordx4 v247, s[48:51], s73 offen offset:3072 lds
  v_mfma_f32_16x16x32_bf16 v[32:35], v[184:187], a[200:203], v[32:35]
  s_add_u32 s72, s72, 0x40000
  s_waitcnt vmcnt(25)
  ds_read_b64_tr_b16 a[16:17], v240 offset:4096
  v_mfma_f32_16x16x32_bf16 v[36:39], v[184:187], a[204:207], v[36:39]
  s_cmp_eq_u32 s72, 0x380000
  s_cselect_b32 s72, 0, s72
  ds_read_b64_tr_b16 a[18:19], v240 offset:6144
  v_mfma_f32_16x16x32_bf16 v[40:43], v[188:191], a[200:203], v[40:43]
  ds_read_b64_tr_b16 a[20:21], v241 offset:4096
  v_mfma_f32_16x16x32_bf16 v[44:47], v[188:191], a[204:207], v[44:47]
  ds_read_b64_tr_b16 a[22:23], v241 offset:6144
  v_mfma_f32_16x16x32_bf16 v[48:51], v[192:195], a[200:203], v[48:51]
  ds_read_b64_tr_b16 a[24:25], v242 offset:4096
  v_mfma_f32_16x16x32_bf16 v[52:55], v[192:195], a[204:207], v[52:55]
  ds_read_b64_tr_b16 a[26:27], v242 offset:6144
  v_mfma_f32_16x16x32_bf16 v[56:59], v[196:199], a[200:203], v[56:59]
  ds_read_b64_tr_b16 a[28:29], v243 offset:4096
  v_mfma_f32_16x16x32_bf16 v[60:63], v[196:199], a[204:207], v[60:63]
  s_waitcnt vmcnt(12)
  v_cmp_ne_u32_e64 vcc, s64, v255
  s_cbranch_vccnz parallel_sum__ssm_conv_h3__mixer_gmlp__prompt_kernel_uf_slow
parallel_sum__ssm_conv_h3__mixer_gmlp__prompt_kernel_uf_ok:
  ds_read_b64_tr_b16 a[30:31], v243 offset:6144
  v_mfma_f32_16x16x32_bf16 v[64:67], v[200:203], a[200:203], v[64:67]
  ds_read_b128 v[180:183], v208 offset:25600
  v_mfma_f32_16x16x32_bf16 v[68:71], v[200:203], a[204:207], v[68:71]
  s_waitcnt lgkmcnt(5)
  ds_read_b128 v[184:187], v208 offset:26624
  v_mfma_f32_16x16x32_bf16 v[72:75], v[204:207], a[200:203], v[72:75]
  s_mov_b32 m0, s68
  ds_read_b128 v[188:191], v208 offset:27648
  v_mfma_f32_16x16x32_bf16 v[76:79], v[204:207], a[204:207], v[76:79]
  ds_read_b128 v[192:195], v208 offset:28672
  v_mfma_f32_16x16x32_bf16 v[16:19], v[144:147], a[208:211], v[16:19]
  ds_read_b128 v[196:199], v208 offset:29696
  v_mfma_f32_16x16x32_bf16 v[20:23], v[144:147], a[212:215], v[20:23]
  buffer_load_dwordx4 v208, s[16:19], s75 offen offset:0 sc1 nt lds
  v_mfma_f32_16x16x32_bf16 v[24:27], v[148:151], a[208:211], v[24:27]
  ds_read_b128 v[200:203], v208 offset:30720
  v_mfma_f32_16x16x32_bf16 v[28:31], v[148:151], a[212:215], v[28:31]
  ds_read_b128 v[204:207], v208 offset:31744
  v_mfma_f32_16x16x32_bf16 v[32:35], v[152:155], a[208:211], v[32:35]
  v_mfma_f32_16x16x32_bf16 v[36:39], v[152:155], a[212:215], v[36:39]
  buffer_load_dwordx4 v208, s[16:19], s75 offen offset:1024 sc1 nt lds
  v_mfma_f32_16x16x32_bf16 v[40:43], v[156:159], a[208:211], v[40:43]
  v_mfma_f32_16x16x32_bf16 v[44:47], v[156:159], a[212:215], v[44:47]
  v_mfma_f32_16x16x32_bf16 v[48:51], v[160:163], a[208:211], v[48:51]
  v_mfma_f32_16x16x32_bf16 v[52:55], v[160:163], a[212:215], v[52:55]
  ds_read_b64_tr_b16 a[32:33], v240 offset:8192
  buffer_load_dwordx4 v208, s[16:19], s75 offen offset:2048 sc1 nt lds
  v_mfma_f32_16x16x32_bf16 v[56:59], v[164:167], a[208:211], v[56:59]
  ds_read_b64_tr_b16 a[34:35], v240 offset:10240
  v_mfma_f32_16x16x32_bf16 v[60:63], v[164:167], a[212:215], v[60:63]
  ds_read_b64_tr_b16 a[36:37], v241 offset:8192
  v_mfma_f32_16x16x32_bf16 v[64:67], v[168:171], a[208:211], v[64:67]
  ds_read_b64_tr_b16 a[38:39], v241 offset:10240
  v_mfma_f32_16x16x32_bf16 v[68:71], v[168:171], a[212:215], v[68:71]
  buffer_load_dwordx4 v208, s[16:19], s75 offen offset:3072 sc1 nt lds
  v_mfma_f32_16x16x32_bf16 v[72:75], v[172:175], a[208:211], v[72:75]
  ds_read_b64_tr_b16 a[40:41], v242 offset:8192
  v_mfma_f32_16x16x32_bf16 v[76:79], v[172:175], a[212:215], v[76:79]
  ds_read_b64_tr_b16 a[42:43], v242 offset:10240
  v_mfma_f32_16x16x32_bf16 v[16:19], v[176:179], a[216:219], v[16:19]
  ds_read_b64_tr_b16 a[44:45], v243 offset:8192
  v_mfma_f32_16x16x32_bf16 v[20:23], v[176:179], a[220:223], v[20:23]
  s_waitcnt lgkmcnt(4)
  ds_read_b64_tr_b16 a[46:47], v243 offset:10240
  v_mfma_f32_16x16x32_bf16 v[24:27], v[180:183], a[216:219], v[24:27]
  v_mfma_f32_16x16x32_bf16 v[28:31], v[180:183], a[220:223], v[28:31]
  v_mfma_f32_16x16x32_bf16 v[32:35], v[184:187], a[216:219], v[32:35]
  v_mfma_f32_16x16x32_bf16 v[36:39], v[184:187], a[220:223], v[36:39]
  v_mfma_f32_16x16x32_bf16 v[40:43], v[188:191], a[216:219], v[40:43]
  v_mfma_f32_16x16x32_bf16 v[44:47], v[188:191], a[220:223], v[44:47]
  v_mfma_f32_16x16x32_bf16 v[48:51], v[192:195], a[216:219], v[48:51]
  s_barrier
  ds_read_b128 v[144:147], v208 offset:32768
  v_mfma_f32_16x16x32_bf16 v[52:55], v[192:195], a[220:223], v[52:55]
  s_add_u32 m0, s63, 0
  ds_read_b128 v[148:151], v208 offset:33792
  ds_read_b128 v[152:155], v208 offset:34816
  v_mfma_f32_16x16x32_bf16 v[56:59], v[196:199], a[216:219], v[56:59]
  s_add_u32 s73, s72, 0x10000
  ds_read_b128 v[156:159], v208 offset:35840
  ds_read_b128 v[160:163], v208 offset:36864
  v_mfma_f32_16x16x32_bf16 v[60:63], v[196:199], a[220:223], v[60:63]
  s_waitcnt vmcnt(12)
  ds_read_b64_tr_b16 a[48:49], v240 offset:12288
  buffer_load_dwordx4 v244, s[48:51], s72 offen offset:0 lds
  v_mfma_f32_16x16x32_bf16 v[64:67], v[200:203], a[216:219], v[64:67]
  ds_read_b64_tr_b16 a[50:51], v240 offset:14336
  ds_read_b64_tr_b16 a[52:53], v241 offset:12288
  v_mfma_f32_16x16x32_bf16 v[68:71], v[200:203], a[220:223], v[68:71]
  ds_read_b64_tr_b16 a[54:55], v241 offset:14336
  ds_read_b64_tr_b16 a[56:57], v242 offset:12288
  v_mfma_f32_16x16x32_bf16 v[72:75], v[204:207], a[216:219], v[72:75]
  buffer_load_dwordx4 v245, s[48:51], s72 offen offset:1024 lds
  ds_read_b64_tr_b16 a[58:59], v242 offset:14336
  v_mfma_f32_16x16x32_bf16 v[76:79], v[204:207], a[220:223], v[76:79]
  s_waitcnt lgkmcnt(8)
  ds_read_b64_tr_b16 a[60:61], v243 offset:12288
  ds_read_b128 v[164:167], v208 offset:37888
  v_mfma_f32_16x16x32_bf16 v[16:19], v[144:147], a[224:227], v[16:19]
  ds_read_b64_tr_b16 a[62:63], v243 offset:14336
  v_lshl_add_u32 v10, v0, 3, s68
  v_mfma_f32_16x16x32_bf16 v[20:23], v[144:147], a[228:231], v[20:23]
  ds_read_b128 v[168:171], v208 offset:38912
  ds_read_b128 v[172:175], v208 offset:39936
  v_mfma_f32_16x16x32_bf16 v[24:27], v[148:151], a[224:227], v[24:27]
  buffer_load_dwordx4 v246, s[48:51], s72 offen offset:2048 lds
  ds_read_b128 v[176:179], v208 offset:40960
  v_mfma_f32_16x16x32_bf16 v[28:31], v[148:151], a[228:231], v[28:31]
  ds_read_b128 v[180:183], v208 offset:41984
  ds_read_b128 v[184:187], v208 offset:43008
  v_mfma_f32_16x16x32_bf16 v[32:35], v[152:155], a[224:227], v[32:35]
  ds_read_b128 v[188:191], v208 offset:44032
  ds_read_b128 v[192:195], v208 offset:45056
  v_mfma_f32_16x16x32_bf16 v[36:39], v[152:155], a[228:231], v[36:39]
  s_waitcnt lgkmcnt(8)
  buffer_load_dwordx4 v247, s[48:51], s72 offen offset:3072 lds
  ds_read_b128 v[196:199], v208 offset:46080
  v_mfma_f32_16x16x32_bf16 v[40:43], v[156:159], a[224:227], v[40:43]
  s_add_u32 m0, s63, 16384
  ds_read_b128 v[200:203], v208 offset:47104
  ds_read_b128 v[204:207], v208 offset:48128
  v_mfma_f32_16x16x32_bf16 v[44:47], v[156:159], a[228:231], v[44:47]
  ds_read_b128 v[144:147], v208 offset:49152
  ds_read_b128 v[148:151], v208 offset:50176
  v_mfma_f32_16x16x32_bf16 v[48:51], v[160:163], a[224:227], v[48:51]
  buffer_load_dwordx4 v244, s[48:51], s73 offen offset:0 lds
  ds_read_b128 v[152:155], v208 offset:51200
  v_mfma_f32_16x16x32_bf16 v[52:55], v[160:163], a[228:231], v[52:55]
  ds_read_b128 v[156:159], v208 offset:52224
  v_mfma_f32_16x16x32_bf16 v[56:59], v[164:167], a[224:227], v[56:59]
  ds_read_b128 v[160:163], v208 offset:53248
  v_mfma_f32_16x16x32_bf16 v[60:63], v[164:167], a[228:231], v[60:63]
  s_waitcnt lgkmcnt(7)
  v_mfma_f32_16x16x32_bf16 v[64:67], v[168:171], a[224:227], v[64:67]
  buffer_load_dwordx4 v245, s[48:51], s73 offen offset:1024 lds
  ds_read_b128 v[164:167], v208 offset:54272
  v_mfma_f32_16x16x32_bf16 v[68:71], v[168:171], a[228:231], v[68:71]
  v_mfma_f32_16x16x32_bf16 v[72:75], v[172:175], a[224:227], v[72:75]
  ds_read_b128 v[168:171], v208 offset:55296
  v_mfma_f32_16x16x32_bf16 v[76:79], v[172:175], a[228:231], v[76:79]
  v_mfma_f32_16x16x32_bf16 v[16:19], v[176:179], a[232:235], v[16:19]
  buffer_load_dwordx4 v246, s[48:51], s73 offen offset:2048 lds
  ds_read_b128 v[172:175], v208 offset:56320
  v_mfma_f32_16x16x32_bf16 v[20:23], v[176:179], a[236:239], v[20:23]
  v_mfma_f32_16x16x32_bf16 v[24:27], v[180:183], a[232:235], v[24:27]
  ds_read_b128 v[176:179], v208 offset:57344
  v_mfma_f32_16x16x32_bf16 v[28:31], v[180:183], a[236:239], v[28:31]
  buffer_load_dwordx4 v247, s[48:51], s73 offen offset:3072 lds
  v_mfma_f32_16x16x32_bf16 v[32:35], v[184:187], a[232:235], v[32:35]
  s_add_u32 s72, s72, 0x40000
  ds_read_b128 v[180:183], v208 offset:58368
  v_mfma_f32_16x16x32_bf16 v[36:39], v[184:187], a[236:239], v[36:39]
  s_cmp_eq_u32 s72, 0x380000
  s_cselect_b32 s72, 0, s72
  v_mfma_f32_16x16x32_bf16 v[40:43], v[188:191], a[232:235], v[40:43]
  s_add_u32 m0, s85, 480
  ds_read_b128 v[184:187], v208 offset:59392
  v_mfma_f32_16x16x32_bf16 v[44:47], v[188:191], a[236:239], v[44:47]
  buffer_load_dwordx4 v208, s[32:35], s71 offen offset:0 nt lds
  v_mfma_f32_16x16x32_bf16 v[48:51], v[192:195], a[232:235], v[48:51]
  s_branch parallel_sum__ssm_conv_h3__mixer_gmlp__prompt_kernel_ps11
parallel_sum__ssm_conv_h3__mixer_gmlp__prompt_kernel_pg11:
  s_branch parallel_sum__ssm_conv_h3__mixer_gmlp__prompt_kernel_pg15
parallel_sum__ssm_conv_h3__mixer_gmlp__prompt_kernel_ps11:
  ds_read_b128 v[188:191], v208 offset:60416
  v_mfma_f32_16x16x32_bf16 v[52:55], v[192:195], a[236:239], v[52:55]
  v_mfma_f32_16x16x32_bf16 v[56:59], v[196:199], a[232:235], v[56:59]
  ds_read_b128 v[192:195], v208 offset:61440
  v_mfma_f32_16x16x32_bf16 v[60:63], v[196:199], a[236:239], v[60:63]
  s_waitcnt lgkmcnt(3)
  buffer_load_dwordx4 v208, s[32:35], s71 offen offset:1024 nt lds
  v_mfma_f32_16x16x32_bf16 v[64:67], v[200:203], a[232:235], v[64:67]
  ds_read_b128 v[196:199], v208 offset:62464
  v_mfma_f32_16x16x32_bf16 v[68:71], v[200:203], a[236:239], v[68:71]
  v_mfma_f32_16x16x32_bf16 v[72:75], v[204:207], a[232:235], v[72:75]
  ds_read_b128 v[200:203], v208 offset:63488
  v_mfma_f32_16x16x32_bf16 v[76:79], v[204:207], a[236:239], v[76:79]
  buffer_load_dwordx4 v208, s[32:35], s71 offen offset:2048 nt lds
  v_mfma_f32_16x16x32_bf16 v[16:19], v[144:147], a[240:243], v[16:19]
  ds_read_b128 v[204:207], v208 offset:64512
  v_mfma_f32_16x16x32_bf16 v[20:23], v[144:147], a[244:247], v[20:23]
  v_mfma_f32_16x16x32_bf16 v[24:27], v[148:151], a[240:243], v[24:27]
  v_mfma_f32_16x16x32_bf16 v[28:31], v[148:151], a[244:247], v[28:31]
  buffer_load_dwordx4 v208, s[32:35], s71 offen offset:3072 nt lds
  v_mfma_f32_16x16x32_bf16 v[32:35], v[152:155], a[240:243], v[32:35]
  v_mfma_f32_16x16x32_bf16 v[36:39], v[152:155], a[244:247], v[36:39]
  v_mfma_f32_16x16x32_bf16 v[40:43], v[156:159], a[240:243], v[40:43]
  v_mfma_f32_16x16x32_bf16 v[44:47], v[156:159], a[244:247], v[44:47]
  v_mfma_f32_16x16x32_bf16 v[48:51], v[160:163], a[240:243], v[48:51]
  v_mfma_f32_16x16x32_bf16 v[52:55], v[160:163], a[244:247], v[52:55]
  s_lshr_b32 s7, s71, 11
  buffer_load_ushort v9, v9, s[36:39], s7 offen
  v_mfma_f32_16x16x32_bf16 v[56:59], v[164:167], a[240:243], v[56:59]
  v_mfma_f32_16x16x32_bf16 v[60:63], v[164:167], a[244:247], v[60:63]
  v_mfma_f32_16x16x32_bf16 v[64:67], v[168:171], a[240:243], v[64:67]
  v_mfma_f32_16x16x32_bf16 v[68:71], v[168:171], a[244:247], v[68:71]
  v_mfma_f32_16x16x32_bf16 v[72:75], v[172:175], a[240:243], v[72:75]
  v_mfma_f32_16x16x32_bf16 v[76:79], v[172:175], a[244:247], v[76:79]
  v_mfma_f32_16x16x32_bf16 v[16:19], v[176:179], a[248:251], v[16:19]
  ds_write_b64 v10, v[236:237] offset:4096
  v_mfma_f32_16x16x32_bf16 v[20:23], v[176:179], a[252:255], v[20:23]
  ds_write_b64 v10, v[236:237] offset:8256
  v_mfma_f32_16x16x32_bf16 v[24:27], v[180:183], a[248:251], v[24:27]
  ds_write_b64 v10, v[236:237] offset:11776
  v_mfma_f32_16x16x32_bf16 v[28:31], v[180:183], a[252:255], v[28:31]
  s_waitcnt lgkmcnt(3)
  v_mfma_f32_16x16x32_bf16 v[32:35], v[184:187], a[248:251], v[32:35]
  v_mfma_f32_16x16x32_bf16 v[36:39], v[184:187], a[252:255], v[36:39]
  v_mfma_f32_16x16x32_bf16 v[40:43], v[188:191], a[248:251], v[40:43]
  v_mfma_f32_16x16x32_bf16 v[44:47], v[188:191], a[252:255], v[44:47]
  v_mfma_f32_16x16x32_bf16 v[48:51], v[192:195], a[248:251], v[48:51]
  s_barrier
  v_mfma_f32_16x16x32_bf16 v[52:55], v[192:195], a[252:255], v[52:55]
  v_mfma_f32_16x16x32_bf16 v[56:59], v[196:199], a[248:251], v[56:59]
  v_mfma_f32_16x16x32_bf16 v[60:63], v[196:199], a[252:255], v[60:63]
  v_mfma_f32_16x16x32_bf16 v[64:67], v[200:203], a[248:251], v[64:67]
  v_mfma_f32_16x16x32_bf16 v[68:71], v[200:203], a[252:255], v[68:71]
  v_mfma_f32_16x16x32_bf16 v[72:75], v[204:207], a[248:251], v[72:75]
  v_mfma_f32_16x16x32_bf16 v[76:79], v[204:207], a[252:255], v[76:79]
  v_pk_fma_f32 v[16:17], v[16:17], v[214:215], v[212:213] op_sel:[0,0,0] op_sel_hi:[1,0,0]
  v_pk_fma_f32 v[18:19], v[18:19], v[214:215], v[212:213] op_sel:[0,0,0] op_sel_hi:[1,0,0]
  v_pk_fma_f32 v[20:21], v[20:21], v[214:215], v[212:213] op_sel:[0,1,1] op_sel_hi:[1,1,1]
  v_pk_fma_f32 v[22:23], v[22:23], v[214:215], v[212:213] op_sel:[0,1,1] op_sel_hi:[1,1,1]
  v_pk_mul_f32 v[16:17], v[16:17], v[80:81]
  v_pk_mul_f32 v[18:19], v[18:19], v[82:83]
  v_pk_mul_f32 v[20:21], v[20:21], v[84:85]
  v_pk_mul_f32 v[22:23], v[22:23], v[86:87]
  v_cvt_pk_bf16_f32 v80, v16, v17
  v_cvt_pk_bf16_f32 v81, v18, v19
  v_cvt_pk_bf16_f32 v84, v20, v21
  v_cvt_pk_bf16_f32 v85, v22, v23
  v_pk_fma_f32 v[24:25], v[24:25], v[214:215], v[212:213] op_sel:[0,0,0] op_sel_hi:[1,0,0]
  v_pk_fma_f32 v[26:27], v[26:27], v[214:215], v[212:213] op_sel:[0,0,0] op_sel_hi:[1,0,0]
  v_pk_fma_f32 v[28:29], v[28:29], v[214:215], v[212:213] op_sel:[0,1,1] op_sel_hi:[1,1,1]
  v_pk_fma_f32 v[30:31], v[30:31], v[214:215], v[212:213] op_sel:[0,1,1] op_sel_hi:[1,1,1]
  v_pk_mul_f32 v[24:25], v[24:25], v[88:89]
  v_pk_mul_f32 v[26:27], v[26:27], v[90:91]
  v_pk_mul_f32 v[28:29], v[28:29], v[92:93]
  v_pk_mul_f32 v[30:31], v[30:31], v[94:95]
  v_cvt_pk_bf16_f32 v82, v24, v25
  v_cvt_pk_bf16_f32 v83, v26, v27
  v_cvt_pk_bf16_f32 v86, v28, v29
  v_cvt_pk_bf16_f32 v87, v30, v31
  buffer_store_dwordx4 v[80:83], v208, s[16:19], s82 offen offset:0 sc1
  buffer_store_dwordx4 v[84:87], v208, s[16:19], s82 offen offset:1024 sc1
  s_add_u32 s82, s82, 4096
  v_pk_fma_f32 v[32:33], v[32:33], v[214:215], v[212:213] op_sel:[0,0,0] op_sel_hi:[1,0,0]
  s_waitcnt vmcnt(15)
  ds_read_b128 v[144:147], v251 offset:0
  v_pk_fma_f32 v[34:35], v[34:35], v[214:215], v[212:213] op_sel:[0,0,0] op_sel_hi:[1,0,0]
  ds_read_b32 v148, v251 offset:16
  v_pk_fma_f32 v[36:37], v[36:37], v[214:215], v[212:213] op_sel:[0,1,1] op_sel_hi:[1,1,1]
  ds_read_b128 v[152:155], v251 offset:1024
  v_pk_fma_f32 v[38:39], v[38:39], v[214:215], v[212:213] op_sel:[0,1,1] op_sel_hi:[1,1,1]
  ds_read_b32 v156, v251 offset:1040
  v_pk_mul_f32 v[32:33], v[32:33], v[96:97]
  ds_read_b128 v[160:163], v251 offset:2048
  v_pk_mul_f32 v[34:35], v[34:35], v[98:99]
  ds_read_b32 v164, v251 offset:2064
  v_pk_mul_f32 v[36:37], v[36:37], v[100:101]
  ds_read_b128 v[168:171], v251 offset:3072
  v_pk_mul_f32 v[38:39], v[38:39], v[102:103]
  ds_read_b32 v172, v251 offset:3088
  v_cvt_pk_bf16_f32 v96, v32, v33
  v_cvt_pk_bf16_f32 v97, v34, v35
  v_cvt_pk_bf16_f32 v100, v36, v37
  v_cvt_pk_bf16_f32 v101, v38, v39
  v_pk_fma_f32 v[40:41], v[40:41], v[214:215], v[212:213] op_sel:[0,0,0] op_sel_hi:[1,0,0]
  v_pk_fma_f32 v[42:43], v[42:43], v[214:215], v[212:213] op_sel:[0,0,0] op_sel_hi:[1,0,0]
  s_waitcnt lgkmcnt(7)
  v_alignbit_b32 v144, v145, v144, 16
  v_pk_fma_f32 v[44:45], v[44:45], v[214:215], v[212:213] op_sel:[0,1,1] op_sel_hi:[1,1,1]
  v_alignbit_b32 v145, v146, v145, 16
  v_pk_fma_f32 v[46:47], v[46:47], v[214:215], v[212:213] op_sel:[0,1,1] op_sel_hi:[1,1,1]
  v_alignbit_b32 v146, v147, v146, 16
  v_pk_mul_f32 v[40:41], v[40:41], v[104:105]
  s_waitcnt lgkmcnt(6)
  v_alignbit_b32 v147, v148, v147, 16
  v_pk_mul_f32 v[42:43], v[42:43], v[106:107]
  ds_write_b128 v251, v[144:147] offset:4160
  v_pk_mul_f32 v[44:45], v[44:45], v[108:109]
  s_waitcnt lgkmcnt(6)
  v_alignbit_b32 v152, v153, v152, 16
  v_pk_mul_f32 v[46:47], v[46:47], v[110:111]
  v_alignbit_b32 v153, v154, v153, 16
  v_cvt_pk_bf16_f32 v98, v40, v41
  v_alignbit_b32 v154, v155, v154, 16
  v_cvt_pk_bf16_f32 v99, v42, v43
  s_waitcnt lgkmcnt(5)
  v_alignbit_b32 v155, v156, v155, 16
  v_cvt_pk_bf16_f32 v102, v44, v45
  ds_write_b128 v251, v[152:155] offset:5184
  v_cvt_pk_bf16_f32 v103, v46, v47
  s_waitcnt lgkmcnt(5)
  v_alignbit_b32 v160, v161, v160, 16
  buffer_store_dwordx4 v[96:99], v208, s[16:19], s82 offen offset:0 sc1
  buffer_store_dwordx4 v[100:103], v208, s[16:19], s82 offen offset:1024 sc1
  s_add_u32 s82, s82, 4096
  v_pk_fma_f32 v[48:49], v[48:49], v[214:215], v[212:213] op_sel:[0,0,0] op_sel_hi:[1,0,0]
  v_alignbit_b32 v161, v162, v161, 16
  v_pk_fma_f32 v[50:51], v[50:51], v[214:215], v[212:213] op_sel:[0,0,0] op_sel_hi:[1,0,0]
  v_alignbit_b32 v162, v163, v162, 16
  v_pk_fma_f32 v[52:53], v[52:53], v[214:215], v[212:213] op_sel:[0,1,1] op_sel_hi:[1,1,1]
  s_waitcnt lgkmcnt(4)
  v_alignbit_b32 v163, v164, v163, 16
  v_pk_fma_f32 v[54:55], v[54:55], v[214:215], v[212:213] op_sel:[0,1,1] op_sel_hi:[1,1,1]
  ds_write_b128 v251, v[160:163] offset:6208
  v_pk_mul_f32 v[48:49], v[48:49], v[112:113]
  s_waitcnt lgkmcnt(4)
  v_alignbit_b32 v168, v169, v168, 16
  v_pk_mul_f32 v[50:51], v[50:51], v[114:115]
  v_alignbit_b32 v169, v170, v169, 16
  v_pk_mul_f32 v[52:53], v[52:53], v[116:117]
  v_alignbit_b32 v170, v171, v170, 16
  v_pk_mul_f32 v[54:55], v[54:55], v[118:119]
  s_waitcnt lgkmcnt(3)
  v_alignbit_b32 v171, v172, v171, 16
  v_cvt_pk_bf16_f32 v112, v48, v49
  ds_write_b128 v251, v[168:171] offset:7232
  v_cvt_pk_bf16_f32 v113, v50, v51
  s_add_u32 m0, s63, 32768
  v_cvt_pk_bf16_f32 v116, v52, v53
  s_add_u32 s73, s72, 0x10000
  v_cvt_pk_bf16_f32 v117, v54, v55
  buffer_load_dwordx4 v244, s[48:51], s72 offen offset:0 lds
  v_pk_fma_f32 v[56:57], v[56:57], v[214:215], v[212:213] op_sel:[0,0,0] op_sel_hi:[1,0,0]
  ds_read2_b32 v[176:177], v4 offset0:128 offset1:129
  v_pk_fma_f32 v[58:59], v[58:59], v[214:215], v[212:213] op_sel:[0,0,0] op_sel_hi:[1,0,0]
  ds_read2_b32 v[178:179], v4 offset0:130 offset1:131
  v_pk_fma_f32 v[60:61], v[60:61], v[214:215], v[212:213] op_sel:[0,1,1] op_sel_hi:[1,1,1]
  buffer_load_dwordx4 v245, s[48:51], s72 offen offset:1024 lds
  v_pk_fma_f32 v[62:63], v[62:63], v[214:215], v[212:213] op_sel:[0,1,1] op_sel_hi:[1,1,1]
  ds_read2_b32 v[180:181], v4 offset0:0 offset1:1
  v_pk_mul_f32 v[56:57], v[56:57], v[120:121]
  ds_read2_b32 v[182:183], v4 offset0:2 offset1:3
  v_pk_mul_f32 v[58:59], v[58:59], v[122:123]
  buffer_load_dwordx4 v246, s[48:51], s72 offen offset:2048 lds
  v_pk_mul_f32 v[60:61], v[60:61], v[124:125]
  ds_read2_b32 v[184:185], v5 offset0:128 offset1:129
  v_pk_mul_f32 v[62:63], v[62:63], v[126:127]
  ds_read2_b32 v[186:187], v5 offset0:130 offset1:131
  v_cvt_pk_bf16_f32 v114, v56, v57
  ds_read2_b32 v[188:189], v5 offset0:0 offset1:1
  v_cvt_pk_bf16_f32 v115, v58, v59
  buffer_load_dwordx4 v247, s[48:51], s72 offen offset:3072 lds
  v_cvt_pk_bf16_f32 v118, v60, v61
  s_add_u32 m0, s63, 49152
  v_cvt_pk_bf16_f32 v119, v62, v63
  ds_read2_b32 v[190:191], v5 offset0:2 offset1:3
  buffer_store_dwordx4 v[112:115], v208, s[16:19], s82 offen offset:0 sc1
  buffer_store_dwordx4 v[116:119], v208, s[16:19], s82 offen offset:1024 sc1
  s_add_u32 s82, s82, 4096
  v_pk_fma_f32 v[64:65], v[64:65], v[214:215], v[212:213] op_sel:[0,0,0] op_sel_hi:[1,0,0]
  ds_read2_b32 v[192:193], v6 offset0:128 offset1:129
  v_pk_fma_f32 v[66:67], v[66:67], v[214:215], v[212:213] op_sel:[0,0,0] op_sel_hi:[1,0,0]
  ds_read2_b32 v[194:195], v6 offset0:130 offset1:131
  v_pk_fma_f32 v[68:69], v[68:69], v[214:215], v[212:213] op_sel:[0,1,1] op_sel_hi:[1,1,1]
  ds_read2_b32 v[196:197], v6 offset0:0 offset1:1
  v_pk_fma_f32 v[70:71], v[70:71], v[214:215], v[212:213] op_sel:[0,1,1] op_sel_hi:[1,1,1]
  ds_read2_b32 v[198:199], v6 offset0:2 offset1:3
  v_pk_mul_f32 v[64:65], v[64:65], v[128:129]
  ds_read2_b32 v[200:201], v7 offset0:128 offset1:129
  v_pk_mul_f32 v[66:67], v[66:67], v[130:131]
  buffer_load_dwordx4 v244, s[48:51], s73 offen offset:0 lds
  v_pk_mul_f32 v[68:69], v[68:69], v[132:133]
  ds_read2_b32 v[202:203], v7 offset0:130 offset1:131
  v_pk_mul_f32 v[70:71], v[70:71], v[134:135]
  ds_read2_b32 v[204:205], v7 offset0:0 offset1:1
  v_cvt_pk_bf16_f32 v128, v64, v65
  buffer_load_dwordx4 v245, s[48:51], s73 offen offset:1024 lds
  v_cvt_pk_bf16_f32 v129, v66, v67
  ds_read2_b32 v[206:207], v7 offset0:2 offset1:3
  v_cvt_pk_bf16_f32 v132, v68, v69
  s_waitcnt vmcnt(13)
  ds_read_b128 v[144:147], v8 offset:0
  v_cvt_pk_bf16_f32 v133, v70, v71
  buffer_load_dwordx4 v246, s[48:51], s73 offen offset:2048 lds
  v_pk_fma_f32 v[72:73], v[72:73], v[214:215], v[212:213] op_sel:[0,0,0] op_sel_hi:[1,0,0]
  ds_read_b128 v[148:151], v8 offset:512
  v_pk_fma_f32 v[74:75], v[74:75], v[214:215], v[212:213] op_sel:[0,0,0] op_sel_hi:[1,0,0]
  ds_read_b128 v[152:155], v8 offset:1024
  v_pk_fma_f32 v[76:77], v[76:77], v[214:215], v[212:213] op_sel:[0,1,1] op_sel_hi:[1,1,1]
  ds_read_b128 v[156:159], v8 offset:1536
  v_pk_fma_f32 v[78:79], v[78:79], v[214:215], v[212:213] op_sel:[0,1,1] op_sel_hi:[1,1,1]
  buffer_load_dwordx4 v247, s[48:51], s73 offen offset:3072 lds
  v_pk_mul_f32 v[72:73], v[72:73], v[136:137]
  s_add_u32 s72, s72, 0x40000
  v_pk_mul_f32 v[74:75], v[74:75], v[138:139]
  s_cmp_eq_u32 s72, 0x380000
  s_cselect_b32 s72, 0, s72
  v_pk_mul_f32 v[76:77], v[76:77], v[140:141]
  ds_read_b128 v[160:163], v8 offset:2048
  v_pk_mul_f32 v[78:79], v[78:79], v[142:143]
  ds_read_b128 v[164:167], v8 offset:2560
  v_cvt_pk_bf16_f32 v130, v72, v73
  ds_read_b128 v[168:171], v8 offset:3072
  v_cvt_pk_bf16_f32 v131, v74, v75
  ds_read_b128 v[172:175], v8 offset:3584
  v_cvt_pk_bf16_f32 v134, v76, v77
  v_cvt_pk_bf16_f32 v135, v78, v79
  buffer_store_dwordx4 v[128:131], v208, s[16:19], s82 offen offset:0 sc1
  buffer_store_dwordx4 v[132:135], v208, s[16:19], s82 offen offset:1024 sc1
parallel_sum__ssm_conv_h3__mixer_gmlp__prompt_kernel_join:
  s_waitcnt lgkmcnt(7)
  v_mfma_f32_16x16x32_bf16 v[16:19], v[176:179], v[144:147], 0
  ds_read_b128 v[112:115], v8 offset:64
  v_mfma_f32_16x16x32_bf16 v[20:23], v[180:183], v[144:147], 0
  s_waitcnt lgkmcnt(7)
  ds_read2_b32 v[48:49], v4 offset0:144 offset1:145
  v_mfma_f32_16x16x32_bf16 v[20:23], v[176:179], v[148:151], v[20:23]
  ds_read2_b32 v[50:51], v4 offset0:146 offset1:147
  v_mfma_f32_16x16x32_bf16 v[24:27], v[180:183], v[148:151], 0
  ds_read_b128 v[116:119], v8 offset:576
  v_mfma_f32_16x16x32_bf16 v[24:27], v[184:187], v[144:147], v[24:27]
  ds_read2_b32 v[52:53], v4 offset0:16 offset1:17
  v_mfma_f32_16x16x32_bf16 v[28:31], v[184:187], v[148:151], 0
  s_waitcnt lgkmcnt(5)
  ds_read2_b32 v[54:55], v4 offset0:18 offset1:19
  v_mfma_f32_16x16x32_bf16 v[24:27], v[176:179], v[152:155], v[24:27]
  ds_read_b128 v[120:123], v8 offset:1088
  v_mfma_f32_16x16x32_bf16 v[28:31], v[180:183], v[152:155], v[28:31]
  ds_read2_b32 v[56:57], v5 offset0:144 offset1:145
  v_mfma_f32_16x16x32_bf16 v[32:35], v[184:187], v[152:155], 0
  ds_read2_b32 v[58:59], v5 offset0:146 offset1:147
  v_mfma_f32_16x16x32_bf16 v[28:31], v[188:191], v[144:147], v[28:31]
  ds_read_b128 v[124:127], v8 offset:1600
  v_mfma_f32_16x16x32_bf16 v[32:35], v[188:191], v[148:151], v[32:35]
  ds_read_b64_tr_b16 a[64:65], v228 offset:0
  v_mfma_f32_16x16x32_bf16 v[36:39], v[188:191], v[152:155], 0
  ds_read_b64_tr_b16 a[66:67], v228 offset:2048
  v_mfma_f32_16x16x32_bf16 v[28:31], v[176:179], v[156:159], v[28:31]
  ds_read_b64_tr_b16 a[68:69], v229 offset:0
  v_mfma_f32_16x16x32_bf16 v[32:35], v[180:183], v[156:159], v[32:35]
  ds_read_b64_tr_b16 a[70:71], v229 offset:2048
  v_mfma_f32_16x16x32_bf16 v[36:39], v[184:187], v[156:159], v[36:39]
  ds_read_b64_tr_b16 a[72:73], v230 offset:0
  v_mfma_f32_16x16x32_bf16 v[40:43], v[188:191], v[156:159], 0
  ds_read_b64_tr_b16 a[74:75], v230 offset:2048
  v_mfma_f32_16x16x32_bf16 v[32:35], v[192:195], v[144:147], v[32:35]
  ds_read_b64_tr_b16 a[76:77], v231 offset:0
  v_mfma_f32_16x16x32_bf16 v[36:39], v[192:195], v[148:151], v[36:39]
  ds_read_b64_tr_b16 a[78:79], v231 offset:2048
  v_mfma_f32_16x16x32_bf16 v[40:43], v[192:195], v[152:155], v[40:43]
  ds_read2_b32 v[60:61], v5 offset0:16 offset1:17
  v_mfma_f32_16x16x32_bf16 v[44:47], v[192:195], v[156:159], 0
  ds_read2_b32 v[62:63], v5 offset0:18 offset1:19
  v_mfma_f32_16x16x32_bf16 v[32:35], v[176:179], v[160:163], v[32:35]
  ds_read_b64_tr_b16 a[80:81], v228 offset:4096
  ds_read_b64_tr_b16 a[82:83], v228 offset:6144
  v_mfma_f32_16x16x32_bf16 v[36:39], v[180:183], v[160:163], v[36:39]
  ds_read_b64_tr_b16 a[84:85], v229 offset:4096
  ds_read_b64_tr_b16 a[86:87], v229 offset:6144
  v_mfma_f32_16x16x32_bf16 v[40:43], v[184:187], v[160:163], v[40:43]
  ds_read_b64_tr_b16 a[88:89], v230 offset:4096
  ds_read_b64_tr_b16 a[90:91], v230 offset:6144
  v_mfma_f32_16x16x32_bf16 v[44:47], v[188:191], v[160:163], v[44:47]
  ds_read_b64_tr_b16 a[92:93], v231 offset:4096
  ds_read_b64_tr_b16 a[94:95], v231 offset:6144
  v_mfma_f32_16x16x32_bf16 v[36:39], v[196:199], v[144:147], v[36:39]
  ds_read_b128 v[128:131], v8 offset:2112
  ds_read2_b32 v[64:65], v6 offset0:144 offset1:145
  v_mfma_f32_16x16x32_bf16 v[40:43], v[196:199], v[148:151], v[40:43]
  ds_read2_b32 v[66:67], v6 offset0:146 offset1:147
  ds_read_b128 v[132:135], v8 offset:2624
  v_mfma_f32_16x16x32_bf16 v[44:47], v[196:199], v[152:155], v[44:47]
  s_waitcnt lgkmcnt(10)
  s_add_u32 m0, s84, 0
  ds_read2_b32 v[68:69], v6 offset0:16 offset1:17
  v_mfma_f32_16x16x32_bf16 v[36:39], v[176:179], v[164:167], v[36:39]
  s_add_u32 s73, s72, 0x10000
  ds_read2_b32 v[70:71], v6 offset0:18 offset1:19
  ds_read_b128 v[136:139], v8 offset:3136
  v_mfma_f32_16x16x32_bf16 v[40:43], v[180:183], v[164:167], v[40:43]
  buffer_load_dwordx4 v244, s[48:51], s72 offen offset:0 lds
  ds_read2_b32 v[72:73], v7 offset0:144 offset1:145
  v_mfma_f32_16x16x32_bf16 v[44:47], v[184:187], v[164:167], v[44:47]
  ds_read2_b32 v[74:75], v7 offset0:146 offset1:147
  ds_read_b128 v[140:143], v8 offset:3648
  v_mfma_f32_16x16x32_bf16 v[40:43], v[200:203], v[144:147], v[40:43]
  ds_read2_b32 v[76:77], v7 offset0:16 offset1:17
  ds_read2_b32 v[78:79], v7 offset0:18 offset1:19
  v_mfma_f32_16x16x32_bf16 v[44:47], v[200:203], v[148:151], v[44:47]
  buffer_load_dwordx4 v245, s[48:51], s72 offen offset:1024 lds
  v_mfma_f32_16x16x32_bf16 v[40:43], v[176:179], v[168:171], v[40:43]
  v_mfma_f32_16x16x32_bf16 v[44:47], v[180:183], v[168:171], v[44:47]
  v_mfma_f32_16x16x32_bf16 v[44:47], v[204:207], v[144:147], v[44:47]
  v_mfma_f32_16x16x32_bf16 v[44:47], v[176:179], v[172:175], v[44:47]
  buffer_load_dwordx4 v246, s[48:51], s72 offen offset:2048 lds
  ds_read_b128 v[144:147], v8 offset:128
  v_mfma_f32_16x16x32_bf16 v[16:19], v[48:51], v[112:115], v[16:19]
  ds_read2_b32 v[176:177], v4 offset0:160 offset1:161
  ds_read2_b32 v[178:179], v4 offset0:162 offset1:163
  v_mfma_f32_16x16x32_bf16 v[20:23], v[52:55], v[112:115], v[20:23]
  ds_read_b128 v[148:151], v8 offset:640
  ds_read2_b32 v[180:181], v4 offset0:32 offset1:33
  v_mfma_f32_16x16x32_bf16 v[20:23], v[48:51], v[116:119], v[20:23]
  buffer_load_dwordx4 v247, s[48:51], s72 offen offset:3072 lds
  ds_read2_b32 v[182:183], v4 offset0:34 offset1:35
  v_mfma_f32_16x16x32_bf16 v[24:27], v[52:55], v[116:119], v[24:27]
  s_waitcnt lgkmcnt(6)
  s_add_u32 m0, s84, 4096
  ds_read_b128 v[152:155], v8 offset:1152
  v_mfma_f32_16x16x32_bf16 v[24:27], v[56:59], v[112:115], v[24:27]
  ds_read2_b32 v[184:185], v5 offset0:160 offset1:161
  ds_read2_b32 v[186:187], v5 offset0:162 offset1:163
  v_mfma_f32_16x16x32_bf16 v[28:31], v[56:59], v[116:119], v[28:31]
  ds_read_b128 v[156:159], v8 offset:1664
  ds_read2_b32 v[188:189], v5 offset0:32 offset1:33
  v_mfma_f32_16x16x32_bf16 v[24:27], v[48:51], v[120:123], v[24:27]
  buffer_load_dwordx4 v244, s[48:51], s73 offen offset:0 lds
  ds_read_b64_tr_b16 a[96:97], v232 offset:0
  v_mfma_f32_16x16x32_bf16 v[28:31], v[52:55], v[120:123], v[28:31]
  ds_read_b64_tr_b16 a[98:99], v232 offset:2048
  ds_read_b64_tr_b16 a[100:101], v233 offset:0
  v_mfma_f32_16x16x32_bf16 v[32:35], v[56:59], v[120:123], v[32:35]
  ds_read_b64_tr_b16 a[102:103], v233 offset:2048
  ds_read_b64_tr_b16 a[104:105], v234 offset:0
  v_mfma_f32_16x16x32_bf16 v[28:31], v[60:63], v[112:115], v[28:31]
  buffer_load_dwordx4 v245, s[48:51], s73 offen offset:1024 lds
  ds_read_b64_tr_b16 a[106:107], v234 offset:2048
  v_mfma_f32_16x16x32_bf16 v[32:35], v[60:63], v[116:119], v[32:35]
  ds_read_b64_tr_b16 a[108:109], v235 offset:0
  ds_read_b64_tr_b16 a[110:111], v235 offset:2048
  v_mfma_f32_16x16x32_bf16 v[36:39], v[60:63], v[120:123], v[36:39]
  ds_read2_b32 v[190:191], v5 offset0:34 offset1:35
  ds_read_b128 v[160:163], v8 offset:2176
  v_mfma_f32_16x16x32_bf16 v[28:31], v[48:51], v[124:127], v[28:31]
  buffer_load_dwordx4 v246, s[48:51], s73 offen offset:2048 lds
  ds_read2_b32 v[192:193], v6 offset0:160 offset1:161
  v_mfma_f32_16x16x32_bf16 v[32:35], v[52:55], v[124:127], v[32:35]
  ds_read2_b32 v[194:195], v6 offset0:162 offset1:163
  ds_read_b128 v[164:167], v8 offset:2688
  v_mfma_f32_16x16x32_bf16 v[36:39], v[56:59], v[124:127], v[36:39]
  ds_read2_b32 v[196:197], v6 offset0:32 offset1:33
  ds_read2_b32 v[198:199], v6 offset0:34 offset1:35
  v_mfma_f32_16x16x32_bf16 v[40:43], v[60:63], v[124:127], v[40:43]
  buffer_load_dwordx4 v247, s[48:51], s73 offen offset:3072 lds
  v_mfma_f32_16x16x32_bf16 v[32:35], v[64:67], v[112:115], v[32:35]
  s_add_u32 s72, s72, 0x40000
  ds_read_b64_tr_b16 a[112:113], v232 offset:16384
  v_mfma_f32_16x16x32_bf16 v[36:39], v[64:67], v[116:119], v[36:39]
  s_cmp_eq_u32 s72, 0x380000
  s_cselect_b32 s72, 0, s72
  ds_read_b64_tr_b16 a[114:115], v232 offset:18432
  v_mfma_f32_16x16x32_bf16 v[40:43], v[64:67], v[120:123], v[40:43]
  ds_read_b64_tr_b16 a[116:117], v233 offset:16384
  v_mfma_f32_16x16x32_bf16 v[44:47], v[64:67], v[124:127], v[44:47]
  s_waitcnt vmcnt(8)
  buffer_store_dword v13, v14, s[16:19], s88 offen sc1
  v_mfma_f32_16x16x32_bf16 v[32:35], v[48:51], v[128:131], v[32:35]
  ds_read_b64_tr_b16 a[118:119], v233 offset:18432
  v_mfma_f32_16x16x32_bf16 v[36:39], v[52:55], v[128:131], v[36:39]
  ds_read_b64_tr_b16 a[120:121], v234 offset:16384
  v_mfma_f32_16x16x32_bf16 v[40:43], v[56:59], v[128:131], v[40:43]
  s_waitcnt lgkmcnt(4)
  s_add_u32 m0, s63, 0
  ds_read_b64_tr_b16 a[122:123], v234 offset:18432
  v_mfma_f32_16x16x32_bf16 v[44:47], v[60:63], v[128:131], v[44:47]
  s_add_u32 s73, s72, 0x10000
  ds_read_b64_tr_b16 a[124:125], v235 offset:16384
  ds_read_b64_tr_b16 a[126:127], v235 offset:18432
  v_mfma_f32_16x16x32_bf16 v[36:39], v[68:71], v[112:115], v[36:39]
  buffer_load_dwordx4 v244, s[48:51], s72 offen offset:0 lds
  ds_read_b128 v[168:171], v8 offset:3200
  v_mfma_f32_16x16x32_bf16 v[40:43], v[68:71], v[116:119], v[40:43]
  ds_read2_b32 v[200:201], v7 offset0:160 offset1:161
  ds_read2_b32 v[202:203], v7 offset0:162 offset1:163
  v_mfma_f32_16x16x32_bf16 v[44:47], v[68:71], v[120:123], v[44:47]
  ds_read_b128 v[172:175], v8 offset:3712
  ds_read2_b32 v[204:205], v7 offset0:32 offset1:33
  v_mfma_f32_16x16x32_bf16 v[36:39], v[48:51], v[132:135], v[36:39]
  buffer_load_dwordx4 v245, s[48:51], s72 offen offset:1024 lds
  ds_read2_b32 v[206:207], v7 offset0:34 offset1:35
  v_mfma_f32_16x16x32_bf16 v[40:43], v[52:55], v[132:135], v[40:43]
  v_mfma_f32_16x16x32_bf16 v[44:47], v[56:59], v[132:135], v[44:47]
  v_mfma_f32_16x16x32_bf16 v[40:43], v[72:75], v[112:115], v[40:43]
  v_mfma_f32_16x16x32_bf16 v[44:47], v[72:75], v[116:119], v[44:47]
  buffer_load_dwordx4 v246, s[48:51], s72 offen offset:2048 lds
  v_mfma_f32_16x16x32_bf16 v[40:43], v[48:51], v[136:139], v[40:43]
  v_mfma_f32_16x16x32_bf16 v[44:47], v[52:55], v[136:139], v[44:47]
  v_mfma_f32_16x16x32_bf16 v[44:47], v[76:79], v[112:115], v[44:47]
  v_mfma_f32_16x16x32_bf16 v[44:47], v[48:51], v[140:143], v[44:47]
  buffer_load_dwordx4 v247, s[48:51], s72 offen offset:3072 lds
  ds_read_b128 v[112:115], v8 offset:192
  v_mfma_f32_16x16x32_bf16 v[16:19], v[176:179], v[144:147], v[16:19]
  s_waitcnt lgkmcnt(1)
  s_add_u32 m0, s63, 16384
  ds_read2_b32 v[48:49], v4 offset0:176 offset1:177
  v_mfma_f32_16x16x32_bf16 v[20:23], v[180:183], v[144:147], v[20:23]
  ds_read2_b32 v[50:51], v4 offset0:178 offset1:179
  ds_read_b128 v[116:119], v8 offset:704
  v_mfma_f32_16x16x32_bf16 v[20:23], v[176:179], v[148:151], v[20:23]
  buffer_load_dwordx4 v244, s[48:51], s73 offen offset:0 lds
  ds_read_b64_tr_b16 a[128:129], v232 offset:32768
  v_mfma_f32_16x16x32_bf16 v[24:27], v[180:183], v[148:151], v[24:27]
  ds_read_b64_tr_b16 a[130:131], v232 offset:34816
  ds_read_b64_tr_b16 a[132:133], v233 offset:32768
  v_mfma_f32_16x16x32_bf16 v[24:27], v[184:187], v[144:147], v[24:27]
  ds_read_b64_tr_b16 a[134:135], v233 offset:34816
  ds_read_b64_tr_b16 a[136:137], v234 offset:32768
  v_mfma_f32_16x16x32_bf16 v[28:31], v[184:187], v[148:151], v[28:31]
  buffer_load_dwordx4 v245, s[48:51], s73 offen offset:1024 lds
  ds_read_b64_tr_b16 a[138:139], v234 offset:34816
  v_mfma_f32_16x16x32_bf16 v[24:27], v[176:179], v[152:155], v[24:27]
  ds_read_b64_tr_b16 a[140:141], v235 offset:32768
  ds_read_b64_tr_b16 a[142:143], v235 offset:34816
  v_mfma_f32_16x16x32_bf16 v[28:31], v[180:183], v[152:155], v[28:31]
  ds_read2_b32 v[52:53], v4 offset0:48 offset1:49
  ds_read2_b32 v[54:55], v4 offset0:50 offset1:51
  v_mfma_f32_16x16x32_bf16 v[32:35], v[184:187], v[152:155], v[32:35]
  ds_read_b128 v[120:123], v8 offset:1216
  ds_read2_b32 v[56:57], v5 offset0:176 offset1:177
  v_mfma_f32_16x16x32_bf16 v[28:31], v[188:191], v[144:147], v[28:31]
  buffer_load_dwordx4 v246, s[48:51], s73 offen offset:2048 lds
  ds_read2_b32 v[58:59], v5 offset0:178 offset1:179
  v_mfma_f32_16x16x32_bf16 v[32:35], v[188:191], v[148:151], v[32:35]
  ds_read_b128 v[124:127], v8 offset:1728
  ds_read2_b32 v[60:61], v5 offset0:48 offset1:49
  v_mfma_f32_16x16x32_bf16 v[36:39], v[188:191], v[152:155], v[36:39]
  ds_read2_b32 v[62:63], v5 offset0:50 offset1:51
  ds_read_b128 v[128:131], v8 offset:2240
  v_mfma_f32_16x16x32_bf16 v[28:31], v[176:179], v[156:159], v[28:31]
  buffer_load_dwordx4 v247, s[48:51], s73 offen offset:3072 lds
  v_mfma_f32_16x16x32_bf16 v[32:35], v[180:183], v[156:159], v[32:35]
  s_add_u32 s72, s72, 0x40000
  ds_read_b64_tr_b16 a[144:145], v232 offset:49152
  v_mfma_f32_16x16x32_bf16 v[36:39], v[184:187], v[156:159], v[36:39]
  s_cmp_eq_u32 s72, 0x380000
  s_cselect_b32 s72, 0, s72
  ds_read_b64_tr_b16 a[146:147], v232 offset:51200
  v_mfma_f32_16x16x32_bf16 v[40:43], v[188:191], v[156:159], v[40:43]
  ds_read_b64_tr_b16 a[148:149], v233 offset:49152
  v_mfma_f32_16x16x32_bf16 v[32:35], v[192:195], v[144:147], v[32:35]
  ds_read_b64_tr_b16 a[150:151], v233 offset:51200
  v_mfma_f32_16x16x32_bf16 v[36:39], v[192:195], v[148:151], v[36:39]
  ds_read_b64_tr_b16 a[152:153], v234 offset:49152
  v_mfma_f32_16x16x32_bf16 v[40:43], v[192:195], v[152:155], v[40:43]
  s_waitcnt lgkmcnt(5)
  s_add_u32 m0, s63, 32768
  ds_read_b64_tr_b16 a[154:155], v234 offset:51200
  v_mfma_f32_16x16x32_bf16 v[44:47], v[192:195], v[156:159], v[44:47]
  s_add_u32 s73, s72, 0x10000
  ds_read_b64_tr_b16 a[156:157], v235 offset:49152
  ds_read_b64_tr_b16 a[158:159], v235 offset:51200
  v_mfma_f32_16x16x32_bf16 v[32:35], v[176:179], v[160:163], v[32:35]
  buffer_load_dwordx4 v244, s[48:51], s72 offen offset:0 lds
  ds_read2_b32 v[64:65], v6 offset0:176 offset1:177
  v_mfma_f32_16x16x32_bf16 v[36:39], v[180:183], v[160:163], v[36:39]
  ds_read2_b32 v[66:67], v6 offset0:178 offset1:179
  ds_read_b128 v[132:135], v8 offset:2752
  v_mfma_f32_16x16x32_bf16 v[40:43], v[184:187], v[160:163], v[40:43]
  ds_read2_b32 v[68:69], v6 offset0:48 offset1:49
  ds_read2_b32 v[70:71], v6 offset0:50 offset1:51
  v_mfma_f32_16x16x32_bf16 v[44:47], v[188:191], v[160:163], v[44:47]
  buffer_load_dwordx4 v245, s[48:51], s72 offen offset:1024 lds
  ds_read_b128 v[136:139], v8 offset:3264
  v_mfma_f32_16x16x32_bf16 v[36:39], v[196:199], v[144:147], v[36:39]
  ds_read2_b32 v[72:73], v7 offset0:176 offset1:177
  ds_read2_b32 v[74:75], v7 offset0:178 offset1:179
  v_mfma_f32_16x16x32_bf16 v[40:43], v[196:199], v[148:151], v[40:43]
  ds_read_b128 v[140:143], v8 offset:3776
  ds_read2_b32 v[76:77], v7 offset0:48 offset1:49
  v_mfma_f32_16x16x32_bf16 v[44:47], v[196:199], v[152:155], v[44:47]
  buffer_load_dwordx4 v246, s[48:51], s72 offen offset:2048 lds
  ds_read2_b32 v[78:79], v7 offset0:50 offset1:51
  v_mfma_f32_16x16x32_bf16 v[36:39], v[176:179], v[164:167], v[36:39]
  v_mfma_f32_16x16x32_bf16 v[40:43], v[180:183], v[164:167], v[40:43]
  v_mfma_f32_16x16x32_bf16 v[44:47], v[184:187], v[164:167], v[44:47]
  v_mfma_f32_16x16x32_bf16 v[40:43], v[200:203], v[144:147], v[40:43]
  buffer_load_dwordx4 v247, s[48:51], s72 offen offset:3072 lds
  v_mfma_f32_16x16x32_bf16 v[44:47], v[200:203], v[148:151], v[44:47]
  s_waitcnt lgkmcnt(1)
  s_add_u32 m0, s63, 49152
  v_mfma_f32_16x16x32_bf16 v[40:43], v[176:179], v[168:171], v[40:43]
  v_mfma_f32_16x16x32_bf16 v[44:47], v[180:183], v[168:171], v[44:47]
  v_mfma_f32_16x16x32_bf16 v[44:47], v[204:207], v[144:147], v[44:47]
  s_waitcnt vmcnt(17)
  ds_read_b64_tr_b16 a[160:161], v228 offset:0
  buffer_load_dwordx4 v244, s[48:51], s73 offen offset:0 lds
  v_mfma_f32_16x16x32_bf16 v[44:47], v[176:179], v[172:175], v[44:47]
  ds_read_b64_tr_b16 a[162:163], v228 offset:2048
  ds_read_b64_tr_b16 a[164:165], v229 offset:0
  v_mfma_f32_16x16x32_bf16 v[16:19], v[48:51], v[112:115], v[16:19]
  ds_read_b64_tr_b16 a[166:167], v229 offset:2048
  ds_read_b64_tr_b16 a[168:169], v230 offset:0
  v_mfma_f32_16x16x32_bf16 v[20:23], v[52:55], v[112:115], v[20:23]
  buffer_load_dwordx4 v245, s[48:51], s73 offen offset:1024 lds
  ds_read_b64_tr_b16 a[170:171], v230 offset:2048
  v_mfma_f32_16x16x32_bf16 v[20:23], v[48:51], v[116:119], v[20:23]
  ds_read_b64_tr_b16 a[172:173], v231 offset:0
  ds_read_b64_tr_b16 a[174:175], v231 offset:2048
  v_mfma_f32_16x16x32_bf16 v[24:27], v[52:55], v[116:119], v[24:27]
  s_branch parallel_sum__ssm_conv_h3__mixer_gmlp__prompt_kernel_ps12
parallel_sum__ssm_conv_h3__mixer_gmlp__prompt_kernel_pg12:
  s_branch parallel_sum__ssm_conv_h3__mixer_gmlp__prompt_kernel_pgback
parallel_sum__ssm_conv_h3__mixer_gmlp__prompt_kernel_ps12:
  ds_read_b128 v[144:147], v8 offset:256
  ds_read2_b32 v[176:177], v4 offset0:192 offset1:193
  v_mfma_f32_16x16x32_bf16 v[24:27], v[56:59], v[112:115], v[24:27]
  buffer_load_dwordx4 v246, s[48:51], s73 offen offset:2048 lds
  ds_read2_b32 v[178:179], v4 offset0:194 offset1:195
  v_mfma_f32_16x16x32_bf16 v[28:31], v[56:59], v[116:119], v[28:31]
  ds_read_b128 v[148:151], v8 offset:768
  ds_read2_b32 v[180:181], v4 offset0:64 offset1:65
  v_mfma_f32_16x16x32_bf16 v[24:27], v[48:51], v[120:123], v[24:27]
  ds_read2_b32 v[182:183], v4 offset0:66 offset1:67
  ds_read_b128 v[152:155], v8 offset:1280
  v_mfma_f32_16x16x32_bf16 v[28:31], v[52:55], v[120:123], v[28:31]
  ds_read2_b32 v[184:185], v5 offset0:192 offset1:193
  ds_read2_b32 v[186:187], v5 offset0:194 offset1:195
  v_mfma_f32_16x16x32_bf16 v[32:35], v[56:59], v[120:123], v[32:35]
  buffer_load_dwordx4 v247, s[48:51], s73 offen offset:3072 lds
  v_mfma_f32_16x16x32_bf16 v[28:31], v[60:63], v[112:115], v[28:31]
  s_add_u32 s72, s72, 0x40000
  s_waitcnt vmcnt(17)
  ds_read_b64_tr_b16 a[176:177], v228 offset:4096
  v_mfma_f32_16x16x32_bf16 v[32:35], v[60:63], v[116:119], v[32:35]
  s_cmp_eq_u32 s72, 0x380000
  s_cselect_b32 s72, 0, s72
  ds_read_b64_tr_b16 a[178:179], v228 offset:6144
  v_mfma_f32_16x16x32_bf16 v[36:39], v[60:63], v[120:123], v[36:39]
  ds_read_b64_tr_b16 a[180:181], v229 offset:4096
  v_mfma_f32_16x16x32_bf16 v[28:31], v[48:51], v[124:127], v[28:31]
  ds_read_b64_tr_b16 a[182:183], v229 offset:6144
  v_mfma_f32_16x16x32_bf16 v[32:35], v[52:55], v[124:127], v[32:35]
  ds_read_b64_tr_b16 a[184:185], v230 offset:4096
  v_mfma_f32_16x16x32_bf16 v[36:39], v[56:59], v[124:127], v[36:39]
  ds_read_b64_tr_b16 a[186:187], v230 offset:6144
  v_mfma_f32_16x16x32_bf16 v[40:43], v[60:63], v[124:127], v[40:43]
  ds_read_b64_tr_b16 a[188:189], v231 offset:4096
  v_mfma_f32_16x16x32_bf16 v[32:35], v[64:67], v[112:115], v[32:35]
  ds_read_b64_tr_b16 a[190:191], v231 offset:6144
  v_mfma_f32_16x16x32_bf16 v[36:39], v[64:67], v[116:119], v[36:39]
  ds_read_b128 v[156:159], v8 offset:1792
  v_mfma_f32_16x16x32_bf16 v[40:43], v[64:67], v[120:123], v[40:43]
  ds_read2_b32 v[188:189], v5 offset0:64 offset1:65
  v_mfma_f32_16x16x32_bf16 v[44:47], v[64:67], v[124:127], v[44:47]
  ds_read2_b32 v[190:191], v5 offset0:66 offset1:67
  v_mfma_f32_16x16x32_bf16 v[32:35], v[48:51], v[128:131], v[32:35]
  ds_read_b128 v[160:163], v8 offset:2304
  v_mfma_f32_16x16x32_bf16 v[36:39], v[52:55], v[128:131], v[36:39]
  ds_read2_b32 v[192:193], v6 offset0:192 offset1:193
  v_mfma_f32_16x16x32_bf16 v[40:43], v[56:59], v[128:131], v[40:43]
  ds_read2_b32 v[194:195], v6 offset0:194 offset1:195
  v_mfma_f32_16x16x32_bf16 v[44:47], v[60:63], v[128:131], v[44:47]
  ds_read_b128 v[164:167], v8 offset:2816
  v_mfma_f32_16x16x32_bf16 v[36:39], v[68:71], v[112:115], v[36:39]
  ds_read2_b32 v[196:197], v6 offset0:64 offset1:65
  v_mfma_f32_16x16x32_bf16 v[40:43], v[68:71], v[116:119], v[40:43]
  ds_read2_b32 v[198:199], v6 offset0:66 offset1:67
  v_mfma_f32_16x16x32_bf16 v[44:47], v[68:71], v[120:123], v[44:47]
  ds_read_b128 v[168:171], v8 offset:3328
  v_mfma_f32_16x16x32_bf16 v[36:39], v[48:51], v[132:135], v[36:39]
  ds_read2_b32 v[200:201], v7 offset0:192 offset1:193
  v_mfma_f32_16x16x32_bf16 v[40:43], v[52:55], v[132:135], v[40:43]
  ds_read2_b32 v[202:203], v7 offset0:194 offset1:195
  v_mfma_f32_16x16x32_bf16 v[44:47], v[56:59], v[132:135], v[44:47]
  ds_read_b128 v[172:175], v8 offset:3840
  v_mfma_f32_16x16x32_bf16 v[40:43], v[72:75], v[112:115], v[40:43]
  s_waitcnt vmcnt(12)
  ds_read_b64_tr_b16 a[192:193], v232 offset:0
  v_mfma_f32_16x16x32_bf16 v[44:47], v[72:75], v[116:119], v[44:47]
  ds_read_b64_tr_b16 a[194:195], v232 offset:2048
  v_mfma_f32_16x16x32_bf16 v[40:43], v[48:51], v[136:139], v[40:43]
  ds_read_b64_tr_b16 a[196:197], v233 offset:0
  v_mfma_f32_16x16x32_bf16 v[44:47], v[52:55], v[136:139], v[44:47]
  s_waitcnt lgkmcnt(5)
  ds_read_b64_tr_b16 a[198:199], v233 offset:2048
  v_mfma_f32_16x16x32_bf16 v[44:47], v[76:79], v[112:115], v[44:47]
  ds_read_b64_tr_b16 a[200:201], v234 offset:0
  ds_read_b64_tr_b16 a[202:203], v234 offset:2048
  v_mfma_f32_16x16x32_bf16 v[44:47], v[48:51], v[140:143], v[44:47]
  ds_read_b64_tr_b16 a[204:205], v235 offset:0
  v_mfma_f32_16x16x32_bf16 v[16:19], v[176:179], v[144:147], v[16:19]
  ds_read_b64_tr_b16 a[206:207], v235 offset:2048
  v_mfma_f32_16x16x32_bf16 v[20:23], v[180:183], v[144:147], v[20:23]
  ds_read2_b32 v[204:205], v7 offset0:64 offset1:65
  v_mfma_f32_16x16x32_bf16 v[20:23], v[176:179], v[148:151], v[20:23]
  ds_read2_b32 v[206:207], v7 offset0:66 offset1:67
  v_mfma_f32_16x16x32_bf16 v[24:27], v[180:183], v[148:151], v[24:27]
  ds_read_b128 v[112:115], v8 offset:320
  v_mfma_f32_16x16x32_bf16 v[24:27], v[184:187], v[144:147], v[24:27]
  s_waitcnt vmcnt(8)
  ds_read_b64_tr_b16 a[208:209], v232 offset:16384
  ds_read_b64_tr_b16 a[210:211], v232 offset:18432
  v_mfma_f32_16x16x32_bf16 v[28:31], v[184:187], v[148:151], v[28:31]
  ds_read_b64_tr_b16 a[212:213], v233 offset:16384
  ds_read_b64_tr_b16 a[214:215], v233 offset:18432
  v_mfma_f32_16x16x32_bf16 v[24:27], v[176:179], v[152:155], v[24:27]
  ds_read_b64_tr_b16 a[216:217], v234 offset:16384
  ds_read_b64_tr_b16 a[218:219], v234 offset:18432
  v_mfma_f32_16x16x32_bf16 v[28:31], v[180:183], v[152:155], v[28:31]
  ds_read_b64_tr_b16 a[220:221], v235 offset:16384
  ds_read_b64_tr_b16 a[222:223], v235 offset:18432
  v_mfma_f32_16x16x32_bf16 v[32:35], v[184:187], v[152:155], v[32:35]
  ds_read2_b32 v[48:49], v4 offset0:208 offset1:209
  ds_read2_b32 v[50:51], v4 offset0:210 offset1:211
  v_mfma_f32_16x16x32_bf16 v[28:31], v[188:191], v[144:147], v[28:31]
  ds_read_b128 v[116:119], v8 offset:832
  v_mfma_f32_16x16x32_bf16 v[32:35], v[188:191], v[148:151], v[32:35]
  s_waitcnt lgkmcnt(9)
  s_add_u32 m0, s63, 0
  ds_read2_b32 v[52:53], v4 offset0:80 offset1:81
  v_mfma_f32_16x16x32_bf16 v[36:39], v[188:191], v[152:155], v[36:39]
  s_add_u32 s73, s72, 0x10000
  ds_read2_b32 v[54:55], v4 offset0:82 offset1:83
  ds_read_b128 v[120:123], v8 offset:1344
  v_mfma_f32_16x16x32_bf16 v[28:31], v[176:179], v[156:159], v[28:31]
  buffer_load_dwordx4 v244, s[48:51], s72 offen offset:0 lds
  ds_read2_b32 v[56:57], v5 offset0:208 offset1:209
  v_mfma_f32_16x16x32_bf16 v[32:35], v[180:183], v[156:159], v[32:35]
  ds_read2_b32 v[58:59], v5 offset0:210 offset1:211
  ds_read_b128 v[124:127], v8 offset:1856
  v_mfma_f32_16x16x32_bf16 v[36:39], v[184:187], v[156:159], v[36:39]
  ds_read2_b32 v[60:61], v5 offset0:80 offset1:81
  ds_read2_b32 v[62:63], v5 offset0:82 offset1:83
  v_mfma_f32_16x16x32_bf16 v[40:43], v[188:191], v[156:159], v[40:43]
  buffer_load_dwordx4 v245, s[48:51], s72 offen offset:1024 lds
  ds_read_b128 v[128:131], v8 offset:2368
  v_mfma_f32_16x16x32_bf16 v[32:35], v[192:195], v[144:147], v[32:35]
  ds_read2_b32 v[64:65], v6 offset0:208 offset1:209
  ds_read2_b32 v[66:67], v6 offset0:210 offset1:211
  v_mfma_f32_16x16x32_bf16 v[36:39], v[192:195], v[148:151], v[36:39]
  ds_read_b128 v[132:135], v8 offset:2880
  ds_read2_b32 v[68:69], v6 offset0:80 offset1:81
  v_mfma_f32_16x16x32_bf16 v[40:43], v[192:195], v[152:155], v[40:43]
  buffer_load_dwordx4 v246, s[48:51], s72 offen offset:2048 lds
  ds_read2_b32 v[70:71], v6 offset0:82 offset1:83
  v_mfma_f32_16x16x32_bf16 v[44:47], v[192:195], v[156:159], v[44:47]
  ds_read_b128 v[136:139], v8 offset:3392
  ds_read2_b32 v[72:73], v7 offset0:208 offset1:209
  v_mfma_f32_16x16x32_bf16 v[32:35], v[176:179], v[160:163], v[32:35]
  ds_read2_b32 v[74:75], v7 offset0:210 offset1:211
  ds_read_b128 v[140:143], v8 offset:3904
  v_mfma_f32_16x16x32_bf16 v[36:39], v[180:183], v[160:163], v[36:39]
  buffer_load_dwordx4 v247, s[48:51], s72 offen offset:3072 lds
  ds_read2_b32 v[76:77], v7 offset0:80 offset1:81
  v_mfma_f32_16x16x32_bf16 v[40:43], v[184:187], v[160:163], v[40:43]
  s_waitcnt lgkmcnt(8)
  s_add_u32 m0, s63, 16384
  ds_read2_b32 v[78:79], v7 offset0:82 offset1:83
  v_mfma_f32_16x16x32_bf16 v[44:47], v[188:191], v[160:163], v[44:47]
  v_mfma_f32_16x16x32_bf16 v[36:39], v[196:199], v[144:147], v[36:39]
  v_mfma_f32_16x16x32_bf16 v[40:43], v[196:199], v[148:151], v[40:43]
  buffer_load_dwordx4 v244, s[48:51], s73 offen offset:0 lds
  v_mfma_f32_16x16x32_bf16 v[44:47], v[196:199], v[152:155], v[44:47]
  s_waitcnt vmcnt(9)
  ds_read_b64_tr_b16 a[224:225], v232 offset:32768
  ds_read_b64_tr_b16 a[226:227], v232 offset:34816
  v_mfma_f32_16x16x32_bf16 v[36:39], v[176:179], v[164:167], v[36:39]
  ds_read_b64_tr_b16 a[228:229], v233 offset:32768
  ds_read_b64_tr_b16 a[230:231], v233 offset:34816
  v_mfma_f32_16x16x32_bf16 v[40:43], v[180:183], v[164:167], v[40:43]
  ds_read_b64_tr_b16 a[232:233], v234 offset:32768
  ds_read_b64_tr_b16 a[234:235], v234 offset:34816
  v_mfma_f32_16x16x32_bf16 v[44:47], v[184:187], v[164:167], v[44:47]
  buffer_load_dwordx4 v245, s[48:51], s73 offen offset:1024 lds
  ds_read_b64_tr_b16 a[236:237], v235 offset:32768
  v_mfma_f32_16x16x32_bf16 v[40:43], v[200:203], v[144:147], v[40:43]
  ds_read_b64_tr_b16 a[238:239], v235 offset:34816
  v_mfma_f32_16x16x32_bf16 v[44:47], v[200:203], v[148:151], v[44:47]
  v_mfma_f32_16x16x32_bf16 v[40:43], v[176:179], v[168:171], v[40:43]
  buffer_load_dwordx4 v246, s[48:51], s73 offen offset:2048 lds
  v_mfma_f32_16x16x32_bf16 v[44:47], v[180:183], v[168:171], v[44:47]
  v_mfma_f32_16x16x32_bf16 v[44:47], v[204:207], v[144:147], v[44:47]
  v_mfma_f32_16x16x32_bf16 v[44:47], v[176:179], v[172:175], v[44:47]
  ds_read_b128 v[144:147], v8 offset:384
  ds_read2_b32 v[176:177], v4 offset0:224 offset1:225
  v_mfma_f32_16x16x32_bf16 v[16:19], v[48:51], v[112:115], v[16:19]
  buffer_load_dwordx4 v247, s[48:51], s73 offen offset:3072 lds
  v_mfma_f32_16x16x32_bf16 v[20:23], v[52:55], v[112:115], v[20:23]
  s_add_u32 s72, s72, 0x40000
  s_waitcnt vmcnt(8)
  ds_read_b64_tr_b16 a[240:241], v232 offset:49152
  v_mfma_f32_16x16x32_bf16 v[20:23], v[48:51], v[116:119], v[20:23]
  s_cmp_eq_u32 s72, 0x380000
  s_cselect_b32 s72, 0, s72
  ds_read_b64_tr_b16 a[242:243], v232 offset:51200
  v_mfma_f32_16x16x32_bf16 v[24:27], v[52:55], v[116:119], v[24:27]
  ds_read_b64_tr_b16 a[244:245], v233 offset:49152
  v_mfma_f32_16x16x32_bf16 v[24:27], v[56:59], v[112:115], v[24:27]
  ds_read_b64_tr_b16 a[246:247], v233 offset:51200
  v_mfma_f32_16x16x32_bf16 v[28:31], v[56:59], v[116:119], v[28:31]
  ds_read_b64_tr_b16 a[248:249], v234 offset:49152
  v_mfma_f32_16x16x32_bf16 v[24:27], v[48:51], v[120:123], v[24:27]
  s_waitcnt lgkmcnt(5)
  s_add_u32 m0, s63, 32768
  ds_read_b64_tr_b16 a[250:251], v234 offset:51200
  v_mfma_f32_16x16x32_bf16 v[28:31], v[52:55], v[120:123], v[28:31]
  s_add_u32 s73, s72, 0x10000
  ds_read_b64_tr_b16 a[252:253], v235 offset:49152
  ds_read_b64_tr_b16 a[254:255], v235 offset:51200
  v_mfma_f32_16x16x32_bf16 v[32:35], v[56:59], v[120:123], v[32:35]
  buffer_load_dwordx4 v244, s[48:51], s72 offen offset:0 lds
  ds_read2_b32 v[178:179], v4 offset0:226 offset1:227
  v_mfma_f32_16x16x32_bf16 v[28:31], v[60:63], v[112:115], v[28:31]
  ds_read_b128 v[148:151], v8 offset:896
  ds_read2_b32 v[180:181], v4 offset0:96 offset1:97
  v_mfma_f32_16x16x32_bf16 v[32:35], v[60:63], v[116:119], v[32:35]
  ds_read2_b32 v[182:183], v4 offset0:98 offset1:99
  ds_read_b128 v[152:155], v8 offset:1408
  v_mfma_f32_16x16x32_bf16 v[36:39], v[60:63], v[120:123], v[36:39]
  buffer_load_dwordx4 v245, s[48:51], s72 offen offset:1024 lds
  ds_read2_b32 v[184:185], v5 offset0:224 offset1:225
  v_mfma_f32_16x16x32_bf16 v[28:31], v[48:51], v[124:127], v[28:31]
  ds_read2_b32 v[186:187], v5 offset0:226 offset1:227
  ds_read_b128 v[156:159], v8 offset:1920
  v_mfma_f32_16x16x32_bf16 v[32:35], v[52:55], v[124:127], v[32:35]
  ds_read2_b32 v[188:189], v5 offset0:96 offset1:97
  ds_read2_b32 v[190:191], v5 offset0:98 offset1:99
  v_mfma_f32_16x16x32_bf16 v[36:39], v[56:59], v[124:127], v[36:39]
  buffer_load_dwordx4 v246, s[48:51], s72 offen offset:2048 lds
  ds_read_b128 v[160:163], v8 offset:2432
  v_mfma_f32_16x16x32_bf16 v[40:43], v[60:63], v[124:127], v[40:43]
  ds_read2_b32 v[192:193], v6 offset0:224 offset1:225
  ds_read2_b32 v[194:195], v6 offset0:226 offset1:227
  v_mfma_f32_16x16x32_bf16 v[32:35], v[64:67], v[112:115], v[32:35]
  ds_read_b128 v[164:167], v8 offset:2944
  ds_read2_b32 v[196:197], v6 offset0:96 offset1:97
  v_mfma_f32_16x16x32_bf16 v[36:39], v[64:67], v[116:119], v[36:39]
  buffer_load_dwordx4 v247, s[48:51], s72 offen offset:3072 lds
  ds_read2_b32 v[198:199], v6 offset0:98 offset1:99
  v_mfma_f32_16x16x32_bf16 v[40:43], v[64:67], v[120:123], v[40:43]
  s_waitcnt lgkmcnt(8)
  s_add_u32 m0, s63, 49152
  ds_read_b128 v[168:171], v8 offset:3456
  v_mfma_f32_16x16x32_bf16 v[44:47], v[64:67], v[124:127], v[44:47]
  ds_read2_b32 v[200:201], v7 offset0:224 offset1:225
  ds_read2_b32 v[202:203], v7 offset0:226 offset1:227
  v_mfma_f32_16x16x32_bf16 v[32:35], v[48:51], v[128:131], v[32:35]
  ds_read_b128 v[172:175], v8 offset:3968
  ds_read2_b32 v[204:205], v7 offset0:96 offset1:97
  v_mfma_f32_16x16x32_bf16 v[36:39], v[52:55], v[128:131], v[36:39]
  buffer_load_dwordx4 v244, s[48:51], s73 offen offset:0 lds
  ds_read2_b32 v[206:207], v7 offset0:98 offset1:99
  v_mfma_f32_16x16x32_bf16 v[40:43], v[56:59], v[128:131], v[40:43]
  v_mfma_f32_16x16x32_bf16 v[44:47], v[60:63], v[128:131], v[44:47]
  v_mfma_f32_16x16x32_bf16 v[36:39], v[68:71], v[112:115], v[36:39]
  buffer_load_dwordx4 v245, s[48:51], s73 offen offset:1024 lds
  v_mfma_f32_16x16x32_bf16 v[40:43], v[68:71], v[116:119], v[40:43]
  v_mfma_f32_16x16x32_bf16 v[44:47], v[68:71], v[120:123], v[44:47]
  v_mfma_f32_16x16x32_bf16 v[36:39], v[48:51], v[132:135], v[36:39]
  v_mfma_f32_16x16x32_bf16 v[40:43], v[52:55], v[132:135], v[40:43]
  buffer_load_dwordx4 v246, s[48:51], s73 offen offset:2048 lds
  v_mfma_f32_16x16x32_bf16 v[44:47], v[56:59], v[132:135], v[44:47]
  v_mfma_f32_16x16x32_bf16 v[40:43], v[72:75], v[112:115], v[40:43]
  v_mfma_f32_16x16x32_bf16 v[44:47], v[72:75], v[116:119], v[44:47]
  v_mfma_f32_16x16x32_bf16 v[40:43], v[48:51], v[136:139], v[40:43]
  buffer_load_dwordx4 v247, s[48:51], s73 offen offset:3072 lds
  v_mfma_f32_16x16x32_bf16 v[44:47], v[52:55], v[136:139], v[44:47]
  s_add_u32 s72, s72, 0x40000
  v_mfma_f32_16x16x32_bf16 v[44:47], v[76:79], v[112:115], v[44:47]
  s_cmp_eq_u32 s72, 0x380000
  s_cselect_b32 s72, 0, s72
  v_mfma_f32_16x16x32_bf16 v[44:47], v[48:51], v[140:143], v[44:47]
  s_add_u32 m0, s84, 0
  ds_read_b128 v[112:115], v8 offset:448
  ds_read2_b32 v[48:49], v4 offset0:240 offset1:241
  v_mfma_f32_16x16x32_bf16 v[16:19], v[176:179], v[144:147], v[16:19]
  s_add_u32 s73, s72, 0x10000
  ds_read2_b32 v[50:51], v4 offset0:242 offset1:243
  ds_read_b128 v[116:119], v8 offset:960
  v_mfma_f32_16x16x32_bf16 v[20:23], v[180:183], v[144:147], v[20:23]
  buffer_load_dwordx4 v244, s[48:51], s72 offen offset:0 lds
  ds_read2_b32 v[52:53], v4 offset0:112 offset1:113
  v_mfma_f32_16x16x32_bf16 v[20:23], v[176:179], v[148:151], v[20:23]
  ds_read2_b32 v[54:55], v4 offset0:114 offset1:115
  ds_read_b128 v[120:123], v8 offset:1472
  v_mfma_f32_16x16x32_bf16 v[24:27], v[180:183], v[148:151], v[24:27]
  ds_read2_b32 v[56:57], v5 offset0:240 offset1:241
  ds_read2_b32 v[58:59], v5 offset0:242 offset1:243
  v_mfma_f32_16x16x32_bf16 v[24:27], v[184:187], v[144:147], v[24:27]
  buffer_load_dwordx4 v245, s[48:51], s72 offen offset:1024 lds
  ds_read_b128 v[124:127], v8 offset:1984
  v_mfma_f32_16x16x32_bf16 v[28:31], v[184:187], v[148:151], v[28:31]
  ds_read2_b32 v[60:61], v5 offset0:112 offset1:113
  ds_read2_b32 v[62:63], v5 offset0:114 offset1:115
  v_mfma_f32_16x16x32_bf16 v[24:27], v[176:179], v[152:155], v[24:27]
  ds_read_b128 v[128:131], v8 offset:2496
  ds_read2_b32 v[64:65], v6 offset0:240 offset1:241
  v_mfma_f32_16x16x32_bf16 v[28:31], v[180:183], v[152:155], v[28:31]
  buffer_load_dwordx4 v246, s[48:51], s72 offen offset:2048 lds
  ds_read2_b32 v[66:67], v6 offset0:242 offset1:243
  v_mfma_f32_16x16x32_bf16 v[32:35], v[184:187], v[152:155], v[32:35]
  s_waitcnt lgkmcnt(8)
  ds_read_b128 v[132:135], v8 offset:3008
  ds_read2_b32 v[68:69], v6 offset0:112 offset1:113
  v_mfma_f32_16x16x32_bf16 v[28:31], v[188:191], v[144:147], v[28:31]
  ds_read2_b32 v[70:71], v6 offset0:114 offset1:115
  ds_read_b128 v[136:139], v8 offset:3520
  v_mfma_f32_16x16x32_bf16 v[32:35], v[188:191], v[148:151], v[32:35]
  buffer_load_dwordx4 v247, s[48:51], s72 offen offset:3072 lds
  ds_read2_b32 v[72:73], v7 offset0:240 offset1:241
  v_mfma_f32_16x16x32_bf16 v[36:39], v[188:191], v[152:155], v[36:39]
  s_add_u32 m0, s84, 4096
  ds_read2_b32 v[74:75], v7 offset0:242 offset1:243
  ds_read_b128 v[140:143], v8 offset:4032
  v_mfma_f32_16x16x32_bf16 v[28:31], v[176:179], v[156:159], v[28:31]
  ds_read2_b32 v[76:77], v7 offset0:112 offset1:113
  ds_read2_b32 v[78:79], v7 offset0:114 offset1:115
  v_mfma_f32_16x16x32_bf16 v[32:35], v[180:183], v[156:159], v[32:35]
  v_mfma_f32_16x16x32_bf16 v[36:39], v[184:187], v[156:159], v[36:39]
  buffer_load_dwordx4 v244, s[48:51], s73 offen offset:0 lds
  v_mfma_f32_16x16x32_bf16 v[40:43], v[188:191], v[156:159], v[40:43]
  v_lshlrev_b32_e64 v254, 3, v254
  v_min_u32 v254, 3456, v254
  buffer_load_dword v255, v254, s[16:19], s91 offen sc1
  v_mfma_f32_16x16x32_bf16 v[32:35], v[192:195], v[144:147], v[32:35]
  v_mfma_f32_16x16x32_bf16 v[36:39], v[192:195], v[148:151], v[36:39]
  buffer_load_dwordx4 v245, s[48:51], s73 offen offset:1024 lds
  v_mfma_f32_16x16x32_bf16 v[40:43], v[192:195], v[152:155], v[40:43]
  v_mfma_f32_16x16x32_bf16 v[44:47], v[192:195], v[156:159], v[44:47]
  v_mfma_f32_16x16x32_bf16 v[32:35], v[176:179], v[160:163], v[32:35]
  v_mfma_f32_16x16x32_bf16 v[36:39], v[180:183], v[160:163], v[36:39]
  buffer_load_dwordx4 v246, s[48:51], s73 offen offset:2048 lds
  v_mfma_f32_16x16x32_bf16 v[40:43], v[184:187], v[160:163], v[40:43]
  v_mfma_f32_16x16x32_bf16 v[44:47], v[188:191], v[160:163], v[44:47]
  v_mfma_f32_16x16x32_bf16 v[36:39], v[196:199], v[144:147], v[36:39]
  v_mfma_f32_16x16x32_bf16 v[40:43], v[196:199], v[148:151], v[40:43]
  buffer_load_dwordx4 v247, s[48:51], s73 offen offset:3072 lds
  v_mfma_f32_16x16x32_bf16 v[44:47], v[196:199], v[152:155], v[44:47]
  s_add_u32 s72, s72, 0x40000
  v_mfma_f32_16x16x32_bf16 v[36:39], v[176:179], v[164:167], v[36:39]
  s_cmp_eq_u32 s72, 0x380000
  s_cselect_b32 s72, 0, s72
  v_mfma_f32_16x16x32_bf16 v[40:43], v[180:183], v[164:167], v[40:43]
  v_mfma_f32_16x16x32_bf16 v[44:47], v[184:187], v[164:167], v[44:47]
  v_mfma_f32_16x16x32_bf16 v[40:43], v[200:203], v[144:147], v[40:43]
  v_mfma_f32_16x16x32_bf16 v[44:47], v[200:203], v[148:151], v[44:47]
  v_mfma_f32_16x16x32_bf16 v[40:43], v[176:179], v[168:171], v[40:43]
  v_mfma_f32_16x16x32_bf16 v[44:47], v[180:183], v[168:171], v[44:47]
  v_mfma_f32_16x16x32_bf16 v[44:47], v[204:207], v[144:147], v[44:47]
  v_mfma_f32_16x16x32_bf16 v[44:47], v[176:179], v[172:175], v[44:47]
  v_mfma_f32_16x16x32_bf16 v[16:19], v[48:51], v[112:115], v[16:19]
  s_waitcnt vmcnt(21)
  ds_read_b64_tr_b16 v[176:177], v232 offset:0
  ds_read_b64_tr_b16 v[178:179], v232 offset:2048
  v_mfma_f32_16x16x32_bf16 v[20:23], v[52:55], v[112:115], v[20:23]
  ds_read_b64_tr_b16 v[180:181], v233 offset:0
  ds_read_b64_tr_b16 v[182:183], v233 offset:2048
  v_mfma_f32_16x16x32_bf16 v[20:23], v[48:51], v[116:119], v[20:23]
  ds_read_b64_tr_b16 v[184:185], v234 offset:0
  ds_read_b64_tr_b16 v[186:187], v234 offset:2048
  v_mfma_f32_16x16x32_bf16 v[24:27], v[52:55], v[116:119], v[24:27]
  s_waitcnt lgkmcnt(6)
  ds_read_b64_tr_b16 v[188:189], v235 offset:0
  ds_read_b64_tr_b16 v[190:191], v235 offset:2048
  v_mfma_f32_16x16x32_bf16 v[24:27], v[56:59], v[112:115], v[24:27]
  ds_read_b64 v[80:81], v11 offset:3584
  ds_read_b64 v[82:83], v11 offset:3072
  v_mfma_f32_16x16x32_bf16 v[28:31], v[56:59], v[116:119], v[28:31]
  ds_read_b64 v[84:85], v11 offset:2560
  ds_read_b64 v[86:87], v11 offset:2048
  v_mfma_f32_16x16x32_bf16 v[24:27], v[48:51], v[120:123], v[24:27]
  ds_read_b64 v[88:89], v11 offset:1536
  v_mfma_f32_16x16x32_bf16 v[28:31], v[52:55], v[120:123], v[28:31]
  s_waitcnt vmcnt(17)
  ds_read_b64_tr_b16 v[192:193], v232 offset:16384
  v_mfma_f32_16x16x32_bf16 v[32:35], v[56:59], v[120:123], v[32:35]
  ds_read_b64_tr_b16 v[194:195], v232 offset:18432
  v_mfma_f32_16x16x32_bf16 v[28:31], v[60:63], v[112:115], v[28:31]
  ds_read_b64_tr_b16 v[196:197], v233 offset:16384
  v_mfma_f32_16x16x32_bf16 v[32:35], v[60:63], v[116:119], v[32:35]
  ds_read_b64_tr_b16 v[198:199], v233 offset:18432
  v_mfma_f32_16x16x32_bf16 v[36:39], v[60:63], v[120:123], v[36:39]
  ds_read_b64_tr_b16 v[200:201], v234 offset:16384
  v_mfma_f32_16x16x32_bf16 v[28:31], v[48:51], v[124:127], v[28:31]
  ds_read_b64_tr_b16 v[202:203], v234 offset:18432
  v_mfma_f32_16x16x32_bf16 v[32:35], v[52:55], v[124:127], v[32:35]
  ds_read_b64_tr_b16 v[204:205], v235 offset:16384
  v_mfma_f32_16x16x32_bf16 v[36:39], v[56:59], v[124:127], v[36:39]
  ds_read_b64_tr_b16 v[206:207], v235 offset:18432
  v_mfma_f32_16x16x32_bf16 v[40:43], v[60:63], v[124:127], v[40:43]
  ds_read_b64 v[90:91], v11 offset:1024
  v_mfma_f32_16x16x32_bf16 v[32:35], v[64:67], v[112:115], v[32:35]
  ds_read_b64 v[92:93], v11 offset:512
  v_mfma_f32_16x16x32_bf16 v[36:39], v[64:67], v[116:119], v[36:39]
  ds_read_b64 v[94:95], v11 offset:0
  v_mfma_f32_16x16x32_bf16 v[40:43], v[64:67], v[120:123], v[40:43]
  s_waitcnt vmcnt(13)
  ds_read_b64_tr_b16 v[144:145], v232 offset:32768
  ds_read_b64_tr_b16 v[146:147], v232 offset:34816
  v_mfma_f32_16x16x32_bf16 v[44:47], v[64:67], v[124:127], v[44:47]
  ds_read_b64_tr_b16 v[148:149], v233 offset:32768
  v_mfma_f32_16x16x32_bf16 v[32:35], v[48:51], v[128:131], v[32:35]
  ds_read_b64_tr_b16 v[150:151], v233 offset:34816
  v_mfma_f32_16x16x32_bf16 v[36:39], v[52:55], v[128:131], v[36:39]
  ds_read_b64_tr_b16 v[152:153], v234 offset:32768
  v_mfma_f32_16x16x32_bf16 v[40:43], v[56:59], v[128:131], v[40:43]
  ds_read_b64_tr_b16 v[154:155], v234 offset:34816
  v_mfma_f32_16x16x32_bf16 v[44:47], v[60:63], v[128:131], v[44:47]
  s_waitcnt vmcnt(3)
  v_cmp_ne_u32 vcc, s64, v255
  s_cbranch_vccnz parallel_sum__ssm_conv_h3__mixer_gmlp__prompt_kernel_pf_slow
parallel_sum__ssm_conv_h3__mixer_gmlp__prompt_kernel_pf_ok:
  v_mfma_f32_16x16x32_bf16 v[36:39], v[68:71], v[112:115], v[36:39]
  s_waitcnt lgkmcnt(4)
  s_add_u32 m0, s63, 0
  ds_read_b64_tr_b16 v[156:157], v235 offset:32768
  v_mfma_f32_16x16x32_bf16 v[40:43], v[68:71], v[116:119], v[40:43]
  buffer_load_dwordx4 v12, s[16:19], s90 offen offset:0 sc1 lds
  ds_read_b64_tr_b16 v[158:159], v235 offset:34816
  v_mfma_f32_16x16x32_bf16 v[44:47], v[68:71], v[120:123], v[44:47]
  ds_read_b64_tr_b16 v[160:161], v232 offset:49152
  ds_read_b64_tr_b16 v[162:163], v232 offset:51200
  v_mfma_f32_16x16x32_bf16 v[36:39], v[48:51], v[132:135], v[36:39]
  ds_read_b64_tr_b16 v[164:165], v233 offset:49152
  ds_read_b64_tr_b16 v[166:167], v233 offset:51200
  v_mfma_f32_16x16x32_bf16 v[40:43], v[52:55], v[132:135], v[40:43]
  buffer_load_dwordx4 v12, s[16:19], s90 offen offset:1024 sc1 lds
  ds_read_b64_tr_b16 v[168:169], v234 offset:49152
  v_mfma_f32_16x16x32_bf16 v[44:47], v[56:59], v[132:135], v[44:47]
  buffer_load_dwordx4 v12, s[16:19], s90 offen offset:2048 sc1 lds
  ds_read_b64_tr_b16 v[170:171], v234 offset:51200
  v_mfma_f32_16x16x32_bf16 v[40:43], v[72:75], v[112:115], v[40:43]
  buffer_load_dwordx4 v12, s[16:19], s90 offen offset:3072 sc1 lds
  ds_read_b64_tr_b16 v[172:173], v235 offset:49152
  v_mfma_f32_16x16x32_bf16 v[44:47], v[72:75], v[116:119], v[44:47]
  s_add_u32 s90, s90, 0x4000
  ds_read_b64_tr_b16 v[174:175], v235 offset:51200
  v_mfma_f32_16x16x32_bf16 v[40:43], v[48:51], v[136:139], v[40:43]
  s_cmp_eq_u32 s90, 0x38000
  s_cselect_b32 s90, 0, s90
  v_mfma_f32_16x16x32_bf16 v[44:47], v[52:55], v[136:139], v[44:47]
  v_mfma_f32_16x16x32_bf16 v[44:47], v[76:79], v[112:115], v[44:47]
  s_add_u32 m0, s63, 16384
  v_mfma_f32_16x16x32_bf16 v[44:47], v[48:51], v[140:143], v[44:47]
  v_lshlrev_b32 v9, 16, v9
  v_and_b32 v100, 0xffff0000, v81
  v_lshlrev_b32_e64 v101, 16, v81
  v_and_b32 v102, 0xffff0000, v80
  v_lshlrev_b32_e64 v103, 16, v80
  v_pk_fma_f32 v[16:17], v[100:101], v[8:9], v[16:17] op_sel:[0,1,0] op_sel_hi:[1,1,1]
  v_pk_fma_f32 v[18:19], v[102:103], v[8:9], v[18:19] op_sel:[0,1,0] op_sel_hi:[1,1,1]
  v_cvt_pk_bf16_f32 v16, v16, v17
  v_cvt_pk_bf16_f32 v17, v18, v19
  ds_write_b64 v3, v[16:17] offset:0
  v_and_b32 v100, 0xffff0000, v83
  v_lshlrev_b32_e64 v101, 16, v83
  v_and_b32 v102, 0xffff0000, v82
  v_lshlrev_b32_e64 v103, 16, v82
  v_pk_fma_f32 v[20:21], v[100:101], v[8:9], v[20:21] op_sel:[0,1,0] op_sel_hi:[1,1,1]
  v_pk_fma_f32 v[22:23], v[102:103], v[8:9], v[22:23] op_sel:[0,1,0] op_sel_hi:[1,1,1]
  v_cvt_pk_bf16_f32 v20, v20, v21
  buffer_load_dwordx4 v12, s[16:19], s90 offen offset:0 sc1 lds
  v_cvt_pk_bf16_f32 v21, v22, v23
  ds_write_b64 v3, v[20:21] offset:512
  v_and_b32 v100, 0xffff0000, v85
  v_lshlrev_b32_e64 v101, 16, v85
  v_and_b32 v102, 0xffff0000, v84
  v_lshlrev_b32_e64 v103, 16, v84
  v_pk_fma_f32 v[24:25], v[100:101], v[8:9], v[24:25] op_sel:[0,1,0] op_sel_hi:[1,1,1]
  v_pk_fma_f32 v[26:27], v[102:103], v[8:9], v[26:27] op_sel:[0,1,0] op_sel_hi:[1,1,1]
  v_cvt_pk_bf16_f32 v24, v24, v25
  buffer_load_dwordx4 v12, s[16:19], s90 offen offset:1024 sc1 lds
  v_cvt_pk_bf16_f32 v25, v26, v27
  ds_write_b64 v3, v[24:25] offset:1024
  v_and_b32 v100, 0xffff0000, v87
  v_lshlrev_b32_e64 v101, 16, v87
  v_and_b32 v102, 0xffff0000, v86
  v_lshlrev_b32_e64 v103, 16, v86
  v_pk_fma_f32 v[28:29], v[100:101], v[8:9], v[28:29] op_sel:[0,1,0] op_sel_hi:[1,1,1]
  v_pk_fma_f32 v[30:31], v[102:103], v[8:9], v[30:31] op_sel:[0,1,0] op_sel_hi:[1,1,1]
  v_cvt_pk_bf16_f32 v28, v28, v29
  buffer_load_dwordx4 v12, s[16:19], s90 offen offset:2048 sc1 lds
  v_cvt_pk_bf16_f32 v29, v30, v31
  ds_write_b64 v3, v[28:29] offset:1536
  v_and_b32 v100, 0xffff0000, v89
  v_lshlrev_b32_e64 v101, 16, v89
  v_and_b32 v102, 0xffff0000, v88
  v_lshlrev_b32_e64 v103, 16, v88
  v_pk_fma_f32 v[32:33], v[100:101], v[8:9], v[32:33] op_sel:[0,1,0] op_sel_hi:[1,1,1]
  v_pk_fma_f32 v[34:35], v[102:103], v[8:9], v[34:35] op_sel:[0,1,0] op_sel_hi:[1,1,1]
  v_cvt_pk_bf16_f32 v32, v32, v33
  buffer_load_dwordx4 v12, s[16:19], s90 offen offset:3072 sc1 lds
  v_cvt_pk_bf16_f32 v33, v34, v35
  s_add_u32 s90, s90, 0x4000
  ds_write_b64 v3, v[32:33] offset:2048
  v_and_b32 v100, 0xffff0000, v91
  v_lshlrev_b32_e64 v101, 16, v91
  v_and_b32 v102, 0xffff0000, v90
  v_lshlrev_b32_e64 v103, 16, v90
  v_pk_fma_f32 v[36:37], v[100:101], v[8:9], v[36:37] op_sel:[0,1,0] op_sel_hi:[1,1,1]
  v_pk_fma_f32 v[38:39], v[102:103], v[8:9], v[38:39] op_sel:[0,1,0] op_sel_hi:[1,1,1]
  v_cvt_pk_bf16_f32 v36, v36, v37
  s_cmp_eq_u32 s90, 0x38000
  s_cselect_b32 s90, 0, s90
  v_cvt_pk_bf16_f32 v37, v38, v39
  s_waitcnt lgkmcnt(7)
  s_add_u32 m0, s63, 32768
  ds_write_b64 v3, v[36:37] offset:2560
  v_and_b32 v100, 0xffff0000, v93
  v_lshlrev_b32_e64 v101, 16, v93
  v_and_b32 v102, 0xffff0000, v92
  v_lshlrev_b32_e64 v103, 16, v92
  v_pk_fma_f32 v[40:41], v[100:101], v[8:9], v[40:41] op_sel:[0,1,0] op_sel_hi:[1,1,1]
  v_pk_fma_f32 v[42:43], v[102:103], v[8:9], v[42:43] op_sel:[0,1,0] op_sel_hi:[1,1,1]
  v_cvt_pk_bf16_f32 v40, v40, v41
  buffer_load_dwordx4 v12, s[16:19], s90 offen offset:0 sc1 lds
  v_cvt_pk_bf16_f32 v41, v42, v43
  ds_write_b64 v3, v[40:41] offset:3072
  v_and_b32 v100, 0xffff0000, v95
  v_lshlrev_b32_e64 v101, 16, v95
  v_and_b32 v102, 0xffff0000, v94
  v_lshlrev_b32_e64 v103, 16, v94
  v_pk_fma_f32 v[44:45], v[100:101], v[8:9], v[44:45] op_sel:[0,1,0] op_sel_hi:[1,1,1]
  v_pk_fma_f32 v[46:47], v[102:103], v[8:9], v[46:47] op_sel:[0,1,0] op_sel_hi:[1,1,1]
  v_cvt_pk_bf16_f32 v44, v44, v45
  buffer_load_dwordx4 v12, s[16:19], s90 offen offset:1024 sc1 lds
  v_cvt_pk_bf16_f32 v45, v46, v47
  ds_write_b64 v3, v[44:45] offset:3584
  ds_read_b128 v[96:99], v250 offset:0
  ds_read_b128 v[100:103], v250 offset:1024
  ds_read_b128 v[104:107], v250 offset:2048
  buffer_load_dwordx4 v12, s[16:19], s90 offen offset:2048 sc1 lds
  ds_read_b128 v[108:111], v250 offset:3072
  buffer_load_dwordx4 v12, s[16:19], s90 offen offset:3072 sc1 lds
  s_waitcnt vmcnt(8)
  s_barrier
  ds_read_b128 v[112:115], v248 offset:0
  ds_read_b128 v[116:119], v248 offset:1024
  ds_read_b128 v[120:123], v249 offset:2048
  ds_read_b128 v[124:127], v249 offset:3072
  s_waitcnt lgkmcnt(3)
  v_mfma_f32_16x16x32_bf16 v[16:19], a[0:3], v[112:115], 0
  s_branch parallel_sum__ssm_conv_h3__mixer_gmlp__prompt_kernel_ps13
parallel_sum__ssm_conv_h3__mixer_gmlp__prompt_kernel_pg13:
  s_branch parallel_sum__ssm_conv_h3__mixer_gmlp__prompt_kernel_pgback
parallel_sum__ssm_conv_h3__mixer_gmlp__prompt_kernel_ps13:
  s_add_u32 s90, s90, 0x4000
  ds_read_b128 v[128:131], v248 offset:4096
  ds_read_b128 v[132:135], v248 offset:5120
  v_mfma_f32_16x16x32_bf16 v[20:23], a[4:7], v[112:115], 0
  s_cmp_eq_u32 s90, 0x38000
  s_cselect_b32 s90, 0, s90
  ds_read_b128 v[136:139], v249 offset:6144
  v_mfma_f32_16x16x32_bf16 v[24:27], a[8:11], v[112:115], 0
  buffer_store_dwordx4 v[96:99], v208, s[16:19], s86 offen offset:0 sc1
  v_mfma_f32_16x16x32_bf16 v[28:31], a[12:15], v[112:115], 0
  s_waitcnt lgkmcnt(5)
  buffer_store_dwordx4 v[100:103], v208, s[16:19], s86 offen offset:1024 sc1
  v_mfma_f32_16x16x32_bf16 v[32:35], a[0:3], v[116:119], 0
  ds_read_b128 v[140:143], v249 offset:7168
  v_min_u32 v14, 1, v0
  v_mfma_f32_16x16x32_bf16 v[36:39], a[4:7], v[116:119], 0
  v_lshlrev_b32_e64 v14, 30, v14
  v_mfma_f32_16x16x32_bf16 v[40:43], a[8:11], v[116:119], 0
  buffer_store_dwordx4 v[104:107], v208, s[16:19], s86 offen offset:2048 sc1
  v_mfma_f32_16x16x32_bf16 v[44:47], a[12:15], v[116:119], 0
  s_waitcnt lgkmcnt(1)
  v_mfma_f32_16x16x32_bf16 v[48:51], a[0:3], v[120:123], 0
  v_mfma_f32_16x16x32_bf16 v[52:55], a[4:7], v[120:123], 0
  buffer_store_dwordx4 v[108:111], v208, s[16:19], s86 offen offset:3072 sc1
  v_mfma_f32_16x16x32_bf16 v[56:59], a[8:11], v[120:123], 0
  v_mfma_f32_16x16x32_bf16 v[60:63], a[12:15], v[120:123], 0
  s_add_u32 m0, s63, 49152
  v_mfma_f32_16x16x32_bf16 v[64:67], a[0:3], v[124:127], 0
  buffer_load_dwordx4 v12, s[16:19], s90 offen offset:0 sc1 lds
  v_mfma_f32_16x16x32_bf16 v[68:71], a[4:7], v[124:127], 0
  v_mfma_f32_16x16x32_bf16 v[72:75], a[8:11], v[124:127], 0
  v_mfma_f32_16x16x32_bf16 v[76:79], a[12:15], v[124:127], 0
  v_mfma_f32_16x16x32_bf16 v[16:19], a[16:19], v[128:131], v[16:19]
  buffer_load_dwordx4 v12, s[16:19], s90 offen offset:1024 sc1 lds
  v_mfma_f32_16x16x32_bf16 v[20:23], a[20:23], v[128:131], v[20:23]
  s_waitcnt vmcnt(10) lgkmcnt(0)
  s_barrier
  v_mfma_f32_16x16x32_bf16 v[24:27], a[24:27], v[128:131], v[24:27]
  ds_read_b128 v[112:115], v248 offset:16384
  v_mfma_f32_16x16x32_bf16 v[28:31], a[28:31], v[128:131], v[28:31]
  ds_read_b128 v[116:119], v248 offset:17408
  v_mfma_f32_16x16x32_bf16 v[32:35], a[16:19], v[132:135], v[32:35]
  ds_read_b128 v[120:123], v249 offset:18432
  v_mfma_f32_16x16x32_bf16 v[36:39], a[20:23], v[132:135], v[36:39]
  buffer_load_dwordx4 v12, s[16:19], s90 offen offset:2048 sc1 lds
  v_mfma_f32_16x16x32_bf16 v[40:43], a[24:27], v[132:135], v[40:43]
  ds_read_b128 v[124:127], v249 offset:19456
  v_mfma_f32_16x16x32_bf16 v[44:47], a[28:31], v[132:135], v[44:47]
  ds_read_b128 v[128:131], v248 offset:20480
  v_mfma_f32_16x16x32_bf16 v[48:51], a[16:19], v[136:139], v[48:51]
  s_and_b32 s5, s3, 1
  s_lshl_b32 s4, s5, 16
  s_andn2_b32 s6, s96, 127
  v_mfma_f32_16x16x32_bf16 v[52:55], a[20:23], v[136:139], v[52:55]
  buffer_load_dwordx4 v12, s[16:19], s90 offen offset:3072 sc1 lds
  v_mfma_f32_16x16x32_bf16 v[56:59], a[24:27], v[136:139], v[56:59]
  s_add_u32 s90, s90, 0x4000
  s_add_u32 s4, s4, s6
  v_lshrrev_b32_e64 v4, 3, v0
  v_mfma_f32_16x16x32_bf16 v[60:63], a[28:31], v[136:139], v[60:63]
  s_cmp_eq_u32 s90, 0x38000
  s_cselect_b32 s90, 0, s90
  v_lshlrev_b32 v4, 11, v4
  v_mfma_f32_16x16x32_bf16 v[64:67], a[16:19], v[140:143], v[64:67]
  v_add_u32 v4, s4, v4
  v_and_b32 v5, 7, v0
  v_mfma_f32_16x16x32_bf16 v[68:71], a[20:23], v[140:143], v[68:71]
  s_add_u32 m0, s63, 0
  v_and_b32 v6, 1, v2
  v_xor_b32_e64 v6, v5, v6
  v_mfma_f32_16x16x32_bf16 v[72:75], a[24:27], v[140:143], v[72:75]
  buffer_load_dwordx4 v12, s[16:19], s90 offen offset:0 sc1 lds
  v_mfma_f32_16x16x32_bf16 v[76:79], a[28:31], v[140:143], v[76:79]
  s_waitcnt lgkmcnt(0)
  ds_read_b128 v[132:135], v248 offset:21504
  v_xor_b32 v7, 0, v6
  v_mfma_f32_16x16x32_bf16 v[16:19], a[32:35], v[112:115], v[16:19]
  ds_read_b128 v[136:139], v249 offset:22528
  v_lshl_add_u32 v7, v7, 4, v4
  v_mfma_f32_16x16x32_bf16 v[20:23], a[36:39], v[112:115], v[20:23]
  ds_read_b128 v[140:143], v249 offset:23552
  v_add_u32_e64 v88, 0, v7
  v_mfma_f32_16x16x32_bf16 v[24:27], a[40:43], v[112:115], v[24:27]
  buffer_load_dwordx4 v12, s[16:19], s90 offen offset:1024 sc1 lds
  v_mfma_f32_16x16x32_bf16 v[28:31], a[44:47], v[112:115], v[28:31]
  v_xor_b32_e64 v7, 2, v6
  v_lshl_add_u32 v7, v7, 4, v4
  v_mfma_f32_16x16x32_bf16 v[32:35], a[32:35], v[116:119], v[32:35]
  v_add_u32 v89, 16384, v7
  v_xor_b32_e64 v7, 4, v6
  v_mfma_f32_16x16x32_bf16 v[36:39], a[36:39], v[116:119], v[36:39]
  v_lshl_add_u32 v7, v7, 4, v4
  v_add_u32 v90, 32768, v7
  v_mfma_f32_16x16x32_bf16 v[40:43], a[40:43], v[116:119], v[40:43]
  v_xor_b32_e64 v7, 6, v6
  v_lshl_add_u32 v7, v7, 4, v4
  v_mfma_f32_16x16x32_bf16 v[44:47], a[44:47], v[116:119], v[44:47]
  buffer_load_dwordx4 v12, s[16:19], s90 offen offset:2048 sc1 lds
  v_mfma_f32_16x16x32_bf16 v[48:51], a[32:35], v[120:123], v[48:51]
  v_add_u32 v91, 49152, v7
  v_lshrrev_b32_e64 v4, 3, v0
  v_mfma_f32_16x16x32_bf16 v[52:55], a[36:39], v[120:123], v[52:55]
  v_lshlrev_b32_e64 v4, 12, v4
  v_lshl_add_u32 v98, v5, 4, v4
  v_mfma_f32_16x16x32_bf16 v[56:59], a[40:43], v[120:123], v[56:59]
  v_add_u32 v99, 31744, v98
  v_add_u32 v100, 63488, v98
  v_mfma_f32_16x16x32_bf16 v[60:63], a[44:47], v[120:123], v[60:63]
  buffer_load_dwordx4 v12, s[16:19], s90 offen offset:3072 sc1 lds
  v_mfma_f32_16x16x32_bf16 v[64:67], a[32:35], v[124:127], v[64:67]
  s_add_u32 s90, s90, 0x4000
  v_add_u32 v101, 95232, v98
  s_add_u32 s61, s84, 4096
  v_mfma_f32_16x16x32_bf16 v[68:71], a[36:39], v[124:127], v[68:71]
  s_cmp_eq_u32 s90, 0x38000
  s_cselect_b32 s90, 0, s90
  v_add_u32 v84, s61, v208
  v_mfma_f32_16x16x32_bf16 v[72:75], a[40:43], v[124:127], v[72:75]
  s_add_u32 m0, s68, 0
  v_lshrrev_b32 v4, 2, v1
  v_lshlrev_b32_e64 v4, 10, v4
  v_mfma_f32_16x16x32_bf16 v[76:79], a[44:47], v[124:127], v[76:79]
  s_add_u32 s73, s72, 0x10000
  v_add_u32 v4, s61, v4
  v_and_b32 v5, 3, v1
  v_mfma_f32_16x16x32_bf16 v[16:19], a[48:51], v[128:131], v[16:19]
  buffer_load_dwordx4 v244, s[48:51], s72 offen offset:0 lds
  v_mfma_f32_16x16x32_bf16 v[20:23], a[52:55], v[128:131], v[20:23]
  s_waitcnt vmcnt(13) lgkmcnt(0)
  s_barrier
  v_mfma_f32_16x16x32_bf16 v[24:27], a[56:59], v[128:131], v[24:27]
  ds_read_b128 v[112:115], v248 offset:32768
  v_lshl_add_u32 v4, v5, 7, v4
  v_mfma_f32_16x16x32_bf16 v[28:31], a[60:63], v[128:131], v[28:31]
  ds_read_b128 v[116:119], v248 offset:33792
  v_and_b32_e64 v5, 1, v2
  v_mfma_f32_16x16x32_bf16 v[32:35], a[48:51], v[132:135], v[32:35]
  buffer_load_dwordx4 v245, s[48:51], s72 offen offset:1024 lds
  v_mfma_f32_16x16x32_bf16 v[36:39], a[52:55], v[132:135], v[36:39]
  ds_read_b128 v[120:123], v249 offset:34816
  v_lshl_add_u32 v4, v5, 3, v4
  v_mfma_f32_16x16x32_bf16 v[40:43], a[56:59], v[132:135], v[40:43]
  ds_read_b128 v[124:127], v249 offset:35840
  v_lshrrev_b32_e64 v5, 1, v1
  v_mfma_f32_16x16x32_bf16 v[44:47], a[60:63], v[132:135], v[44:47]
  ds_read_b128 v[128:131], v248 offset:36864
  v_lshrrev_b32_e64 v6, 1, v2
  v_mfma_f32_16x16x32_bf16 v[48:51], a[48:51], v[136:139], v[48:51]
  ds_read_b128 v[132:135], v248 offset:37888
  v_xor_b32_e64 v5, v5, v6
  v_mfma_f32_16x16x32_bf16 v[52:55], a[52:55], v[136:139], v[52:55]
  buffer_load_dwordx4 v246, s[48:51], s72 offen offset:2048 lds
  v_mfma_f32_16x16x32_bf16 v[56:59], a[56:59], v[136:139], v[56:59]
  v_lshl_add_u32 v92, v5, 4, v4
  v_xor_b32_e64 v93, 32, v92
  v_mfma_f32_16x16x32_bf16 v[60:63], a[60:63], v[136:139], v[60:63]
  v_xor_b32_e64 v94, 64, v92
  v_xor_b32 v95, 96, v92
  v_mfma_f32_16x16x32_bf16 v[64:67], a[48:51], v[140:143], v[64:67]
  s_and_b32 s4, s3, 2
  ds_read_b128 v[136:139], v249 offset:38912
  s_mul_i32 s4, s4, 8192
  v_mfma_f32_16x16x32_bf16 v[68:71], a[52:55], v[140:143], v[68:71]
  buffer_load_dwordx4 v247, s[48:51], s72 offen offset:3072 lds
  v_mfma_f32_16x16x32_bf16 v[72:75], a[56:59], v[140:143], v[72:75]
  s_lshl_b32 s5, s5, 6
  s_add_u32 s4, s4, s5
  s_add_u32 s4, s4, 65536
  v_mfma_f32_16x16x32_bf16 v[76:79], a[60:63], v[140:143], v[76:79]
  s_waitcnt lgkmcnt(1)
  v_lshlrev_b32_e64 v4, 2, v2
  v_bfe_u32 v6, v0, 2, 2
  v_mfma_f32_16x16x32_bf16 v[16:19], a[64:67], v[112:115], v[16:19]
  s_waitcnt vmcnt(12)
  buffer_store_dword v13, v14, s[16:19], s98 offen sc1
  v_mfma_f32_16x16x32_bf16 v[20:23], a[68:71], v[112:115], v[20:23]
  s_add_u32 m0, s63, 16384
  ds_read_b128 v[140:143], v249 offset:39936
  v_add_u32 v4, v4, v6
  v_mfma_f32_16x16x32_bf16 v[24:27], a[72:75], v[112:115], v[24:27]
  buffer_load_dwordx4 v12, s[16:19], s90 offen offset:0 sc1 lds
  v_mfma_f32_16x16x32_bf16 v[28:31], a[76:79], v[112:115], v[28:31]
  v_lshlrev_b32 v4, 7, v4
  v_and_b32 v5, 3, v0
  v_mfma_f32_16x16x32_bf16 v[32:35], a[64:67], v[116:119], v[32:35]
  v_lshl_add_u32 v4, v5, 4, v4
  v_add_u32_e64 v87, s4, v4
  v_mfma_f32_16x16x32_bf16 v[36:39], a[68:71], v[116:119], v[36:39]
  s_lshl_b32 s4, s3, 13
  s_add_u32 s4, s4, 32768
  v_add_u32 v96, s4, v208
  v_mfma_f32_16x16x32_bf16 v[40:43], a[72:75], v[116:119], v[40:43]
  buffer_load_dwordx4 v12, s[16:19], s90 offen offset:1024 sc1 lds
  v_mfma_f32_16x16x32_bf16 v[44:47], a[76:79], v[116:119], v[44:47]
  v_xor_b32 v97, 8192, v96
  v_mfma_f32_16x16x32_bf16 v[48:51], a[64:67], v[120:123], v[48:51]
  v_mfma_f32_16x16x32_bf16 v[52:55], a[68:71], v[120:123], v[52:55]
  v_mfma_f32_16x16x32_bf16 v[56:59], a[72:75], v[120:123], v[56:59]
  v_mfma_f32_16x16x32_bf16 v[60:63], a[76:79], v[120:123], v[60:63]
  buffer_load_dwordx4 v12, s[16:19], s90 offen offset:2048 sc1 lds
  v_mfma_f32_16x16x32_bf16 v[64:67], a[64:67], v[124:127], v[64:67]
  v_mfma_f32_16x16x32_bf16 v[68:71], a[68:71], v[124:127], v[68:71]
  v_mfma_f32_16x16x32_bf16 v[72:75], a[72:75], v[124:127], v[72:75]
  v_mfma_f32_16x16x32_bf16 v[76:79], a[76:79], v[124:127], v[76:79]
  buffer_load_dwordx4 v12, s[16:19], s90 offen offset:3072 sc1 lds
  v_mfma_f32_16x16x32_bf16 v[16:19], a[80:83], v[128:131], v[16:19]
  s_add_u32 s90, s90, 0x4000
  v_mfma_f32_16x16x32_bf16 v[20:23], a[84:87], v[128:131], v[20:23]
  s_waitcnt vmcnt(13) lgkmcnt(0)
  s_barrier
  s_cmp_eq_u32 s90, 0x38000
  s_cselect_b32 s90, 0, s90
  v_mfma_f32_16x16x32_bf16 v[24:27], a[88:91], v[128:131], v[24:27]
  ds_read_b128 v[112:115], v248 offset:49152
  v_mfma_f32_16x16x32_bf16 v[28:31], a[92:95], v[128:131], v[28:31]
  s_add_u32 m0, s68, 4096
  ds_read_b128 v[116:119], v248 offset:50176
  v_mfma_f32_16x16x32_bf16 v[32:35], a[80:83], v[132:135], v[32:35]
  buffer_load_dwordx4 v244, s[48:51], s73 offen offset:0 lds
  v_mfma_f32_16x16x32_bf16 v[36:39], a[84:87], v[132:135], v[36:39]
  ds_read_b128 v[120:123], v249 offset:51200
  v_mfma_f32_16x16x32_bf16 v[40:43], a[88:91], v[132:135], v[40:43]
  ds_read_b128 v[124:127], v249 offset:52224
  v_mfma_f32_16x16x32_bf16 v[44:47], a[92:95], v[132:135], v[44:47]
  ds_read_b128 v[128:131], v248 offset:53248
  v_mfma_f32_16x16x32_bf16 v[48:51], a[80:83], v[136:139], v[48:51]
  buffer_load_dwordx4 v245, s[48:51], s73 offen offset:1024 lds
  v_mfma_f32_16x16x32_bf16 v[52:55], a[84:87], v[136:139], v[52:55]
  ds_read_b128 v[132:135], v248 offset:54272
  v_mfma_f32_16x16x32_bf16 v[56:59], a[88:91], v[136:139], v[56:59]
  v_mfma_f32_16x16x32_bf16 v[60:63], a[92:95], v[136:139], v[60:63]
  v_mfma_f32_16x16x32_bf16 v[64:67], a[80:83], v[140:143], v[64:67]
  ds_read_b128 v[136:139], v249 offset:55296
  v_mfma_f32_16x16x32_bf16 v[68:71], a[84:87], v[140:143], v[68:71]
  buffer_load_dwordx4 v246, s[48:51], s73 offen offset:2048 lds
  v_mfma_f32_16x16x32_bf16 v[72:75], a[88:91], v[140:143], v[72:75]
  v_mfma_f32_16x16x32_bf16 v[76:79], a[92:95], v[140:143], v[76:79]
  s_waitcnt lgkmcnt(1)
  v_mfma_f32_16x16x32_bf16 v[16:19], a[96:99], v[112:115], v[16:19]
  ds_read_b64_tr_b16 a[64:65], v228 offset:0
  v_mfma_f32_16x16x32_bf16 v[20:23], a[100:103], v[112:115], v[20:23]
  buffer_load_dwordx4 v247, s[48:51], s73 offen offset:3072 lds
  v_mfma_f32_16x16x32_bf16 v[24:27], a[104:107], v[112:115], v[24:27]
  s_add_u32 s72, s72, 0x40000
  ds_read_b64_tr_b16 a[66:67], v228 offset:2048
  v_mfma_f32_16x16x32_bf16 v[28:31], a[108:111], v[112:115], v[28:31]
  s_cmp_eq_u32 s72, 0x380000
  s_cselect_b32 s72, 0, s72
  ds_read_b64_tr_b16 a[68:69], v229 offset:0
  v_mfma_f32_16x16x32_bf16 v[32:35], a[96:99], v[116:119], v[32:35]
  ds_read_b64_tr_b16 a[70:71], v229 offset:2048
  v_mfma_f32_16x16x32_bf16 v[36:39], a[100:103], v[116:119], v[36:39]
  s_add_u32 m0, s63, 32768
  ds_read_b64_tr_b16 a[72:73], v230 offset:0
  v_mfma_f32_16x16x32_bf16 v[40:43], a[104:107], v[116:119], v[40:43]
  buffer_load_dwordx4 v12, s[16:19], s90 offen offset:0 sc1 lds
  v_mfma_f32_16x16x32_bf16 v[44:47], a[108:111], v[116:119], v[44:47]
  ds_read_b64_tr_b16 a[74:75], v230 offset:2048
  v_mfma_f32_16x16x32_bf16 v[48:51], a[96:99], v[120:123], v[48:51]
  ds_read_b128 v[140:143], v249 offset:56320
  v_mfma_f32_16x16x32_bf16 v[52:55], a[100:103], v[120:123], v[52:55]
  ds_read_b64_tr_b16 a[76:77], v231 offset:0
  v_mfma_f32_16x16x32_bf16 v[56:59], a[104:107], v[120:123], v[56:59]
  buffer_load_dwordx4 v12, s[16:19], s90 offen offset:1024 sc1 lds
  v_mfma_f32_16x16x32_bf16 v[60:63], a[108:111], v[120:123], v[60:63]
  ds_read_b64_tr_b16 a[78:79], v231 offset:2048
  v_mfma_f32_16x16x32_bf16 v[64:67], a[96:99], v[124:127], v[64:67]
  ds_read_b64_tr_b16 a[80:81], v228 offset:4096
  v_mfma_f32_16x16x32_bf16 v[68:71], a[100:103], v[124:127], v[68:71]
  ds_read_b64_tr_b16 a[82:83], v228 offset:6144
  v_mfma_f32_16x16x32_bf16 v[72:75], a[104:107], v[124:127], v[72:75]
  ds_read_b64_tr_b16 a[84:85], v229 offset:4096
  v_mfma_f32_16x16x32_bf16 v[76:79], a[108:111], v[124:127], v[76:79]
  buffer_load_dwordx4 v12, s[16:19], s90 offen offset:2048 sc1 lds
  v_mfma_f32_16x16x32_bf16 v[16:19], a[112:115], v[128:131], v[16:19]
  ds_read_b64_tr_b16 a[86:87], v229 offset:6144
  v_mfma_f32_16x16x32_bf16 v[20:23], a[116:119], v[128:131], v[20:23]
  s_waitcnt vmcnt(16) lgkmcnt(4)
  s_barrier
  v_mfma_f32_16x16x32_bf16 v[24:27], a[120:123], v[128:131], v[24:27]
  ds_read_b64_tr_b16 a[88:89], v230 offset:4096
  v_mfma_f32_16x16x32_bf16 v[28:31], a[124:127], v[128:131], v[28:31]
  buffer_load_dwordx4 v12, s[16:19], s90 offen offset:3072 sc1 lds
  v_mfma_f32_16x16x32_bf16 v[32:35], a[112:115], v[132:135], v[32:35]
  s_add_u32 s90, s90, 0x4000
  ds_read_b64_tr_b16 a[90:91], v230 offset:6144
  v_mfma_f32_16x16x32_bf16 v[36:39], a[116:119], v[132:135], v[36:39]
  s_cmp_eq_u32 s90, 0x38000
  s_cselect_b32 s90, 0, s90
  ds_read_b64_tr_b16 a[92:93], v231 offset:4096
  v_mfma_f32_16x16x32_bf16 v[40:43], a[120:123], v[132:135], v[40:43]
  s_add_u32 m0, s68, 8192
  ds_read_b64_tr_b16 a[94:95], v231 offset:6144
  v_mfma_f32_16x16x32_bf16 v[44:47], a[124:127], v[132:135], v[44:47]
  s_add_u32 s73, s72, 0x10000
  ds_read_b128 v[112:115], v248 offset:0
  v_mfma_f32_16x16x32_bf16 v[48:51], a[112:115], v[136:139], v[48:51]
  buffer_load_dwordx4 v244, s[48:51], s72 offen offset:0 lds
  v_mfma_f32_16x16x32_bf16 v[52:55], a[116:119], v[136:139], v[52:55]
  ds_read_b128 v[116:119], v248 offset:1024
  v_mfma_f32_16x16x32_bf16 v[56:59], a[120:123], v[136:139], v[56:59]
  ds_read_b128 v[120:123], v249 offset:2048
  v_mfma_f32_16x16x32_bf16 v[60:63], a[124:127], v[136:139], v[60:63]
  ds_read_b128 v[124:127], v249 offset:3072
  v_mfma_f32_16x16x32_bf16 v[64:67], a[112:115], v[140:143], v[64:67]
  buffer_load_dwordx4 v245, s[48:51], s72 offen offset:1024 lds
  v_mfma_f32_16x16x32_bf16 v[68:71], a[116:119], v[140:143], v[68:71]
  ds_read_b128 v[128:131], v248 offset:4096
  v_mfma_f32_16x16x32_bf16 v[72:75], a[120:123], v[140:143], v[72:75]
  ds_read_b128 v[132:135], v248 offset:5120
  v_mfma_f32_16x16x32_bf16 v[76:79], a[124:127], v[140:143], v[76:79]
  s_waitcnt lgkmcnt(4)
  ds_read_b128 v[136:139], v249 offset:6144
  v_mfma_f32_16x16x32_bf16 v[16:19], a[128:131], v[112:115], v[16:19]
  ds_read_b128 v[140:143], v249 offset:7168
  v_lshrrev_b32 v4, 1, v2
  v_mfma_f32_16x16x32_bf16 v[20:23], a[132:135], v[112:115], v[20:23]
  buffer_load_dwordx4 v246, s[48:51], s72 offen offset:2048 lds
  v_mfma_f32_16x16x32_bf16 v[24:27], a[136:139], v[112:115], v[24:27]
  v_and_b32 v5, 1, v2
  v_lshlrev_b32 v4, 5, v4
  v_mfma_f32_16x16x32_bf16 v[28:31], a[140:143], v[112:115], v[28:31]
  v_lshl_add_u32 v4, v5, 3, v4
  v_add_u32_e64 v4, v4, v209
  v_mfma_f32_16x16x32_bf16 v[32:35], a[128:131], v[116:119], v[32:35]
  v_mfma_f32_16x16x32_bf16 v[36:39], a[132:135], v[116:119], v[36:39]
  buffer_load_dwordx4 v247, s[48:51], s72 offen offset:3072 lds
  v_mfma_f32_16x16x32_bf16 v[40:43], a[136:139], v[116:119], v[40:43]
  v_mfma_f32_16x16x32_bf16 v[44:47], a[140:143], v[116:119], v[44:47]
  s_waitcnt lgkmcnt(0)
  v_mfma_f32_16x16x32_bf16 v[48:51], a[128:131], v[120:123], v[48:51]
  v_mfma_f32_16x16x32_bf16 v[52:55], a[132:135], v[120:123], v[52:55]
  s_add_u32 m0, s63, 49152
  v_mfma_f32_16x16x32_bf16 v[56:59], a[136:139], v[120:123], v[56:59]
  buffer_load_dwordx4 v12, s[16:19], s90 offen offset:0 sc1 lds
  v_mfma_f32_16x16x32_bf16 v[60:63], a[140:143], v[120:123], v[60:63]
  v_mfma_f32_16x16x32_bf16 v[64:67], a[128:131], v[124:127], v[64:67]
  v_mfma_f32_16x16x32_bf16 v[68:71], a[132:135], v[124:127], v[68:71]
  v_mfma_f32_16x16x32_bf16 v[72:75], a[136:139], v[124:127], v[72:75]
  buffer_load_dwordx4 v12, s[16:19], s90 offen offset:1024 sc1 lds
  v_mfma_f32_16x16x32_bf16 v[76:79], a[140:143], v[124:127], v[76:79]
  v_mfma_f32_16x16x32_bf16 v[16:19], a[144:147], v[128:131], v[16:19]
  v_mfma_f32_16x16x32_bf16 v[20:23], a[148:151], v[128:131], v[20:23]
  s_waitcnt vmcnt(14)
  s_barrier
  v_mfma_f32_16x16x32_bf16 v[24:27], a[152:155], v[128:131], v[24:27]
  ds_read_b128 v[112:115], v248 offset:16384
  v_mfma_f32_16x16x32_bf16 v[28:31], a[156:159], v[128:131], v[28:31]
  buffer_load_dwordx4 v12, s[16:19], s90 offen offset:2048 sc1 lds
  v_mfma_f32_16x16x32_bf16 v[32:35], a[144:147], v[132:135], v[32:35]
  ds_read_b128 v[116:119], v248 offset:17408
  v_mfma_f32_16x16x32_bf16 v[36:39], a[148:151], v[132:135], v[36:39]
  ds_read_b128 v[120:123], v249 offset:18432
  v_mfma_f32_16x16x32_bf16 v[40:43], a[152:155], v[132:135], v[40:43]
  ds_read_b128 v[124:127], v249 offset:19456
  v_mfma_f32_16x16x32_bf16 v[44:47], a[156:159], v[132:135], v[44:47]
  buffer_load_dwordx4 v12, s[16:19], s90 offen offset:3072 sc1 lds
  v_mfma_f32_16x16x32_bf16 v[48:51], a[144:147], v[136:139], v[48:51]
  s_add_u32 s90, s90, 0x4000
  ds_read_b128 v[128:131], v248 offset:20480
  v_mfma_f32_16x16x32_bf16 v[52:55], a[148:151], v[136:139], v[52:55]
  s_cmp_eq_u32 s90, 0x38000
  s_cselect_b32 s90, 0, s90
  ds_read_b128 v[132:135], v248 offset:21504
  v_mfma_f32_16x16x32_bf16 v[56:59], a[152:155], v[136:139], v[56:59]
  v_mfma_f32_16x16x32_bf16 v[60:63], a[156:159], v[136:139], v[60:63]
  s_add_u32 m0, s68, 12288
  v_mfma_f32_16x16x32_bf16 v[64:67], a[144:147], v[140:143], v[64:67]
  buffer_load_dwordx4 v244, s[48:51], s73 offen offset:0 lds
  v_mfma_f32_16x16x32_bf16 v[68:71], a[148:151], v[140:143], v[68:71]
  ds_read_b128 v[136:139], v249 offset:22528
  v_mfma_f32_16x16x32_bf16 v[72:75], a[152:155], v[140:143], v[72:75]
  v_mfma_f32_16x16x32_bf16 v[76:79], a[156:159], v[140:143], v[76:79]
  s_waitcnt lgkmcnt(1)
  v_mfma_f32_16x16x32_bf16 v[16:19], a[160:163], v[112:115], v[16:19]
  buffer_load_dwordx4 v245, s[48:51], s73 offen offset:1024 lds
  v_mfma_f32_16x16x32_bf16 v[20:23], a[164:167], v[112:115], v[20:23]
  ds_read_b128 v[140:143], v249 offset:23552
  v_mfma_f32_16x16x32_bf16 v[24:27], a[168:171], v[112:115], v[24:27]
  v_mfma_f32_16x16x32_bf16 v[28:31], a[172:175], v[112:115], v[28:31]
  v_mfma_f32_16x16x32_bf16 v[32:35], a[160:163], v[116:119], v[32:35]
  v_mfma_f32_16x16x32_bf16 v[36:39], a[164:167], v[116:119], v[36:39]
  buffer_load_dwordx4 v246, s[48:51], s73 offen offset:2048 lds
  v_mfma_f32_16x16x32_bf16 v[40:43], a[168:171], v[116:119], v[40:43]
  v_mfma_f32_16x16x32_bf16 v[44:47], a[172:175], v[116:119], v[44:47]
  v_mfma_f32_16x16x32_bf16 v[48:51], a[160:163], v[120:123], v[48:51]
  v_mfma_f32_16x16x32_bf16 v[52:55], a[164:167], v[120:123], v[52:55]
  buffer_load_dwordx4 v247, s[48:51], s73 offen offset:3072 lds
  v_mfma_f32_16x16x32_bf16 v[56:59], a[168:171], v[120:123], v[56:59]
  s_add_u32 s72, s72, 0x40000
  v_mfma_f32_16x16x32_bf16 v[60:63], a[172:175], v[120:123], v[60:63]
  s_cmp_eq_u32 s72, 0x380000
  s_cselect_b32 s72, 0, s72
  v_mfma_f32_16x16x32_bf16 v[64:67], a[160:163], v[124:127], v[64:67]
  v_mfma_f32_16x16x32_bf16 v[68:71], a[164:167], v[124:127], v[68:71]
  s_add_u32 m0, s63, 0
  v_mfma_f32_16x16x32_bf16 v[72:75], a[168:171], v[124:127], v[72:75]
  buffer_load_dwordx4 v12, s[16:19], s90 offen offset:0 sc1 lds
  v_mfma_f32_16x16x32_bf16 v[76:79], a[172:175], v[124:127], v[76:79]
  v_mfma_f32_16x16x32_bf16 v[16:19], a[176:179], v[128:131], v[16:19]
  v_mfma_f32_16x16x32_bf16 v[20:23], a[180:183], v[128:131], v[20:23]
  s_waitcnt vmcnt(13) lgkmcnt(0)
  s_barrier
  v_mfma_f32_16x16x32_bf16 v[24:27], a[184:187], v[128:131], v[24:27]
  buffer_load_dwordx4 v12, s[16:19], s90 offen offset:1024 sc1 lds
  v_mfma_f32_16x16x32_bf16 v[28:31], a[188:191], v[128:131], v[28:31]
  ds_read_b128 v[112:115], v248 offset:32768
  v_mfma_f32_16x16x32_bf16 v[32:35], a[176:179], v[132:135], v[32:35]
  ds_read_b128 v[116:119], v248 offset:33792
  v_mfma_f32_16x16x32_bf16 v[36:39], a[180:183], v[132:135], v[36:39]
  ds_read_b128 v[120:123], v249 offset:34816
  v_mfma_f32_16x16x32_bf16 v[40:43], a[184:187], v[132:135], v[40:43]
  ds_read_b128 v[124:127], v249 offset:35840
  v_mfma_f32_16x16x32_bf16 v[44:47], a[188:191], v[132:135], v[44:47]
  buffer_load_dwordx4 v12, s[16:19], s90 offen offset:2048 sc1 lds
  v_mfma_f32_16x16x32_bf16 v[48:51], a[176:179], v[136:139], v[48:51]
  ds_read_b128 v[128:131], v248 offset:36864
  v_mfma_f32_16x16x32_bf16 v[52:55], a[180:183], v[136:139], v[52:55]
  ds_read_b128 v[132:135], v248 offset:37888
  v_mfma_f32_16x16x32_bf16 v[56:59], a[184:187], v[136:139], v[56:59]
  v_mfma_f32_16x16x32_bf16 v[60:63], a[188:191], v[136:139], v[60:63]
  buffer_load_dwordx4 v12, s[16:19], s90 offen offset:3072 sc1 lds
  v_mfma_f32_16x16x32_bf16 v[64:67], a[176:179], v[140:143], v[64:67]
  s_add_u32 s90, s90, 0x4000
  ds_read_b128 v[136:139], v249 offset:38912
  v_mfma_f32_16x16x32_bf16 v[68:71], a[180:183], v[140:143], v[68:71]
  s_cmp_eq_u32 s90, 0x38000
  s_cselect_b32 s90, 0, s90
  v_mfma_f32_16x16x32_bf16 v[72:75], a[184:187], v[140:143], v[72:75]
  v_mfma_f32_16x16x32_bf16 v[76:79], a[188:191], v[140:143], v[76:79]
  s_waitcnt lgkmcnt(1)
  s_add_u32 m0, s61, 0
  v_mfma_f32_16x16x32_bf16 v[16:19], a[192:195], v[112:115], v[16:19]
  buffer_load_dwordx4 v88, s[8:11], s87 offen nt lds
  v_mfma_f32_16x16x32_bf16 v[20:23], a[196:199], v[112:115], v[20:23]
  s_add_u32 m0, s61, 1024
  ds_read_b64_tr_b16 a[96:97], v240 offset:0
  v_mfma_f32_16x16x32_bf16 v[24:27], a[200:203], v[112:115], v[24:27]
  ds_read_b64_tr_b16 a[98:99], v240 offset:2048
  v_mfma_f32_16x16x32_bf16 v[28:31], a[204:207], v[112:115], v[28:31]
  ds_read_b64_tr_b16 a[100:101], v241 offset:0
  v_mfma_f32_16x16x32_bf16 v[32:35], a[192:195], v[116:119], v[32:35]
  buffer_load_dwordx4 v89, s[8:11], s87 offen nt lds
  v_mfma_f32_16x16x32_bf16 v[36:39], a[196:199], v[116:119], v[36:39]
  s_add_u32 m0, s61, 2048
  ds_read_b64_tr_b16 a[102:103], v241 offset:2048
  v_mfma_f32_16x16x32_bf16 v[40:43], a[200:203], v[116:119], v[40:43]
  ds_read_b64_tr_b16 a[104:105], v242 offset:0
  v_mfma_f32_16x16x32_bf16 v[44:47], a[204:207], v[116:119], v[44:47]
  ds_read_b64_tr_b16 a[106:107], v242 offset:2048
  v_mfma_f32_16x16x32_bf16 v[48:51], a[192:195], v[120:123], v[48:51]
  ds_read_b128 v[140:143], v249 offset:39936
  v_mfma_f32_16x16x32_bf16 v[52:55], a[196:199], v[120:123], v[52:55]
  buffer_load_dwordx4 v90, s[8:11], s87 offen nt lds
  v_mfma_f32_16x16x32_bf16 v[56:59], a[200:203], v[120:123], v[56:59]
  s_add_u32 m0, s61, 3072
  ds_read_b64_tr_b16 a[108:109], v243 offset:0
  v_mfma_f32_16x16x32_bf16 v[60:63], a[204:207], v[120:123], v[60:63]
  ds_read_b64_tr_b16 a[110:111], v243 offset:2048
  v_mfma_f32_16x16x32_bf16 v[64:67], a[192:195], v[124:127], v[64:67]
  ds_read_b64_tr_b16 a[112:113], v240 offset:4096
  v_mfma_f32_16x16x32_bf16 v[68:71], a[196:199], v[124:127], v[68:71]
  buffer_load_dwordx4 v91, s[8:11], s87 offen nt lds
  v_mfma_f32_16x16x32_bf16 v[72:75], a[200:203], v[124:127], v[72:75]
  ds_read_b64_tr_b16 a[114:115], v240 offset:6144
  v_mfma_f32_16x16x32_bf16 v[76:79], a[204:207], v[124:127], v[76:79]
  ds_read_b64_tr_b16 a[116:117], v241 offset:4096
  v_mfma_f32_16x16x32_bf16 v[16:19], a[208:211], v[128:131], v[16:19]
  ds_read_b64_tr_b16 a[118:119], v241 offset:6144
  v_mfma_f32_16x16x32_bf16 v[20:23], a[212:215], v[128:131], v[20:23]
  s_waitcnt vmcnt(12) lgkmcnt(4)
  s_barrier
  ds_read_b64_tr_b16 a[120:121], v242 offset:4096
  v_mfma_f32_16x16x32_bf16 v[24:27], a[216:219], v[128:131], v[24:27]
  s_add_u32 m0, s63, 16384
  ds_read_b64_tr_b16 a[122:123], v242 offset:6144
  buffer_load_dword v80, v4, s[16:19], s60 offen sc1
  v_mfma_f32_16x16x32_bf16 v[28:31], a[220:223], v[128:131], v[28:31]
  buffer_load_dwordx4 v12, s[16:19], s90 offen offset:0 sc1 lds
  v_mfma_f32_16x16x32_bf16 v[32:35], a[208:211], v[132:135], v[32:35]
  ds_read_b64_tr_b16 a[124:125], v243 offset:4096
  v_mfma_f32_16x16x32_bf16 v[36:39], a[212:215], v[132:135], v[36:39]
  ds_read_b64_tr_b16 a[126:127], v243 offset:6144
  v_mfma_f32_16x16x32_bf16 v[40:43], a[216:219], v[132:135], v[40:43]
  buffer_load_dwordx4 v12, s[16:19], s90 offen offset:1024 sc1 lds
  v_mfma_f32_16x16x32_bf16 v[44:47], a[220:223], v[132:135], v[44:47]
  ds_read_b128 v[112:115], v248 offset:49152
  v_mfma_f32_16x16x32_bf16 v[48:51], a[208:211], v[136:139], v[48:51]
  ds_read_b128 v[116:119], v248 offset:50176
  v_mfma_f32_16x16x32_bf16 v[52:55], a[212:215], v[136:139], v[52:55]
  ds_read_b128 v[120:123], v249 offset:51200
  v_mfma_f32_16x16x32_bf16 v[56:59], a[216:219], v[136:139], v[56:59]
  ds_read_b128 v[124:127], v249 offset:52224
  v_mfma_f32_16x16x32_bf16 v[60:63], a[220:223], v[136:139], v[60:63]
  buffer_load_dwordx4 v12, s[16:19], s90 offen offset:2048 sc1 lds
  v_mfma_f32_16x16x32_bf16 v[64:67], a[208:211], v[140:143], v[64:67]
  ds_read_b128 v[128:131], v248 offset:53248
  v_mfma_f32_16x16x32_bf16 v[68:71], a[212:215], v[140:143], v[68:71]
  ds_read_b128 v[132:135], v248 offset:54272
  v_mfma_f32_16x16x32_bf16 v[72:75], a[216:219], v[140:143], v[72:75]
  ds_read_b128 v[136:139], v249 offset:55296
  v_mfma_f32_16x16x32_bf16 v[76:79], a[220:223], v[140:143], v[76:79]
  s_waitcnt lgkmcnt(4)
  buffer_load_dwordx4 v12, s[16:19], s90 offen offset:3072 sc1 lds
  v_mfma_f32_16x16x32_bf16 v[16:19], a[224:227], v[112:115], v[16:19]
  s_add_u32 s90, s90, 0x4000
  ds_read_b128 v[140:143], v249 offset:56320
  v_mfma_f32_16x16x32_bf16 v[20:23], a[228:231], v[112:115], v[20:23]
  s_cmp_eq_u32 s90, 0x38000
  s_cselect_b32 s90, 0, s90
  v_mfma_f32_16x16x32_bf16 v[24:27], a[232:235], v[112:115], v[24:27]
  s_add_u32 m0, s68, 0
  v_mfma_f32_16x16x32_bf16 v[28:31], a[236:239], v[112:115], v[28:31]
  s_add_u32 s73, s72, 0x10000
  v_mfma_f32_16x16x32_bf16 v[32:35], a[224:227], v[116:119], v[32:35]
  buffer_load_dwordx4 v244, s[48:51], s72 offen offset:0 lds
  v_mfma_f32_16x16x32_bf16 v[36:39], a[228:231], v[116:119], v[36:39]
  v_mfma_f32_16x16x32_bf16 v[40:43], a[232:235], v[116:119], v[40:43]
  v_mfma_f32_16x16x32_bf16 v[44:47], a[236:239], v[116:119], v[44:47]
  v_mfma_f32_16x16x32_bf16 v[48:51], a[224:227], v[120:123], v[48:51]
  buffer_load_dwordx4 v245, s[48:51], s72 offen offset:1024 lds
  v_mfma_f32_16x16x32_bf16 v[52:55], a[228:231], v[120:123], v[52:55]
  v_mfma_f32_16x16x32_bf16 v[56:59], a[232:235], v[120:123], v[56:59]
  v_mfma_f32_16x16x32_bf16 v[60:63], a[236:239], v[120:123], v[60:63]
  s_waitcnt lgkmcnt(0)
  v_mfma_f32_16x16x32_bf16 v[64:67], a[224:227], v[124:127], v[64:67]
  v_mfma_f32_16x16x32_bf16 v[68:71], a[228:231], v[124:127], v[68:71]
  buffer_load_dwordx4 v246, s[48:51], s72 offen offset:2048 lds
  v_mfma_f32_16x16x32_bf16 v[72:75], a[232:235], v[124:127], v[72:75]
  v_mfma_f32_16x16x32_bf16 v[76:79], a[236:239], v[124:127], v[76:79]
  v_mfma_f32_16x16x32_bf16 v[16:19], a[240:243], v[128:131], v[16:19]
  v_mfma_f32_16x16x32_bf16 v[20:23], a[244:247], v[128:131], v[20:23]
  s_waitcnt vmcnt(12)
  s_barrier
  ds_read_b128 v[112:115], v248 offset:0
  v_mfma_f32_16x16x32_bf16 v[24:27], a[248:251], v[128:131], v[24:27]
  buffer_load_dwordx4 v247, s[48:51], s72 offen offset:3072 lds
  v_mfma_f32_16x16x32_bf16 v[28:31], a[252:255], v[128:131], v[28:31]
  ds_read_b128 v[116:119], v248 offset:1024
  v_mfma_f32_16x16x32_bf16 v[32:35], a[240:243], v[132:135], v[32:35]
  ds_read_b128 v[120:123], v249 offset:2048
  v_mfma_f32_16x16x32_bf16 v[36:39], a[244:247], v[132:135], v[36:39]
  s_add_u32 m0, s63, 32768
  ds_read_b128 v[124:127], v249 offset:3072
  v_mfma_f32_16x16x32_bf16 v[40:43], a[248:251], v[132:135], v[40:43]
  s_branch parallel_sum__ssm_conv_h3__mixer_gmlp__prompt_kernel_ps14
parallel_sum__ssm_conv_h3__mixer_gmlp__prompt_kernel_pg14:
  s_branch parallel_sum__ssm_conv_h3__mixer_gmlp__prompt_kernel_pgback
parallel_sum__ssm_conv_h3__mixer_gmlp__prompt_kernel_ps14:
  buffer_load_dwordx4 v12, s[16:19], s90 offen offset:0 sc1 lds
  v_mfma_f32_16x16x32_bf16 v[44:47], a[252:255], v[132:135], v[44:47]
  ds_read_b128 v[128:131], v248 offset:4096
  v_mfma_f32_16x16x32_bf16 v[48:51], a[240:243], v[136:139], v[48:51]
  ds_read_b128 v[132:135], v248 offset:5120
  v_mfma_f32_16x16x32_bf16 v[52:55], a[244:247], v[136:139], v[52:55]
  v_mfma_f32_16x16x32_bf16 v[56:59], a[248:251], v[136:139], v[56:59]
  buffer_load_dwordx4 v12, s[16:19], s90 offen offset:1024 sc1 lds
  v_mfma_f32_16x16x32_bf16 v[60:63], a[252:255], v[136:139], v[60:63]
  v_mfma_f32_16x16x32_bf16 v[64:67], a[240:243], v[140:143], v[64:67]
  ds_read_b128 v[136:139], v249 offset:6144
  v_mfma_f32_16x16x32_bf16 v[68:71], a[244:247], v[140:143], v[68:71]
  v_mfma_f32_16x16x32_bf16 v[72:75], a[248:251], v[140:143], v[72:75]
  v_mfma_f32_16x16x32_bf16 v[76:79], a[252:255], v[140:143], v[76:79]
  s_waitcnt lgkmcnt(1)
  buffer_load_dwordx4 v12, s[16:19], s90 offen offset:2048 sc1 lds
  v_mfma_f32_16x16x32_bf16 v[16:19], v[176:179], v[112:115], v[16:19]
  ds_read_b64_tr_b16 a[128:129], v240 offset:8192
  v_mfma_f32_16x16x32_bf16 v[20:23], v[180:183], v[112:115], v[20:23]
  ds_read_b64_tr_b16 a[130:131], v240 offset:10240
  v_mfma_f32_16x16x32_bf16 v[24:27], v[184:187], v[112:115], v[24:27]
  ds_read_b64_tr_b16 a[132:133], v241 offset:8192
  v_mfma_f32_16x16x32_bf16 v[28:31], v[188:191], v[112:115], v[28:31]
  buffer_load_dwordx4 v12, s[16:19], s90 offen offset:3072 sc1 lds
  v_mfma_f32_16x16x32_bf16 v[32:35], v[176:179], v[116:119], v[32:35]
  s_add_u32 s90, s90, 0x4000
  ds_read_b64_tr_b16 a[134:135], v241 offset:10240
  v_mfma_f32_16x16x32_bf16 v[36:39], v[180:183], v[116:119], v[36:39]
  s_cmp_eq_u32 s90, 0x38000
  s_cselect_b32 s90, 0, s90
  ds_read_b64_tr_b16 a[136:137], v242 offset:8192
  v_mfma_f32_16x16x32_bf16 v[40:43], v[184:187], v[116:119], v[40:43]
  ds_read_b64_tr_b16 a[138:139], v242 offset:10240
  v_mfma_f32_16x16x32_bf16 v[44:47], v[188:191], v[116:119], v[44:47]
  s_add_u32 m0, s68, 4096
  ds_read_b128 v[140:143], v249 offset:7168
  v_mfma_f32_16x16x32_bf16 v[48:51], v[176:179], v[120:123], v[48:51]
  buffer_load_dwordx4 v244, s[48:51], s73 offen offset:0 lds
  v_mfma_f32_16x16x32_bf16 v[52:55], v[180:183], v[120:123], v[52:55]
  ds_read_b64_tr_b16 a[140:141], v243 offset:8192
  v_mfma_f32_16x16x32_bf16 v[56:59], v[184:187], v[120:123], v[56:59]
  ds_read_b64_tr_b16 a[142:143], v243 offset:10240
  v_mfma_f32_16x16x32_bf16 v[60:63], v[188:191], v[120:123], v[60:63]
  ds_read_b64_tr_b16 a[144:145], v240 offset:12288
  v_mfma_f32_16x16x32_bf16 v[64:67], v[176:179], v[124:127], v[64:67]
  buffer_load_dwordx4 v245, s[48:51], s73 offen offset:1024 lds
  v_mfma_f32_16x16x32_bf16 v[68:71], v[180:183], v[124:127], v[68:71]
  ds_read_b64_tr_b16 a[146:147], v240 offset:14336
  v_mfma_f32_16x16x32_bf16 v[72:75], v[184:187], v[124:127], v[72:75]
  ds_read_b64_tr_b16 a[148:149], v241 offset:12288
  v_mfma_f32_16x16x32_bf16 v[76:79], v[188:191], v[124:127], v[76:79]
  ds_read_b64_tr_b16 a[150:151], v241 offset:14336
  v_mfma_f32_16x16x32_bf16 v[16:19], v[192:195], v[128:131], v[16:19]
  ds_read_b64_tr_b16 a[152:153], v242 offset:12288
  v_mfma_f32_16x16x32_bf16 v[20:23], v[196:199], v[128:131], v[20:23]
  s_waitcnt vmcnt(10) lgkmcnt(4)
  s_barrier
  ds_read_b64_tr_b16 a[154:155], v242 offset:14336
  v_mfma_f32_16x16x32_bf16 v[24:27], v[200:203], v[128:131], v[24:27]
  buffer_load_dwordx4 v246, s[48:51], s73 offen offset:2048 lds
  v_mfma_f32_16x16x32_bf16 v[28:31], v[204:207], v[128:131], v[28:31]
  ds_read_b64_tr_b16 a[156:157], v243 offset:12288
  v_mfma_f32_16x16x32_bf16 v[32:35], v[192:195], v[132:135], v[32:35]
  ds_read_b64_tr_b16 a[158:159], v243 offset:14336
  v_mfma_f32_16x16x32_bf16 v[36:39], v[196:199], v[132:135], v[36:39]
  buffer_load_dwordx4 v247, s[48:51], s73 offen offset:3072 lds
  v_mfma_f32_16x16x32_bf16 v[40:43], v[200:203], v[132:135], v[40:43]
  s_add_u32 s72, s72, 0x40000
  ds_read_b128 v[112:115], v248 offset:16384
  v_mfma_f32_16x16x32_bf16 v[44:47], v[204:207], v[132:135], v[44:47]
  s_cmp_eq_u32 s72, 0x380000
  s_cselect_b32 s72, 0, s72
  ds_read_b128 v[116:119], v248 offset:17408
  v_mfma_f32_16x16x32_bf16 v[48:51], v[192:195], v[136:139], v[48:51]
  ds_read_b128 v[120:123], v249 offset:18432
  v_mfma_f32_16x16x32_bf16 v[52:55], v[196:199], v[136:139], v[52:55]
  s_add_u32 m0, s63, 49152
  ds_read_b128 v[124:127], v249 offset:19456
  v_mfma_f32_16x16x32_bf16 v[56:59], v[200:203], v[136:139], v[56:59]
  buffer_load_dwordx4 v12, s[16:19], s90 offen offset:0 sc1 lds
  v_mfma_f32_16x16x32_bf16 v[60:63], v[204:207], v[136:139], v[60:63]
  ds_read_b128 v[128:131], v248 offset:20480
  v_mfma_f32_16x16x32_bf16 v[64:67], v[192:195], v[140:143], v[64:67]
  ds_read_b128 v[132:135], v248 offset:21504
  v_mfma_f32_16x16x32_bf16 v[68:71], v[196:199], v[140:143], v[68:71]
  ds_read_b128 v[136:139], v249 offset:22528
  v_mfma_f32_16x16x32_bf16 v[72:75], v[200:203], v[140:143], v[72:75]
  buffer_load_dwordx4 v12, s[16:19], s90 offen offset:1024 sc1 lds
  v_mfma_f32_16x16x32_bf16 v[76:79], v[204:207], v[140:143], v[76:79]
  s_waitcnt lgkmcnt(3)
  v_and_b32 v254, 31, v0
  v_lshlrev_b32 v254, 4, v254
  buffer_load_dword v255, v254, s[16:19], s99 offen sc1
  v_mfma_f32_16x16x32_bf16 v[16:19], v[144:147], v[112:115], v[16:19]
  ds_read_b128 v[140:143], v249 offset:23552
  v_mfma_f32_16x16x32_bf16 v[20:23], v[148:151], v[112:115], v[20:23]
  v_mfma_f32_16x16x32_bf16 v[24:27], v[152:155], v[112:115], v[24:27]
  v_mfma_f32_16x16x32_bf16 v[28:31], v[156:159], v[112:115], v[28:31]
  buffer_load_dwordx4 v12, s[16:19], s90 offen offset:2048 sc1 lds
  v_mfma_f32_16x16x32_bf16 v[32:35], v[144:147], v[116:119], v[32:35]
  v_mov_b32 v82, v80
  s_nop 1
  v_permlane32_swap_b32_e64 v80, v82
  v_mfma_f32_16x16x32_bf16 v[36:39], v[148:151], v[116:119], v[36:39]
  v_mov_b32 v81, v80
  v_mov_b32 v83, v82
  v_mfma_f32_16x16x32_bf16 v[40:43], v[152:155], v[116:119], v[40:43]
  v_permlane16_swap_b32 v80, v81
  v_permlane16_swap_b32 v82, v83
  v_mfma_f32_16x16x32_bf16 v[44:47], v[156:159], v[116:119], v[44:47]
  buffer_load_dwordx4 v12, s[16:19], s90 offen offset:3072 sc1 lds
  ds_read_b64 v[224:225], v92 offset:0
  v_mfma_f32_16x16x32_bf16 v[48:51], v[144:147], v[120:123], v[48:51]
  s_add_u32 s90, s90, 0x4000
  ds_read_b64 v[226:227], v93 offset:0
  v_mfma_f32_16x16x32_bf16 v[52:55], v[148:151], v[120:123], v[52:55]
  s_cmp_eq_u32 s90, 0x38000
  s_cselect_b32 s90, 0, s90
  ds_read_b64 v[228:229], v94 offset:0
  v_mfma_f32_16x16x32_bf16 v[56:59], v[152:155], v[120:123], v[56:59]
  ds_read_b64 v[230:231], v95 offset:0
  v_mfma_f32_16x16x32_bf16 v[60:63], v[156:159], v[120:123], v[60:63]
  s_add_u32 m0, s63, 0
  ds_read_b64 v[232:233], v92 offset:512
  v_mfma_f32_16x16x32_bf16 v[64:67], v[144:147], v[124:127], v[64:67]
  buffer_load_dwordx4 v12, s[16:19], s90 offen offset:0 sc1 lds
  v_mfma_f32_16x16x32_bf16 v[68:71], v[148:151], v[124:127], v[68:71]
  ds_read_b64 v[234:235], v93 offset:512
  v_mfma_f32_16x16x32_bf16 v[72:75], v[152:155], v[124:127], v[72:75]
  ds_read_b64 v[236:237], v94 offset:512
  v_mfma_f32_16x16x32_bf16 v[76:79], v[156:159], v[124:127], v[76:79]
  s_waitcnt lgkmcnt(4)
  ds_read_b64 v[238:239], v95 offset:512
  v_mul_f32 v80, v80, v81
  v_mfma_f32_16x16x32_bf16 v[16:19], v[160:163], v[128:131], v[16:19]
  buffer_load_dwordx4 v12, s[16:19], s90 offen offset:1024 sc1 lds
  v_mfma_f32_16x16x32_bf16 v[20:23], v[164:167], v[128:131], v[20:23]
  s_waitcnt vmcnt(11)
  s_barrier
  v_mul_f32_e64 v82, v82, v83
  v_mfma_f32_16x16x32_bf16 v[24:27], v[168:171], v[128:131], v[24:27]
  v_lshlrev_b32_e64 v176, 16, v224
  v_and_b32 v177, 0xffff0000, v224
  v_mfma_f32_16x16x32_bf16 v[28:31], v[172:175], v[128:131], v[28:31]
  v_lshlrev_b32_e64 v178, 16, v225
  v_and_b32 v179, 0xffff0000, v225
  v_mfma_f32_16x16x32_bf16 v[32:35], v[160:163], v[132:135], v[32:35]
  v_fma_f32 v210, v176, v81, -v80
  v_fma_f32 v211, v177, v81, -v80
  v_mfma_f32_16x16x32_bf16 v[36:39], v[164:167], v[132:135], v[36:39]
  buffer_load_dwordx4 v12, s[16:19], s90 offen offset:2048 sc1 lds
  v_mfma_f32_16x16x32_bf16 v[40:43], v[168:171], v[132:135], v[40:43]
  ds_read_b128 v[112:115], v248 offset:32768
  v_fma_f32 v212, v178, v81, -v80
  v_mfma_f32_16x16x32_bf16 v[44:47], v[172:175], v[132:135], v[44:47]
  v_fma_f32 v213, v179, v81, -v80
  v_lshlrev_b32_e64 v180, 16, v226
  v_mfma_f32_16x16x32_bf16 v[48:51], v[160:163], v[136:139], v[48:51]
  v_and_b32 v181, 0xffff0000, v226
  v_lshlrev_b32_e64 v182, 16, v227
  v_mfma_f32_16x16x32_bf16 v[52:55], v[164:167], v[136:139], v[52:55]
  buffer_load_dwordx4 v12, s[16:19], s90 offen offset:3072 sc1 lds
  v_mfma_f32_16x16x32_bf16 v[56:59], v[168:171], v[136:139], v[56:59]
  s_add_u32 s90, s90, 0x4000
  ds_read_b128 v[116:119], v248 offset:33792
  v_and_b32 v183, 0xffff0000, v227
  v_mfma_f32_16x16x32_bf16 v[60:63], v[172:175], v[136:139], v[60:63]
  s_cmp_eq_u32 s90, 0x38000
  s_cselect_b32 s90, 0, s90
  v_fma_f32 v214, v180, v81, -v80
  v_mfma_f32_16x16x32_bf16 v[64:67], v[160:163], v[140:143], v[64:67]
  v_fma_f32 v215, v181, v81, -v80
  v_fma_f32 v216, v182, v81, -v80
  v_mfma_f32_16x16x32_bf16 v[68:71], v[164:167], v[140:143], v[68:71]
  s_add_u32 m0, s63, 16384
  ds_read_b128 v[120:123], v249 offset:34816
  v_fma_f32 v217, v183, v81, -v80
  v_mfma_f32_16x16x32_bf16 v[72:75], v[168:171], v[140:143], v[72:75]
  buffer_load_dwordx4 v12, s[16:19], s90 offen offset:0 sc1 lds
  v_mfma_f32_16x16x32_bf16 v[76:79], v[172:175], v[140:143], v[76:79]
  s_waitcnt lgkmcnt(2)
  v_lshlrev_b32_e64 v184, 16, v228
  v_and_b32 v185, 0xffff0000, v228
  v_mfma_f32_16x16x32_bf16 v[16:19], a[64:67], v[112:115], v[16:19]
  v_lshlrev_b32_e64 v186, 16, v229
  v_and_b32 v187, 0xffff0000, v229
  v_mfma_f32_16x16x32_bf16 v[20:23], a[68:71], v[112:115], v[20:23]
  ds_read_b128 v[124:127], v249 offset:35840
  v_fma_f32 v218, v184, v81, -v80
  v_mfma_f32_16x16x32_bf16 v[24:27], a[72:75], v[112:115], v[24:27]
  buffer_load_dwordx4 v12, s[16:19], s90 offen offset:1024 sc1 lds
  v_mfma_f32_16x16x32_bf16 v[28:31], a[76:79], v[112:115], v[28:31]
  s_waitcnt lgkmcnt(1)
  v_fma_f32 v219, v185, v81, -v80
  v_fma_f32 v220, v186, v81, -v80
  v_mfma_f32_16x16x32_bf16 v[32:35], a[64:67], v[116:119], v[32:35]
  ds_read_b128 v[128:131], v248 offset:36864
  v_fma_f32 v221, v187, v81, -v80
  v_mfma_f32_16x16x32_bf16 v[36:39], a[68:71], v[116:119], v[36:39]
  ds_read_b128 v[132:135], v248 offset:37888
  v_lshlrev_b32 v188, 16, v230
  v_mfma_f32_16x16x32_bf16 v[40:43], a[72:75], v[116:119], v[40:43]
  ds_read_b128 v[136:139], v249 offset:38912
  v_and_b32 v189, 0xffff0000, v230
  v_mfma_f32_16x16x32_bf16 v[44:47], a[76:79], v[116:119], v[44:47]
  buffer_load_dwordx4 v12, s[16:19], s90 offen offset:2048 sc1 lds
  v_mfma_f32_16x16x32_bf16 v[48:51], a[64:67], v[120:123], v[48:51]
  ds_read_b128 v[140:143], v249 offset:39936
  v_lshlrev_b32_e64 v190, 16, v231
  v_mfma_f32_16x16x32_bf16 v[52:55], a[68:71], v[120:123], v[52:55]
  v_and_b32 v191, 0xffff0000, v231
  v_fma_f32 v222, v188, v81, -v80
  v_mfma_f32_16x16x32_bf16 v[56:59], a[72:75], v[120:123], v[56:59]
  v_fma_f32 v223, v189, v81, -v80
  v_fma_f32 v244, v190, v81, -v80
  v_mfma_f32_16x16x32_bf16 v[60:63], a[76:79], v[120:123], v[60:63]
  s_waitcnt lgkmcnt(2)
  buffer_load_dwordx4 v12, s[16:19], s90 offen offset:3072 sc1 lds
  v_mfma_f32_16x16x32_bf16 v[64:67], a[64:67], v[124:127], v[64:67]
  s_add_u32 s90, s90, 0x4000
  v_fma_f32 v245, v191, v81, -v80
  v_lshlrev_b32 v192, 16, v232
  v_mfma_f32_16x16x32_bf16 v[68:71], a[68:71], v[124:127], v[68:71]
  s_cmp_eq_u32 s90, 0x38000
  s_cselect_b32 s90, 0, s90
  v_and_b32 v193, 0xffff0000, v232
  v_mfma_f32_16x16x32_bf16 v[72:75], a[72:75], v[124:127], v[72:75]
  v_lshlrev_b32 v194, 16, v233
  v_and_b32 v195, 0xffff0000, v233
  v_mfma_f32_16x16x32_bf16 v[76:79], a[76:79], v[124:127], v[76:79]
  v_fma_f32 v160, v192, v83, -v82
  v_fma_f32 v161, v193, v83, -v82
  v_mfma_f32_16x16x32_bf16 v[16:19], a[80:83], v[128:131], v[16:19]
  v_fma_f32 v162, v194, v83, -v82
  v_fma_f32 v163, v195, v83, -v82
  v_mfma_f32_16x16x32_bf16 v[20:23], a[84:87], v[128:131], v[20:23]
  s_waitcnt vmcnt(8) lgkmcnt(0)
  s_barrier
  v_mfma_f32_16x16x32_bf16 v[24:27], a[88:91], v[128:131], v[24:27]
  v_lshlrev_b32_e64 v196, 16, v234
  v_and_b32 v197, 0xffff0000, v234
  v_mfma_f32_16x16x32_bf16 v[28:31], a[92:95], v[128:131], v[28:31]
  v_lshlrev_b32_e64 v198, 16, v235
  v_and_b32 v199, 0xffff0000, v235
  v_mfma_f32_16x16x32_bf16 v[32:35], a[80:83], v[132:135], v[32:35]
  ds_read_b128 v[112:115], v248 offset:49152
  v_fma_f32 v164, v196, v83, -v82
  v_mfma_f32_16x16x32_bf16 v[36:39], a[84:87], v[132:135], v[36:39]
  v_fma_f32 v165, v197, v83, -v82
  v_fma_f32 v166, v198, v83, -v82
  v_mfma_f32_16x16x32_bf16 v[40:43], a[88:91], v[132:135], v[40:43]
  v_fma_f32 v167, v199, v83, -v82
  v_lshlrev_b32_e64 v200, 16, v236
  v_mfma_f32_16x16x32_bf16 v[44:47], a[92:95], v[132:135], v[44:47]
  ds_read_b128 v[116:119], v248 offset:50176
  v_and_b32 v201, 0xffff0000, v236
  v_mfma_f32_16x16x32_bf16 v[48:51], a[80:83], v[136:139], v[48:51]
  v_lshlrev_b32_e64 v202, 16, v237
  v_and_b32 v203, 0xffff0000, v237
  v_mfma_f32_16x16x32_bf16 v[52:55], a[84:87], v[136:139], v[52:55]
  v_fma_f32 v168, v200, v83, -v82
  v_fma_f32 v169, v201, v83, -v82
  v_mfma_f32_16x16x32_bf16 v[56:59], a[88:91], v[136:139], v[56:59]
  ds_read_b128 v[120:123], v249 offset:51200
  v_cmp_ne_u32 vcc, s64, v255
  s_cbranch_vccnz parallel_sum__ssm_conv_h3__mixer_gmlp__prompt_kernel_yf_slow
parallel_sum__ssm_conv_h3__mixer_gmlp__prompt_kernel_yf_ok:
  v_mfma_f32_16x16x32_bf16 v[60:63], a[92:95], v[136:139], v[60:63]
  s_mov_b32 m0, s84
  ds_read_b128 v[124:127], v249 offset:52224
  v_fma_f32 v170, v202, v83, -v82
  v_fma_f32 v171, v203, v83, -v82
  v_mfma_f32_16x16x32_bf16 v[64:67], a[80:83], v[140:143], v[64:67]
  buffer_load_dwordx4 v98, s[16:19], s100 offen offset:0 sc1 nt lds
  v_mfma_f32_16x16x32_bf16 v[68:71], a[84:87], v[140:143], v[68:71]
  ds_read_b128 v[128:131], v248 offset:53248
  v_lshlrev_b32 v204, 16, v238
  v_and_b32 v205, 0xffff0000, v238
  v_mfma_f32_16x16x32_bf16 v[72:75], a[88:91], v[140:143], v[72:75]
  ds_read_b128 v[132:135], v248 offset:54272
  v_lshlrev_b32_e64 v206, 16, v239
  v_and_b32 v207, 0xffff0000, v239
  v_mfma_f32_16x16x32_bf16 v[76:79], a[92:95], v[140:143], v[76:79]
  s_waitcnt lgkmcnt(4)
  ds_read_b128 v[136:139], v249 offset:55296
  v_fma_f32 v172, v204, v83, -v82
  v_fma_f32 v173, v205, v83, -v82
  v_mfma_f32_16x16x32_bf16 v[16:19], a[96:99], v[112:115], v[16:19]
  buffer_load_dwordx4 v99, s[16:19], s100 offen offset:1024 sc1 nt lds
  v_mfma_f32_16x16x32_bf16 v[20:23], a[100:103], v[112:115], v[20:23]
  ds_read_b64_tr_b16 a[160:161], v240 offset:0
  v_fma_f32 v174, v206, v83, -v82
  v_mfma_f32_16x16x32_bf16 v[24:27], a[104:107], v[112:115], v[24:27]
  ds_read_b64_tr_b16 a[162:163], v240 offset:2048
  v_fma_f32 v175, v207, v83, -v82
  v_mfma_f32_16x16x32_bf16 v[28:31], a[108:111], v[112:115], v[28:31]
  ds_read_b64_tr_b16 a[164:165], v241 offset:0
  v_lshrrev_b32 v89, 5, v0
  v_mfma_f32_16x16x32_bf16 v[32:35], a[96:99], v[116:119], v[32:35]
  ds_read_b64_tr_b16 a[166:167], v241 offset:2048
  v_lshl_add_u32 v84, v89, 9, v84
  v_mfma_f32_16x16x32_bf16 v[36:39], a[100:103], v[116:119], v[36:39]
  buffer_load_dwordx4 v100, s[16:19], s100 offen offset:2048 sc1 nt lds
  v_mfma_f32_16x16x32_bf16 v[40:43], a[104:107], v[116:119], v[40:43]
  ds_read_b64_tr_b16 a[168:169], v242 offset:0
  v_lshl_add_u32 v88, v89, 13, v88
  v_mfma_f32_16x16x32_bf16 v[44:47], a[108:111], v[116:119], v[44:47]
  s_waitcnt lgkmcnt(4)
  ds_read_b64_tr_b16 a[170:171], v242 offset:2048
  v_lshlrev_b32 v89, 5, v89
  v_mfma_f32_16x16x32_bf16 v[48:51], a[96:99], v[120:123], v[48:51]
  ds_read_b128 v[140:143], v249 offset:56320
  v_xor_b32_e64 v88, v88, v89
  v_mfma_f32_16x16x32_bf16 v[52:55], a[100:103], v[120:123], v[52:55]
  buffer_load_dwordx4 v101, s[16:19], s100 offen offset:3072 sc1 nt lds
  v_mfma_f32_16x16x32_bf16 v[56:59], a[104:107], v[120:123], v[56:59]
  ds_read_b64_tr_b16 a[172:173], v243 offset:0
  v_xor_b32_e64 v89, 64, v88
  v_mfma_f32_16x16x32_bf16 v[60:63], a[108:111], v[120:123], v[60:63]
  ds_read_b64_tr_b16 a[174:175], v243 offset:2048
  v_add_u32 v89, 0x8000, v89
  v_mfma_f32_16x16x32_bf16 v[64:67], a[96:99], v[124:127], v[64:67]
  ds_read_b64_tr_b16 a[176:177], v240 offset:4096
  v_add_u32 v90, 0x2000, v88
  v_mfma_f32_16x16x32_bf16 v[68:71], a[100:103], v[124:127], v[68:71]
  ds_read_b64_tr_b16 a[178:179], v240 offset:6144
  v_add_u32 v91, 0x2000, v89
  v_mfma_f32_16x16x32_bf16 v[72:75], a[104:107], v[124:127], v[72:75]
  ds_read_b64_tr_b16 a[180:181], v241 offset:4096
  v_mfma_f32_16x16x32_bf16 v[76:79], a[108:111], v[124:127], v[76:79]
  ds_read_b64_tr_b16 a[182:183], v241 offset:6144
  v_mfma_f32_16x16x32_bf16 v[16:19], a[112:115], v[128:131], v[16:19]
  ds_read_b64_tr_b16 a[184:185], v242 offset:4096
  v_mfma_f32_16x16x32_bf16 v[20:23], a[116:119], v[128:131], v[20:23]
  s_waitcnt vmcnt(8) lgkmcnt(5)
  s_barrier
  v_mfma_f32_16x16x32_bf16 v[24:27], a[120:123], v[128:131], v[24:27]
  ds_read_b64_tr_b16 a[186:187], v242 offset:6144
  v_mfma_f32_16x16x32_bf16 v[28:31], a[124:127], v[128:131], v[28:31]
  ds_read_b64_tr_b16 a[188:189], v243 offset:4096
  v_mfma_f32_16x16x32_bf16 v[32:35], a[112:115], v[132:135], v[32:35]
  ds_read_b64_tr_b16 a[190:191], v243 offset:6144
  v_mfma_f32_16x16x32_bf16 v[36:39], a[116:119], v[132:135], v[36:39]
  ds_read_b128 v[112:115], v248 offset:0
  v_mfma_f32_16x16x32_bf16 v[40:43], a[120:123], v[132:135], v[40:43]
  ds_read_b128 v[116:119], v248 offset:1024
  v_mfma_f32_16x16x32_bf16 v[44:47], a[124:127], v[132:135], v[44:47]
  ds_read_b128 v[120:123], v249 offset:2048
  v_mfma_f32_16x16x32_bf16 v[48:51], a[112:115], v[136:139], v[48:51]
  ds_read_b128 v[124:127], v249 offset:3072
  v_mfma_f32_16x16x32_bf16 v[52:55], a[116:119], v[136:139], v[52:55]
  ds_read_b128 v[128:131], v248 offset:4096
  v_mfma_f32_16x16x32_bf16 v[56:59], a[120:123], v[136:139], v[56:59]
  ds_read_b128 v[132:135], v248 offset:5120
  v_mfma_f32_16x16x32_bf16 v[60:63], a[124:127], v[136:139], v[60:63]
  v_mfma_f32_16x16x32_bf16 v[64:67], a[112:115], v[140:143], v[64:67]
  ds_read_b128 v[136:139], v249 offset:6144
  v_mfma_f32_16x16x32_bf16 v[68:71], a[116:119], v[140:143], v[68:71]
  v_mfma_f32_16x16x32_bf16 v[72:75], a[120:123], v[140:143], v[72:75]
  v_mfma_f32_16x16x32_bf16 v[76:79], a[124:127], v[140:143], v[76:79]
  s_waitcnt lgkmcnt(2)
  v_mfma_f32_16x16x32_bf16 v[16:19], a[128:131], v[112:115], v[16:19]
  ds_read_b128 v[140:143], v249 offset:7168
  v_mfma_f32_16x16x32_bf16 v[20:23], a[132:135], v[112:115], v[20:23]
  v_mfma_f32_16x16x32_bf16 v[24:27], a[136:139], v[112:115], v[24:27]
  v_mfma_f32_16x16x32_bf16 v[28:31], a[140:143], v[112:115], v[28:31]
  v_mfma_f32_16x16x32_bf16 v[32:35], a[128:131], v[116:119], v[32:35]
  v_mfma_f32_16x16x32_bf16 v[36:39], a[132:135], v[116:119], v[36:39]
  v_mfma_f32_16x16x32_bf16 v[40:43], a[136:139], v[116:119], v[40:43]
  v_mfma_f32_16x16x32_bf16 v[44:47], a[140:143], v[116:119], v[44:47]
  v_mfma_f32_16x16x32_bf16 v[48:51], a[128:131], v[120:123], v[48:51]
  v_mfma_f32_16x16x32_bf16 v[52:55], a[132:135], v[120:123], v[52:55]
  v_mfma_f32_16x16x32_bf16 v[56:59], a[136:139], v[120:123], v[56:59]
  v_mfma_f32_16x16x32_bf16 v[60:63], a[140:143], v[120:123], v[60:63]
  v_mfma_f32_16x16x32_bf16 v[64:67], a[128:131], v[124:127], v[64:67]
  v_mfma_f32_16x16x32_bf16 v[68:71], a[132:135], v[124:127], v[68:71]
  v_mfma_f32_16x16x32_bf16 v[72:75], a[136:139], v[124:127], v[72:75]
  v_mfma_f32_16x16x32_bf16 v[76:79], a[140:143], v[124:127], v[76:79]
  v_mfma_f32_16x16x32_bf16 v[16:19], a[144:147], v[128:131], v[16:19]
  v_mfma_f32_16x16x32_bf16 v[20:23], a[148:151], v[128:131], v[20:23]
  s_waitcnt vmcnt(0) lgkmcnt(0)
  s_barrier
  ds_read_b128 v[112:115], v248 offset:16384
  v_mfma_f32_16x16x32_bf16 v[24:27], a[152:155], v[128:131], v[24:27]
  ds_read_b64_tr_b16 v[144:145], v87 offset:0
  ds_read_b64_tr_b16 v[146:147], v87 offset:2048
  v_mfma_f32_16x16x32_bf16 v[28:31], a[156:159], v[128:131], v[28:31]
  ds_read_b64_tr_b16 v[148:149], v87 offset:8192
  ds_read_b64_tr_b16 v[150:151], v87 offset:10240
  v_mfma_f32_16x16x32_bf16 v[32:35], a[144:147], v[132:135], v[32:35]
  ds_read_b64_tr_b16 v[152:153], v87 offset:8
  ds_read_b64_tr_b16 v[154:155], v87 offset:2056
  v_mfma_f32_16x16x32_bf16 v[36:39], a[148:151], v[132:135], v[36:39]
  ds_read_b64_tr_b16 v[156:157], v87 offset:8200
  ds_read_b64_tr_b16 v[158:159], v87 offset:10248
  v_mfma_f32_16x16x32_bf16 v[40:43], a[152:155], v[132:135], v[40:43]
  s_waitcnt lgkmcnt(7)
  v_lshlrev_b32_e64 v104, 16, v144
  v_and_b32 v105, 0xffff0000, v144
  v_mfma_f32_16x16x32_bf16 v[44:47], a[156:159], v[132:135], v[44:47]
  v_lshlrev_b32_e64 v106, 16, v145
  v_and_b32 v107, 0xffff0000, v145
  v_mfma_f32_16x16x32_bf16 v[48:51], a[144:147], v[136:139], v[48:51]
  ds_read_b128 v[116:119], v248 offset:17408
  v_fmac_f32 v176, v210, v104
  v_fmac_f32 v177, v211, v105
  v_mfma_f32_16x16x32_bf16 v[52:55], a[148:151], v[136:139], v[52:55]
  ds_read_b128 v[120:123], v249 offset:18432
  v_fmac_f32 v178, v212, v106
  v_fmac_f32 v179, v213, v107
  v_mfma_f32_16x16x32_bf16 v[56:59], a[152:155], v[136:139], v[56:59]
  s_waitcnt lgkmcnt(4)
  v_lshlrev_b32 v104, 16, v146
  v_and_b32 v105, 0xffff0000, v146
  v_mfma_f32_16x16x32_bf16 v[60:63], a[156:159], v[136:139], v[60:63]
  v_lshlrev_b32_e64 v106, 16, v147
  v_and_b32 v107, 0xffff0000, v147
  v_mfma_f32_16x16x32_bf16 v[64:67], a[144:147], v[140:143], v[64:67]
  ds_read_b128 v[124:127], v249 offset:19456
  v_fmac_f32_e64 v180, v214, v104
  v_mfma_f32_16x16x32_bf16 v[68:71], a[148:151], v[140:143], v[68:71]
  v_fmac_f32 v181, v215, v105
  v_fmac_f32 v182, v216, v106
  v_mfma_f32_16x16x32_bf16 v[72:75], a[152:155], v[140:143], v[72:75]
  v_fmac_f32 v183, v217, v107
  v_lshlrev_b32 v104, 16, v148
  v_mfma_f32_16x16x32_bf16 v[76:79], a[156:159], v[140:143], v[76:79]
  s_waitcnt lgkmcnt(1)
  ds_read_b128 v[128:131], v248 offset:20480
  v_and_b32 v105, 0xffff0000, v148
  v_mfma_f32_16x16x32_bf16 v[48:51], a[160:163], v[120:123], v[48:51]
  ds_read_b128 v[132:135], v248 offset:21504
  v_lshlrev_b32 v106, 16, v149
  v_and_b32 v107, 0xffff0000, v149
  v_mfma_f32_16x16x32_bf16 v[52:55], a[164:167], v[120:123], v[52:55]
  ds_read_b128 v[136:139], v249 offset:22528
  v_fmac_f32 v184, v218, v104
  v_fmac_f32 v185, v219, v105
  v_mfma_f32_16x16x32_bf16 v[56:59], a[168:171], v[120:123], v[56:59]
  ds_read_b128 v[140:143], v249 offset:23552
  v_fmac_f32 v186, v220, v106
  v_fmac_f32 v187, v221, v107
  v_mfma_f32_16x16x32_bf16 v[60:63], a[172:175], v[120:123], v[60:63]
  s_waitcnt lgkmcnt(4)
  v_lshlrev_b32 v104, 16, v150
  v_and_b32 v105, 0xffff0000, v150
  v_mfma_f32_16x16x32_bf16 v[64:67], a[160:163], v[124:127], v[64:67]
  v_lshlrev_b32_e64 v106, 16, v151
  v_and_b32 v107, 0xffff0000, v151
  v_mfma_f32_16x16x32_bf16 v[68:71], a[164:167], v[124:127], v[68:71]
  v_fmac_f32 v188, v222, v104
  v_fmac_f32 v189, v223, v105
  v_mfma_f32_16x16x32_bf16 v[72:75], a[168:171], v[124:127], v[72:75]
  v_fmac_f32 v190, v244, v106
  v_fmac_f32 v191, v245, v107
  v_mfma_f32_16x16x32_bf16 v[76:79], a[172:175], v[124:127], v[76:79]
  s_waitcnt lgkmcnt(1)
  v_lshlrev_b32 v104, 16, v152
  v_and_b32 v105, 0xffff0000, v152
  v_mfma_f32_16x16x32_bf16 v[48:51], a[176:179], v[136:139], v[48:51]
  v_lshlrev_b32_e64 v106, 16, v153
  v_and_b32 v107, 0xffff0000, v153
  v_mfma_f32_16x16x32_bf16 v[52:55], a[180:183], v[136:139], v[52:55]
  v_fmac_f32 v192, v160, v104
  v_fmac_f32 v193, v161, v105
  v_mfma_f32_16x16x32_bf16 v[56:59], a[184:187], v[136:139], v[56:59]
  s_nop 1
  ds_write_b128 v96, v[48:51] offset:0
  v_mfma_f32_16x16x32_bf16 v[60:63], a[188:191], v[136:139], v[60:63]
  s_waitcnt lgkmcnt(1)
  v_fmac_f32 v194, v162, v106
  v_fmac_f32 v195, v163, v107
  v_mfma_f32_16x16x32_bf16 v[64:67], a[176:179], v[140:143], v[64:67]
  ds_write_b128 v96, v[52:55] offset:1024
  v_lshlrev_b32_e64 v104, 16, v154
  v_mfma_f32_16x16x32_bf16 v[68:71], a[180:183], v[140:143], v[68:71]
  v_and_b32 v105, 0xffff0000, v154
  v_lshlrev_b32_e64 v106, 16, v155
  v_and_b32 v107, 0xffff0000, v155
  v_mfma_f32_16x16x32_bf16 v[72:75], a[184:187], v[140:143], v[72:75]
  ds_write_b128 v96, v[56:59] offset:2048
  v_fmac_f32_e64 v196, v164, v104
  v_mfma_f32_16x16x32_bf16 v[76:79], a[188:191], v[140:143], v[76:79]
  ds_write_b128 v96, v[60:63] offset:3072
  v_fmac_f32_e64 v197, v165, v105
  v_mfma_f32_16x16x32_bf16 v[16:19], a[160:163], v[112:115], v[16:19]
  ds_write_b128 v96, v[64:67] offset:4096
  v_fmac_f32_e64 v198, v166, v106
  v_mfma_f32_16x16x32_bf16 v[20:23], a[164:167], v[112:115], v[20:23]
  ds_write_b128 v96, v[68:71] offset:5120
  v_fmac_f32_e64 v199, v167, v107
  v_mfma_f32_16x16x32_bf16 v[24:27], a[168:171], v[112:115], v[24:27]
  v_lshlrev_b32_e64 v104, 16, v156
  v_and_b32 v105, 0xffff0000, v156
  v_lshlrev_b32_e64 v106, 16, v157
  v_mfma_f32_16x16x32_bf16 v[28:31], a[172:175], v[112:115], v[28:31]
  ds_write_b128 v96, v[72:75] offset:6144
  v_and_b32 v107, 0xffff0000, v157
  v_mfma_f32_16x16x32_bf16 v[32:35], a[160:163], v[116:119], v[32:35]
  ds_write_b128 v96, v[76:79] offset:7168
  v_fmac_f32_e64 v200, v168, v104
  v_mfma_f32_16x16x32_bf16 v[36:39], a[164:167], v[116:119], v[36:39]
  v_fmac_f32 v201, v169, v105
  v_fmac_f32 v202, v170, v106
  v_fmac_f32_e64 v203, v171, v107
  v_mfma_f32_16x16x32_bf16 v[40:43], a[168:171], v[116:119], v[40:43]
  v_lshlrev_b32_e64 v104, 16, v158
  v_and_b32 v105, 0xffff0000, v158
  v_lshlrev_b32_e64 v106, 16, v159
  v_mfma_f32_16x16x32_bf16 v[44:47], a[172:175], v[116:119], v[44:47]
  v_and_b32 v107, 0xffff0000, v159
  v_fmac_f32 v204, v172, v104
  v_fmac_f32 v205, v173, v105
  v_mfma_f32_16x16x32_bf16 v[16:19], a[176:179], v[128:131], v[16:19]
  s_waitcnt lgkmcnt(0)
  s_barrier
  ds_read_b128 v[48:51], v97 offset:0
  v_mfma_f32_16x16x32_bf16 v[20:23], a[180:183], v[128:131], v[20:23]
  ds_read_b128 v[52:55], v97 offset:1024
  v_fmac_f32 v206, v174, v106
  v_fmac_f32 v207, v175, v107
  v_mfma_f32_16x16x32_bf16 v[24:27], a[184:187], v[128:131], v[24:27]
  ds_read_b128 v[56:59], v97 offset:2048
  v_mfma_f32_16x16x32_bf16 v[28:31], a[188:191], v[128:131], v[28:31]
  ds_read_b128 v[60:63], v97 offset:3072
  v_mfma_f32_16x16x32_bf16 v[32:35], a[176:179], v[132:135], v[32:35]
  ds_read_b128 v[64:67], v97 offset:4096
  v_mfma_f32_16x16x32_bf16 v[36:39], a[180:183], v[132:135], v[36:39]
  ds_read_b128 v[68:71], v97 offset:5120
  v_mfma_f32_16x16x32_bf16 v[40:43], a[184:187], v[132:135], v[40:43]
  ds_read_b128 v[72:75], v97 offset:6144
  v_mfma_f32_16x16x32_bf16 v[44:47], a[188:191], v[132:135], v[44:47]
  ds_read_b128 v[76:79], v97 offset:7168
  v_pk_add_f32 v[16:17], v[16:17], v[176:177]
  v_pk_add_f32 v[18:19], v[18:19], v[178:179]
  v_pk_add_f32 v[20:21], v[20:21], v[180:181]
  v_pk_add_f32 v[22:23], v[22:23], v[182:183]
  v_pk_add_f32 v[24:25], v[24:25], v[184:185]
  v_pk_add_f32 v[26:27], v[26:27], v[186:187]
  v_pk_add_f32 v[28:29], v[28:29], v[188:189]
  v_pk_add_f32 v[30:31], v[30:31], v[190:191]
  v_pk_add_f32 v[32:33], v[32:33], v[192:193]
  v_pk_add_f32 v[34:35], v[34:35], v[194:195]
  v_pk_add_f32 v[36:37], v[36:37], v[196:197]
  v_pk_add_f32 v[38:39], v[38:39], v[198:199]
  v_pk_add_f32 v[40:41], v[40:41], v[200:201]
  v_pk_add_f32 v[42:43], v[42:43], v[202:203]
  v_pk_add_f32 v[44:45], v[44:45], v[204:205]
  v_pk_add_f32 v[46:47], v[46:47], v[206:207]
  s_waitcnt lgkmcnt(6)
  v_pk_add_f32 v[16:17], v[16:17], v[48:49]
  s_branch parallel_sum__ssm_conv_h3__mixer_gmlp__prompt_kernel_ps15
parallel_sum__ssm_conv_h3__mixer_gmlp__prompt_kernel_pg15:
  s_branch parallel_sum__ssm_conv_h3__mixer_gmlp__prompt_kernel_pgback
parallel_sum__ssm_conv_h3__mixer_gmlp__prompt_kernel_ps15:
  v_pk_add_f32 v[18:19], v[18:19], v[50:51]
  v_cvt_pk_bf16_f32 v16, v16, v17
  v_cvt_pk_bf16_f32 v17, v18, v19
  ds_write_b64 v92, v[16:17] offset:0
  v_pk_add_f32 v[20:21], v[20:21], v[52:53]
  v_pk_add_f32 v[22:23], v[22:23], v[54:55]
  v_cvt_pk_bf16_f32 v20, v20, v21
  v_cvt_pk_bf16_f32 v21, v22, v23
  ds_write_b64 v93, v[20:21] offset:0
  s_waitcnt lgkmcnt(7)
  v_pk_add_f32 v[24:25], v[24:25], v[56:57]
  v_pk_add_f32 v[26:27], v[26:27], v[58:59]
  v_cvt_pk_bf16_f32 v24, v24, v25
  v_cvt_pk_bf16_f32 v25, v26, v27
  ds_write_b64 v94, v[24:25] offset:0
  s_waitcnt lgkmcnt(7)
  v_pk_add_f32 v[28:29], v[28:29], v[60:61]
  v_pk_add_f32 v[30:31], v[30:31], v[62:63]
  v_cvt_pk_bf16_f32 v28, v28, v29
  v_cvt_pk_bf16_f32 v29, v30, v31
  ds_write_b64 v95, v[28:29] offset:0
  ds_read_b128 v[224:227], v84 offset:0
  ds_read_b128 v[228:231], v84 offset:2048
  s_waitcnt lgkmcnt(9)
  v_pk_add_f32 v[32:33], v[32:33], v[64:65]
  v_pk_add_f32 v[34:35], v[34:35], v[66:67]
  v_cvt_pk_bf16_f32 v32, v32, v33
  v_cvt_pk_bf16_f32 v33, v34, v35
  ds_write_b64 v92, v[32:33] offset:512
  s_waitcnt lgkmcnt(9)
  v_pk_add_f32 v[36:37], v[36:37], v[68:69]
  v_pk_add_f32 v[38:39], v[38:39], v[70:71]
  v_cvt_pk_bf16_f32 v36, v36, v37
  v_cvt_pk_bf16_f32 v37, v38, v39
  ds_write_b64 v93, v[36:37] offset:512
  s_waitcnt lgkmcnt(3)
  buffer_store_dwordx4 v[224:227], v88, s[52:55], s87 offen sc1
  v_pk_add_f32 v[40:41], v[40:41], v[72:73]
  v_pk_add_f32 v[42:43], v[42:43], v[74:75]
  v_cvt_pk_bf16_f32 v40, v40, v41
  v_cvt_pk_bf16_f32 v41, v42, v43
  ds_write_b64 v94, v[40:41] offset:512
  s_waitcnt lgkmcnt(3)
  buffer_store_dwordx4 v[228:231], v89, s[52:55], s87 offen sc1
  v_pk_add_f32 v[44:45], v[44:45], v[76:77]
  v_pk_add_f32 v[46:47], v[46:47], v[78:79]
  v_cvt_pk_bf16_f32 v44, v44, v45
  v_cvt_pk_bf16_f32 v45, v46, v47
  ds_write_b64 v95, v[44:45] offset:512
  ds_read_b128 v[232:235], v84 offset:512
  ds_read_b128 v[236:239], v84 offset:2560
  s_waitcnt lgkmcnt(1)
  buffer_store_dwordx4 v[232:235], v90, s[52:55], s87 offen sc1
  s_waitcnt lgkmcnt(0)
  buffer_store_dwordx4 v[236:239], v91, s[52:55], s87 offen sc1
parallel_sum__ssm_conv_h3__mixer_gmlp__prompt_kernel_end:
  s_endpgm
parallel_sum__ssm_conv_h3__mixer_gmlp__prompt_kernel_nonce_slow:
  s_movk_i32 s101, 0x7fff
parallel_sum__ssm_conv_h3__mixer_gmlp__prompt_kernel_nonce_loop:
  s_mov_b64 exec, vcc
  buffer_load_dword v13, v10, s[56:59], 0 offen sc0 sc1
  s_waitcnt vmcnt(0)
  v_cmp_eq_u32 vcc, 0, v13
  s_cbranch_vccz parallel_sum__ssm_conv_h3__mixer_gmlp__prompt_kernel_nonce_done
  s_sub_u32 s101, s101, 1
  s_cmp_lg_u32 s101, 0
  s_cbranch_scc1 parallel_sum__ssm_conv_h3__mixer_gmlp__prompt_kernel_nonce_loop
parallel_sum__ssm_conv_h3__mixer_gmlp__prompt_kernel_nonce_done:
  s_mov_b64 exec, -1
  s_branch parallel_sum__ssm_conv_h3__mixer_gmlp__prompt_kernel_nonce_ok
parallel_sum__ssm_conv_h3__mixer_gmlp__prompt_kernel_stat_slow:
  s_movk_i32 s101, 0x7fff
parallel_sum__ssm_conv_h3__mixer_gmlp__prompt_kernel_stat_loop:
  s_mov_b64 exec, vcc
  buffer_load_dwordx4 v[252:255], v5, s[16:19], s83 offen sc1
  buffer_load_dwordx4 v[236:239], v6, s[16:19], s82 offen offset:0 sc1
  buffer_load_dwordx4 v[240:243], v6, s[16:19], s82 offen offset:16 sc1
  s_waitcnt vmcnt(0)
  v_xor_b32 v3, s64, v252
  v_bitop3_b32 v3, v3, v253, s65 bitop3:0xf6
  v_bitop3_b32 v3, v3, v254, s66 bitop3:0xf6
  v_bitop3_b32 v3, v3, v255, s67 bitop3:0xf6
  v_bitop3_b32 v3, v3, v236, s64 bitop3:0xf6
  v_bitop3_b32 v3, v3, v237, s65 bitop3:0xf6
  v_bitop3_b32 v3, v3, v238, s66 bitop3:0xf6
  v_bitop3_b32 v3, v3, v239, s67 bitop3:0xf6
  v_bitop3_b32 v3, v3, v240, s64 bitop3:0xf6
  v_bitop3_b32 v3, v3, v241, s65 bitop3:0xf6
  v_bitop3_b32 v3, v3, v242, s66 bitop3:0xf6
  v_bitop3_b32 v3, v3, v243, s67 bitop3:0xf6
  v_and_b32 v3, 0xff, v3
  v_cmp_ne_u32_e64 vcc, 0, v3
  s_cbranch_vccz parallel_sum__ssm_conv_h3__mixer_gmlp__prompt_kernel_stat_done
  s_sub_u32 s101, s101, 1
  s_cmp_lg_u32 s101, 0
  s_cbranch_scc1 parallel_sum__ssm_conv_h3__mixer_gmlp__prompt_kernel_stat_loop
parallel_sum__ssm_conv_h3__mixer_gmlp__prompt_kernel_stat_done:
  s_mov_b64 exec, -1
  s_branch parallel_sum__ssm_conv_h3__mixer_gmlp__prompt_kernel_stat_ok
parallel_sum__ssm_conv_h3__mixer_gmlp__prompt_kernel_z2s_slow:
  s_movk_i32 s101, 0x7fff
parallel_sum__ssm_conv_h3__mixer_gmlp__prompt_kernel_z2s_loop:
  s_mov_b64 exec, vcc
  buffer_load_dwordx4 v[236:239], v12, s[16:19], s85 offen offset:0 sc1
  buffer_load_dwordx4 v[240:243], v12, s[16:19], s85 offen offset:256 sc1
  buffer_load_dwordx4 v[244:247], v12, s[16:19], s85 offen offset:512 sc1
  buffer_load_dwordx4 v[248:251], v12, s[16:19], s85 offen offset:768 sc1
  s_waitcnt vmcnt(0)
  v_xor_b32 v7, s64, v236
  v_bitop3_b32 v7, v7, v237, s65 bitop3:0xf6
  v_bitop3_b32 v7, v7, v238, s66 bitop3:0xf6
  v_bitop3_b32 v7, v7, v239, s67 bitop3:0xf6
  v_bitop3_b32 v7, v7, v240, s64 bitop3:0xf6
  v_bitop3_b32 v7, v7, v241, s65 bitop3:0xf6
  v_bitop3_b32 v7, v7, v242, s66 bitop3:0xf6
  v_bitop3_b32 v7, v7, v243, s67 bitop3:0xf6
  v_bitop3_b32 v7, v7, v244, s64 bitop3:0xf6
  v_bitop3_b32 v7, v7, v245, s65 bitop3:0xf6
  v_bitop3_b32 v7, v7, v246, s66 bitop3:0xf6
  v_bitop3_b32 v7, v7, v247, s67 bitop3:0xf6
  v_bitop3_b32 v7, v7, v248, s64 bitop3:0xf6
  v_bitop3_b32 v7, v7, v249, s65 bitop3:0xf6
  v_bitop3_b32 v7, v7, v250, s66 bitop3:0xf6
  v_bitop3_b32 v7, v7, v251, s67 bitop3:0xf6
  v_and_b32 v7, 0xff, v7
  v_cmp_ne_u32_e64 vcc, 0, v7
  s_cbranch_vccz parallel_sum__ssm_conv_h3__mixer_gmlp__prompt_kernel_z2s_done
  s_sub_u32 s101, s101, 1
  s_cmp_lg_u32 s101, 0
  s_cbranch_scc1 parallel_sum__ssm_conv_h3__mixer_gmlp__prompt_kernel_z2s_loop
parallel_sum__ssm_conv_h3__mixer_gmlp__prompt_kernel_z2s_done:
  s_mov_b64 exec, -1
  s_branch parallel_sum__ssm_conv_h3__mixer_gmlp__prompt_kernel_z2s_ok
parallel_sum__ssm_conv_h3__mixer_gmlp__prompt_kernel_cs1_slow:
  s_movk_i32 s101, 0x7fff
parallel_sum__ssm_conv_h3__mixer_gmlp__prompt_kernel_cs1_loop:
  s_mov_b64 exec, vcc
  buffer_load_dwordx4 v[236:239], v10, s[16:19], s99 offen offset:0 sc1
  buffer_load_dwordx4 v[240:243], v10, s[16:19], s99 offen offset:256 sc1
  buffer_load_dwordx4 v[244:247], v10, s[16:19], s99 offen offset:512 sc1
  buffer_load_dwordx4 v[248:251], v10, s[16:19], s99 offen offset:768 sc1
  s_waitcnt vmcnt(0)
  v_xor_b32 v3, s62, v237
  v_bitop3_b32 v3, v3, v239, s62 bitop3:0xf6
  v_bitop3_b32 v3, v3, v241, s62 bitop3:0xf6
  v_bitop3_b32 v3, v3, v243, s62 bitop3:0xf6
  v_bitop3_b32 v3, v3, v245, s62 bitop3:0xf6
  v_bitop3_b32 v3, v3, v247, s62 bitop3:0xf6
  v_bitop3_b32 v3, v3, v249, s62 bitop3:0xf6
  v_bitop3_b32 v3, v3, v251, s62 bitop3:0xf6
  v_cmp_ne_u32_e64 vcc, 0, v3
  s_cbranch_vccz parallel_sum__ssm_conv_h3__mixer_gmlp__prompt_kernel_cs1_done
  s_sub_u32 s101, s101, 1
  s_cmp_lg_u32 s101, 0
  s_cbranch_scc1 parallel_sum__ssm_conv_h3__mixer_gmlp__prompt_kernel_cs1_loop
parallel_sum__ssm_conv_h3__mixer_gmlp__prompt_kernel_cs1_done:
  s_mov_b64 exec, -1
  s_branch parallel_sum__ssm_conv_h3__mixer_gmlp__prompt_kernel_cs1_ok
parallel_sum__ssm_conv_h3__mixer_gmlp__prompt_kernel_zf_slow:
  s_movk_i32 s101, 0x7fff
parallel_sum__ssm_conv_h3__mixer_gmlp__prompt_kernel_zf_loop:
  s_mov_b64 exec, vcc
  buffer_load_dword v255, v254, s[16:19], s89 offen sc1
  s_waitcnt vmcnt(0)
  v_cmp_ne_u32 vcc, s64, v255
  s_cbranch_vccz parallel_sum__ssm_conv_h3__mixer_gmlp__prompt_kernel_zf_done
  s_sub_u32 s101, s101, 1
  s_cmp_lg_u32 s101, 0
  s_cbranch_scc1 parallel_sum__ssm_conv_h3__mixer_gmlp__prompt_kernel_zf_loop
parallel_sum__ssm_conv_h3__mixer_gmlp__prompt_kernel_zf_done:
  s_mov_b64 exec, -1
  s_branch parallel_sum__ssm_conv_h3__mixer_gmlp__prompt_kernel_zf_ok
parallel_sum__ssm_conv_h3__mixer_gmlp__prompt_kernel_uf_slow:
  s_movk_i32 s101, 0x7fff
parallel_sum__ssm_conv_h3__mixer_gmlp__prompt_kernel_uf_loop:
  s_mov_b64 exec, vcc
  buffer_load_dword v255, v254, s[16:19], s94 offen sc1
  s_waitcnt vmcnt(0)
  v_cmp_ne_u32 vcc, s64, v255
  s_cbranch_vccz parallel_sum__ssm_conv_h3__mixer_gmlp__prompt_kernel_uf_done
  s_sub_u32 s101, s101, 1
  s_cmp_lg_u32 s101, 0
  s_cbranch_scc1 parallel_sum__ssm_conv_h3__mixer_gmlp__prompt_kernel_uf_loop
parallel_sum__ssm_conv_h3__mixer_gmlp__prompt_kernel_uf_done:
  s_mov_b64 exec, -1
  s_branch parallel_sum__ssm_conv_h3__mixer_gmlp__prompt_kernel_uf_ok
parallel_sum__ssm_conv_h3__mixer_gmlp__prompt_kernel_pf_slow:
  s_movk_i32 s101, 0x7fff
parallel_sum__ssm_conv_h3__mixer_gmlp__prompt_kernel_pf_loop:
  s_mov_b64 exec, vcc
  buffer_load_dword v255, v254, s[16:19], s91 offen sc1
  s_waitcnt vmcnt(0)
  v_cmp_ne_u32 vcc, s64, v255
  s_cbranch_vccz parallel_sum__ssm_conv_h3__mixer_gmlp__prompt_kernel_pf_done
  s_sub_u32 s101, s101, 1
  s_cmp_lg_u32 s101, 0
  s_cbranch_scc1 parallel_sum__ssm_conv_h3__mixer_gmlp__prompt_kernel_pf_loop
parallel_sum__ssm_conv_h3__mixer_gmlp__prompt_kernel_pf_done:
  s_mov_b64 exec, -1
  s_branch parallel_sum__ssm_conv_h3__mixer_gmlp__prompt_kernel_pf_ok
parallel_sum__ssm_conv_h3__mixer_gmlp__prompt_kernel_yf_slow:
  s_movk_i32 s101, 0x7fff
parallel_sum__ssm_conv_h3__mixer_gmlp__prompt_kernel_yf_loop:
  s_mov_b64 exec, vcc
  buffer_load_dword v255, v254, s[16:19], s99 offen sc1
  s_waitcnt vmcnt(0)
  v_cmp_ne_u32 vcc, s64, v255
  s_cbranch_vccz parallel_sum__ssm_conv_h3__mixer_gmlp__prompt_kernel_yf_done
  s_sub_u32 s101, s101, 1
  s_cmp_lg_u32 s101, 0
  s_cbranch_scc1 parallel_sum__ssm_conv_h3__mixer_gmlp__prompt_kernel_yf_loop
parallel_sum__ssm_conv_h3__mixer_gmlp__prompt_kernel_yf_done:
  s_mov_b64 exec, -1
  s_branch parallel_sum__ssm_conv_h3__mixer_gmlp__prompt_kernel_yf_ok
parallel_sum__ssm_conv_h3__mixer_gmlp__prompt_kernel_hn1_slow:
  s_movk_i32 s101, 0x7fff
parallel_sum__ssm_conv_h3__mixer_gmlp__prompt_kernel_hn1_loop:
  s_mov_b64 exec, vcc
  buffer_load_dword v13, v10, s[56:59], 0 offen sc0 sc1
  s_waitcnt vmcnt(0)
  v_cmp_eq_u32 vcc, 0, v13
  s_cbranch_vccz parallel_sum__ssm_conv_h3__mixer_gmlp__prompt_kernel_hn1_done
  s_sub_u32 s101, s101, 1
  s_cmp_lg_u32 s101, 0
  s_cbranch_scc1 parallel_sum__ssm_conv_h3__mixer_gmlp__prompt_kernel_hn1_loop
parallel_sum__ssm_conv_h3__mixer_gmlp__prompt_kernel_hn1_done:
  s_mov_b64 exec, -1
  s_branch parallel_sum__ssm_conv_h3__mixer_gmlp__prompt_kernel_hn1_ok
parallel_sum__ssm_conv_h3__mixer_gmlp__prompt_kernel_hn2_slow:
  s_movk_i32 s101, 0x7fff
parallel_sum__ssm_conv_h3__mixer_gmlp__prompt_kernel_hn2_loop:
  s_mov_b64 exec, vcc
  buffer_load_dword v13, v10, s[56:59], 0 offen sc0 sc1
  s_waitcnt vmcnt(0)
  v_cmp_eq_u32 vcc, 0, v13
  s_cbranch_vccz parallel_sum__ssm_conv_h3__mixer_gmlp__prompt_kernel_hn2_done
  s_sub_u32 s101, s101, 1
  s_cmp_lg_u32 s101, 0
  s_cbranch_scc1 parallel_sum__ssm_conv_h3__mixer_gmlp__prompt_kernel_hn2_loop
parallel_sum__ssm_conv_h3__mixer_gmlp__prompt_kernel_hn2_done:
  s_mov_b64 exec, -1
  s_branch parallel_sum__ssm_conv_h3__mixer_gmlp__prompt_kernel_hn2_ok
parallel_sum__ssm_conv_h3__mixer_gmlp__prompt_kernel_ug_slow:
  s_movk_i32 s101, 0x7fff
parallel_sum__ssm_conv_h3__mixer_gmlp__prompt_kernel_ug_loop:
  s_mov_b64 exec, vcc
  buffer_load_dword v255, v254, s[16:19], s94 offen sc1
  s_waitcnt vmcnt(0)
  v_cmp_ne_u32 vcc, s64, v255
  s_cbranch_vccz parallel_sum__ssm_conv_h3__mixer_gmlp__prompt_kernel_ug_done
  s_sub_u32 s101, s101, 1
  s_cmp_lg_u32 s101, 0
  s_cbranch_scc1 parallel_sum__ssm_conv_h3__mixer_gmlp__prompt_kernel_ug_loop
parallel_sum__ssm_conv_h3__mixer_gmlp__prompt_kernel_ug_done:
  s_mov_b64 exec, -1
  s_branch parallel_sum__ssm_conv_h3__mixer_gmlp__prompt_kernel_ug_ok
parallel_sum__ssm_conv_h3__mixer_gmlp__prompt_kernel_helper:
  s_mov_b32 s60, s4
  s_mov_b32 s61, s5
  s_load_dwordx2 s[16:17], s[0:1], 104
  s_load_dwordx2 s[56:57], s[0:1], 96
  s_load_dwordx2 s[20:21], s[0:1], 8
  s_load_dwordx2 s[24:25], s[0:1], 16
  s_load_dwordx2 s[28:29], s[0:1], 24
  s_load_dwordx2 s[32:33], s[0:1], 32
  s_load_dwordx2 s[36:37], s[0:1], 40
  s_load_dwordx2 s[40:41], s[0:1], 64
  s_load_dwordx2 s[44:45], s[0:1], 72
  s_load_dwordx2 s[48:49], s[0:1], 80
  s_load_dwordx2 s[52:53], s[0:1], 88
  v_lshrrev_b32 v14, 5, v0
  v_min_u32 v14, 1, v14
  v_lshlrev_b32_e64 v14, 30, v14
  v_lshl_add_u32 v14, v0, 2, v14
  v_mov_b32 v10, 0
  s_waitcnt lgkmcnt(0)
  s_and_b32 s9, s9, 0xffff
  s_mov_b32 s10, 0x400000
  s_mov_b32 s11, 0x20000
  s_and_b32 s13, s13, 0xffff
  s_mov_b32 s14, 0x700000
  s_mov_b32 s15, 0x20000
  s_and_b32 s17, s17, 0xffff
  s_mov_b32 s18, 0x10000000
  s_mov_b32 s19, 0x20000
  s_and_b32 s57, s57, 0xffff
  s_mov_b32 s58, 0x100
  s_mov_b32 s59, 0x20000
  s_and_b32 s21, s21, 0xffff
  s_mov_b32 s22, 0x400000
  s_mov_b32 s23, 0x20000
  s_and_b32 s25, s25, 0xffff
  s_mov_b32 s26, 0x400000
  s_mov_b32 s27, 0x20000
  s_and_b32 s29, s29, 0xffff
  s_mov_b32 s30, 0x2000
  s_mov_b32 s31, 0x20000
  s_and_b32 s33, s33, 0xffff
  s_mov_b32 s34, 0x400000
  s_mov_b32 s35, 0x20000
  s_and_b32 s37, s37, 0xffff
  s_mov_b32 s38, 0x800
  s_mov_b32 s39, 0x20000
  s_and_b32 s41, s41, 0xffff
  s_mov_b32 s42, 0x800000
  s_mov_b32 s43, 0x20000
  s_and_b32 s45, s45, 0xffff
  s_mov_b32 s46, 0x1000
  s_mov_b32 s47, 0x20000
  s_and_b32 s49, s49, 0xffff
  s_mov_b32 s50, 0x380000
  s_mov_b32 s51, 0x20000
  s_and_b32 s53, s53, 0xffff
  s_mov_b32 s54, 0x400000
  s_mov_b32 s55, 0x20000
  s_or_b32 s4, s2, s3
  s_cmp_lg_u32 s4, 0
  s_cbranch_scc1 parallel_sum__ssm_conv_h3__mixer_gmlp__prompt_kernel_nononce
  s_mul_i32 s4, s92, 0x9E3779B1
  s_or_b32 s4, s4, 1
  v_mov_b32_e64 v3, s4
  buffer_store_dword v3, v14, s[56:59], 0 offen sc0 sc1
parallel_sum__ssm_conv_h3__mixer_gmlp__prompt_kernel_nononce:
  s_cmp_ge_u32 s61, 2
  s_cbranch_scc1 parallel_sum__ssm_conv_h3__mixer_gmlp__prompt_kernel_colsum
  s_lshr_b32 s4, s60, 1
  s_lshl_b32 s4, s4, 1
  s_and_b32 s5, s60, 1
  s_add_u32 s4, s4, s5
  s_lshl_b32 s4, s4, 1
  s_add_u32 s74, s4, s61
  s_lshl_b32 s63, s74, 7
  s_lshl_b32 s4, s3, 5
  s_add_u32 s63, s63, s4
  s_lshl_b32 s70, s63, 11
  buffer_load_dwordx4 v[16:19], v208, s[8:11], s70 offen offset:0
  buffer_load_dwordx4 v[20:23], v208, s[8:11], s70 offen offset:1024
  buffer_load_dwordx4 v[24:27], v208, s[8:11], s70 offen offset:2048
  buffer_load_dwordx4 v[28:31], v208, s[8:11], s70 offen offset:3072
  s_add_u32 s70, s70, 4096
  buffer_load_dwordx4 v[32:35], v208, s[8:11], s70 offen offset:0
  buffer_load_dwordx4 v[36:39], v208, s[8:11], s70 offen offset:1024
  buffer_load_dwordx4 v[40:43], v208, s[8:11], s70 offen offset:2048
  buffer_load_dwordx4 v[44:47], v208, s[8:11], s70 offen offset:3072
  s_add_u32 s70, s70, 4096
  buffer_load_dwordx4 v[48:51], v208, s[8:11], s70 offen offset:0
  buffer_load_dwordx4 v[52:55], v208, s[8:11], s70 offen offset:1024
  buffer_load_dwordx4 v[56:59], v208, s[8:11], s70 offen offset:2048
  buffer_load_dwordx4 v[60:63], v208, s[8:11], s70 offen offset:3072
  s_add_u32 s70, s70, 4096
  buffer_load_dwordx4 v[64:67], v208, s[8:11], s70 offen offset:0
  buffer_load_dwordx4 v[68:71], v208, s[8:11], s70 offen offset:1024
  buffer_load_dwordx4 v[72:75], v208, s[8:11], s70 offen offset:2048
  buffer_load_dwordx4 v[76:79], v208, s[8:11], s70 offen offset:3072
  s_add_u32 s70, s70, 4096
  buffer_load_dwordx4 v[80:83], v208, s[8:11], s70 offen offset:0
  buffer_load_dwordx4 v[84:87], v208, s[8:11], s70 offen offset:1024
  buffer_load_dwordx4 v[88:91], v208, s[8:11], s70 offen offset:2048
  buffer_load_dwordx4 v[92:95], v208, s[8:11], s70 offen offset:3072
  s_add_u32 s70, s70, 4096
  buffer_load_dwordx4 v[96:99], v208, s[8:11], s70 offen offset:0
  buffer_load_dwordx4 v[100:103], v208, s[8:11], s70 offen offset:1024
  buffer_load_dwordx4 v[104:107], v208, s[8:11], s70 offen offset:2048
  buffer_load_dwordx4 v[108:111], v208, s[8:11], s70 offen offset:3072
  s_add_u32 s70, s70, 4096
  buffer_load_dwordx4 v[112:115], v208, s[8:11], s70 offen offset:0
  buffer_load_dwordx4 v[116:119], v208, s[8:11], s70 offen offset:1024
  buffer_load_dwordx4 v[120:123], v208, s[8:11], s70 offen offset:2048
  buffer_load_dwordx4 v[124:127], v208, s[8:11], s70 offen offset:3072
  s_add_u32 s70, s70, 4096
  buffer_load_dwordx4 v[128:131], v208, s[8:11], s70 offen offset:0
  buffer_load_dwordx4 v[132:135], v208, s[8:11], s70 offen offset:1024
  buffer_load_dwordx4 v[136:139], v208, s[8:11], s70 offen offset:2048
  buffer_load_dwordx4 v[140:143], v208, s[8:11], s70 offen offset:3072
  s_add_u32 s70, s70, 4096
  buffer_load_dwordx4 v[144:147], v208, s[8:11], s70 offen offset:0
  buffer_load_dwordx4 v[148:151], v208, s[8:11], s70 offen offset:1024
  buffer_load_dwordx4 v[152:155], v208, s[8:11], s70 offen offset:2048
  buffer_load_dwordx4 v[156:159], v208, s[8:11], s70 offen offset:3072
  s_add_u32 s70, s70, 4096
  buffer_load_dwordx4 v[160:163], v208, s[8:11], s70 offen offset:0
  buffer_load_dwordx4 v[164:167], v208, s[8:11], s70 offen offset:1024
  buffer_load_dwordx4 v[168:171], v208, s[8:11], s70 offen offset:2048
  buffer_load_dwordx4 v[172:175], v208, s[8:11], s70 offen offset:3072
  s_add_u32 s70, s70, 4096
  buffer_load_dwordx4 v[176:179], v208, s[8:11], s70 offen offset:0
  buffer_load_dwordx4 v[180:183], v208, s[8:11], s70 offen offset:1024
  buffer_load_dwordx4 v[184:187], v208, s[8:11], s70 offen offset:2048
  buffer_load_dwordx4 v[188:191], v208, s[8:11], s70 offen offset:3072
  s_add_u32 s70, s70, 4096
  buffer_load_dwordx4 v[192:195], v208, s[8:11], s70 offen offset:0
  buffer_load_dwordx4 v[196:199], v208, s[8:11], s70 offen offset:1024
  buffer_load_dwordx4 v[200:203], v208, s[8:11], s70 offen offset:2048
  buffer_load_dwordx4 v[204:207], v208, s[8:11], s70 offen offset:3072
  s_add_u32 s70, s70, 4096
  v_mov_b32 v240, 0x3f803f80
  s_mov_b32 s76, 0x7060500
  s_mov_b32 s77, 0x7060501
  s_mov_b32 s78, 0x7060502
  s_mov_b32 s79, 0x7060503
  s_mov_b32 s96, s74
  v_lshrrev_b32 v3, 1, v0
  v_add_u32 v3, s63, v3
  v_lshlrev_b32 v3, 12, v3
  v_and_b32_e64 v4, 1, v0
  v_lshl_add_u32 v210, v4, 7, v3
  s_waitcnt vmcnt(47)
  v_dot2_f32_bf16 v212, v16, v240, 0
  v_dot2_f32_bf16 v214, v16, v16, 0
  s_waitcnt vmcnt(45)
  v_dot2_f32_bf16 v213, v24, v240, 0
  v_dot2_f32_bf16 v215, v24, v24, 0
  s_waitcnt vmcnt(43)
  v_dot2_f32_bf16 v216, v32, v240, 0
  v_dot2_f32_bf16 v218, v32, v32, 0
  s_waitcnt vmcnt(41)
  v_dot2_f32_bf16 v217, v40, v240, 0
  v_dot2_f32_bf16 v219, v40, v40, 0
  s_waitcnt vmcnt(39)
  v_dot2_f32_bf16 v220, v48, v240, 0
  v_dot2_f32_bf16 v222, v48, v48, 0
  s_waitcnt vmcnt(37)
  v_dot2_f32_bf16 v221, v56, v240, 0
  v_dot2_f32_bf16 v223, v56, v56, 0
  s_waitcnt vmcnt(35)
  v_dot2_f32_bf16 v224, v64, v240, 0
  v_dot2_f32_bf16 v226, v64, v64, 0
  s_waitcnt vmcnt(33)
  v_dot2_f32_bf16 v225, v72, v240, 0
  v_dot2_f32_bf16 v227, v72, v72, 0
  v_dot2c_f32_bf16 v212, v17, v240
  v_dot2c_f32_bf16 v214, v17, v17
  v_dot2c_f32_bf16 v213, v25, v240
  v_dot2c_f32_bf16 v215, v25, v25
  v_dot2c_f32_bf16 v216, v33, v240
  v_dot2c_f32_bf16 v218, v33, v33
  v_dot2c_f32_bf16 v217, v41, v240
  v_dot2c_f32_bf16 v219, v41, v41
  v_dot2c_f32_bf16 v220, v49, v240
  v_dot2c_f32_bf16 v222, v49, v49
  v_dot2c_f32_bf16 v221, v57, v240
  v_dot2c_f32_bf16 v223, v57, v57
  v_dot2c_f32_bf16 v224, v65, v240
  v_dot2c_f32_bf16 v226, v65, v65
  v_dot2c_f32_bf16 v225, v73, v240
  v_dot2c_f32_bf16 v227, v73, v73
  v_dot2c_f32_bf16 v212, v18, v240
  v_dot2c_f32_bf16 v214, v18, v18
  v_dot2c_f32_bf16 v213, v26, v240
  v_dot2c_f32_bf16 v215, v26, v26
  v_dot2c_f32_bf16 v216, v34, v240
  v_dot2c_f32_bf16 v218, v34, v34
  v_dot2c_f32_bf16 v217, v42, v240
  v_dot2c_f32_bf16 v219, v42, v42
  v_dot2c_f32_bf16 v220, v50, v240
  v_dot2c_f32_bf16 v222, v50, v50
  v_dot2c_f32_bf16 v221, v58, v240
  v_dot2c_f32_bf16 v223, v58, v58
  v_dot2c_f32_bf16 v224, v66, v240
  v_dot2c_f32_bf16 v226, v66, v66
  v_dot2c_f32_bf16 v225, v74, v240
  v_dot2c_f32_bf16 v227, v74, v74
  v_dot2c_f32_bf16 v212, v19, v240
  v_dot2c_f32_bf16 v214, v19, v19
  v_dot2c_f32_bf16 v213, v27, v240
  v_dot2c_f32_bf16 v215, v27, v27
  v_dot2c_f32_bf16 v216, v35, v240
  v_dot2c_f32_bf16 v218, v35, v35
  v_dot2c_f32_bf16 v217, v43, v240
  v_dot2c_f32_bf16 v219, v43, v43
  v_dot2c_f32_bf16 v220, v51, v240
  v_dot2c_f32_bf16 v222, v51, v51
  v_dot2c_f32_bf16 v221, v59, v240
  v_dot2c_f32_bf16 v223, v59, v59
  v_dot2c_f32_bf16 v224, v67, v240
  v_dot2c_f32_bf16 v226, v67, v67
  v_dot2c_f32_bf16 v225, v75, v240
  v_dot2c_f32_bf16 v227, v75, v75
  v_dot2c_f32_bf16 v212, v20, v240
  v_dot2c_f32_bf16 v214, v20, v20
  v_dot2c_f32_bf16 v213, v28, v240
  v_dot2c_f32_bf16 v215, v28, v28
  v_dot2c_f32_bf16 v216, v36, v240
  v_dot2c_f32_bf16 v218, v36, v36
  v_dot2c_f32_bf16 v217, v44, v240
  v_dot2c_f32_bf16 v219, v44, v44
  v_dot2c_f32_bf16 v220, v52, v240
  v_dot2c_f32_bf16 v222, v52, v52
  v_dot2c_f32_bf16 v221, v60, v240
  v_dot2c_f32_bf16 v223, v60, v60
  v_dot2c_f32_bf16 v224, v68, v240
  v_dot2c_f32_bf16 v226, v68, v68
  s_waitcnt vmcnt(32)
  v_dot2c_f32_bf16 v225, v76, v240
  v_dot2c_f32_bf16 v227, v76, v76
  v_dot2c_f32_bf16 v212, v21, v240
  v_dot2c_f32_bf16 v214, v21, v21
  v_dot2c_f32_bf16 v213, v29, v240
  v_dot2c_f32_bf16 v215, v29, v29
  v_dot2c_f32_bf16 v216, v37, v240
  v_dot2c_f32_bf16 v218, v37, v37
  v_dot2c_f32_bf16 v217, v45, v240
  v_dot2c_f32_bf16 v219, v45, v45
  v_dot2c_f32_bf16 v220, v53, v240
  v_dot2c_f32_bf16 v222, v53, v53
  v_dot2c_f32_bf16 v221, v61, v240
  v_dot2c_f32_bf16 v223, v61, v61
  v_dot2c_f32_bf16 v224, v69, v240
  v_dot2c_f32_bf16 v226, v69, v69
  v_dot2c_f32_bf16 v225, v77, v240
  v_dot2c_f32_bf16 v227, v77, v77
  v_dot2c_f32_bf16 v212, v22, v240
  v_dot2c_f32_bf16 v214, v22, v22
  v_dot2c_f32_bf16 v213, v30, v240
  v_dot2c_f32_bf16 v215, v30, v30
  v_dot2c_f32_bf16 v216, v38, v240
  v_dot2c_f32_bf16 v218, v38, v38
  v_dot2c_f32_bf16 v217, v46, v240
  v_dot2c_f32_bf16 v219, v46, v46
  v_dot2c_f32_bf16 v220, v54, v240
  v_dot2c_f32_bf16 v222, v54, v54
  v_dot2c_f32_bf16 v221, v62, v240
  v_dot2c_f32_bf16 v223, v62, v62
  v_dot2c_f32_bf16 v224, v70, v240
  v_dot2c_f32_bf16 v226, v70, v70
  v_dot2c_f32_bf16 v225, v78, v240
  v_dot2c_f32_bf16 v227, v78, v78
  v_dot2c_f32_bf16 v212, v23, v240
  v_dot2c_f32_bf16 v214, v23, v23
  v_dot2c_f32_bf16 v213, v31, v240
  v_dot2c_f32_bf16 v215, v31, v31
  v_dot2c_f32_bf16 v216, v39, v240
  v_dot2c_f32_bf16 v218, v39, v39
  v_dot2c_f32_bf16 v217, v47, v240
  v_dot2c_f32_bf16 v219, v47, v47
  v_dot2c_f32_bf16 v220, v55, v240
  v_dot2c_f32_bf16 v222, v55, v55
  v_dot2c_f32_bf16 v221, v63, v240
  v_dot2c_f32_bf16 v223, v63, v63
  v_dot2c_f32_bf16 v224, v71, v240
  v_dot2c_f32_bf16 v226, v71, v71
  v_dot2c_f32_bf16 v225, v79, v240
  v_dot2c_f32_bf16_e64 v227, v79, v79
  buffer_load_dwordx4 v[16:19], v208, s[8:11], s70 offen offset:0
  buffer_load_dwordx4 v[20:23], v208, s[8:11], s70 offen offset:1024
  buffer_load_dwordx4 v[24:27], v208, s[8:11], s70 offen offset:2048
  buffer_load_dwordx4 v[28:31], v208, s[8:11], s70 offen offset:3072
  s_add_u32 s70, s70, 4096
  buffer_load_dwordx4 v[32:35], v208, s[8:11], s70 offen offset:0
  buffer_load_dwordx4 v[36:39], v208, s[8:11], s70 offen offset:1024
  buffer_load_dwordx4 v[40:43], v208, s[8:11], s70 offen offset:2048
  buffer_load_dwordx4 v[44:47], v208, s[8:11], s70 offen offset:3072
  s_add_u32 s70, s70, 4096
  buffer_load_dwordx4 v[48:51], v208, s[8:11], s70 offen offset:0
  buffer_load_dwordx4 v[52:55], v208, s[8:11], s70 offen offset:1024
  buffer_load_dwordx4 v[56:59], v208, s[8:11], s70 offen offset:2048
  buffer_load_dwordx4 v[60:63], v208, s[8:11], s70 offen offset:3072
  s_add_u32 s70, s70, 4096
  buffer_load_dwordx4 v[64:67], v208, s[8:11], s70 offen offset:0
  buffer_load_dwordx4 v[68:71], v208, s[8:11], s70 offen offset:1024
  buffer_load_dwordx4 v[72:75], v208, s[8:11], s70 offen offset:2048
  buffer_load_dwordx4 v[76:79], v208, s[8:11], s70 offen offset:3072
  s_add_u32 s70, s70, 4096
  buffer_load_dword v13, v10, s[56:59], 0 offen sc0 sc1
  s_xor_b32 s97, s96, 0
  s_lshl_b32 s97, s97, 8
  buffer_load_dword v211, v210, s[40:43], s97 offen
  v_add_f32_dpp v212, v212, v212 row_ror:8 row_mask:0xf bank_mask:0x3
  v_add_f32_dpp v213, v213, v213 row_ror:8 row_mask:0xf bank_mask:0x3
  v_add_f32_dpp v214, v214, v214 row_ror:8 row_mask:0xf bank_mask:0x3
  v_add_f32_dpp v215, v215, v215 row_ror:8 row_mask:0xf bank_mask:0x3
  v_add_f32_dpp v216, v216, v216 row_ror:8 row_mask:0xf bank_mask:0x3
  v_add_f32_dpp v217, v217, v217 row_ror:8 row_mask:0xf bank_mask:0x3
  v_add_f32_dpp v218, v218, v218 row_ror:8 row_mask:0xf bank_mask:0x3
  v_add_f32_dpp v219, v219, v219 row_ror:8 row_mask:0xf bank_mask:0x3
  v_add_f32_dpp v212, v220, v220 row_ror:8 row_mask:0xf bank_mask:0xc
  v_add_f32_dpp v213, v221, v221 row_ror:8 row_mask:0xf bank_mask:0xc
  v_add_f32_dpp v214, v222, v222 row_ror:8 row_mask:0xf bank_mask:0xc
  v_add_f32_dpp v215, v223, v223 row_ror:8 row_mask:0xf bank_mask:0xc
  v_add_f32_dpp v216, v224, v224 row_ror:8 row_mask:0xf bank_mask:0xc
  v_add_f32_dpp v217, v225, v225 row_ror:8 row_mask:0xf bank_mask:0xc
  v_add_f32_dpp v218, v226, v226 row_ror:8 row_mask:0xf bank_mask:0xc
  v_add_f32_dpp v219, v227, v227 row_ror:8 row_mask:0xf bank_mask:0xc
  v_add_f32_dpp v212, v212, v212 row_half_mirror row_mask:0xf bank_mask:0x5
  v_add_f32_dpp v213, v213, v213 row_half_mirror row_mask:0xf bank_mask:0x5
  v_add_f32_dpp v214, v214, v214 row_half_mirror row_mask:0xf bank_mask:0x5
  v_add_f32_dpp v215, v215, v215 row_half_mirror row_mask:0xf bank_mask:0x5
  v_add_f32_dpp v212, v216, v216 row_half_mirror row_mask:0xf bank_mask:0xa
  v_add_f32_dpp v213, v217, v217 row_half_mirror row_mask:0xf bank_mask:0xa
  v_add_f32_dpp v214, v218, v218 row_half_mirror row_mask:0xf bank_mask:0xa
  v_add_f32_dpp v215, v219, v219 row_half_mirror row_mask:0xf bank_mask:0xa
  v_add_f32_dpp v212, v212, v212 quad_perm:[1,0,3,2] row_mask:0xf bank_mask:0xf
  v_add_f32_dpp v213, v213, v213 quad_perm:[1,0,3,2] row_mask:0xf bank_mask:0xf
  v_add_f32_dpp v214, v214, v214 quad_perm:[1,0,3,2] row_mask:0xf bank_mask:0xf
  v_add_f32_dpp v215, v215, v215 quad_perm:[1,0,3,2] row_mask:0xf bank_mask:0xf
  v_add_f32_dpp v212, v212, v212 quad_perm:[2,3,0,1] row_mask:0xf bank_mask:0xf
  v_add_f32_dpp v213, v213, v213 quad_perm:[2,3,0,1] row_mask:0xf bank_mask:0xf
  v_add_f32_dpp v214, v214, v214 quad_perm:[2,3,0,1] row_mask:0xf bank_mask:0xf
  v_add_f32_dpp v215, v215, v215 quad_perm:[2,3,0,1] row_mask:0xf bank_mask:0xf
  s_waitcnt vmcnt(49)
  v_dot2_f32_bf16 v216, v80, v240, 0
  v_dot2_f32_bf16 v218, v80, v80, 0
  s_waitcnt vmcnt(47)
  v_dot2_f32_bf16 v217, v88, v240, 0
  v_dot2_f32_bf16 v219, v88, v88, 0
  s_waitcnt vmcnt(45)
  v_dot2_f32_bf16 v220, v96, v240, 0
  v_dot2_f32_bf16 v222, v96, v96, 0
  s_waitcnt vmcnt(43)
  v_dot2_f32_bf16 v221, v104, v240, 0
  v_dot2_f32_bf16 v223, v104, v104, 0
  s_waitcnt vmcnt(41)
  v_dot2_f32_bf16 v224, v112, v240, 0
  v_dot2_f32_bf16 v226, v112, v112, 0
  s_waitcnt vmcnt(39)
  v_dot2_f32_bf16 v225, v120, v240, 0
  v_dot2_f32_bf16 v227, v120, v120, 0
  s_waitcnt vmcnt(37)
  v_dot2_f32_bf16 v228, v128, v240, 0
  v_dot2_f32_bf16 v230, v128, v128, 0
  s_waitcnt vmcnt(35)
  v_dot2_f32_bf16 v229, v136, v240, 0
  v_dot2_f32_bf16 v231, v136, v136, 0
  v_dot2c_f32_bf16 v216, v81, v240
  v_dot2c_f32_bf16 v218, v81, v81
  v_dot2c_f32_bf16 v217, v89, v240
  v_dot2c_f32_bf16 v219, v89, v89
  v_dot2c_f32_bf16 v220, v97, v240
  v_dot2c_f32_bf16 v222, v97, v97
  v_dot2c_f32_bf16 v221, v105, v240
  v_dot2c_f32_bf16 v223, v105, v105
  v_dot2c_f32_bf16 v224, v113, v240
  v_dot2c_f32_bf16 v226, v113, v113
  v_dot2c_f32_bf16 v225, v121, v240
  v_dot2c_f32_bf16 v227, v121, v121
  v_dot2c_f32_bf16 v228, v129, v240
  v_dot2c_f32_bf16 v230, v129, v129
  v_dot2c_f32_bf16 v229, v137, v240
  v_dot2c_f32_bf16 v231, v137, v137
  v_dot2c_f32_bf16 v216, v82, v240
  v_dot2c_f32_bf16 v218, v82, v82
  v_dot2c_f32_bf16 v217, v90, v240
  v_dot2c_f32_bf16 v219, v90, v90
  v_dot2c_f32_bf16 v220, v98, v240
  v_dot2c_f32_bf16 v222, v98, v98
  v_dot2c_f32_bf16 v221, v106, v240
  v_dot2c_f32_bf16 v223, v106, v106
  v_dot2c_f32_bf16 v224, v114, v240
  v_dot2c_f32_bf16 v226, v114, v114
  v_dot2c_f32_bf16 v225, v122, v240
  v_dot2c_f32_bf16 v227, v122, v122
  v_dot2c_f32_bf16 v228, v130, v240
  v_dot2c_f32_bf16 v230, v130, v130
  v_dot2c_f32_bf16 v229, v138, v240
  v_dot2c_f32_bf16 v231, v138, v138
  v_dot2c_f32_bf16 v216, v83, v240
  v_dot2c_f32_bf16 v218, v83, v83
  v_dot2c_f32_bf16 v217, v91, v240
  v_dot2c_f32_bf16 v219, v91, v91
  v_dot2c_f32_bf16 v220, v99, v240
  v_dot2c_f32_bf16 v222, v99, v99
  v_dot2c_f32_bf16 v221, v107, v240
  v_dot2c_f32_bf16 v223, v107, v107
  v_dot2c_f32_bf16 v224, v115, v240
  v_dot2c_f32_bf16 v226, v115, v115
  v_dot2c_f32_bf16 v225, v123, v240
  v_dot2c_f32_bf16 v227, v123, v123
  v_dot2c_f32_bf16 v228, v131, v240
  v_dot2c_f32_bf16 v230, v131, v131
  v_dot2c_f32_bf16 v229, v139, v240
  v_dot2c_f32_bf16 v231, v139, v139
  v_dot2c_f32_bf16 v216, v84, v240
  v_dot2c_f32_bf16 v218, v84, v84
  v_dot2c_f32_bf16 v217, v92, v240
  v_dot2c_f32_bf16 v219, v92, v92
  v_dot2c_f32_bf16 v220, v100, v240
  v_dot2c_f32_bf16 v222, v100, v100
  v_dot2c_f32_bf16 v221, v108, v240
  v_dot2c_f32_bf16 v223, v108, v108
  v_dot2c_f32_bf16 v224, v116, v240
  v_dot2c_f32_bf16 v226, v116, v116
  v_dot2c_f32_bf16 v225, v124, v240
  v_dot2c_f32_bf16 v227, v124, v124
  v_dot2c_f32_bf16 v228, v132, v240
  v_dot2c_f32_bf16 v230, v132, v132
  s_waitcnt vmcnt(34)
  v_dot2c_f32_bf16 v229, v140, v240
  v_dot2c_f32_bf16 v231, v140, v140
  v_dot2c_f32_bf16 v216, v85, v240
  v_dot2c_f32_bf16 v218, v85, v85
  v_dot2c_f32_bf16 v217, v93, v240
  v_dot2c_f32_bf16 v219, v93, v93
  v_dot2c_f32_bf16 v220, v101, v240
  v_dot2c_f32_bf16 v222, v101, v101
  v_dot2c_f32_bf16 v221, v109, v240
  v_dot2c_f32_bf16 v223, v109, v109
  v_dot2c_f32_bf16 v224, v117, v240
  v_dot2c_f32_bf16 v226, v117, v117
  v_dot2c_f32_bf16 v225, v125, v240
  v_dot2c_f32_bf16 v227, v125, v125
  v_dot2c_f32_bf16 v228, v133, v240
  v_dot2c_f32_bf16 v230, v133, v133
  v_dot2c_f32_bf16 v229, v141, v240
  v_dot2c_f32_bf16 v231, v141, v141
  v_dot2c_f32_bf16 v216, v86, v240
  v_dot2c_f32_bf16 v218, v86, v86
  v_dot2c_f32_bf16 v217, v94, v240
  v_dot2c_f32_bf16 v219, v94, v94
  v_dot2c_f32_bf16 v220, v102, v240
  v_dot2c_f32_bf16 v222, v102, v102
  v_dot2c_f32_bf16 v221, v110, v240
  v_dot2c_f32_bf16 v223, v110, v110
  v_dot2c_f32_bf16 v224, v118, v240
  v_dot2c_f32_bf16 v226, v118, v118
  v_dot2c_f32_bf16 v225, v126, v240
  v_dot2c_f32_bf16 v227, v126, v126
  v_dot2c_f32_bf16 v228, v134, v240
  v_dot2c_f32_bf16 v230, v134, v134
  v_dot2c_f32_bf16 v229, v142, v240
  v_dot2c_f32_bf16 v231, v142, v142
  v_dot2c_f32_bf16 v216, v87, v240
  v_dot2c_f32_bf16 v218, v87, v87
  v_dot2c_f32_bf16 v217, v95, v240
  v_dot2c_f32_bf16 v219, v95, v95
  v_dot2c_f32_bf16 v220, v103, v240
  v_dot2c_f32_bf16 v222, v103, v103
  v_dot2c_f32_bf16 v221, v111, v240
  v_dot2c_f32_bf16 v223, v111, v111
  v_dot2c_f32_bf16 v224, v119, v240
  v_dot2c_f32_bf16 v226, v119, v119
  v_dot2c_f32_bf16 v225, v127, v240
  v_dot2c_f32_bf16 v227, v127, v127
  v_dot2c_f32_bf16 v228, v135, v240
  v_dot2c_f32_bf16 v230, v135, v135
  v_dot2c_f32_bf16 v229, v143, v240
  v_dot2c_f32_bf16_e64 v231, v143, v143
  v_add_f32_dpp v216, v216, v216 row_ror:8 row_mask:0xf bank_mask:0x3
  v_add_f32_dpp v217, v217, v217 row_ror:8 row_mask:0xf bank_mask:0x3
  v_add_f32_dpp v218, v218, v218 row_ror:8 row_mask:0xf bank_mask:0x3
  v_add_f32_dpp v219, v219, v219 row_ror:8 row_mask:0xf bank_mask:0x3
  v_add_f32_dpp v220, v220, v220 row_ror:8 row_mask:0xf bank_mask:0x3
  v_add_f32_dpp v221, v221, v221 row_ror:8 row_mask:0xf bank_mask:0x3
  v_add_f32_dpp v222, v222, v222 row_ror:8 row_mask:0xf bank_mask:0x3
  v_add_f32_dpp v223, v223, v223 row_ror:8 row_mask:0xf bank_mask:0x3
  v_add_f32_dpp v216, v224, v224 row_ror:8 row_mask:0xf bank_mask:0xc
  v_add_f32_dpp v217, v225, v225 row_ror:8 row_mask:0xf bank_mask:0xc
  v_add_f32_dpp v218, v226, v226 row_ror:8 row_mask:0xf bank_mask:0xc
  v_add_f32_dpp v219, v227, v227 row_ror:8 row_mask:0xf bank_mask:0xc
  v_add_f32_dpp v220, v228, v228 row_ror:8 row_mask:0xf bank_mask:0xc
  v_add_f32_dpp v221, v229, v229 row_ror:8 row_mask:0xf bank_mask:0xc
  v_add_f32_dpp v222, v230, v230 row_ror:8 row_mask:0xf bank_mask:0xc
  v_add_f32_dpp v223, v231, v231 row_ror:8 row_mask:0xf bank_mask:0xc
  v_add_f32_dpp v216, v216, v216 row_half_mirror row_mask:0xf bank_mask:0x5
  v_add_f32_dpp v217, v217, v217 row_half_mirror row_mask:0xf bank_mask:0x5
  v_add_f32_dpp v218, v218, v218 row_half_mirror row_mask:0xf bank_mask:0x5
  v_add_f32_dpp v219, v219, v219 row_half_mirror row_mask:0xf bank_mask:0x5
  v_add_f32_dpp v216, v220, v220 row_half_mirror row_mask:0xf bank_mask:0xa
  v_add_f32_dpp v217, v221, v221 row_half_mirror row_mask:0xf bank_mask:0xa
  v_add_f32_dpp v218, v222, v222 row_half_mirror row_mask:0xf bank_mask:0xa
  v_add_f32_dpp v219, v223, v223 row_half_mirror row_mask:0xf bank_mask:0xa
  v_add_f32_dpp v216, v216, v216 quad_perm:[1,0,3,2] row_mask:0xf bank_mask:0xf
  v_add_f32_dpp v217, v217, v217 quad_perm:[1,0,3,2] row_mask:0xf bank_mask:0xf
  v_add_f32_dpp v218, v218, v218 quad_perm:[1,0,3,2] row_mask:0xf bank_mask:0xf
  v_add_f32_dpp v219, v219, v219 quad_perm:[1,0,3,2] row_mask:0xf bank_mask:0xf
  v_add_f32_dpp v216, v216, v216 quad_perm:[2,3,0,1] row_mask:0xf bank_mask:0xf
  v_add_f32_dpp v217, v217, v217 quad_perm:[2,3,0,1] row_mask:0xf bank_mask:0xf
  v_add_f32_dpp v218, v218, v218 quad_perm:[2,3,0,1] row_mask:0xf bank_mask:0xf
  v_add_f32_dpp v219, v219, v219 quad_perm:[2,3,0,1] row_mask:0xf bank_mask:0xf
  s_waitcnt vmcnt(33)
  v_dot2_f32_bf16 v220, v144, v240, 0
  v_dot2_f32_bf16 v222, v144, v144, 0
  s_waitcnt vmcnt(31)
  v_dot2_f32_bf16 v221, v152, v240, 0
  v_dot2_f32_bf16 v223, v152, v152, 0
  s_waitcnt vmcnt(29)
  v_dot2_f32_bf16 v224, v160, v240, 0
  v_dot2_f32_bf16 v226, v160, v160, 0
  s_waitcnt vmcnt(27)
  v_dot2_f32_bf16 v225, v168, v240, 0
  v_dot2_f32_bf16 v227, v168, v168, 0
  s_waitcnt vmcnt(25)
  v_dot2_f32_bf16 v228, v176, v240, 0
  v_dot2_f32_bf16 v230, v176, v176, 0
  s_waitcnt vmcnt(23)
  v_dot2_f32_bf16 v229, v184, v240, 0
  v_dot2_f32_bf16 v231, v184, v184, 0
  s_waitcnt vmcnt(21)
  v_dot2_f32_bf16 v232, v192, v240, 0
  v_dot2_f32_bf16 v234, v192, v192, 0
  s_waitcnt vmcnt(19)
  v_dot2_f32_bf16 v233, v200, v240, 0
  v_dot2_f32_bf16 v235, v200, v200, 0
  v_dot2c_f32_bf16 v220, v145, v240
  v_dot2c_f32_bf16 v222, v145, v145
  v_dot2c_f32_bf16 v221, v153, v240
  v_dot2c_f32_bf16 v223, v153, v153
  v_dot2c_f32_bf16 v224, v161, v240
  v_dot2c_f32_bf16 v226, v161, v161
  v_dot2c_f32_bf16 v225, v169, v240
  v_dot2c_f32_bf16 v227, v169, v169
  v_dot2c_f32_bf16 v228, v177, v240
  v_dot2c_f32_bf16 v230, v177, v177
  v_dot2c_f32_bf16 v229, v185, v240
  v_dot2c_f32_bf16 v231, v185, v185
  v_dot2c_f32_bf16 v232, v193, v240
  v_dot2c_f32_bf16 v234, v193, v193
  v_dot2c_f32_bf16 v233, v201, v240
  v_dot2c_f32_bf16 v235, v201, v201
  v_dot2c_f32_bf16 v220, v146, v240
  v_dot2c_f32_bf16 v222, v146, v146
  v_dot2c_f32_bf16 v221, v154, v240
  v_dot2c_f32_bf16 v223, v154, v154
  v_dot2c_f32_bf16 v224, v162, v240
  v_dot2c_f32_bf16 v226, v162, v162
  v_dot2c_f32_bf16 v225, v170, v240
  v_dot2c_f32_bf16 v227, v170, v170
  v_dot2c_f32_bf16 v228, v178, v240
  v_dot2c_f32_bf16 v230, v178, v178
  v_dot2c_f32_bf16 v229, v186, v240
  v_dot2c_f32_bf16 v231, v186, v186
  v_dot2c_f32_bf16 v232, v194, v240
  v_dot2c_f32_bf16 v234, v194, v194
  v_dot2c_f32_bf16 v233, v202, v240
  v_dot2c_f32_bf16 v235, v202, v202
  v_dot2c_f32_bf16 v220, v147, v240
  v_dot2c_f32_bf16 v222, v147, v147
  v_dot2c_f32_bf16 v221, v155, v240
  v_dot2c_f32_bf16 v223, v155, v155
  v_dot2c_f32_bf16 v224, v163, v240
  v_dot2c_f32_bf16 v226, v163, v163
  v_dot2c_f32_bf16 v225, v171, v240
  v_dot2c_f32_bf16 v227, v171, v171
  v_dot2c_f32_bf16 v228, v179, v240
  v_dot2c_f32_bf16 v230, v179, v179
  v_dot2c_f32_bf16 v229, v187, v240
  v_dot2c_f32_bf16 v231, v187, v187
  v_dot2c_f32_bf16 v232, v195, v240
  v_dot2c_f32_bf16 v234, v195, v195
  v_dot2c_f32_bf16 v233, v203, v240
  v_dot2c_f32_bf16 v235, v203, v203
  v_dot2c_f32_bf16 v220, v148, v240
  v_dot2c_f32_bf16 v222, v148, v148
  v_dot2c_f32_bf16 v221, v156, v240
  v_dot2c_f32_bf16 v223, v156, v156
  v_dot2c_f32_bf16 v224, v164, v240
  v_dot2c_f32_bf16 v226, v164, v164
  v_dot2c_f32_bf16 v225, v172, v240
  v_dot2c_f32_bf16 v227, v172, v172
  v_dot2c_f32_bf16 v228, v180, v240
  v_dot2c_f32_bf16 v230, v180, v180
  v_dot2c_f32_bf16 v229, v188, v240
  v_dot2c_f32_bf16 v231, v188, v188
  v_dot2c_f32_bf16 v232, v196, v240
  v_dot2c_f32_bf16 v234, v196, v196
  s_waitcnt vmcnt(18)
  v_dot2c_f32_bf16 v233, v204, v240
  v_dot2c_f32_bf16 v235, v204, v204
  v_dot2c_f32_bf16 v220, v149, v240
  v_dot2c_f32_bf16 v222, v149, v149
  v_dot2c_f32_bf16 v221, v157, v240
  v_dot2c_f32_bf16 v223, v157, v157
  v_dot2c_f32_bf16 v224, v165, v240
  v_dot2c_f32_bf16 v226, v165, v165
  v_dot2c_f32_bf16 v225, v173, v240
  v_dot2c_f32_bf16 v227, v173, v173
  v_dot2c_f32_bf16 v228, v181, v240
  v_dot2c_f32_bf16 v230, v181, v181
  v_dot2c_f32_bf16 v229, v189, v240
  v_dot2c_f32_bf16 v231, v189, v189
  v_dot2c_f32_bf16 v232, v197, v240
  v_dot2c_f32_bf16 v234, v197, v197
  v_dot2c_f32_bf16 v233, v205, v240
  v_dot2c_f32_bf16 v235, v205, v205
  v_dot2c_f32_bf16 v220, v150, v240
  v_dot2c_f32_bf16 v222, v150, v150
  v_dot2c_f32_bf16 v221, v158, v240
  v_dot2c_f32_bf16 v223, v158, v158
  v_dot2c_f32_bf16 v224, v166, v240
  v_dot2c_f32_bf16 v226, v166, v166
  v_dot2c_f32_bf16 v225, v174, v240
  v_dot2c_f32_bf16 v227, v174, v174
  v_dot2c_f32_bf16 v228, v182, v240
  v_dot2c_f32_bf16 v230, v182, v182
  v_dot2c_f32_bf16 v229, v190, v240
  v_dot2c_f32_bf16 v231, v190, v190
  v_dot2c_f32_bf16 v232, v198, v240
  v_dot2c_f32_bf16 v234, v198, v198
  v_dot2c_f32_bf16 v233, v206, v240
  v_dot2c_f32_bf16 v235, v206, v206
  v_dot2c_f32_bf16 v220, v151, v240
  v_dot2c_f32_bf16 v222, v151, v151
  v_dot2c_f32_bf16 v221, v159, v240
  v_dot2c_f32_bf16 v223, v159, v159
  v_dot2c_f32_bf16 v224, v167, v240
  v_dot2c_f32_bf16 v226, v167, v167
  v_dot2c_f32_bf16 v225, v175, v240
  v_dot2c_f32_bf16 v227, v175, v175
  v_dot2c_f32_bf16 v228, v183, v240
  v_dot2c_f32_bf16 v230, v183, v183
  v_dot2c_f32_bf16 v229, v191, v240
  v_dot2c_f32_bf16 v231, v191, v191
  v_dot2c_f32_bf16 v232, v199, v240
  v_dot2c_f32_bf16 v234, v199, v199
  v_dot2c_f32_bf16 v233, v207, v240
  v_dot2c_f32_bf16_e64 v235, v207, v207
  v_add_f32_dpp v220, v220, v220 row_ror:8 row_mask:0xf bank_mask:0x3
  v_add_f32_dpp v221, v221, v221 row_ror:8 row_mask:0xf bank_mask:0x3
  v_add_f32_dpp v222, v222, v222 row_ror:8 row_mask:0xf bank_mask:0x3
  v_add_f32_dpp v223, v223, v223 row_ror:8 row_mask:0xf bank_mask:0x3
  v_add_f32_dpp v224, v224, v224 row_ror:8 row_mask:0xf bank_mask:0x3
  v_add_f32_dpp v225, v225, v225 row_ror:8 row_mask:0xf bank_mask:0x3
  v_add_f32_dpp v226, v226, v226 row_ror:8 row_mask:0xf bank_mask:0x3
  v_add_f32_dpp v227, v227, v227 row_ror:8 row_mask:0xf bank_mask:0x3
  v_add_f32_dpp v220, v228, v228 row_ror:8 row_mask:0xf bank_mask:0xc
  v_add_f32_dpp v221, v229, v229 row_ror:8 row_mask:0xf bank_mask:0xc
  v_add_f32_dpp v222, v230, v230 row_ror:8 row_mask:0xf bank_mask:0xc
  v_add_f32_dpp v223, v231, v231 row_ror:8 row_mask:0xf bank_mask:0xc
  v_add_f32_dpp v224, v232, v232 row_ror:8 row_mask:0xf bank_mask:0xc
  v_add_f32_dpp v225, v233, v233 row_ror:8 row_mask:0xf bank_mask:0xc
  v_add_f32_dpp v226, v234, v234 row_ror:8 row_mask:0xf bank_mask:0xc
  v_add_f32_dpp v227, v235, v235 row_ror:8 row_mask:0xf bank_mask:0xc
  v_add_f32_dpp v220, v220, v220 row_half_mirror row_mask:0xf bank_mask:0x5
  v_add_f32_dpp v221, v221, v221 row_half_mirror row_mask:0xf bank_mask:0x5
  v_add_f32_dpp v222, v222, v222 row_half_mirror row_mask:0xf bank_mask:0x5
  v_add_f32_dpp v223, v223, v223 row_half_mirror row_mask:0xf bank_mask:0x5
  v_add_f32_dpp v220, v224, v224 row_half_mirror row_mask:0xf bank_mask:0xa
  v_add_f32_dpp v221, v225, v225 row_half_mirror row_mask:0xf bank_mask:0xa
  v_add_f32_dpp v222, v226, v226 row_half_mirror row_mask:0xf bank_mask:0xa
  v_add_f32_dpp v223, v227, v227 row_half_mirror row_mask:0xf bank_mask:0xa
  v_add_f32_dpp v220, v220, v220 quad_perm:[1,0,3,2] row_mask:0xf bank_mask:0xf
  v_add_f32_dpp v221, v221, v221 quad_perm:[1,0,3,2] row_mask:0xf bank_mask:0xf
  v_add_f32_dpp v222, v222, v222 quad_perm:[1,0,3,2] row_mask:0xf bank_mask:0xf
  v_add_f32_dpp v223, v223, v223 quad_perm:[1,0,3,2] row_mask:0xf bank_mask:0xf
  v_add_f32_dpp v220, v220, v220 quad_perm:[2,3,0,1] row_mask:0xf bank_mask:0xf
  v_add_f32_dpp v221, v221, v221 quad_perm:[2,3,0,1] row_mask:0xf bank_mask:0xf
  v_add_f32_dpp v222, v222, v222 quad_perm:[2,3,0,1] row_mask:0xf bank_mask:0xf
  v_add_f32_dpp v223, v223, v223 quad_perm:[2,3,0,1] row_mask:0xf bank_mask:0xf
  s_waitcnt vmcnt(17)
  v_dot2_f32_bf16 v224, v16, v240, 0
  v_dot2_f32_bf16 v226, v16, v16, 0
  s_waitcnt vmcnt(15)
  v_dot2_f32_bf16 v225, v24, v240, 0
  v_dot2_f32_bf16 v227, v24, v24, 0
  s_waitcnt vmcnt(13)
  v_dot2_f32_bf16 v228, v32, v240, 0
  v_dot2_f32_bf16 v230, v32, v32, 0
  s_waitcnt vmcnt(11)
  v_dot2_f32_bf16 v229, v40, v240, 0
  v_dot2_f32_bf16 v231, v40, v40, 0
  s_waitcnt vmcnt(9)
  v_dot2_f32_bf16 v232, v48, v240, 0
  v_dot2_f32_bf16 v234, v48, v48, 0
  s_waitcnt vmcnt(7)
  v_dot2_f32_bf16 v233, v56, v240, 0
  v_dot2_f32_bf16 v235, v56, v56, 0
  s_waitcnt vmcnt(5)
  v_dot2_f32_bf16 v236, v64, v240, 0
  v_dot2_f32_bf16 v238, v64, v64, 0
  s_waitcnt vmcnt(3)
  v_dot2_f32_bf16 v237, v72, v240, 0
  v_dot2_f32_bf16 v239, v72, v72, 0
  v_dot2c_f32_bf16 v224, v17, v240
  v_dot2c_f32_bf16 v226, v17, v17
  v_dot2c_f32_bf16 v225, v25, v240
  v_dot2c_f32_bf16 v227, v25, v25
  v_dot2c_f32_bf16 v228, v33, v240
  v_dot2c_f32_bf16 v230, v33, v33
  v_dot2c_f32_bf16 v229, v41, v240
  v_dot2c_f32_bf16 v231, v41, v41
  v_dot2c_f32_bf16 v232, v49, v240
  v_dot2c_f32_bf16 v234, v49, v49
  v_dot2c_f32_bf16 v233, v57, v240
  v_dot2c_f32_bf16 v235, v57, v57
  v_dot2c_f32_bf16 v236, v65, v240
  v_dot2c_f32_bf16 v238, v65, v65
  v_dot2c_f32_bf16 v237, v73, v240
  v_dot2c_f32_bf16 v239, v73, v73
  v_dot2c_f32_bf16 v224, v18, v240
  v_dot2c_f32_bf16 v226, v18, v18
  v_dot2c_f32_bf16 v225, v26, v240
  v_dot2c_f32_bf16 v227, v26, v26
  v_dot2c_f32_bf16 v228, v34, v240
  v_dot2c_f32_bf16 v230, v34, v34
  v_dot2c_f32_bf16 v229, v42, v240
  v_dot2c_f32_bf16 v231, v42, v42
  v_dot2c_f32_bf16 v232, v50, v240
  v_dot2c_f32_bf16 v234, v50, v50
  v_dot2c_f32_bf16 v233, v58, v240
  v_dot2c_f32_bf16 v235, v58, v58
  v_dot2c_f32_bf16 v236, v66, v240
  v_dot2c_f32_bf16 v238, v66, v66
  v_dot2c_f32_bf16 v237, v74, v240
  v_dot2c_f32_bf16 v239, v74, v74
  v_dot2c_f32_bf16 v224, v19, v240
  v_dot2c_f32_bf16 v226, v19, v19
  v_dot2c_f32_bf16 v225, v27, v240
  v_dot2c_f32_bf16 v227, v27, v27
  v_dot2c_f32_bf16 v228, v35, v240
  v_dot2c_f32_bf16 v230, v35, v35
  v_dot2c_f32_bf16 v229, v43, v240
  v_dot2c_f32_bf16 v231, v43, v43
  v_dot2c_f32_bf16 v232, v51, v240
  v_dot2c_f32_bf16 v234, v51, v51
  v_dot2c_f32_bf16 v233, v59, v240
  v_dot2c_f32_bf16 v235, v59, v59
  v_dot2c_f32_bf16 v236, v67, v240
  v_dot2c_f32_bf16 v238, v67, v67
  v_dot2c_f32_bf16 v237, v75, v240
  v_dot2c_f32_bf16 v239, v75, v75
  v_dot2c_f32_bf16 v224, v20, v240
  v_dot2c_f32_bf16 v226, v20, v20
  v_dot2c_f32_bf16 v225, v28, v240
  v_dot2c_f32_bf16 v227, v28, v28
  v_dot2c_f32_bf16 v228, v36, v240
  v_dot2c_f32_bf16 v230, v36, v36
  v_dot2c_f32_bf16 v229, v44, v240
  v_dot2c_f32_bf16 v231, v44, v44
  v_dot2c_f32_bf16 v232, v52, v240
  v_dot2c_f32_bf16 v234, v52, v52
  v_dot2c_f32_bf16 v233, v60, v240
  v_dot2c_f32_bf16 v235, v60, v60
  v_dot2c_f32_bf16 v236, v68, v240
  v_dot2c_f32_bf16 v238, v68, v68
  s_waitcnt vmcnt(2)
  v_dot2c_f32_bf16 v237, v76, v240
  v_dot2c_f32_bf16 v239, v76, v76
  v_dot2c_f32_bf16 v224, v21, v240
  v_dot2c_f32_bf16 v226, v21, v21
  v_dot2c_f32_bf16 v225, v29, v240
  v_dot2c_f32_bf16 v227, v29, v29
  v_dot2c_f32_bf16 v228, v37, v240
  v_dot2c_f32_bf16 v230, v37, v37
  v_dot2c_f32_bf16 v229, v45, v240
  v_dot2c_f32_bf16 v231, v45, v45
  v_dot2c_f32_bf16 v232, v53, v240
  v_dot2c_f32_bf16 v234, v53, v53
  v_dot2c_f32_bf16 v233, v61, v240
  v_dot2c_f32_bf16 v235, v61, v61
  v_dot2c_f32_bf16 v236, v69, v240
  v_dot2c_f32_bf16 v238, v69, v69
  v_dot2c_f32_bf16 v237, v77, v240
  v_dot2c_f32_bf16 v239, v77, v77
  v_dot2c_f32_bf16 v224, v22, v240
  v_dot2c_f32_bf16 v226, v22, v22
  v_dot2c_f32_bf16 v225, v30, v240
  v_dot2c_f32_bf16 v227, v30, v30
  v_dot2c_f32_bf16 v228, v38, v240
  v_dot2c_f32_bf16 v230, v38, v38
  v_dot2c_f32_bf16 v229, v46, v240
  v_dot2c_f32_bf16 v231, v46, v46
  v_dot2c_f32_bf16 v232, v54, v240
  v_dot2c_f32_bf16 v234, v54, v54
  v_dot2c_f32_bf16 v233, v62, v240
  v_dot2c_f32_bf16 v235, v62, v62
  v_dot2c_f32_bf16 v236, v70, v240
  v_dot2c_f32_bf16 v238, v70, v70
  v_dot2c_f32_bf16 v237, v78, v240
  v_dot2c_f32_bf16 v239, v78, v78
  v_dot2c_f32_bf16 v224, v23, v240
  v_dot2c_f32_bf16 v226, v23, v23
  v_dot2c_f32_bf16 v225, v31, v240
  v_dot2c_f32_bf16 v227, v31, v31
  v_dot2c_f32_bf16 v228, v39, v240
  v_dot2c_f32_bf16 v230, v39, v39
  v_dot2c_f32_bf16 v229, v47, v240
  v_dot2c_f32_bf16 v231, v47, v47
  v_dot2c_f32_bf16 v232, v55, v240
  v_dot2c_f32_bf16 v234, v55, v55
  v_dot2c_f32_bf16 v233, v63, v240
  v_dot2c_f32_bf16 v235, v63, v63
  v_dot2c_f32_bf16 v236, v71, v240
  v_dot2c_f32_bf16 v238, v71, v71
  v_dot2c_f32_bf16 v237, v79, v240
  v_dot2c_f32_bf16_e64 v239, v79, v79
  v_add_f32_dpp v224, v224, v224 row_ror:8 row_mask:0xf bank_mask:0x3
  v_add_f32_dpp v225, v225, v225 row_ror:8 row_mask:0xf bank_mask:0x3
  v_add_f32_dpp v226, v226, v226 row_ror:8 row_mask:0xf bank_mask:0x3
  v_add_f32_dpp v227, v227, v227 row_ror:8 row_mask:0xf bank_mask:0x3
  v_add_f32_dpp v228, v228, v228 row_ror:8 row_mask:0xf bank_mask:0x3
  v_add_f32_dpp v229, v229, v229 row_ror:8 row_mask:0xf bank_mask:0x3
  v_add_f32_dpp v230, v230, v230 row_ror:8 row_mask:0xf bank_mask:0x3
  v_add_f32_dpp v231, v231, v231 row_ror:8 row_mask:0xf bank_mask:0x3
  v_add_f32_dpp v224, v232, v232 row_ror:8 row_mask:0xf bank_mask:0xc
  v_add_f32_dpp v225, v233, v233 row_ror:8 row_mask:0xf bank_mask:0xc
  v_add_f32_dpp v226, v234, v234 row_ror:8 row_mask:0xf bank_mask:0xc
  v_add_f32_dpp v227, v235, v235 row_ror:8 row_mask:0xf bank_mask:0xc
  v_add_f32_dpp v228, v236, v236 row_ror:8 row_mask:0xf bank_mask:0xc
  v_add_f32_dpp v229, v237, v237 row_ror:8 row_mask:0xf bank_mask:0xc
  v_add_f32_dpp v230, v238, v238 row_ror:8 row_mask:0xf bank_mask:0xc
  v_add_f32_dpp v231, v239, v239 row_ror:8 row_mask:0xf bank_mask:0xc
  v_add_f32_dpp v224, v224, v224 row_half_mirror row_mask:0xf bank_mask:0x5
  v_add_f32_dpp v225, v225, v225 row_half_mirror row_mask:0xf bank_mask:0x5
  v_add_f32_dpp v226, v226, v226 row_half_mirror row_mask:0xf bank_mask:0x5
  v_add_f32_dpp v227, v227, v227 row_half_mirror row_mask:0xf bank_mask:0x5
  v_add_f32_dpp v224, v228, v228 row_half_mirror row_mask:0xf bank_mask:0xa
  v_add_f32_dpp v225, v229, v229 row_half_mirror row_mask:0xf bank_mask:0xa
  v_add_f32_dpp v226, v230, v230 row_half_mirror row_mask:0xf bank_mask:0xa
  v_add_f32_dpp v227, v231, v231 row_half_mirror row_mask:0xf bank_mask:0xa
  v_add_f32_dpp v224, v224, v224 quad_perm:[1,0,3,2] row_mask:0xf bank_mask:0xf
  v_add_f32_dpp v225, v225, v225 quad_perm:[1,0,3,2] row_mask:0xf bank_mask:0xf
  v_add_f32_dpp v226, v226, v226 quad_perm:[1,0,3,2] row_mask:0xf bank_mask:0xf
  v_add_f32_dpp v227, v227, v227 quad_perm:[1,0,3,2] row_mask:0xf bank_mask:0xf
  v_add_f32_dpp v224, v224, v224 quad_perm:[2,3,0,1] row_mask:0xf bank_mask:0xf
  v_add_f32_dpp v225, v225, v225 quad_perm:[2,3,0,1] row_mask:0xf bank_mask:0xf
  v_add_f32_dpp v226, v226, v226 quad_perm:[2,3,0,1] row_mask:0xf bank_mask:0xf
  v_add_f32_dpp v227, v227, v227 quad_perm:[2,3,0,1] row_mask:0xf bank_mask:0xf
  v_permlane32_swap_b32 v212, v220
  v_permlane32_swap_b32 v213, v221
  v_permlane32_swap_b32 v214, v222
  v_permlane32_swap_b32 v215, v223
  v_add_f32 v212, v212, v220
  v_add_f32 v213, v213, v221
  v_add_f32 v214, v214, v222
  v_add_f32 v215, v215, v223
  v_permlane32_swap_b32 v216, v224
  v_permlane32_swap_b32 v217, v225
  v_permlane32_swap_b32 v218, v226
  v_permlane32_swap_b32 v219, v227
  v_add_f32 v216, v216, v224
  v_add_f32 v217, v217, v225
  v_add_f32 v218, v218, v226
  v_add_f32 v219, v219, v227
  v_permlane16_swap_b32 v212, v216
  v_permlane16_swap_b32 v213, v217
  v_permlane16_swap_b32 v214, v218
  v_permlane16_swap_b32 v215, v219
  v_add_f32 v212, v212, v216
  v_add_f32 v213, v213, v217
  v_add_f32 v214, v214, v218
  v_add_f32 v215, v215, v219
  v_mul_f32 v212, 0x3a800000, v212
  v_mul_f32 v213, 0x3a800000, v213
  v_mul_f32 v214, 0x3a800000, v214
  v_mul_f32 v215, 0x3a800000, v215
  v_fma_f32 v214, -v212, v212, v214
  v_fma_f32 v215, -v213, v213, v215
  v_max_f32 v214, 0, v214
  v_max_f32 v215, 0, v215
  v_add_f32 v214, 0x3727c5ac, v214
  v_add_f32 v215, 0x3727c5ac, v215
  v_rsq_f32 v214, v214
  v_rsq_f32 v215, v215
  s_waitcnt vmcnt(1)
  v_cmp_eq_u32_e64 vcc, 0, v13
  s_cbranch_vccnz parallel_sum__ssm_conv_h3__mixer_gmlp__prompt_kernel_hn1_slow
parallel_sum__ssm_conv_h3__mixer_gmlp__prompt_kernel_hn1_ok:
  v_perm_b32 v212, v212, v13, s76
  v_perm_b32 v213, v213, v13, s77
  v_perm_b32 v214, v214, v13, s78
  v_perm_b32 v215, v215, v13, s79
  v_lshlrev_b32_e64 v3, 6, v2
  v_lshl_add_u32 v3, v1, 2, v3
  s_lshl_b32 s4, s63, 3
  s_mov_b32 exec_lo, 0x11111111
  s_mov_b32 exec_hi, 0x11111111
  buffer_store_dwordx4 v[212:215], v3, s[16:19], s4 offen sc1
  s_mov_b64 exec, -1
  v_mov_b32 v16, 0
  v_mov_b32 v17, 0
  v_mov_b32 v18, 0
  v_mov_b32 v19, 0
  v_perm_b32 v16, v16, v13, s76
  v_perm_b32 v17, v17, v13, s77
  v_perm_b32 v18, v18, v13, s78
  v_perm_b32 v19, v19, v13, s79
  v_lshrrev_b32 v3, 3, v0
  v_lshlrev_b32 v3, 10, v3
  v_and_b32_e64 v4, 7, v0
  v_lshl_add_u32 v3, v4, 4, v3
  s_lshl_b32 s4, s74, 14
  s_lshl_b32 s5, s3, 12
  s_add_u32 s4, s4, s5
  s_add_u32 s4, s4, 66432
  s_mov_b32 exec_hi, 0
  buffer_store_dwordx4 v[16:19], v3, s[16:19], s4 offen sc1
  s_mov_b64 exec, -1
  s_branch parallel_sum__ssm_conv_h3__mixer_gmlp__prompt_kernel_kv
parallel_sum__ssm_conv_h3__mixer_gmlp__prompt_kernel_colsum:
  s_lshr_b32 s4, s60, 1
  s_lshl_b32 s4, s4, 1
  s_add_u32 s4, s4, s61
  s_sub_u32 s4, s4, 2
  s_and_b32 s5, s60, 1
  s_mul_i32 s5, s5, 7
  s_add_u32 s74, s4, s5
  s_cmp_eq_u32 s4, 7
  s_cselect_b32 s75, 0x40000000, 0
  s_mul_i32 s71, s3, 1835008
  s_lshl_b32 s4, s74, 8
  s_add_u32 s71, s71, s4
  s_add_u32 s70, s71, 3584
  v_mul_u32_u24 v3, 7168, v2
  v_lshl_add_u32 v3, v1, 4, v3
  v_add_u32 v3, s75, v3
  s_mov_b32 s96, 0
  v_mov_b32 v210, 0x40000000
  buffer_load_dwordx4 a[0:3], v3, s[12:15], s70 offen
  s_add_u32 s70, s70, 28672
  buffer_load_dwordx4 a[4:7], v3, s[12:15], s70 offen
  s_add_u32 s70, s70, 28672
  buffer_load_dwordx4 a[8:11], v3, s[12:15], s70 offen
  s_add_u32 s70, s70, 28672
  buffer_load_dwordx4 a[12:15], v3, s[12:15], s70 offen
  s_add_u32 s70, s70, 28672
  buffer_load_dwordx4 a[16:19], v3, s[12:15], s70 offen
  s_add_u32 s70, s70, 28672
  buffer_load_dwordx4 a[20:23], v3, s[12:15], s70 offen
  s_add_u32 s70, s70, 28672
  buffer_load_dwordx4 a[24:27], v3, s[12:15], s70 offen
  s_add_u32 s70, s70, 28672
  buffer_load_dwordx4 a[28:31], v3, s[12:15], s70 offen
  s_add_u32 s70, s70, 28672
  buffer_load_dwordx4 a[32:35], v3, s[12:15], s70 offen
  s_add_u32 s70, s70, 28672
  buffer_load_dwordx4 a[36:39], v3, s[12:15], s70 offen
  s_add_u32 s70, s70, 28672
  buffer_load_dwordx4 a[40:43], v3, s[12:15], s70 offen
  s_add_u32 s70, s70, 28672
  buffer_load_dwordx4 a[44:47], v3, s[12:15], s70 offen
  s_add_u32 s70, s70, 28672
  buffer_load_dwordx4 a[48:51], v3, s[12:15], s70 offen
  s_add_u32 s70, s70, 28672
  buffer_load_dwordx4 a[52:55], v3, s[12:15], s70 offen
  s_add_u32 s70, s70, 28672
  buffer_load_dwordx4 a[56:59], v3, s[12:15], s70 offen
  s_add_u32 s70, s70, 28672
  buffer_load_dwordx4 a[60:63], v3, s[12:15], s70 offen
  s_add_u32 s70, s70, 28672
  buffer_load_dwordx4 a[64:67], v3, s[12:15], s70 offen
  s_add_u32 s70, s70, 28672
  buffer_load_dwordx4 a[68:71], v3, s[12:15], s70 offen
  s_add_u32 s70, s70, 28672
  buffer_load_dwordx4 a[72:75], v3, s[12:15], s70 offen
  s_add_u32 s70, s70, 28672
  buffer_load_dwordx4 a[76:79], v3, s[12:15], s70 offen
  s_add_u32 s70, s70, 28672
  buffer_load_dwordx4 a[80:83], v3, s[12:15], s70 offen
  s_add_u32 s70, s70, 28672
  buffer_load_dwordx4 a[84:87], v3, s[12:15], s70 offen
  s_add_u32 s70, s70, 28672
  buffer_load_dwordx4 a[88:91], v3, s[12:15], s70 offen
  s_add_u32 s70, s70, 28672
  buffer_load_dwordx4 a[92:95], v3, s[12:15], s70 offen
  s_add_u32 s70, s70, 28672
  buffer_load_dwordx4 a[96:99], v3, s[12:15], s70 offen
  s_add_u32 s70, s70, 28672
  buffer_load_dwordx4 a[100:103], v3, s[12:15], s70 offen
  s_add_u32 s70, s70, 28672
  buffer_load_dwordx4 a[104:107], v3, s[12:15], s70 offen
  s_add_u32 s70, s70, 28672
  buffer_load_dwordx4 a[108:111], v3, s[12:15], s70 offen
  s_add_u32 s70, s70, 28672
  buffer_load_dwordx4 a[112:115], v3, s[12:15], s70 offen
  s_add_u32 s70, s70, 28672
  buffer_load_dwordx4 a[116:119], v3, s[12:15], s70 offen
  s_add_u32 s70, s70, 28672
  buffer_load_dwordx4 a[120:123], v3, s[12:15], s70 offen
  s_add_u32 s70, s70, 28672
  buffer_load_dwordx4 a[124:127], v3, s[12:15], s70 offen
  s_add_u32 s70, s70, 28672
  buffer_load_dwordx4 a[128:131], v3, s[12:15], s70 offen
  s_add_u32 s70, s70, 28672
  buffer_load_dwordx4 a[132:135], v3, s[12:15], s70 offen
  s_add_u32 s70, s70, 28672
  buffer_load_dwordx4 a[136:139], v3, s[12:15], s70 offen
  s_add_u32 s70, s70, 28672
  buffer_load_dwordx4 a[140:143], v3, s[12:15], s70 offen
  s_add_u32 s70, s70, 28672
  buffer_load_dwordx4 a[144:147], v3, s[12:15], s70 offen
  s_add_u32 s70, s70, 28672
  buffer_load_dwordx4 a[148:151], v3, s[12:15], s70 offen
  s_add_u32 s70, s70, 28672
  buffer_load_dwordx4 a[152:155], v3, s[12:15], s70 offen
  s_add_u32 s70, s70, 28672
  buffer_load_dwordx4 a[156:159], v3, s[12:15], s70 offen
  s_add_u32 s70, s70, 28672
  buffer_load_dwordx4 a[160:163], v3, s[12:15], s70 offen
  s_add_u32 s70, s70, 28672
  buffer_load_dwordx4 a[164:167], v3, s[12:15], s70 offen
  s_add_u32 s70, s70, 28672
  buffer_load_dwordx4 a[168:171], v3, s[12:15], s70 offen
  s_add_u32 s70, s70, 28672
  buffer_load_dwordx4 a[172:175], v3, s[12:15], s70 offen
  s_add_u32 s70, s70, 28672
  buffer_load_dwordx4 a[176:179], v3, s[12:15], s70 offen
  s_add_u32 s70, s70, 28672
  buffer_load_dwordx4 a[180:183], v3, s[12:15], s70 offen
  s_add_u32 s70, s70, 28672
  buffer_load_dwordx4 a[184:187], v3, s[12:15], s70 offen
  s_add_u32 s70, s70, 28672
  buffer_load_dwordx4 a[188:191], v3, s[12:15], s70 offen
  s_add_u32 s70, s70, 28672
  buffer_load_dwordx4 a[192:195], v3, s[12:15], s70 offen
  s_add_u32 s70, s70, 28672
  buffer_load_dwordx4 a[196:199], v3, s[12:15], s70 offen
  s_add_u32 s70, s70, 28672
  buffer_load_dwordx4 a[200:203], v3, s[12:15], s70 offen
  s_add_u32 s70, s70, 28672
  buffer_load_dwordx4 a[204:207], v3, s[12:15], s70 offen
  s_add_u32 s70, s70, 28672
  buffer_load_dwordx4 a[208:211], v3, s[12:15], s70 offen
  s_add_u32 s70, s70, 28672
  buffer_load_dwordx4 a[212:215], v3, s[12:15], s70 offen
  s_add_u32 s70, s70, 28672
  buffer_load_dwordx4 a[216:219], v3, s[12:15], s70 offen
  s_add_u32 s70, s70, 28672
  buffer_load_dwordx4 a[220:223], v3, s[12:15], s70 offen
  s_add_u32 s70, s70, 28672
  buffer_load_dwordx4 a[224:227], v3, s[12:15], s70 offen
  s_add_u32 s70, s70, 28672
  buffer_load_dwordx4 a[228:231], v3, s[12:15], s70 offen
  s_add_u32 s70, s70, 28672
  buffer_load_dwordx4 a[232:235], v3, s[12:15], s70 offen
  s_add_u32 s70, s70, 28672
  buffer_load_dwordx4 a[236:239], v3, s[12:15], s70 offen
  s_add_u32 s70, s70, 28672
  buffer_load_dwordx4 a[240:243], v3, s[12:15], s70 offen
  s_add_u32 s70, s70, 28672
  buffer_load_dwordx4 a[244:247], v3, s[12:15], s70 offen
  s_add_u32 s70, s70, 28672
  buffer_load_dwordx4 a[248:251], v3, s[12:15], s70 offen
  s_add_u32 s70, s70, 28672
  buffer_load_dwordx4 a[252:255], v3, s[12:15], s70 offen
  s_mov_b32 s70, s71
  v_and_b32 v4, 1, v1
  v_lshlrev_b32_e64 v4, 4, v4
  v_mov_b32 v5, 0x3f80
  v_lshlrev_b32 v4, v4, v5
  v_lshrrev_b32 v5, 1, v1
  v_cmp_eq_u32 vcc, 0, v5
  s_nop 1
  v_cndmask_b32 v240, 0, v4, vcc
  v_cmp_eq_u32 vcc, 1, v5
  s_nop 1
  v_cndmask_b32 v241, 0, v4, vcc
  v_cmp_eq_u32 vcc, 2, v5
  s_nop 1
  v_cndmask_b32 v242, 0, v4, vcc
  v_cmp_eq_u32 vcc, 3, v5
  s_nop 1
  v_cndmask_b32 v243, 0, v4, vcc
  s_lshl_b32 s4, s3, 9
  v_lshlrev_b32 v4, 7, v2
  v_lshl_add_u32 v4, v1, 2, v4
  v_add_u32 v4, s4, v4
  s_and_b32 s4, s3, 1
  s_lshl_b32 s4, s4, 6
  v_add_u32 v5, s4, v0
  v_and_b32 v6, 7, v5
  v_lshlrev_b32 v6, 6, v6
  v_lshrrev_b32_e64 v7, 3, v5
  v_lshl_add_u32 v6, v7, 2, v6
  v_lshlrev_b32 v7, 2, v5
  v_add_u32 v8, s75, v7
  v_and_b32 v9, 15, v5
  v_lshlrev_b32 v9, 4, v9
  v_bfe_u32 v11, v5, 4, 1
  v_lshl_add_u32 v9, v11, 3, v9
  v_lshrrev_b32_e64 v11, 5, v5
  v_lshl_add_u32 v9, v11, 8, v9
  v_add_u32 v9, s75, v9
  s_waitcnt vmcnt(63)
  v_mfma_f32_16x16x32_bf16 v[212:215], a[0:3], v[240:243], 0
  s_waitcnt vmcnt(62)
  v_mfma_f32_16x16x32_bf16 v[216:219], a[4:7], v[240:243], 0
  s_waitcnt vmcnt(61)
  v_mfma_f32_16x16x32_bf16 v[212:215], a[8:11], v[240:243], v[212:215]
  s_waitcnt vmcnt(60)
  v_mfma_f32_16x16x32_bf16 v[216:219], a[12:15], v[240:243], v[216:219]
  s_waitcnt vmcnt(59)
  v_mfma_f32_16x16x32_bf16 v[212:215], a[16:19], v[240:243], v[212:215]
  s_waitcnt vmcnt(58)
  v_mfma_f32_16x16x32_bf16 v[216:219], a[20:23], v[240:243], v[216:219]
  s_waitcnt vmcnt(57)
  v_mfma_f32_16x16x32_bf16 v[212:215], a[24:27], v[240:243], v[212:215]
  s_waitcnt vmcnt(56)
  v_mfma_f32_16x16x32_bf16 v[216:219], a[28:31], v[240:243], v[216:219]
  s_waitcnt vmcnt(55)
  v_mfma_f32_16x16x32_bf16 v[212:215], a[32:35], v[240:243], v[212:215]
  s_waitcnt vmcnt(54)
  v_mfma_f32_16x16x32_bf16 v[216:219], a[36:39], v[240:243], v[216:219]
  s_waitcnt vmcnt(53)
  v_mfma_f32_16x16x32_bf16 v[212:215], a[40:43], v[240:243], v[212:215]
  s_waitcnt vmcnt(52)
  v_mfma_f32_16x16x32_bf16 v[216:219], a[44:47], v[240:243], v[216:219]
  s_waitcnt vmcnt(51)
  v_mfma_f32_16x16x32_bf16 v[212:215], a[48:51], v[240:243], v[212:215]
  s_waitcnt vmcnt(50)
  v_mfma_f32_16x16x32_bf16 v[216:219], a[52:55], v[240:243], v[216:219]
  s_waitcnt vmcnt(49)
  v_mfma_f32_16x16x32_bf16 v[212:215], a[56:59], v[240:243], v[212:215]
  s_waitcnt vmcnt(48)
  v_mfma_f32_16x16x32_bf16 v[216:219], a[60:63], v[240:243], v[216:219]
  buffer_load_dword v13, v10, s[56:59], 0 offen sc0 sc1
  s_waitcnt vmcnt(48)
  v_mfma_f32_16x16x32_bf16 v[212:215], a[64:67], v[240:243], v[212:215]
  s_waitcnt vmcnt(47)
  v_mfma_f32_16x16x32_bf16 v[216:219], a[68:71], v[240:243], v[216:219]
  s_waitcnt vmcnt(46)
  v_mfma_f32_16x16x32_bf16 v[212:215], a[72:75], v[240:243], v[212:215]
  s_waitcnt vmcnt(45)
  v_mfma_f32_16x16x32_bf16 v[216:219], a[76:79], v[240:243], v[216:219]
  s_waitcnt vmcnt(44)
  v_mfma_f32_16x16x32_bf16 v[212:215], a[80:83], v[240:243], v[212:215]
  s_waitcnt vmcnt(43)
  v_mfma_f32_16x16x32_bf16 v[216:219], a[84:87], v[240:243], v[216:219]
  s_waitcnt vmcnt(42)
  v_mfma_f32_16x16x32_bf16 v[212:215], a[88:91], v[240:243], v[212:215]
  s_waitcnt vmcnt(41)
  v_mfma_f32_16x16x32_bf16 v[216:219], a[92:95], v[240:243], v[216:219]
  s_waitcnt vmcnt(40)
  v_mfma_f32_16x16x32_bf16 v[212:215], a[96:99], v[240:243], v[212:215]
  s_waitcnt vmcnt(39)
  v_mfma_f32_16x16x32_bf16 v[216:219], a[100:103], v[240:243], v[216:219]
  s_waitcnt vmcnt(38)
  v_mfma_f32_16x16x32_bf16 v[212:215], a[104:107], v[240:243], v[212:215]
  s_waitcnt vmcnt(37)
  v_mfma_f32_16x16x32_bf16 v[216:219], a[108:111], v[240:243], v[216:219]
  s_waitcnt vmcnt(36)
  v_mfma_f32_16x16x32_bf16 v[212:215], a[112:115], v[240:243], v[212:215]
  s_waitcnt vmcnt(35)
  v_mfma_f32_16x16x32_bf16 v[216:219], a[116:119], v[240:243], v[216:219]
  s_waitcnt vmcnt(34)
  v_mfma_f32_16x16x32_bf16 v[212:215], a[120:123], v[240:243], v[212:215]
  s_waitcnt vmcnt(33)
  v_mfma_f32_16x16x32_bf16 v[216:219], a[124:127], v[240:243], v[216:219]
  s_waitcnt vmcnt(32)
  v_mfma_f32_16x16x32_bf16 v[212:215], a[128:131], v[240:243], v[212:215]
  s_waitcnt vmcnt(31)
  v_mfma_f32_16x16x32_bf16 v[216:219], a[132:135], v[240:243], v[216:219]
  s_waitcnt vmcnt(30)
  v_mfma_f32_16x16x32_bf16 v[212:215], a[136:139], v[240:243], v[212:215]
  s_waitcnt vmcnt(29)
  v_mfma_f32_16x16x32_bf16 v[216:219], a[140:143], v[240:243], v[216:219]
  s_waitcnt vmcnt(28)
  v_mfma_f32_16x16x32_bf16 v[212:215], a[144:147], v[240:243], v[212:215]
  s_waitcnt vmcnt(27)
  v_mfma_f32_16x16x32_bf16 v[216:219], a[148:151], v[240:243], v[216:219]
  s_waitcnt vmcnt(26)
  v_mfma_f32_16x16x32_bf16 v[212:215], a[152:155], v[240:243], v[212:215]
  s_waitcnt vmcnt(25)
  v_mfma_f32_16x16x32_bf16 v[216:219], a[156:159], v[240:243], v[216:219]
  s_waitcnt vmcnt(24)
  v_mfma_f32_16x16x32_bf16 v[212:215], a[160:163], v[240:243], v[212:215]
  s_waitcnt vmcnt(23)
  v_mfma_f32_16x16x32_bf16 v[216:219], a[164:167], v[240:243], v[216:219]
  s_waitcnt vmcnt(22)
  v_mfma_f32_16x16x32_bf16 v[212:215], a[168:171], v[240:243], v[212:215]
  s_waitcnt vmcnt(21)
  v_mfma_f32_16x16x32_bf16 v[216:219], a[172:175], v[240:243], v[216:219]
  s_waitcnt vmcnt(20)
  v_mfma_f32_16x16x32_bf16 v[212:215], a[176:179], v[240:243], v[212:215]
  s_waitcnt vmcnt(19)
  v_mfma_f32_16x16x32_bf16 v[216:219], a[180:183], v[240:243], v[216:219]
  s_waitcnt vmcnt(18)
  v_mfma_f32_16x16x32_bf16 v[212:215], a[184:187], v[240:243], v[212:215]
  s_waitcnt vmcnt(17)
  v_mfma_f32_16x16x32_bf16 v[216:219], a[188:191], v[240:243], v[216:219]
  s_waitcnt vmcnt(16)
  v_mfma_f32_16x16x32_bf16 v[212:215], a[192:195], v[240:243], v[212:215]
  s_waitcnt vmcnt(15)
  v_mfma_f32_16x16x32_bf16 v[216:219], a[196:199], v[240:243], v[216:219]
  s_waitcnt vmcnt(14)
  v_mfma_f32_16x16x32_bf16 v[212:215], a[200:203], v[240:243], v[212:215]
  s_waitcnt vmcnt(13)
  v_mfma_f32_16x16x32_bf16 v[216:219], a[204:207], v[240:243], v[216:219]
  s_waitcnt vmcnt(12)
  v_mfma_f32_16x16x32_bf16 v[212:215], a[208:211], v[240:243], v[212:215]
  s_waitcnt vmcnt(11)
  v_mfma_f32_16x16x32_bf16 v[216:219], a[212:215], v[240:243], v[216:219]
  s_waitcnt vmcnt(10)
  v_mfma_f32_16x16x32_bf16 v[212:215], a[216:219], v[240:243], v[212:215]
  s_waitcnt vmcnt(9)
  v_mfma_f32_16x16x32_bf16 v[216:219], a[220:223], v[240:243], v[216:219]
  s_waitcnt vmcnt(8)
  v_mfma_f32_16x16x32_bf16 v[212:215], a[224:227], v[240:243], v[212:215]
  s_waitcnt vmcnt(7)
  v_mfma_f32_16x16x32_bf16 v[216:219], a[228:231], v[240:243], v[216:219]
  s_waitcnt vmcnt(6)
  v_mfma_f32_16x16x32_bf16 v[212:215], a[232:235], v[240:243], v[212:215]
  s_waitcnt vmcnt(5)
  v_mfma_f32_16x16x32_bf16 v[216:219], a[236:239], v[240:243], v[216:219]
  s_waitcnt vmcnt(4)
  v_mfma_f32_16x16x32_bf16 v[212:215], a[240:243], v[240:243], v[212:215]
  s_waitcnt vmcnt(3)
  v_mfma_f32_16x16x32_bf16 v[216:219], a[244:247], v[240:243], v[216:219]
  s_waitcnt vmcnt(2)
  v_mfma_f32_16x16x32_bf16 v[212:215], a[248:251], v[240:243], v[212:215]
  s_waitcnt vmcnt(1)
  v_mfma_f32_16x16x32_bf16 v[216:219], a[252:255], v[240:243], v[216:219]
  s_nop 7
  v_add_f32 v220, v212, v216
  v_add_f32 v221, v213, v217
  v_add_f32 v222, v214, v218
  v_add_f32 v223, v215, v219
  s_mov_b32 exec_lo, 0x00ff00ff
  s_mov_b32 exec_hi, 0x00ff00ff
  ds_write_b32 v4, v220 offset:0
  ds_write_b32 v4, v221 offset:32
  ds_write_b32 v4, v222 offset:64
  ds_write_b32 v4, v223 offset:96
  s_mov_b64 exec, -1
  s_waitcnt lgkmcnt(0)
  s_barrier
  ds_read_b32 v220, v6 offset:0
  ds_read_b32 v221, v6 offset:512
  ds_read_b32 v222, v6 offset:1024
  ds_read_b32 v223, v6 offset:1536
  s_waitcnt lgkmcnt(2)
  v_add_f32 v220, v220, v221
  s_waitcnt lgkmcnt(0)
  v_add_f32 v222, v222, v223
  v_add_f32 v220, v220, v222
  s_waitcnt vmcnt(0)
  v_cmp_eq_u32_e64 vcc, 0, v13
  s_cbranch_vccnz parallel_sum__ssm_conv_h3__mixer_gmlp__prompt_kernel_hn2_slow
parallel_sum__ssm_conv_h3__mixer_gmlp__prompt_kernel_hn2_ok:
  v_readfirstlane_b32 s64, v13
  s_lshr_b32 s65, s64, 8
  s_lshr_b32 s66, s64, 16
  s_lshr_b32 s67, s64, 24
  s_and_b32 s62, s64, 0xbfffbfff
  v_and_b32 v221, 3, v0
  v_lshlrev_b32 v221, 3, v221
  v_lshrrev_b32 v221, v221, v13
  s_movk_i32 s4, 0xff
  v_bfi_b32 v220, s4, v221, v220
  s_lshl_b32 s4, s74, 9
  s_add_u32 s4, s4, 409600
  buffer_store_dword v220, v8, s[16:19], s4 offen sc1
  buffer_load_dwordx4 v[16:19], v3, s[12:15], s70 offen
  s_add_u32 s70, s70, 28672
  buffer_load_dwordx4 v[20:23], v3, s[12:15], s70 offen
  s_add_u32 s70, s70, 28672
  buffer_load_dwordx4 v[24:27], v3, s[12:15], s70 offen
  s_add_u32 s70, s70, 28672
  buffer_load_dwordx4 v[28:31], v3, s[12:15], s70 offen
  s_add_u32 s70, s70, 28672
  buffer_load_dwordx4 v[32:35], v3, s[12:15], s70 offen
  s_add_u32 s70, s70, 28672
  buffer_load_dwordx4 v[36:39], v3, s[12:15], s70 offen
  s_add_u32 s70, s70, 28672
  buffer_load_dwordx4 v[40:43], v3, s[12:15], s70 offen
  s_add_u32 s70, s70, 28672
  buffer_load_dwordx4 v[44:47], v3, s[12:15], s70 offen
  s_add_u32 s70, s70, 28672
  buffer_load_dwordx4 v[48:51], v3, s[12:15], s70 offen
  s_add_u32 s70, s70, 28672
  buffer_load_dwordx4 v[52:55], v3, s[12:15], s70 offen
  s_add_u32 s70, s70, 28672
  buffer_load_dwordx4 v[56:59], v3, s[12:15], s70 offen
  s_add_u32 s70, s70, 28672
  buffer_load_dwordx4 v[60:63], v3, s[12:15], s70 offen
  s_add_u32 s70, s70, 28672
  buffer_load_dwordx4 v[64:67], v3, s[12:15], s70 offen
  s_add_u32 s70, s70, 28672
  buffer_load_dwordx4 v[68:71], v3, s[12:15], s70 offen
  s_add_u32 s70, s70, 28672
  buffer_load_dwordx4 v[72:75], v3, s[12:15], s70 offen
  s_add_u32 s70, s70, 28672
  buffer_load_dwordx4 v[76:79], v3, s[12:15], s70 offen
  s_add_u32 s70, s70, 28672
  buffer_load_dwordx4 v[80:83], v3, s[12:15], s70 offen
  s_add_u32 s70, s70, 28672
  buffer_load_dwordx4 v[84:87], v3, s[12:15], s70 offen
  s_add_u32 s70, s70, 28672
  buffer_load_dwordx4 v[88:91], v3, s[12:15], s70 offen
  s_add_u32 s70, s70, 28672
  buffer_load_dwordx4 v[92:95], v3, s[12:15], s70 offen
  s_add_u32 s70, s70, 28672
  buffer_load_dwordx4 v[96:99], v3, s[12:15], s70 offen
  s_add_u32 s70, s70, 28672
  buffer_load_dwordx4 v[100:103], v3, s[12:15], s70 offen
  s_add_u32 s70, s70, 28672
  buffer_load_dwordx4 v[104:107], v3, s[12:15], s70 offen
  s_add_u32 s70, s70, 28672
  buffer_load_dwordx4 v[108:111], v3, s[12:15], s70 offen
  s_add_u32 s70, s70, 28672
  buffer_load_dwordx4 v[112:115], v3, s[12:15], s70 offen
  s_add_u32 s70, s70, 28672
  buffer_load_dwordx4 v[116:119], v3, s[12:15], s70 offen
  s_add_u32 s70, s70, 28672
  buffer_load_dwordx4 v[120:123], v3, s[12:15], s70 offen
  s_add_u32 s70, s70, 28672
  buffer_load_dwordx4 v[124:127], v3, s[12:15], s70 offen
  s_add_u32 s70, s70, 28672
  buffer_load_dwordx4 v[128:131], v3, s[12:15], s70 offen
  s_add_u32 s70, s70, 28672
  buffer_load_dwordx4 v[132:135], v3, s[12:15], s70 offen
  s_add_u32 s70, s70, 28672
  buffer_load_dwordx4 v[136:139], v3, s[12:15], s70 offen
  s_add_u32 s70, s70, 28672
  buffer_load_dwordx4 v[140:143], v3, s[12:15], s70 offen
  s_add_u32 s70, s70, 28672
  buffer_load_dwordx4 v[144:147], v3, s[12:15], s70 offen
  s_add_u32 s70, s70, 28672
  buffer_load_dwordx4 v[148:151], v3, s[12:15], s70 offen
  s_add_u32 s70, s70, 28672
  buffer_load_dwordx4 v[152:155], v3, s[12:15], s70 offen
  s_add_u32 s70, s70, 28672
  buffer_load_dwordx4 v[156:159], v3, s[12:15], s70 offen
  s_add_u32 s70, s70, 28672
  buffer_load_dwordx4 v[160:163], v3, s[12:15], s70 offen
  s_add_u32 s70, s70, 28672
  buffer_load_dwordx4 v[164:167], v3, s[12:15], s70 offen
  s_add_u32 s70, s70, 28672
  buffer_load_dwordx4 v[168:171], v3, s[12:15], s70 offen
  s_add_u32 s70, s70, 28672
  buffer_load_dwordx4 v[172:175], v3, s[12:15], s70 offen
  s_add_u32 s70, s70, 28672
  buffer_load_dwordx4 v[176:179], v3, s[12:15], s70 offen
  s_add_u32 s70, s70, 28672
  buffer_load_dwordx4 v[180:183], v3, s[12:15], s70 offen
  s_add_u32 s70, s70, 28672
  buffer_load_dwordx4 v[184:187], v3, s[12:15], s70 offen
  s_add_u32 s70, s70, 28672
  buffer_load_dwordx4 v[188:191], v3, s[12:15], s70 offen
  s_add_u32 s70, s70, 28672
  buffer_load_dwordx4 v[192:195], v3, s[12:15], s70 offen
  s_add_u32 s70, s70, 28672
  buffer_load_dwordx4 v[196:199], v3, s[12:15], s70 offen
  s_add_u32 s70, s70, 28672
  buffer_load_dwordx4 v[200:203], v3, s[12:15], s70 offen
  s_add_u32 s70, s70, 28672
  buffer_load_dwordx4 v[204:207], v3, s[12:15], s70 offen
  s_add_u32 s70, s70, 28672
  buffer_load_dwordx4 a[0:3], v3, s[12:15], s70 offen
  s_add_u32 s70, s70, 28672
  buffer_load_dwordx4 a[4:7], v3, s[12:15], s70 offen
  s_add_u32 s70, s70, 28672
  buffer_load_dwordx4 a[8:11], v3, s[12:15], s70 offen
  s_add_u32 s70, s70, 28672
  buffer_load_dwordx4 a[12:15], v3, s[12:15], s70 offen
  s_add_u32 s70, s70, 28672
  buffer_load_dwordx4 a[16:19], v3, s[12:15], s70 offen
  s_add_u32 s70, s70, 28672
  buffer_load_dwordx4 a[20:23], v3, s[12:15], s70 offen
  s_add_u32 s70, s70, 28672
  buffer_load_dwordx4 a[24:27], v3, s[12:15], s70 offen
  s_add_u32 s70, s70, 28672
  buffer_load_dwordx4 a[28:31], v3, s[12:15], s70 offen
  s_add_u32 s70, s70, 28672
  buffer_load_dwordx4 a[32:35], v3, s[12:15], s70 offen
  s_add_u32 s70, s70, 28672
  buffer_load_dwordx4 a[36:39], v3, s[12:15], s70 offen
  s_add_u32 s70, s70, 28672
  buffer_load_dwordx4 a[40:43], v3, s[12:15], s70 offen
  s_add_u32 s70, s70, 28672
  buffer_load_dwordx4 a[44:47], v3, s[12:15], s70 offen
  s_add_u32 s70, s70, 28672
  buffer_load_dwordx4 a[48:51], v3, s[12:15], s70 offen
  s_add_u32 s70, s70, 28672
  buffer_load_dwordx4 a[52:55], v3, s[12:15], s70 offen
  s_add_u32 s70, s70, 28672
  buffer_load_dwordx4 a[56:59], v3, s[12:15], s70 offen
  s_add_u32 s70, s70, 28672
  buffer_load_dwordx4 a[60:63], v3, s[12:15], s70 offen
  s_add_u32 s70, s70, 28672
  s_waitcnt vmcnt(63)
  v_mfma_f32_16x16x32_bf16 v[212:215], v[16:19], v[240:243], 0
  s_waitcnt vmcnt(62)
  v_mfma_f32_16x16x32_bf16 v[216:219], v[20:23], v[240:243], 0
  s_waitcnt vmcnt(61)
  v_mfma_f32_16x16x32_bf16 v[212:215], v[24:27], v[240:243], v[212:215]
  s_waitcnt vmcnt(60)
  v_mfma_f32_16x16x32_bf16 v[216:219], v[28:31], v[240:243], v[216:219]
  s_waitcnt vmcnt(59)
  v_mfma_f32_16x16x32_bf16 v[212:215], v[32:35], v[240:243], v[212:215]
  s_waitcnt vmcnt(58)
  v_mfma_f32_16x16x32_bf16 v[216:219], v[36:39], v[240:243], v[216:219]
  s_waitcnt vmcnt(57)
  v_mfma_f32_16x16x32_bf16 v[212:215], v[40:43], v[240:243], v[212:215]
  s_waitcnt vmcnt(56)
  v_mfma_f32_16x16x32_bf16 v[216:219], v[44:47], v[240:243], v[216:219]
  s_waitcnt vmcnt(55)
  v_mfma_f32_16x16x32_bf16 v[212:215], v[48:51], v[240:243], v[212:215]
  s_waitcnt vmcnt(54)
  v_mfma_f32_16x16x32_bf16 v[216:219], v[52:55], v[240:243], v[216:219]
  s_waitcnt vmcnt(53)
  v_mfma_f32_16x16x32_bf16 v[212:215], v[56:59], v[240:243], v[212:215]
  s_waitcnt vmcnt(52)
  v_mfma_f32_16x16x32_bf16 v[216:219], v[60:63], v[240:243], v[216:219]
  s_waitcnt vmcnt(51)
  v_mfma_f32_16x16x32_bf16 v[212:215], v[64:67], v[240:243], v[212:215]
  s_waitcnt vmcnt(50)
  v_mfma_f32_16x16x32_bf16 v[216:219], v[68:71], v[240:243], v[216:219]
  s_waitcnt vmcnt(49)
  v_mfma_f32_16x16x32_bf16 v[212:215], v[72:75], v[240:243], v[212:215]
  s_waitcnt vmcnt(48)
  v_mfma_f32_16x16x32_bf16 v[216:219], v[76:79], v[240:243], v[216:219]
  s_waitcnt vmcnt(47)
  v_mfma_f32_16x16x32_bf16 v[212:215], v[80:83], v[240:243], v[212:215]
  s_waitcnt vmcnt(46)
  v_mfma_f32_16x16x32_bf16 v[216:219], v[84:87], v[240:243], v[216:219]
  s_waitcnt vmcnt(45)
  v_mfma_f32_16x16x32_bf16 v[212:215], v[88:91], v[240:243], v[212:215]
  s_waitcnt vmcnt(44)
  v_mfma_f32_16x16x32_bf16 v[216:219], v[92:95], v[240:243], v[216:219]
  s_waitcnt vmcnt(43)
  v_mfma_f32_16x16x32_bf16 v[212:215], v[96:99], v[240:243], v[212:215]
  s_waitcnt vmcnt(42)
  v_mfma_f32_16x16x32_bf16 v[216:219], v[100:103], v[240:243], v[216:219]
  s_waitcnt vmcnt(41)
  v_mfma_f32_16x16x32_bf16 v[212:215], v[104:107], v[240:243], v[212:215]
  s_waitcnt vmcnt(40)
  v_mfma_f32_16x16x32_bf16 v[216:219], v[108:111], v[240:243], v[216:219]
  s_waitcnt vmcnt(39)
  v_mfma_f32_16x16x32_bf16 v[212:215], v[112:115], v[240:243], v[212:215]
  s_waitcnt vmcnt(38)
  v_mfma_f32_16x16x32_bf16 v[216:219], v[116:119], v[240:243], v[216:219]
  s_waitcnt vmcnt(37)
  v_mfma_f32_16x16x32_bf16 v[212:215], v[120:123], v[240:243], v[212:215]
  s_waitcnt vmcnt(36)
  v_mfma_f32_16x16x32_bf16 v[216:219], v[124:127], v[240:243], v[216:219]
  s_waitcnt vmcnt(35)
  v_mfma_f32_16x16x32_bf16 v[212:215], v[128:131], v[240:243], v[212:215]
  s_waitcnt vmcnt(34)
  v_mfma_f32_16x16x32_bf16 v[216:219], v[132:135], v[240:243], v[216:219]
  s_waitcnt vmcnt(33)
  v_mfma_f32_16x16x32_bf16 v[212:215], v[136:139], v[240:243], v[212:215]
  s_waitcnt vmcnt(32)
  v_mfma_f32_16x16x32_bf16 v[216:219], v[140:143], v[240:243], v[216:219]
  s_waitcnt vmcnt(31)
  v_mfma_f32_16x16x32_bf16 v[212:215], v[144:147], v[240:243], v[212:215]
  s_waitcnt vmcnt(30)
  v_mfma_f32_16x16x32_bf16 v[216:219], v[148:151], v[240:243], v[216:219]
  s_waitcnt vmcnt(29)
  v_mfma_f32_16x16x32_bf16 v[212:215], v[152:155], v[240:243], v[212:215]
  s_waitcnt vmcnt(28)
  v_mfma_f32_16x16x32_bf16 v[216:219], v[156:159], v[240:243], v[216:219]
  s_waitcnt vmcnt(27)
  v_mfma_f32_16x16x32_bf16 v[212:215], v[160:163], v[240:243], v[212:215]
  s_waitcnt vmcnt(26)
  v_mfma_f32_16x16x32_bf16 v[216:219], v[164:167], v[240:243], v[216:219]
  s_waitcnt vmcnt(25)
  v_mfma_f32_16x16x32_bf16 v[212:215], v[168:171], v[240:243], v[212:215]
  s_waitcnt vmcnt(24)
  v_mfma_f32_16x16x32_bf16 v[216:219], v[172:175], v[240:243], v[216:219]
  s_waitcnt vmcnt(23)
  v_mfma_f32_16x16x32_bf16 v[212:215], v[176:179], v[240:243], v[212:215]
  s_waitcnt vmcnt(22)
  v_mfma_f32_16x16x32_bf16 v[216:219], v[180:183], v[240:243], v[216:219]
  s_waitcnt vmcnt(21)
  v_mfma_f32_16x16x32_bf16 v[212:215], v[184:187], v[240:243], v[212:215]
  s_waitcnt vmcnt(20)
  v_mfma_f32_16x16x32_bf16 v[216:219], v[188:191], v[240:243], v[216:219]
  s_waitcnt vmcnt(19)
  v_mfma_f32_16x16x32_bf16 v[212:215], v[192:195], v[240:243], v[212:215]
  s_waitcnt vmcnt(18)
  v_mfma_f32_16x16x32_bf16 v[216:219], v[196:199], v[240:243], v[216:219]
  s_waitcnt vmcnt(17)
  v_mfma_f32_16x16x32_bf16 v[212:215], v[200:203], v[240:243], v[212:215]
  s_waitcnt vmcnt(16)
  v_mfma_f32_16x16x32_bf16 v[216:219], v[204:207], v[240:243], v[216:219]
  s_waitcnt vmcnt(15)
  v_mfma_f32_16x16x32_bf16 v[212:215], a[0:3], v[240:243], v[212:215]
  s_waitcnt vmcnt(14)
  v_mfma_f32_16x16x32_bf16 v[216:219], a[4:7], v[240:243], v[216:219]
  s_waitcnt vmcnt(13)
  v_mfma_f32_16x16x32_bf16 v[212:215], a[8:11], v[240:243], v[212:215]
  s_waitcnt vmcnt(12)
  v_mfma_f32_16x16x32_bf16 v[216:219], a[12:15], v[240:243], v[216:219]
  s_waitcnt vmcnt(11)
  v_mfma_f32_16x16x32_bf16 v[212:215], a[16:19], v[240:243], v[212:215]
  s_waitcnt vmcnt(10)
  v_mfma_f32_16x16x32_bf16 v[216:219], a[20:23], v[240:243], v[216:219]
  s_waitcnt vmcnt(9)
  v_mfma_f32_16x16x32_bf16 v[212:215], a[24:27], v[240:243], v[212:215]
  s_waitcnt vmcnt(8)
  v_mfma_f32_16x16x32_bf16 v[216:219], a[28:31], v[240:243], v[216:219]
  s_waitcnt vmcnt(7)
  v_mfma_f32_16x16x32_bf16 v[212:215], a[32:35], v[240:243], v[212:215]
  s_waitcnt vmcnt(6)
  v_mfma_f32_16x16x32_bf16 v[216:219], a[36:39], v[240:243], v[216:219]
  s_waitcnt vmcnt(5)
  v_mfma_f32_16x16x32_bf16 v[212:215], a[40:43], v[240:243], v[212:215]
  s_waitcnt vmcnt(4)
  v_mfma_f32_16x16x32_bf16 v[216:219], a[44:47], v[240:243], v[216:219]
  s_waitcnt vmcnt(3)
  v_mfma_f32_16x16x32_bf16 v[212:215], a[48:51], v[240:243], v[212:215]
  s_waitcnt vmcnt(2)
  v_mfma_f32_16x16x32_bf16 v[216:219], a[52:55], v[240:243], v[216:219]
  s_waitcnt vmcnt(1)
  v_mfma_f32_16x16x32_bf16 v[212:215], a[56:59], v[240:243], v[212:215]
  s_waitcnt vmcnt(0)
  v_mfma_f32_16x16x32_bf16 v[216:219], a[60:63], v[240:243], v[216:219]
  s_nop 7
  v_add_f32 v220, v212, v216
  v_add_f32 v221, v213, v217
  v_add_f32 v222, v214, v218
  v_add_f32 v223, v215, v219
  s_mov_b32 exec_lo, 0x00ff00ff
  s_mov_b32 exec_hi, 0x00ff00ff
  ds_write_b32 v4, v220 offset:2048
  ds_write_b32 v4, v221 offset:2080
  ds_write_b32 v4, v222 offset:2112
  ds_write_b32 v4, v223 offset:2144
  s_mov_b64 exec, -1
  s_waitcnt lgkmcnt(0)
  s_barrier
  ds_read_b32 v220, v7 offset:2048
  ds_read_b32 v221, v7 offset:2560
  ds_read_b32 v222, v7 offset:3072
  ds_read_b32 v223, v7 offset:3584
  s_waitcnt lgkmcnt(2)
  v_add_f32 v220, v220, v221
  s_waitcnt lgkmcnt(0)
  v_add_f32 v222, v222, v223
  v_add_f32 v220, v220, v222
  v_cvt_pk_bf16_f32 v221, v220, v220
  v_lshlrev_b32 v221, 16, v221
  v_sub_f32 v222, v220, v221
  v_cvt_pk_bf16_f32 v220, v221, v222
  v_mov_b32 v221, s62
  s_lshl_b32 s4, s74, 10
  s_add_u32 s4, s4, 417792
  buffer_store_dwordx2 v[220:221], v9, s[16:19], s4 offen sc1
  s_barrier
parallel_sum__ssm_conv_h3__mixer_gmlp__prompt_kernel_kv:
  v_readfirstlane_b32 s64, v13
  s_lshr_b32 s65, s64, 8
  s_lshr_b32 s66, s64, 16
  s_lshr_b32 s67, s64, 24
  s_and_b32 s62, s64, 0xbfffbfff
  v_lshrrev_b32 v4, 3, v0
  v_and_b32_e64 v5, 7, v0
  s_lshl_b32 s5, s60, 2
  s_add_u32 s5, s5, s3
  s_mul_i32 s4, s61, 5
  s_cmp_eq_u32 s61, 3
  s_cselect_b32 s6, 2, 0
  s_sub_u32 s4, s4, s6
  s_cmp_ge_u32 s61, 2
  s_cselect_b32 s73, 0x40000000, 0
  s_cselect_b32 s80, 63, 1023
  s_lshl_b32 s6, s5, 17
  s_lshl_b32 s7, s4, 7
  s_add_u32 s6, s6, s7
  v_lshlrev_b32 v6, 14, v4
  v_lshl_add_u32 v6, v5, 4, v6
  v_add_u32_e64 v202, s6, v6
  v_subrev_u32 v200, 6144, v202
  v_subrev_u32 v201, 2048, v202
  v_add_u32 v203, 4096, v202
  v_add_u32 v204, 8192, v202
  v_add_u32 v205, 12288, v202
  v_lshlrev_b32 v206, 6, v5
  s_lshl_b32 s72, s4, 9
  buffer_load_dwordx4 v[168:171], v206, s[28:31], s72 offen offset:0
  buffer_load_dwordx4 v[172:175], v206, s[28:31], s72 offen offset:16
  buffer_load_dwordx4 v[176:179], v206, s[28:31], s72 offen offset:32
  buffer_load_dwordx4 v[180:183], v206, s[28:31], s72 offen offset:48
  buffer_load_dwordx4 v[16:19], v200, s[20:23], 0 offen offset:0 nt
  buffer_load_dwordx4 v[20:23], v200, s[20:23], 0 offen offset:2048 nt
  buffer_load_dwordx4 v[24:27], v201, s[20:23], 0 offen offset:0 nt
  buffer_load_dwordx4 v[28:31], v202, s[20:23], 0 offen offset:0 nt
  buffer_load_dwordx4 v[32:35], v202, s[20:23], 0 offen offset:2048 nt
  buffer_load_dwordx4 v[36:39], v203, s[20:23], 0 offen offset:0 nt
  buffer_load_dwordx4 v[40:43], v203, s[20:23], 0 offen offset:2048 nt
  buffer_load_dwordx4 v[44:47], v204, s[20:23], 0 offen offset:0 nt
  buffer_load_dwordx4 v[48:51], v204, s[20:23], 0 offen offset:2048 nt
  buffer_load_dwordx4 v[52:55], v205, s[20:23], 0 offen offset:0 nt
  buffer_load_dwordx4 v[56:59], v205, s[20:23], 0 offen offset:2048 nt
  buffer_load_dwordx4 v[60:63], v202, s[24:27], 0 offen offset:0 nt
  buffer_load_dwordx4 v[64:67], v202, s[24:27], 0 offen offset:2048 nt
  buffer_load_dwordx4 v[68:71], v203, s[24:27], 0 offen offset:0 nt
  buffer_load_dwordx4 v[72:75], v203, s[24:27], 0 offen offset:2048 nt
  buffer_load_dwordx4 v[76:79], v204, s[24:27], 0 offen offset:0 nt
  buffer_load_dwordx4 v[80:83], v204, s[24:27], 0 offen offset:2048 nt
  buffer_load_dwordx4 v[84:87], v205, s[24:27], 0 offen offset:0 nt
  buffer_load_dwordx4 v[88:91], v205, s[24:27], 0 offen offset:2048 nt
  buffer_load_dwordx4 v[184:187], v206, s[28:31], s72 offen offset:512
  buffer_load_dwordx4 v[188:191], v206, s[28:31], s72 offen offset:528
  buffer_load_dwordx4 v[192:195], v206, s[28:31], s72 offen offset:544
  buffer_load_dwordx4 v[196:199], v206, s[28:31], s72 offen offset:560
  buffer_load_dwordx4 v[92:95], v200, s[20:23], 0 offen offset:128 nt
  buffer_load_dwordx4 v[96:99], v200, s[20:23], 0 offen offset:2176 nt
  buffer_load_dwordx4 v[100:103], v201, s[20:23], 0 offen offset:128 nt
  buffer_load_dwordx4 v[104:107], v202, s[20:23], 0 offen offset:128 nt
  buffer_load_dwordx4 v[108:111], v202, s[20:23], 0 offen offset:2176 nt
  buffer_load_dwordx4 v[112:115], v203, s[20:23], 0 offen offset:128 nt
  buffer_load_dwordx4 v[116:119], v203, s[20:23], 0 offen offset:2176 nt
  buffer_load_dwordx4 v[120:123], v204, s[20:23], 0 offen offset:128 nt
  buffer_load_dwordx4 v[124:127], v204, s[20:23], 0 offen offset:2176 nt
  buffer_load_dwordx4 v[128:131], v205, s[20:23], 0 offen offset:128 nt
  buffer_load_dwordx4 v[132:135], v205, s[20:23], 0 offen offset:2176 nt
  buffer_load_dwordx4 v[136:139], v202, s[24:27], 0 offen offset:128 nt
  buffer_load_dwordx4 v[140:143], v202, s[24:27], 0 offen offset:2176 nt
  buffer_load_dwordx4 v[144:147], v203, s[24:27], 0 offen offset:128 nt
  buffer_load_dwordx4 v[148:151], v203, s[24:27], 0 offen offset:2176 nt
  buffer_load_dwordx4 v[152:155], v204, s[24:27], 0 offen offset:128 nt
  buffer_load_dwordx4 v[156:159], v204, s[24:27], 0 offen offset:2176 nt
  buffer_load_dwordx4 v[160:163], v205, s[24:27], 0 offen offset:128 nt
  buffer_load_dwordx4 v[164:167], v205, s[24:27], 0 offen offset:2176 nt
  v_sub_u32 v6, 7, v4
  v_xor_b32 v6, v6, v5
  v_lshlrev_b32_e64 v6, 4, v6
  v_lshl_add_u32 v6, v5, 7, v6
  v_add_u32 v3, s68, v6
  v_xor_b32 v6, v4, v5
  v_lshlrev_b32_e64 v6, 4, v6
  v_lshl_add_u32 v6, v4, 7, v6
  v_add_u32_e64 v10, s68, v6
  v_mul_u32_u24 v6, 32768, v4
  v_lshl_add_u32 v12, v5, 4, v6
  s_mul_i32 s6, s4, 8192
  s_lshl_b32 s7, s5, 4
  s_add_u32 s6, s6, s7
  s_add_u32 s70, s6, 1572864
  s_mul_i32 s6, s4, 262144
  s_lshl_b32 s7, s5, 7
  s_sub_u32 s6, s6, s7
  s_add_u32 s84, s6, 33558400
  s_mov_b32 s74, 0x05040100
  s_mov_b32 s75, 0x07060302
  s_waitcnt vmcnt(40)
  v_perm_b32 v212, v16, v20, s74
  s_waitcnt vmcnt(39)
  v_perm_b32 v213, v20, v24, s74
  s_waitcnt vmcnt(38)
  v_perm_b32 v214, v24, v28, s74
  s_waitcnt vmcnt(37)
  v_perm_b32 v215, v28, v32, s74
  s_waitcnt vmcnt(36)
  v_perm_b32 v216, v32, v36, s74
  s_waitcnt vmcnt(35)
  v_perm_b32 v217, v36, v40, s74
  s_waitcnt vmcnt(34)
  v_perm_b32 v218, v40, v44, s74
  s_waitcnt vmcnt(33)
  v_perm_b32 v219, v44, v48, s74
  s_waitcnt vmcnt(32)
  v_perm_b32 v220, v48, v52, s74
  s_waitcnt vmcnt(31)
  v_perm_b32 v221, v52, v56, s74
  v_dot2_f32_bf16 v222, v214, v168, 0
  v_dot2_f32_bf16 v223, v215, v168, 0
  v_dot2_f32_bf16 v224, v216, v168, 0
  v_dot2_f32_bf16 v225, v217, v168, 0
  v_dot2_f32_bf16 v226, v218, v168, 0
  v_dot2_f32_bf16 v227, v219, v168, 0
  v_dot2_f32_bf16 v228, v220, v168, 0
  v_dot2_f32_bf16 v229, v221, v168, 0
  s_waitcnt vmcnt(30)
  v_lshlrev_b32 v230, 16, v60
  s_waitcnt vmcnt(29)
  v_lshlrev_b32 v231, 16, v64
  s_waitcnt vmcnt(28)
  v_lshlrev_b32 v232, 16, v68
  s_waitcnt vmcnt(27)
  v_lshlrev_b32 v233, 16, v72
  s_waitcnt vmcnt(26)
  v_lshlrev_b32 v234, 16, v76
  s_waitcnt vmcnt(25)
  v_lshlrev_b32 v235, 16, v80
  s_waitcnt vmcnt(24)
  v_lshlrev_b32 v236, 16, v84
  s_waitcnt vmcnt(23)
  v_lshlrev_b32 v237, 16, v88
  v_dot2c_f32_bf16 v222, v212, v169
  v_dot2c_f32_bf16 v223, v213, v169
  v_dot2c_f32_bf16 v224, v214, v169
  v_dot2c_f32_bf16 v225, v215, v169
  v_dot2c_f32_bf16 v226, v216, v169
  v_dot2c_f32_bf16 v227, v217, v169
  v_dot2c_f32_bf16 v228, v218, v169
  v_dot2c_f32_bf16 v229, v219, v169
  v_mul_f32 v222, v222, v230
  v_mul_f32 v223, v223, v231
  v_mul_f32 v224, v224, v232
  v_mul_f32 v225, v225, v233
  v_mul_f32 v226, v226, v234
  v_mul_f32 v227, v227, v235
  v_mul_f32 v228, v228, v236
  v_mul_f32 v229, v229, v237
  v_cvt_pk_bf16_f32 v238, v229, v228
  v_cvt_pk_bf16_f32 v239, v227, v226
  v_cvt_pk_bf16_f32 v240, v225, v224
  v_cvt_pk_bf16_f32 v241, v223, v222
  ds_write_b128 v3, v[238:241] offset:0
  ds_read_b128 v[246:249], v10 offset:0
  v_perm_b32 v212, v16, v20, s75
  v_perm_b32 v213, v20, v24, s75
  v_perm_b32 v214, v24, v28, s75
  v_perm_b32 v215, v28, v32, s75
  v_perm_b32 v216, v32, v36, s75
  v_perm_b32 v217, v36, v40, s75
  v_perm_b32 v218, v40, v44, s75
  v_perm_b32 v219, v44, v48, s75
  v_perm_b32 v220, v48, v52, s75
  v_perm_b32 v221, v52, v56, s75
  v_dot2_f32_bf16 v222, v214, v170, 0
  v_dot2_f32_bf16 v223, v215, v170, 0
  v_dot2_f32_bf16 v224, v216, v170, 0
  v_dot2_f32_bf16 v225, v217, v170, 0
  v_dot2_f32_bf16 v226, v218, v170, 0
  v_dot2_f32_bf16 v227, v219, v170, 0
  v_dot2_f32_bf16 v228, v220, v170, 0
  v_dot2_f32_bf16 v229, v221, v170, 0
  v_and_b32 v230, 0xffff0000, v60
  v_and_b32 v231, 0xffff0000, v64
  v_and_b32 v232, 0xffff0000, v68
  v_and_b32 v233, 0xffff0000, v72
  v_and_b32 v234, 0xffff0000, v76
  v_and_b32 v235, 0xffff0000, v80
  v_and_b32 v236, 0xffff0000, v84
  v_and_b32 v237, 0xffff0000, v88
  v_dot2c_f32_bf16 v222, v212, v171
  v_dot2c_f32_bf16 v223, v213, v171
  v_dot2c_f32_bf16 v224, v214, v171
  v_dot2c_f32_bf16 v225, v215, v171
  v_dot2c_f32_bf16 v226, v216, v171
  v_dot2c_f32_bf16 v227, v217, v171
  v_dot2c_f32_bf16 v228, v218, v171
  v_dot2c_f32_bf16_e64 v229, v219, v171
  s_waitcnt lgkmcnt(0)
  buffer_store_dwordx4 v[246:249], v12, s[16:19], s84 offen sc1
  s_add_u32 s84, s84, 4096
  v_mul_f32 v222, v222, v230
  v_mul_f32 v223, v223, v231
  v_mul_f32 v224, v224, v232
  v_mul_f32 v225, v225, v233
  v_mul_f32 v226, v226, v234
  v_mul_f32 v227, v227, v235
  v_mul_f32 v228, v228, v236
  v_mul_f32 v229, v229, v237
  v_cvt_pk_bf16_f32 v242, v229, v228
  v_cvt_pk_bf16_f32 v243, v227, v226
  v_cvt_pk_bf16_f32 v244, v225, v224
  v_cvt_pk_bf16_f32 v245, v223, v222
  ds_write_b128 v3, v[242:245] offset:1024
  ds_read_b128 v[250:253], v10 offset:1024
  v_perm_b32 v212, v17, v21, s74
  v_perm_b32 v213, v21, v25, s74
  v_perm_b32 v214, v25, v29, s74
  v_perm_b32 v215, v29, v33, s74
  v_perm_b32 v216, v33, v37, s74
  v_perm_b32 v217, v37, v41, s74
  v_perm_b32 v218, v41, v45, s74
  v_perm_b32 v219, v45, v49, s74
  v_perm_b32 v220, v49, v53, s74
  v_perm_b32 v221, v53, v57, s74
  v_dot2_f32_bf16 v222, v214, v172, 0
  v_dot2_f32_bf16 v223, v215, v172, 0
  v_dot2_f32_bf16 v224, v216, v172, 0
  v_dot2_f32_bf16 v225, v217, v172, 0
  v_dot2_f32_bf16 v226, v218, v172, 0
  v_dot2_f32_bf16 v227, v219, v172, 0
  v_dot2_f32_bf16 v228, v220, v172, 0
  v_dot2_f32_bf16 v229, v221, v172, 0
  v_lshlrev_b32 v230, 16, v61
  v_lshlrev_b32 v231, 16, v65
  v_lshlrev_b32 v232, 16, v69
  v_lshlrev_b32 v233, 16, v73
  v_lshlrev_b32 v234, 16, v77
  v_lshlrev_b32 v235, 16, v81
  v_lshlrev_b32 v236, 16, v85
  v_lshlrev_b32 v237, 16, v89
  v_dot2c_f32_bf16 v222, v212, v173
  v_dot2c_f32_bf16 v223, v213, v173
  v_dot2c_f32_bf16 v224, v214, v173
  v_dot2c_f32_bf16 v225, v215, v173
  v_dot2c_f32_bf16 v226, v216, v173
  v_dot2c_f32_bf16 v227, v217, v173
  v_dot2c_f32_bf16 v228, v218, v173
  v_dot2c_f32_bf16_e64 v229, v219, v173
  s_waitcnt lgkmcnt(0)
  buffer_store_dwordx4 v[250:253], v12, s[16:19], s84 offen sc1
  s_add_u32 s84, s84, 4096
  v_mul_f32 v222, v222, v230
  v_mul_f32 v223, v223, v231
  v_mul_f32 v224, v224, v232
  v_mul_f32 v225, v225, v233
  v_mul_f32 v226, v226, v234
  v_mul_f32 v227, v227, v235
  v_mul_f32 v228, v228, v236
  v_mul_f32 v229, v229, v237
  v_cvt_pk_bf16_f32 v238, v229, v228
  v_cvt_pk_bf16_f32 v239, v227, v226
  v_cvt_pk_bf16_f32 v240, v225, v224
  v_cvt_pk_bf16_f32 v241, v223, v222
  ds_write_b128 v3, v[238:241] offset:0
  ds_read_b128 v[246:249], v10 offset:0
  v_perm_b32 v212, v17, v21, s75
  v_perm_b32 v213, v21, v25, s75
  v_perm_b32 v214, v25, v29, s75
  v_perm_b32 v215, v29, v33, s75
  v_perm_b32 v216, v33, v37, s75
  v_perm_b32 v217, v37, v41, s75
  v_perm_b32 v218, v41, v45, s75
  v_perm_b32 v219, v45, v49, s75
  v_perm_b32 v220, v49, v53, s75
  v_perm_b32 v221, v53, v57, s75
  v_dot2_f32_bf16 v222, v214, v174, 0
  v_dot2_f32_bf16 v223, v215, v174, 0
  v_dot2_f32_bf16 v224, v216, v174, 0
  v_dot2_f32_bf16 v225, v217, v174, 0
  v_dot2_f32_bf16 v226, v218, v174, 0
  v_dot2_f32_bf16 v227, v219, v174, 0
  v_dot2_f32_bf16 v228, v220, v174, 0
  v_dot2_f32_bf16 v229, v221, v174, 0
  v_and_b32 v230, 0xffff0000, v61
  v_and_b32 v231, 0xffff0000, v65
  v_and_b32 v232, 0xffff0000, v69
  v_and_b32 v233, 0xffff0000, v73
  v_and_b32 v234, 0xffff0000, v77
  v_and_b32 v235, 0xffff0000, v81
  v_and_b32 v236, 0xffff0000, v85
  v_and_b32 v237, 0xffff0000, v89
  v_dot2c_f32_bf16 v222, v212, v175
  v_dot2c_f32_bf16 v223, v213, v175
  v_dot2c_f32_bf16 v224, v214, v175
  v_dot2c_f32_bf16 v225, v215, v175
  v_dot2c_f32_bf16 v226, v216, v175
  v_dot2c_f32_bf16 v227, v217, v175
  v_dot2c_f32_bf16 v228, v218, v175
  v_dot2c_f32_bf16_e64 v229, v219, v175
  s_waitcnt lgkmcnt(0)
  buffer_store_dwordx4 v[246:249], v12, s[16:19], s84 offen sc1
  s_add_u32 s84, s84, 4096
  v_mul_f32 v222, v222, v230
  v_mul_f32 v223, v223, v231
  v_mul_f32 v224, v224, v232
  v_mul_f32 v225, v225, v233
  v_mul_f32 v226, v226, v234
  v_mul_f32 v227, v227, v235
  v_mul_f32 v228, v228, v236
  v_mul_f32 v229, v229, v237
  v_cvt_pk_bf16_f32 v242, v229, v228
  v_cvt_pk_bf16_f32 v243, v227, v226
  v_cvt_pk_bf16_f32 v244, v225, v224
  v_cvt_pk_bf16_f32 v245, v223, v222
  ds_write_b128 v3, v[242:245] offset:1024
  ds_read_b128 v[250:253], v10 offset:1024
  v_perm_b32 v212, v18, v22, s74
  v_perm_b32 v213, v22, v26, s74
  v_perm_b32 v214, v26, v30, s74
  v_perm_b32 v215, v30, v34, s74
  v_perm_b32 v216, v34, v38, s74
  v_perm_b32 v217, v38, v42, s74
  v_perm_b32 v218, v42, v46, s74
  v_perm_b32 v219, v46, v50, s74
  v_perm_b32 v220, v50, v54, s74
  v_perm_b32 v221, v54, v58, s74
  v_dot2_f32_bf16 v222, v214, v176, 0
  v_dot2_f32_bf16 v223, v215, v176, 0
  v_dot2_f32_bf16 v224, v216, v176, 0
  v_dot2_f32_bf16 v225, v217, v176, 0
  v_dot2_f32_bf16 v226, v218, v176, 0
  v_dot2_f32_bf16 v227, v219, v176, 0
  v_dot2_f32_bf16 v228, v220, v176, 0
  v_dot2_f32_bf16 v229, v221, v176, 0
  v_lshlrev_b32 v230, 16, v62
  v_lshlrev_b32 v231, 16, v66
  v_lshlrev_b32 v232, 16, v70
  v_lshlrev_b32 v233, 16, v74
  v_lshlrev_b32 v234, 16, v78
  v_lshlrev_b32 v235, 16, v82
  v_lshlrev_b32 v236, 16, v86
  v_lshlrev_b32 v237, 16, v90
  v_dot2c_f32_bf16 v222, v212, v177
  v_dot2c_f32_bf16 v223, v213, v177
  v_dot2c_f32_bf16 v224, v214, v177
  v_dot2c_f32_bf16 v225, v215, v177
  v_dot2c_f32_bf16 v226, v216, v177
  v_dot2c_f32_bf16 v227, v217, v177
  v_dot2c_f32_bf16 v228, v218, v177
  v_dot2c_f32_bf16_e64 v229, v219, v177
  s_waitcnt lgkmcnt(0)
  buffer_store_dwordx4 v[250:253], v12, s[16:19], s84 offen sc1
  s_add_u32 s84, s84, 4096
  v_mul_f32 v222, v222, v230
  v_mul_f32 v223, v223, v231
  v_mul_f32 v224, v224, v232
  v_mul_f32 v225, v225, v233
  v_mul_f32 v226, v226, v234
  v_mul_f32 v227, v227, v235
  v_mul_f32 v228, v228, v236
  v_mul_f32 v229, v229, v237
  v_cvt_pk_bf16_f32 v238, v229, v228
  v_cvt_pk_bf16_f32 v239, v227, v226
  v_cvt_pk_bf16_f32 v240, v225, v224
  v_cvt_pk_bf16_f32 v241, v223, v222
  ds_write_b128 v3, v[238:241] offset:0
  ds_read_b128 v[246:249], v10 offset:0
  v_perm_b32 v212, v18, v22, s75
  v_perm_b32 v213, v22, v26, s75
  v_perm_b32 v214, v26, v30, s75
  v_perm_b32 v215, v30, v34, s75
  v_perm_b32 v216, v34, v38, s75
  v_perm_b32 v217, v38, v42, s75
  v_perm_b32 v218, v42, v46, s75
  v_perm_b32 v219, v46, v50, s75
  v_perm_b32 v220, v50, v54, s75
  v_perm_b32 v221, v54, v58, s75
  v_dot2_f32_bf16 v222, v214, v178, 0
  v_dot2_f32_bf16 v223, v215, v178, 0
  v_dot2_f32_bf16 v224, v216, v178, 0
  v_dot2_f32_bf16 v225, v217, v178, 0
  v_dot2_f32_bf16 v226, v218, v178, 0
  v_dot2_f32_bf16 v227, v219, v178, 0
  v_dot2_f32_bf16 v228, v220, v178, 0
  v_dot2_f32_bf16 v229, v221, v178, 0
  v_and_b32 v230, 0xffff0000, v62
  v_and_b32 v231, 0xffff0000, v66
  v_and_b32 v232, 0xffff0000, v70
  v_and_b32 v233, 0xffff0000, v74
  v_and_b32 v234, 0xffff0000, v78
  v_and_b32 v235, 0xffff0000, v82
  v_and_b32 v236, 0xffff0000, v86
  v_and_b32 v237, 0xffff0000, v90
  v_dot2c_f32_bf16 v222, v212, v179
  v_dot2c_f32_bf16 v223, v213, v179
  v_dot2c_f32_bf16 v224, v214, v179
  v_dot2c_f32_bf16 v225, v215, v179
  v_dot2c_f32_bf16 v226, v216, v179
  v_dot2c_f32_bf16 v227, v217, v179
  v_dot2c_f32_bf16 v228, v218, v179
  v_dot2c_f32_bf16_e64 v229, v219, v179
  s_waitcnt lgkmcnt(0)
  buffer_store_dwordx4 v[246:249], v12, s[16:19], s84 offen sc1
  s_add_u32 s84, s84, 4096
  v_mul_f32 v222, v222, v230
  v_mul_f32 v223, v223, v231
  v_mul_f32 v224, v224, v232
  v_mul_f32 v225, v225, v233
  v_mul_f32 v226, v226, v234
  v_mul_f32 v227, v227, v235
  v_mul_f32 v228, v228, v236
  v_mul_f32 v229, v229, v237
  v_cvt_pk_bf16_f32 v242, v229, v228
  v_cvt_pk_bf16_f32 v243, v227, v226
  v_cvt_pk_bf16_f32 v244, v225, v224
  v_cvt_pk_bf16_f32 v245, v223, v222
  ds_write_b128 v3, v[242:245] offset:1024
  ds_read_b128 v[250:253], v10 offset:1024
  v_perm_b32 v212, v19, v23, s74
  v_perm_b32 v213, v23, v27, s74
  v_perm_b32 v214, v27, v31, s74
  v_perm_b32 v215, v31, v35, s74
  v_perm_b32 v216, v35, v39, s74
  v_perm_b32 v217, v39, v43, s74
  v_perm_b32 v218, v43, v47, s74
  v_perm_b32 v219, v47, v51, s74
  v_perm_b32 v220, v51, v55, s74
  v_perm_b32 v221, v55, v59, s74
  v_dot2_f32_bf16 v222, v214, v180, 0
  v_dot2_f32_bf16 v223, v215, v180, 0
  v_dot2_f32_bf16 v224, v216, v180, 0
  v_dot2_f32_bf16 v225, v217, v180, 0
  v_dot2_f32_bf16 v226, v218, v180, 0
  v_dot2_f32_bf16 v227, v219, v180, 0
  v_dot2_f32_bf16 v228, v220, v180, 0
  v_dot2_f32_bf16 v229, v221, v180, 0
  v_lshlrev_b32 v230, 16, v63
  v_lshlrev_b32 v231, 16, v67
  v_lshlrev_b32 v232, 16, v71
  v_lshlrev_b32 v233, 16, v75
  v_lshlrev_b32 v234, 16, v79
  v_lshlrev_b32 v235, 16, v83
  v_lshlrev_b32 v236, 16, v87
  v_lshlrev_b32 v237, 16, v91
  v_dot2c_f32_bf16 v222, v212, v181
  v_dot2c_f32_bf16 v223, v213, v181
  v_dot2c_f32_bf16 v224, v214, v181
  v_dot2c_f32_bf16 v225, v215, v181
  v_dot2c_f32_bf16 v226, v216, v181
  v_dot2c_f32_bf16 v227, v217, v181
  v_dot2c_f32_bf16 v228, v218, v181
  v_dot2c_f32_bf16_e64 v229, v219, v181
  s_waitcnt lgkmcnt(0)
  buffer_store_dwordx4 v[250:253], v12, s[16:19], s84 offen sc1
  s_add_u32 s84, s84, 4096
  v_mul_f32 v222, v222, v230
  v_mul_f32 v223, v223, v231
  v_mul_f32 v224, v224, v232
  v_mul_f32 v225, v225, v233
  v_mul_f32 v226, v226, v234
  v_mul_f32 v227, v227, v235
  v_mul_f32 v228, v228, v236
  v_mul_f32 v229, v229, v237
  v_cvt_pk_bf16_f32 v238, v229, v228
  v_cvt_pk_bf16_f32 v239, v227, v226
  v_cvt_pk_bf16_f32 v240, v225, v224
  v_cvt_pk_bf16_f32 v241, v223, v222
  ds_write_b128 v3, v[238:241] offset:0
  ds_read_b128 v[246:249], v10 offset:0
  v_perm_b32 v212, v19, v23, s75
  v_perm_b32 v213, v23, v27, s75
  v_perm_b32 v214, v27, v31, s75
  v_perm_b32 v215, v31, v35, s75
  v_perm_b32 v216, v35, v39, s75
  v_perm_b32 v217, v39, v43, s75
  v_perm_b32 v218, v43, v47, s75
  v_perm_b32 v219, v47, v51, s75
  v_perm_b32 v220, v51, v55, s75
  v_perm_b32 v221, v55, v59, s75
  v_dot2_f32_bf16 v222, v214, v182, 0
  v_dot2_f32_bf16 v223, v215, v182, 0
  v_dot2_f32_bf16 v224, v216, v182, 0
  v_dot2_f32_bf16 v225, v217, v182, 0
  v_dot2_f32_bf16 v226, v218, v182, 0
  v_dot2_f32_bf16 v227, v219, v182, 0
  v_dot2_f32_bf16 v228, v220, v182, 0
  v_dot2_f32_bf16 v229, v221, v182, 0
  v_and_b32 v230, 0xffff0000, v63
  v_and_b32 v231, 0xffff0000, v67
  v_and_b32 v232, 0xffff0000, v71
  v_and_b32 v233, 0xffff0000, v75
  v_and_b32 v234, 0xffff0000, v79
  v_and_b32 v235, 0xffff0000, v83
  v_and_b32 v236, 0xffff0000, v87
  v_and_b32 v237, 0xffff0000, v91
  v_dot2c_f32_bf16 v222, v212, v183
  v_dot2c_f32_bf16 v223, v213, v183
  v_dot2c_f32_bf16 v224, v214, v183
  v_dot2c_f32_bf16 v225, v215, v183
  v_dot2c_f32_bf16 v226, v216, v183
  v_dot2c_f32_bf16 v227, v217, v183
  v_dot2c_f32_bf16 v228, v218, v183
  v_dot2c_f32_bf16_e64 v229, v219, v183
  s_waitcnt lgkmcnt(0)
  buffer_store_dwordx4 v[246:249], v12, s[16:19], s84 offen sc1
  s_add_u32 s84, s84, 4096
  buffer_load_dwordx4 a[152:155], v206, s[28:31], s72 offen offset:1024
  buffer_load_dwordx4 a[156:159], v206, s[28:31], s72 offen offset:1040
  buffer_load_dwordx4 a[160:163], v206, s[28:31], s72 offen offset:1056
  buffer_load_dwordx4 a[164:167], v206, s[28:31], s72 offen offset:1072
  buffer_load_dwordx4 a[0:3], v200, s[20:23], 0 offen offset:256 nt
  buffer_load_dwordx4 a[4:7], v200, s[20:23], 0 offen offset:2304 nt
  buffer_load_dwordx4 a[8:11], v201, s[20:23], 0 offen offset:256 nt
  buffer_load_dwordx4 a[12:15], v202, s[20:23], 0 offen offset:256 nt
  buffer_load_dwordx4 a[16:19], v202, s[20:23], 0 offen offset:2304 nt
  buffer_load_dwordx4 a[20:23], v203, s[20:23], 0 offen offset:256 nt
  buffer_load_dwordx4 a[24:27], v203, s[20:23], 0 offen offset:2304 nt
  buffer_load_dwordx4 a[28:31], v204, s[20:23], 0 offen offset:256 nt
  buffer_load_dwordx4 a[32:35], v204, s[20:23], 0 offen offset:2304 nt
  buffer_load_dwordx4 a[36:39], v205, s[20:23], 0 offen offset:256 nt
  buffer_load_dwordx4 a[40:43], v205, s[20:23], 0 offen offset:2304 nt
  buffer_load_dwordx4 a[44:47], v202, s[24:27], 0 offen offset:256 nt
  buffer_load_dwordx4 a[48:51], v202, s[24:27], 0 offen offset:2304 nt
  buffer_load_dwordx4 a[52:55], v203, s[24:27], 0 offen offset:256 nt
  buffer_load_dwordx4 a[56:59], v203, s[24:27], 0 offen offset:2304 nt
  buffer_load_dwordx4 a[60:63], v204, s[24:27], 0 offen offset:256 nt
  buffer_load_dwordx4 a[64:67], v204, s[24:27], 0 offen offset:2304 nt
  buffer_load_dwordx4 a[68:71], v205, s[24:27], 0 offen offset:256 nt
  buffer_load_dwordx4 a[72:75], v205, s[24:27], 0 offen offset:2304 nt
  v_mul_f32 v222, v222, v230
  v_mul_f32 v223, v223, v231
  v_mul_f32 v224, v224, v232
  v_mul_f32 v225, v225, v233
  v_mul_f32 v226, v226, v234
  v_mul_f32 v227, v227, v235
  v_mul_f32 v228, v228, v236
  v_mul_f32 v229, v229, v237
  v_cvt_pk_bf16_f32 v242, v229, v228
  v_cvt_pk_bf16_f32 v243, v227, v226
  v_cvt_pk_bf16_f32 v244, v225, v224
  v_cvt_pk_bf16_f32 v245, v223, v222
  ds_write_b128 v3, v[242:245] offset:1024
  ds_read_b128 v[250:253], v10 offset:1024
  s_waitcnt vmcnt(47)
  v_perm_b32 v212, v92, v96, s74
  s_waitcnt vmcnt(46)
  v_perm_b32 v213, v96, v100, s74
  s_waitcnt vmcnt(45)
  v_perm_b32 v214, v100, v104, s74
  s_waitcnt vmcnt(44)
  v_perm_b32 v215, v104, v108, s74
  s_waitcnt vmcnt(43)
  v_perm_b32 v216, v108, v112, s74
  s_waitcnt vmcnt(42)
  v_perm_b32 v217, v112, v116, s74
  s_waitcnt vmcnt(41)
  v_perm_b32 v218, v116, v120, s74
  s_waitcnt vmcnt(40)
  v_perm_b32 v219, v120, v124, s74
  s_waitcnt vmcnt(39)
  v_perm_b32 v220, v124, v128, s74
  s_waitcnt vmcnt(38)
  v_perm_b32 v221, v128, v132, s74
  v_dot2_f32_bf16 v222, v214, v184, 0
  v_dot2_f32_bf16 v223, v215, v184, 0
  v_dot2_f32_bf16 v224, v216, v184, 0
  v_dot2_f32_bf16 v225, v217, v184, 0
  v_dot2_f32_bf16 v226, v218, v184, 0
  v_dot2_f32_bf16 v227, v219, v184, 0
  v_dot2_f32_bf16 v228, v220, v184, 0
  v_dot2_f32_bf16 v229, v221, v184, 0
  s_waitcnt vmcnt(37)
  v_lshlrev_b32 v230, 16, v136
  s_waitcnt vmcnt(36)
  v_lshlrev_b32 v231, 16, v140
  s_waitcnt vmcnt(35)
  v_lshlrev_b32 v232, 16, v144
  s_waitcnt vmcnt(34)
  v_lshlrev_b32 v233, 16, v148
  s_waitcnt vmcnt(33)
  v_lshlrev_b32 v234, 16, v152
  s_waitcnt vmcnt(32)
  v_lshlrev_b32 v235, 16, v156
  s_waitcnt vmcnt(31)
  v_lshlrev_b32 v236, 16, v160
  s_waitcnt vmcnt(30)
  v_lshlrev_b32 v237, 16, v164
  v_dot2c_f32_bf16 v222, v212, v185
  v_dot2c_f32_bf16 v223, v213, v185
  v_dot2c_f32_bf16 v224, v214, v185
  v_dot2c_f32_bf16 v225, v215, v185
  v_dot2c_f32_bf16 v226, v216, v185
  v_dot2c_f32_bf16 v227, v217, v185
  v_dot2c_f32_bf16 v228, v218, v185
  v_dot2c_f32_bf16_e64 v229, v219, v185
  s_waitcnt lgkmcnt(0)
  buffer_store_dwordx4 v[250:253], v12, s[16:19], s84 offen sc1
  s_add_u32 s84, s84, 233472
  v_mul_f32 v222, v222, v230
  v_mul_f32 v223, v223, v231
  v_mul_f32 v224, v224, v232
  v_mul_f32 v225, v225, v233
  v_mul_f32 v226, v226, v234
  v_mul_f32 v227, v227, v235
  v_mul_f32 v228, v228, v236
  v_mul_f32 v229, v229, v237
  v_cvt_pk_bf16_f32 v238, v229, v228
  v_cvt_pk_bf16_f32 v239, v227, v226
  v_cvt_pk_bf16_f32 v240, v225, v224
  v_cvt_pk_bf16_f32 v241, v223, v222
  ds_write_b128 v3, v[238:241] offset:0
  ds_read_b128 v[246:249], v10 offset:0
  v_perm_b32 v212, v92, v96, s75
  v_perm_b32 v213, v96, v100, s75
  v_perm_b32 v214, v100, v104, s75
  v_perm_b32 v215, v104, v108, s75
  v_perm_b32 v216, v108, v112, s75
  v_perm_b32 v217, v112, v116, s75
  v_perm_b32 v218, v116, v120, s75
  v_perm_b32 v219, v120, v124, s75
  v_perm_b32 v220, v124, v128, s75
  v_perm_b32 v221, v128, v132, s75
  v_dot2_f32_bf16 v222, v214, v186, 0
  v_dot2_f32_bf16 v223, v215, v186, 0
  v_dot2_f32_bf16 v224, v216, v186, 0
  v_dot2_f32_bf16 v225, v217, v186, 0
  v_dot2_f32_bf16 v226, v218, v186, 0
  v_dot2_f32_bf16 v227, v219, v186, 0
  v_dot2_f32_bf16 v228, v220, v186, 0
  v_dot2_f32_bf16 v229, v221, v186, 0
  v_and_b32 v230, 0xffff0000, v136
  v_and_b32 v231, 0xffff0000, v140
  v_and_b32 v232, 0xffff0000, v144
  v_and_b32 v233, 0xffff0000, v148
  v_and_b32 v234, 0xffff0000, v152
  v_and_b32 v235, 0xffff0000, v156
  v_and_b32 v236, 0xffff0000, v160
  v_and_b32 v237, 0xffff0000, v164
  v_dot2c_f32_bf16 v222, v212, v187
  v_dot2c_f32_bf16 v223, v213, v187
  v_dot2c_f32_bf16 v224, v214, v187
  v_dot2c_f32_bf16 v225, v215, v187
  v_dot2c_f32_bf16 v226, v216, v187
  v_dot2c_f32_bf16 v227, v217, v187
  v_dot2c_f32_bf16 v228, v218, v187
  v_dot2c_f32_bf16_e64 v229, v219, v187
  s_waitcnt lgkmcnt(0)
  buffer_store_dwordx4 v[246:249], v12, s[16:19], s84 offen sc1
  s_add_u32 s84, s84, 4096
  v_mul_f32 v222, v222, v230
  v_mul_f32 v223, v223, v231
  v_mul_f32 v224, v224, v232
  v_mul_f32 v225, v225, v233
  v_mul_f32 v226, v226, v234
  v_mul_f32 v227, v227, v235
  v_mul_f32 v228, v228, v236
  v_mul_f32 v229, v229, v237
  v_cvt_pk_bf16_f32 v242, v229, v228
  v_cvt_pk_bf16_f32 v243, v227, v226
  v_cvt_pk_bf16_f32 v244, v225, v224
  v_cvt_pk_bf16_f32 v245, v223, v222
  ds_write_b128 v3, v[242:245] offset:1024
  ds_read_b128 v[250:253], v10 offset:1024
  v_perm_b32 v212, v93, v97, s74
  v_perm_b32 v213, v97, v101, s74
  v_perm_b32 v214, v101, v105, s74
  v_perm_b32 v215, v105, v109, s74
  v_perm_b32 v216, v109, v113, s74
  v_perm_b32 v217, v113, v117, s74
  v_perm_b32 v218, v117, v121, s74
  v_perm_b32 v219, v121, v125, s74
  v_perm_b32 v220, v125, v129, s74
  v_perm_b32 v221, v129, v133, s74
  v_dot2_f32_bf16 v222, v214, v188, 0
  v_dot2_f32_bf16 v223, v215, v188, 0
  v_dot2_f32_bf16 v224, v216, v188, 0
  v_dot2_f32_bf16 v225, v217, v188, 0
  v_dot2_f32_bf16 v226, v218, v188, 0
  v_dot2_f32_bf16 v227, v219, v188, 0
  v_dot2_f32_bf16 v228, v220, v188, 0
  v_dot2_f32_bf16 v229, v221, v188, 0
  v_lshlrev_b32 v230, 16, v137
  v_lshlrev_b32 v231, 16, v141
  v_lshlrev_b32 v232, 16, v145
  v_lshlrev_b32 v233, 16, v149
  v_lshlrev_b32 v234, 16, v153
  v_lshlrev_b32 v235, 16, v157
  v_lshlrev_b32 v236, 16, v161
  v_lshlrev_b32 v237, 16, v165
  v_dot2c_f32_bf16 v222, v212, v189
  v_dot2c_f32_bf16 v223, v213, v189
  v_dot2c_f32_bf16 v224, v214, v189
  v_dot2c_f32_bf16 v225, v215, v189
  v_dot2c_f32_bf16 v226, v216, v189
  v_dot2c_f32_bf16 v227, v217, v189
  v_dot2c_f32_bf16 v228, v218, v189
  v_dot2c_f32_bf16_e64 v229, v219, v189
  s_waitcnt lgkmcnt(0)
  buffer_store_dwordx4 v[250:253], v12, s[16:19], s84 offen sc1
  s_add_u32 s84, s84, 4096
  v_mul_f32 v222, v222, v230
  v_mul_f32 v223, v223, v231
  v_mul_f32 v224, v224, v232
  v_mul_f32 v225, v225, v233
  v_mul_f32 v226, v226, v234
  v_mul_f32 v227, v227, v235
  v_mul_f32 v228, v228, v236
  v_mul_f32 v229, v229, v237
  v_cvt_pk_bf16_f32 v238, v229, v228
  v_cvt_pk_bf16_f32 v239, v227, v226
  v_cvt_pk_bf16_f32 v240, v225, v224
  v_cvt_pk_bf16_f32 v241, v223, v222
  ds_write_b128 v3, v[238:241] offset:0
  ds_read_b128 v[246:249], v10 offset:0
  v_perm_b32 v212, v93, v97, s75
  v_perm_b32 v213, v97, v101, s75
  v_perm_b32 v214, v101, v105, s75
  v_perm_b32 v215, v105, v109, s75
  v_perm_b32 v216, v109, v113, s75
  v_perm_b32 v217, v113, v117, s75
  v_perm_b32 v218, v117, v121, s75
  v_perm_b32 v219, v121, v125, s75
  v_perm_b32 v220, v125, v129, s75
  v_perm_b32 v221, v129, v133, s75
  v_dot2_f32_bf16 v222, v214, v190, 0
  v_dot2_f32_bf16 v223, v215, v190, 0
  v_dot2_f32_bf16 v224, v216, v190, 0
  v_dot2_f32_bf16 v225, v217, v190, 0
  v_dot2_f32_bf16 v226, v218, v190, 0
  v_dot2_f32_bf16 v227, v219, v190, 0
  v_dot2_f32_bf16 v228, v220, v190, 0
  v_dot2_f32_bf16 v229, v221, v190, 0
  v_and_b32 v230, 0xffff0000, v137
  v_and_b32 v231, 0xffff0000, v141
  v_and_b32 v232, 0xffff0000, v145
  v_and_b32 v233, 0xffff0000, v149
  v_and_b32 v234, 0xffff0000, v153
  v_and_b32 v235, 0xffff0000, v157
  v_and_b32 v236, 0xffff0000, v161
  v_and_b32 v237, 0xffff0000, v165
  v_dot2c_f32_bf16 v222, v212, v191
  v_dot2c_f32_bf16 v223, v213, v191
  v_dot2c_f32_bf16 v224, v214, v191
  v_dot2c_f32_bf16 v225, v215, v191
  v_dot2c_f32_bf16 v226, v216, v191
  v_dot2c_f32_bf16 v227, v217, v191
  v_dot2c_f32_bf16 v228, v218, v191
  v_dot2c_f32_bf16_e64 v229, v219, v191
  s_waitcnt lgkmcnt(0)
  buffer_store_dwordx4 v[246:249], v12, s[16:19], s84 offen sc1
  s_add_u32 s84, s84, 4096
  v_mul_f32 v222, v222, v230
  v_mul_f32 v223, v223, v231
  v_mul_f32 v224, v224, v232
  v_mul_f32 v225, v225, v233
  v_mul_f32 v226, v226, v234
  v_mul_f32 v227, v227, v235
  v_mul_f32 v228, v228, v236
  v_mul_f32 v229, v229, v237
  v_cvt_pk_bf16_f32 v242, v229, v228
  v_cvt_pk_bf16_f32 v243, v227, v226
  v_cvt_pk_bf16_f32 v244, v225, v224
  v_cvt_pk_bf16_f32 v245, v223, v222
  ds_write_b128 v3, v[242:245] offset:1024
  ds_read_b128 v[250:253], v10 offset:1024
  v_perm_b32 v212, v94, v98, s74
  v_perm_b32 v213, v98, v102, s74
  v_perm_b32 v214, v102, v106, s74
  v_perm_b32 v215, v106, v110, s74
  v_perm_b32 v216, v110, v114, s74
  v_perm_b32 v217, v114, v118, s74
  v_perm_b32 v218, v118, v122, s74
  v_perm_b32 v219, v122, v126, s74
  v_perm_b32 v220, v126, v130, s74
  v_perm_b32 v221, v130, v134, s74
  v_dot2_f32_bf16 v222, v214, v192, 0
  v_dot2_f32_bf16 v223, v215, v192, 0
  v_dot2_f32_bf16 v224, v216, v192, 0
  v_dot2_f32_bf16 v225, v217, v192, 0
  v_dot2_f32_bf16 v226, v218, v192, 0
  v_dot2_f32_bf16 v227, v219, v192, 0
  v_dot2_f32_bf16 v228, v220, v192, 0
  v_dot2_f32_bf16 v229, v221, v192, 0
  v_lshlrev_b32 v230, 16, v138
  v_lshlrev_b32 v231, 16, v142
  v_lshlrev_b32 v232, 16, v146
  v_lshlrev_b32 v233, 16, v150
  v_lshlrev_b32 v234, 16, v154
  v_lshlrev_b32 v235, 16, v158
  v_lshlrev_b32 v236, 16, v162
  v_lshlrev_b32 v237, 16, v166
  v_dot2c_f32_bf16 v222, v212, v193
  v_dot2c_f32_bf16 v223, v213, v193
  v_dot2c_f32_bf16 v224, v214, v193
  v_dot2c_f32_bf16 v225, v215, v193
  v_dot2c_f32_bf16 v226, v216, v193
  v_dot2c_f32_bf16 v227, v217, v193
  v_dot2c_f32_bf16 v228, v218, v193
  v_dot2c_f32_bf16_e64 v229, v219, v193
  s_waitcnt lgkmcnt(0)
  buffer_store_dwordx4 v[250:253], v12, s[16:19], s84 offen sc1
  s_add_u32 s84, s84, 4096
  v_mul_f32 v222, v222, v230
  v_mul_f32 v223, v223, v231
  v_mul_f32 v224, v224, v232
  v_mul_f32 v225, v225, v233
  v_mul_f32 v226, v226, v234
  v_mul_f32 v227, v227, v235
  v_mul_f32 v228, v228, v236
  v_mul_f32 v229, v229, v237
  v_cvt_pk_bf16_f32 v238, v229, v228
  v_cvt_pk_bf16_f32 v239, v227, v226
  v_cvt_pk_bf16_f32 v240, v225, v224
  v_cvt_pk_bf16_f32 v241, v223, v222
  ds_write_b128 v3, v[238:241] offset:0
  ds_read_b128 v[246:249], v10 offset:0
  v_perm_b32 v212, v94, v98, s75
  v_perm_b32 v213, v98, v102, s75
  v_perm_b32 v214, v102, v106, s75
  v_perm_b32 v215, v106, v110, s75
  v_perm_b32 v216, v110, v114, s75
  v_perm_b32 v217, v114, v118, s75
  v_perm_b32 v218, v118, v122, s75
  v_perm_b32 v219, v122, v126, s75
  v_perm_b32 v220, v126, v130, s75
  v_perm_b32 v221, v130, v134, s75
  v_dot2_f32_bf16 v222, v214, v194, 0
  v_dot2_f32_bf16 v223, v215, v194, 0
  v_dot2_f32_bf16 v224, v216, v194, 0
  v_dot2_f32_bf16 v225, v217, v194, 0
  v_dot2_f32_bf16 v226, v218, v194, 0
  v_dot2_f32_bf16 v227, v219, v194, 0
  v_dot2_f32_bf16 v228, v220, v194, 0
  v_dot2_f32_bf16 v229, v221, v194, 0
  v_and_b32 v230, 0xffff0000, v138
  v_and_b32 v231, 0xffff0000, v142
  v_and_b32 v232, 0xffff0000, v146
  v_and_b32 v233, 0xffff0000, v150
  v_and_b32 v234, 0xffff0000, v154
  v_and_b32 v235, 0xffff0000, v158
  v_and_b32 v236, 0xffff0000, v162
  v_and_b32 v237, 0xffff0000, v166
  v_dot2c_f32_bf16 v222, v212, v195
  v_dot2c_f32_bf16 v223, v213, v195
  v_dot2c_f32_bf16 v224, v214, v195
  v_dot2c_f32_bf16 v225, v215, v195
  v_dot2c_f32_bf16 v226, v216, v195
  v_dot2c_f32_bf16 v227, v217, v195
  v_dot2c_f32_bf16 v228, v218, v195
  v_dot2c_f32_bf16_e64 v229, v219, v195
  s_waitcnt lgkmcnt(0)
  buffer_store_dwordx4 v[246:249], v12, s[16:19], s84 offen sc1
  s_add_u32 s84, s84, 4096
  v_mul_f32 v222, v222, v230
  v_mul_f32 v223, v223, v231
  v_mul_f32 v224, v224, v232
  v_mul_f32 v225, v225, v233
  v_mul_f32 v226, v226, v234
  v_mul_f32 v227, v227, v235
  v_mul_f32 v228, v228, v236
  v_mul_f32 v229, v229, v237
  v_cvt_pk_bf16_f32 v242, v229, v228
  v_cvt_pk_bf16_f32 v243, v227, v226
  v_cvt_pk_bf16_f32 v244, v225, v224
  v_cvt_pk_bf16_f32 v245, v223, v222
  ds_write_b128 v3, v[242:245] offset:1024
  ds_read_b128 v[250:253], v10 offset:1024
  v_perm_b32 v212, v95, v99, s74
  v_perm_b32 v213, v99, v103, s74
  v_perm_b32 v214, v103, v107, s74
  v_perm_b32 v215, v107, v111, s74
  v_perm_b32 v216, v111, v115, s74
  v_perm_b32 v217, v115, v119, s74
  v_perm_b32 v218, v119, v123, s74
  v_perm_b32 v219, v123, v127, s74
  v_perm_b32 v220, v127, v131, s74
  v_perm_b32 v221, v131, v135, s74
  v_dot2_f32_bf16 v222, v214, v196, 0
  v_dot2_f32_bf16 v223, v215, v196, 0
  v_dot2_f32_bf16 v224, v216, v196, 0
  v_dot2_f32_bf16 v225, v217, v196, 0
  v_dot2_f32_bf16 v226, v218, v196, 0
  v_dot2_f32_bf16 v227, v219, v196, 0
  v_dot2_f32_bf16 v228, v220, v196, 0
  v_dot2_f32_bf16 v229, v221, v196, 0
  v_lshlrev_b32 v230, 16, v139
  v_lshlrev_b32 v231, 16, v143
  v_lshlrev_b32 v232, 16, v147
  v_lshlrev_b32 v233, 16, v151
  v_lshlrev_b32 v234, 16, v155
  v_lshlrev_b32 v235, 16, v159
  v_lshlrev_b32 v236, 16, v163
  v_lshlrev_b32 v237, 16, v167
  v_dot2c_f32_bf16 v222, v212, v197
  v_dot2c_f32_bf16 v223, v213, v197
  v_dot2c_f32_bf16 v224, v214, v197
  v_dot2c_f32_bf16 v225, v215, v197
  v_dot2c_f32_bf16 v226, v216, v197
  v_dot2c_f32_bf16 v227, v217, v197
  v_dot2c_f32_bf16 v228, v218, v197
  v_dot2c_f32_bf16_e64 v229, v219, v197
  s_waitcnt lgkmcnt(0)
  buffer_store_dwordx4 v[250:253], v12, s[16:19], s84 offen sc1
  s_add_u32 s84, s84, 4096
  v_mul_f32 v222, v222, v230
  v_mul_f32 v223, v223, v231
  v_mul_f32 v224, v224, v232
  v_mul_f32 v225, v225, v233
  v_mul_f32 v226, v226, v234
  v_mul_f32 v227, v227, v235
  v_mul_f32 v228, v228, v236
  v_mul_f32 v229, v229, v237
  v_cvt_pk_bf16_f32 v238, v229, v228
  v_cvt_pk_bf16_f32 v239, v227, v226
  v_cvt_pk_bf16_f32 v240, v225, v224
  v_cvt_pk_bf16_f32 v241, v223, v222
  ds_write_b128 v3, v[238:241] offset:0
  ds_read_b128 v[246:249], v10 offset:0
  v_perm_b32 v212, v95, v99, s75
  v_perm_b32 v213, v99, v103, s75
  v_perm_b32 v214, v103, v107, s75
  v_perm_b32 v215, v107, v111, s75
  v_perm_b32 v216, v111, v115, s75
  v_perm_b32 v217, v115, v119, s75
  v_perm_b32 v218, v119, v123, s75
  v_perm_b32 v219, v123, v127, s75
  v_perm_b32 v220, v127, v131, s75
  v_perm_b32 v221, v131, v135, s75
  v_dot2_f32_bf16 v222, v214, v198, 0
  v_dot2_f32_bf16 v223, v215, v198, 0
  v_dot2_f32_bf16 v224, v216, v198, 0
  v_dot2_f32_bf16 v225, v217, v198, 0
  v_dot2_f32_bf16 v226, v218, v198, 0
  v_dot2_f32_bf16 v227, v219, v198, 0
  v_dot2_f32_bf16 v228, v220, v198, 0
  v_dot2_f32_bf16 v229, v221, v198, 0
  v_and_b32 v230, 0xffff0000, v139
  v_and_b32 v231, 0xffff0000, v143
  v_and_b32 v232, 0xffff0000, v147
  v_and_b32 v233, 0xffff0000, v151
  v_and_b32 v234, 0xffff0000, v155
  v_and_b32 v235, 0xffff0000, v159
  v_and_b32 v236, 0xffff0000, v163
  v_and_b32 v237, 0xffff0000, v167
  v_dot2c_f32_bf16 v222, v212, v199
  v_dot2c_f32_bf16 v223, v213, v199
  v_dot2c_f32_bf16 v224, v214, v199
  v_dot2c_f32_bf16 v225, v215, v199
  v_dot2c_f32_bf16 v226, v216, v199
  v_dot2c_f32_bf16 v227, v217, v199
  v_dot2c_f32_bf16 v228, v218, v199
  v_dot2c_f32_bf16_e64 v229, v219, v199
  s_waitcnt lgkmcnt(0)
  buffer_store_dwordx4 v[246:249], v12, s[16:19], s84 offen sc1
  s_add_u32 s84, s84, 4096
  v_add_u32 v200, s73, v200
  v_add_u32 v201, s73, v201
  v_add_u32 v202, s73, v202
  v_add_u32 v203, s73, v203
  v_add_u32 v204, s73, v204
  v_add_u32 v205, s73, v205
  v_add_u32_e64 v206, s73, v206
  buffer_load_dwordx4 a[168:171], v206, s[28:31], s72 offen offset:1536
  buffer_load_dwordx4 a[172:175], v206, s[28:31], s72 offen offset:1552
  buffer_load_dwordx4 a[176:179], v206, s[28:31], s72 offen offset:1568
  buffer_load_dwordx4 a[180:183], v206, s[28:31], s72 offen offset:1584
  buffer_load_dwordx4 a[76:79], v200, s[20:23], 0 offen offset:384 nt
  buffer_load_dwordx4 a[80:83], v200, s[20:23], 0 offen offset:2432 nt
  buffer_load_dwordx4 a[84:87], v201, s[20:23], 0 offen offset:384 nt
  buffer_load_dwordx4 a[88:91], v202, s[20:23], 0 offen offset:384 nt
  buffer_load_dwordx4 a[92:95], v202, s[20:23], 0 offen offset:2432 nt
  buffer_load_dwordx4 a[96:99], v203, s[20:23], 0 offen offset:384 nt
  buffer_load_dwordx4 a[100:103], v203, s[20:23], 0 offen offset:2432 nt
  buffer_load_dwordx4 a[104:107], v204, s[20:23], 0 offen offset:384 nt
  buffer_load_dwordx4 a[108:111], v204, s[20:23], 0 offen offset:2432 nt
  buffer_load_dwordx4 a[112:115], v205, s[20:23], 0 offen offset:384 nt
  buffer_load_dwordx4 a[116:119], v205, s[20:23], 0 offen offset:2432 nt
  buffer_load_dwordx4 a[120:123], v202, s[24:27], 0 offen offset:384 nt
  buffer_load_dwordx4 a[124:127], v202, s[24:27], 0 offen offset:2432 nt
  buffer_load_dwordx4 a[128:131], v203, s[24:27], 0 offen offset:384 nt
  buffer_load_dwordx4 a[132:135], v203, s[24:27], 0 offen offset:2432 nt
  buffer_load_dwordx4 a[136:139], v204, s[24:27], 0 offen offset:384 nt
  buffer_load_dwordx4 a[140:143], v204, s[24:27], 0 offen offset:2432 nt
  buffer_load_dwordx4 a[144:147], v205, s[24:27], 0 offen offset:384 nt
  buffer_load_dwordx4 a[148:151], v205, s[24:27], 0 offen offset:2432 nt
  s_xor_b32 s97, s96, 15
  s_lshl_b32 s97, s97, 8
  buffer_load_dword v211, v210, s[40:43], s97 offen
  v_mul_f32 v222, v222, v230
  v_mul_f32 v223, v223, v231
  v_mul_f32 v224, v224, v232
  v_mul_f32 v225, v225, v233
  v_mul_f32 v226, v226, v234
  v_mul_f32 v227, v227, v235
  v_mul_f32 v228, v228, v236
  v_mul_f32 v229, v229, v237
  v_cvt_pk_bf16_f32 v242, v229, v228
  v_cvt_pk_bf16_f32 v243, v227, v226
  v_cvt_pk_bf16_f32 v244, v225, v224
  v_cvt_pk_bf16_f32 v245, v223, v222
  ds_write_b128 v3, v[242:245] offset:1024
  ds_read_b128 v[250:253], v10 offset:1024
  s_waitcnt vmcnt(54)
  v_accvgpr_read_b32 v168, a152
  v_accvgpr_read_b32 v169, a153
  v_accvgpr_read_b32 v170, a154
  v_accvgpr_read_b32 v171, a155
  s_waitcnt vmcnt(50)
  v_accvgpr_read_b32 v16, a0
  s_waitcnt vmcnt(49)
  v_accvgpr_read_b32 v20, a4
  s_waitcnt vmcnt(48)
  v_accvgpr_read_b32 v24, a8
  s_waitcnt vmcnt(47)
  v_accvgpr_read_b32 v28, a12
  s_waitcnt vmcnt(46)
  v_accvgpr_read_b32 v32, a16
  s_waitcnt vmcnt(45)
  v_accvgpr_read_b32 v36, a20
  s_waitcnt vmcnt(44)
  v_accvgpr_read_b32 v40, a24
  s_waitcnt vmcnt(43)
  v_accvgpr_read_b32 v44, a28
  s_waitcnt vmcnt(42)
  v_accvgpr_read_b32 v48, a32
  s_waitcnt vmcnt(41)
  v_accvgpr_read_b32 v52, a36
  s_waitcnt vmcnt(40)
  v_accvgpr_read_b32 v56, a40
  s_waitcnt vmcnt(39)
  v_accvgpr_read_b32 v60, a44
  s_waitcnt vmcnt(38)
  v_accvgpr_read_b32 v64, a48
  s_waitcnt vmcnt(37)
  v_accvgpr_read_b32 v68, a52
  s_waitcnt vmcnt(36)
  v_accvgpr_read_b32 v72, a56
  s_waitcnt vmcnt(35)
  v_accvgpr_read_b32 v76, a60
  s_waitcnt vmcnt(34)
  v_accvgpr_read_b32 v80, a64
  s_waitcnt vmcnt(33)
  v_accvgpr_read_b32 v84, a68
  s_waitcnt vmcnt(32)
  v_accvgpr_read_b32 v88, a72
  v_perm_b32 v212, v16, v20, s74
  v_perm_b32 v213, v20, v24, s74
  v_perm_b32 v214, v24, v28, s74
  v_perm_b32 v215, v28, v32, s74
  v_perm_b32 v216, v32, v36, s74
  v_perm_b32 v217, v36, v40, s74
  v_perm_b32 v218, v40, v44, s74
  v_perm_b32 v219, v44, v48, s74
  v_perm_b32 v220, v48, v52, s74
  v_perm_b32 v221, v52, v56, s74
  v_dot2_f32_bf16 v222, v214, v168, 0
  v_dot2_f32_bf16 v223, v215, v168, 0
  v_dot2_f32_bf16 v224, v216, v168, 0
  v_dot2_f32_bf16 v225, v217, v168, 0
  v_dot2_f32_bf16 v226, v218, v168, 0
  v_dot2_f32_bf16 v227, v219, v168, 0
  v_dot2_f32_bf16 v228, v220, v168, 0
  v_dot2_f32_bf16 v229, v221, v168, 0
  v_lshlrev_b32 v230, 16, v60
  v_lshlrev_b32 v231, 16, v64
  v_lshlrev_b32 v232, 16, v68
  v_lshlrev_b32 v233, 16, v72
  v_lshlrev_b32 v234, 16, v76
  v_lshlrev_b32 v235, 16, v80
  v_lshlrev_b32 v236, 16, v84
  v_lshlrev_b32 v237, 16, v88
  v_dot2c_f32_bf16 v222, v212, v169
  v_dot2c_f32_bf16 v223, v213, v169
  v_dot2c_f32_bf16 v224, v214, v169
  v_dot2c_f32_bf16 v225, v215, v169
  v_dot2c_f32_bf16 v226, v216, v169
  v_dot2c_f32_bf16 v227, v217, v169
  v_dot2c_f32_bf16 v228, v218, v169
  v_dot2c_f32_bf16_e64 v229, v219, v169
  s_waitcnt lgkmcnt(0)
  buffer_store_dwordx4 v[250:253], v12, s[16:19], s84 offen sc1
  s_add_u32 s84, s84, 233472
  v_mul_f32 v222, v222, v230
  v_mul_f32 v223, v223, v231
  v_mul_f32 v224, v224, v232
  v_mul_f32 v225, v225, v233
  v_mul_f32 v226, v226, v234
  v_mul_f32 v227, v227, v235
  v_mul_f32 v228, v228, v236
  v_mul_f32 v229, v229, v237
  v_cvt_pk_bf16_f32 v238, v229, v228
  v_cvt_pk_bf16_f32 v239, v227, v226
  v_cvt_pk_bf16_f32 v240, v225, v224
  v_cvt_pk_bf16_f32 v241, v223, v222
  ds_write_b128 v3, v[238:241] offset:0
  ds_read_b128 v[246:249], v10 offset:0
  v_perm_b32 v212, v16, v20, s75
  v_perm_b32 v213, v20, v24, s75
  v_perm_b32 v214, v24, v28, s75
  v_perm_b32 v215, v28, v32, s75
  v_perm_b32 v216, v32, v36, s75
  v_perm_b32 v217, v36, v40, s75
  v_perm_b32 v218, v40, v44, s75
  v_perm_b32 v219, v44, v48, s75
  v_perm_b32 v220, v48, v52, s75
  v_perm_b32 v221, v52, v56, s75
  v_dot2_f32_bf16 v222, v214, v170, 0
  v_dot2_f32_bf16 v223, v215, v170, 0
  v_dot2_f32_bf16 v224, v216, v170, 0
  v_dot2_f32_bf16 v225, v217, v170, 0
  v_dot2_f32_bf16 v226, v218, v170, 0
  v_dot2_f32_bf16 v227, v219, v170, 0
  v_dot2_f32_bf16 v228, v220, v170, 0
  v_dot2_f32_bf16 v229, v221, v170, 0
  v_and_b32 v230, 0xffff0000, v60
  v_and_b32 v231, 0xffff0000, v64
  v_and_b32 v232, 0xffff0000, v68
  v_and_b32 v233, 0xffff0000, v72
  v_and_b32 v234, 0xffff0000, v76
  v_and_b32 v235, 0xffff0000, v80
  v_and_b32 v236, 0xffff0000, v84
  v_and_b32 v237, 0xffff0000, v88
  v_dot2c_f32_bf16 v222, v212, v171
  v_dot2c_f32_bf16 v223, v213, v171
  v_dot2c_f32_bf16 v224, v214, v171
  v_dot2c_f32_bf16 v225, v215, v171
  v_dot2c_f32_bf16 v226, v216, v171
  v_dot2c_f32_bf16 v227, v217, v171
  v_dot2c_f32_bf16 v228, v218, v171
  v_dot2c_f32_bf16_e64 v229, v219, v171
  s_waitcnt lgkmcnt(0)
  buffer_store_dwordx4 v[246:249], v12, s[16:19], s84 offen sc1
  s_add_u32 s84, s84, 4096
  v_mul_f32 v222, v222, v230
  v_mul_f32 v223, v223, v231
  v_mul_f32 v224, v224, v232
  v_mul_f32 v225, v225, v233
  v_mul_f32 v226, v226, v234
  v_mul_f32 v227, v227, v235
  v_mul_f32 v228, v228, v236
  v_mul_f32 v229, v229, v237
  v_cvt_pk_bf16_f32 v242, v229, v228
  v_cvt_pk_bf16_f32 v243, v227, v226
  v_cvt_pk_bf16_f32 v244, v225, v224
  v_cvt_pk_bf16_f32 v245, v223, v222
  ds_write_b128 v3, v[242:245] offset:1024
  ds_read_b128 v[250:253], v10 offset:1024
  v_accvgpr_read_b32 v172, a156
  v_accvgpr_read_b32 v173, a157
  v_accvgpr_read_b32 v174, a158
  v_accvgpr_read_b32 v175, a159
  v_accvgpr_read_b32 v17, a1
  v_accvgpr_read_b32 v21, a5
  v_accvgpr_read_b32 v25, a9
  v_accvgpr_read_b32 v29, a13
  v_accvgpr_read_b32 v33, a17
  v_accvgpr_read_b32 v37, a21
  v_accvgpr_read_b32 v41, a25
  v_accvgpr_read_b32 v45, a29
  v_accvgpr_read_b32 v49, a33
  v_accvgpr_read_b32 v53, a37
  v_accvgpr_read_b32 v57, a41
  v_accvgpr_read_b32 v61, a45
  v_accvgpr_read_b32 v65, a49
  v_accvgpr_read_b32 v69, a53
  v_accvgpr_read_b32 v73, a57
  v_accvgpr_read_b32 v77, a61
  v_accvgpr_read_b32 v81, a65
  v_accvgpr_read_b32 v85, a69
  v_accvgpr_read_b32 v89, a73
  v_perm_b32 v212, v17, v21, s74
  v_perm_b32 v213, v21, v25, s74
  v_perm_b32 v214, v25, v29, s74
  v_perm_b32 v215, v29, v33, s74
  v_perm_b32 v216, v33, v37, s74
  v_perm_b32 v217, v37, v41, s74
  v_perm_b32 v218, v41, v45, s74
  v_perm_b32 v219, v45, v49, s74
  v_perm_b32 v220, v49, v53, s74
  v_perm_b32 v221, v53, v57, s74
  v_dot2_f32_bf16 v222, v214, v172, 0
  v_dot2_f32_bf16 v223, v215, v172, 0
  v_dot2_f32_bf16 v224, v216, v172, 0
  v_dot2_f32_bf16 v225, v217, v172, 0
  v_dot2_f32_bf16 v226, v218, v172, 0
  v_dot2_f32_bf16 v227, v219, v172, 0
  v_dot2_f32_bf16 v228, v220, v172, 0
  v_dot2_f32_bf16 v229, v221, v172, 0
  v_lshlrev_b32 v230, 16, v61
  v_lshlrev_b32 v231, 16, v65
  v_lshlrev_b32 v232, 16, v69
  v_lshlrev_b32 v233, 16, v73
  v_lshlrev_b32 v234, 16, v77
  v_lshlrev_b32 v235, 16, v81
  v_lshlrev_b32 v236, 16, v85
  v_lshlrev_b32 v237, 16, v89
  v_dot2c_f32_bf16 v222, v212, v173
  v_dot2c_f32_bf16 v223, v213, v173
  v_dot2c_f32_bf16 v224, v214, v173
  v_dot2c_f32_bf16 v225, v215, v173
  v_dot2c_f32_bf16 v226, v216, v173
  v_dot2c_f32_bf16 v227, v217, v173
  v_dot2c_f32_bf16 v228, v218, v173
  v_dot2c_f32_bf16_e64 v229, v219, v173
  s_waitcnt lgkmcnt(0)
  buffer_store_dwordx4 v[250:253], v12, s[16:19], s84 offen sc1
  s_add_u32 s84, s84, 4096
  v_mul_f32 v222, v222, v230
  v_mul_f32 v223, v223, v231
  v_mul_f32 v224, v224, v232
  v_mul_f32 v225, v225, v233
  v_mul_f32 v226, v226, v234
  v_mul_f32 v227, v227, v235
  v_mul_f32 v228, v228, v236
  v_mul_f32 v229, v229, v237
  v_cvt_pk_bf16_f32 v238, v229, v228
  v_cvt_pk_bf16_f32 v239, v227, v226
  v_cvt_pk_bf16_f32 v240, v225, v224
  v_cvt_pk_bf16_f32 v241, v223, v222
  ds_write_b128 v3, v[238:241] offset:0
  ds_read_b128 v[246:249], v10 offset:0
  v_perm_b32 v212, v17, v21, s75
  v_perm_b32 v213, v21, v25, s75
  v_perm_b32 v214, v25, v29, s75
  v_perm_b32 v215, v29, v33, s75
  v_perm_b32 v216, v33, v37, s75
  v_perm_b32 v217, v37, v41, s75
  v_perm_b32 v218, v41, v45, s75
  v_perm_b32 v219, v45, v49, s75
  v_perm_b32 v220, v49, v53, s75
  v_perm_b32 v221, v53, v57, s75
  v_dot2_f32_bf16 v222, v214, v174, 0
  v_dot2_f32_bf16 v223, v215, v174, 0
  v_dot2_f32_bf16 v224, v216, v174, 0
  v_dot2_f32_bf16 v225, v217, v174, 0
  v_dot2_f32_bf16 v226, v218, v174, 0
  v_dot2_f32_bf16 v227, v219, v174, 0
  v_dot2_f32_bf16 v228, v220, v174, 0
  v_dot2_f32_bf16 v229, v221, v174, 0
  v_and_b32 v230, 0xffff0000, v61
  v_and_b32 v231, 0xffff0000, v65
  v_and_b32 v232, 0xffff0000, v69
  v_and_b32 v233, 0xffff0000, v73
  v_and_b32 v234, 0xffff0000, v77
  v_and_b32 v235, 0xffff0000, v81
  v_and_b32 v236, 0xffff0000, v85
  v_and_b32 v237, 0xffff0000, v89
  v_dot2c_f32_bf16 v222, v212, v175
  v_dot2c_f32_bf16 v223, v213, v175
  v_dot2c_f32_bf16 v224, v214, v175
  v_dot2c_f32_bf16 v225, v215, v175
  v_dot2c_f32_bf16 v226, v216, v175
  v_dot2c_f32_bf16 v227, v217, v175
  v_dot2c_f32_bf16 v228, v218, v175
  v_dot2c_f32_bf16_e64 v229, v219, v175
  s_waitcnt lgkmcnt(0)
  buffer_store_dwordx4 v[246:249], v12, s[16:19], s84 offen sc1
  s_add_u32 s84, s84, 4096
  v_mul_f32 v222, v222, v230
  v_mul_f32 v223, v223, v231
  v_mul_f32 v224, v224, v232
  v_mul_f32 v225, v225, v233
  v_mul_f32 v226, v226, v234
  v_mul_f32 v227, v227, v235
  v_mul_f32 v228, v228, v236
  v_mul_f32 v229, v229, v237
  v_cvt_pk_bf16_f32 v242, v229, v228
  v_cvt_pk_bf16_f32 v243, v227, v226
  v_cvt_pk_bf16_f32 v244, v225, v224
  v_cvt_pk_bf16_f32 v245, v223, v222
  ds_write_b128 v3, v[242:245] offset:1024
  ds_read_b128 v[250:253], v10 offset:1024
  v_accvgpr_read_b32 v176, a160
  v_accvgpr_read_b32 v177, a161
  v_accvgpr_read_b32 v178, a162
  v_accvgpr_read_b32 v179, a163
  v_accvgpr_read_b32 v18, a2
  v_accvgpr_read_b32 v22, a6
  v_accvgpr_read_b32 v26, a10
  v_accvgpr_read_b32 v30, a14
  v_accvgpr_read_b32 v34, a18
  v_accvgpr_read_b32 v38, a22
  v_accvgpr_read_b32 v42, a26
  v_accvgpr_read_b32 v46, a30
  v_accvgpr_read_b32 v50, a34
  v_accvgpr_read_b32 v54, a38
  v_accvgpr_read_b32 v58, a42
  v_accvgpr_read_b32 v62, a46
  v_accvgpr_read_b32 v66, a50
  v_accvgpr_read_b32 v70, a54
  v_accvgpr_read_b32 v74, a58
  v_accvgpr_read_b32 v78, a62
  v_accvgpr_read_b32 v82, a66
  v_accvgpr_read_b32 v86, a70
  v_accvgpr_read_b32 v90, a74
  v_perm_b32 v212, v18, v22, s74
  v_perm_b32 v213, v22, v26, s74
  v_perm_b32 v214, v26, v30, s74
  v_perm_b32 v215, v30, v34, s74
  v_perm_b32 v216, v34, v38, s74
  v_perm_b32 v217, v38, v42, s74
  v_perm_b32 v218, v42, v46, s74
  v_perm_b32 v219, v46, v50, s74
  v_perm_b32 v220, v50, v54, s74
  v_perm_b32 v221, v54, v58, s74
  v_dot2_f32_bf16 v222, v214, v176, 0
  v_dot2_f32_bf16 v223, v215, v176, 0
  v_dot2_f32_bf16 v224, v216, v176, 0
  v_dot2_f32_bf16 v225, v217, v176, 0
  v_dot2_f32_bf16 v226, v218, v176, 0
  v_dot2_f32_bf16 v227, v219, v176, 0
  v_dot2_f32_bf16 v228, v220, v176, 0
  v_dot2_f32_bf16 v229, v221, v176, 0
  v_lshlrev_b32 v230, 16, v62
  v_lshlrev_b32 v231, 16, v66
  v_lshlrev_b32 v232, 16, v70
  v_lshlrev_b32 v233, 16, v74
  v_lshlrev_b32 v234, 16, v78
  v_lshlrev_b32 v235, 16, v82
  v_lshlrev_b32 v236, 16, v86
  v_lshlrev_b32 v237, 16, v90
  v_dot2c_f32_bf16 v222, v212, v177
  v_dot2c_f32_bf16 v223, v213, v177
  v_dot2c_f32_bf16 v224, v214, v177
  v_dot2c_f32_bf16 v225, v215, v177
  v_dot2c_f32_bf16 v226, v216, v177
  v_dot2c_f32_bf16 v227, v217, v177
  v_dot2c_f32_bf16 v228, v218, v177
  v_dot2c_f32_bf16_e64 v229, v219, v177
  s_waitcnt lgkmcnt(0)
  buffer_store_dwordx4 v[250:253], v12, s[16:19], s84 offen sc1
  s_add_u32 s84, s84, 4096
  v_mul_f32 v222, v222, v230
  v_mul_f32 v223, v223, v231
  v_mul_f32 v224, v224, v232
  v_mul_f32 v225, v225, v233
  v_mul_f32 v226, v226, v234
  v_mul_f32 v227, v227, v235
  v_mul_f32 v228, v228, v236
  v_mul_f32 v229, v229, v237
  v_cvt_pk_bf16_f32 v238, v229, v228
  v_cvt_pk_bf16_f32 v239, v227, v226
  v_cvt_pk_bf16_f32 v240, v225, v224
  v_cvt_pk_bf16_f32 v241, v223, v222
  ds_write_b128 v3, v[238:241] offset:0
  ds_read_b128 v[246:249], v10 offset:0
  v_perm_b32 v212, v18, v22, s75
  v_perm_b32 v213, v22, v26, s75
  v_perm_b32 v214, v26, v30, s75
  v_perm_b32 v215, v30, v34, s75
  v_perm_b32 v216, v34, v38, s75
  v_perm_b32 v217, v38, v42, s75
  v_perm_b32 v218, v42, v46, s75
  v_perm_b32 v219, v46, v50, s75
  v_perm_b32 v220, v50, v54, s75
  v_perm_b32 v221, v54, v58, s75
  v_dot2_f32_bf16 v222, v214, v178, 0
  v_dot2_f32_bf16 v223, v215, v178, 0
  v_dot2_f32_bf16 v224, v216, v178, 0
  v_dot2_f32_bf16 v225, v217, v178, 0
  v_dot2_f32_bf16 v226, v218, v178, 0
  v_dot2_f32_bf16 v227, v219, v178, 0
  v_dot2_f32_bf16 v228, v220, v178, 0
  v_dot2_f32_bf16 v229, v221, v178, 0
  v_and_b32 v230, 0xffff0000, v62
  v_and_b32 v231, 0xffff0000, v66
  v_and_b32 v232, 0xffff0000, v70
  v_and_b32 v233, 0xffff0000, v74
  v_and_b32 v234, 0xffff0000, v78
  v_and_b32 v235, 0xffff0000, v82
  v_and_b32 v236, 0xffff0000, v86
  v_and_b32 v237, 0xffff0000, v90
  v_dot2c_f32_bf16 v222, v212, v179
  v_dot2c_f32_bf16 v223, v213, v179
  v_dot2c_f32_bf16 v224, v214, v179
  v_dot2c_f32_bf16 v225, v215, v179
  v_dot2c_f32_bf16 v226, v216, v179
  v_dot2c_f32_bf16 v227, v217, v179
  v_dot2c_f32_bf16 v228, v218, v179
  v_dot2c_f32_bf16_e64 v229, v219, v179
  s_waitcnt lgkmcnt(0)
  buffer_store_dwordx4 v[246:249], v12, s[16:19], s84 offen sc1
  s_add_u32 s84, s84, 4096
  v_mul_f32 v222, v222, v230
  v_mul_f32 v223, v223, v231
  v_mul_f32 v224, v224, v232
  v_mul_f32 v225, v225, v233
  v_mul_f32 v226, v226, v234
  v_mul_f32 v227, v227, v235
  v_mul_f32 v228, v228, v236
  v_mul_f32 v229, v229, v237
  v_cvt_pk_bf16_f32 v242, v229, v228
  v_cvt_pk_bf16_f32 v243, v227, v226
  v_cvt_pk_bf16_f32 v244, v225, v224
  v_cvt_pk_bf16_f32 v245, v223, v222
  ds_write_b128 v3, v[242:245] offset:1024
  ds_read_b128 v[250:253], v10 offset:1024
  v_accvgpr_read_b32 v180, a164
  v_accvgpr_read_b32 v181, a165
  v_accvgpr_read_b32 v182, a166
  v_accvgpr_read_b32 v183, a167
  v_accvgpr_read_b32 v19, a3
  v_accvgpr_read_b32 v23, a7
  v_accvgpr_read_b32 v27, a11
  v_accvgpr_read_b32 v31, a15
  v_accvgpr_read_b32 v35, a19
  v_accvgpr_read_b32 v39, a23
  v_accvgpr_read_b32 v43, a27
  v_accvgpr_read_b32 v47, a31
  v_accvgpr_read_b32 v51, a35
  v_accvgpr_read_b32 v55, a39
  v_accvgpr_read_b32 v59, a43
  v_accvgpr_read_b32 v63, a47
  v_accvgpr_read_b32 v67, a51
  v_accvgpr_read_b32 v71, a55
  v_accvgpr_read_b32 v75, a59
  v_accvgpr_read_b32 v79, a63
  v_accvgpr_read_b32 v83, a67
  v_accvgpr_read_b32 v87, a71
  v_accvgpr_read_b32 v91, a75
  v_perm_b32 v212, v19, v23, s74
  v_perm_b32 v213, v23, v27, s74
  v_perm_b32 v214, v27, v31, s74
  v_perm_b32 v215, v31, v35, s74
  v_perm_b32 v216, v35, v39, s74
  v_perm_b32 v217, v39, v43, s74
  v_perm_b32 v218, v43, v47, s74
  v_perm_b32 v219, v47, v51, s74
  v_perm_b32 v220, v51, v55, s74
  v_perm_b32 v221, v55, v59, s74
  v_dot2_f32_bf16 v222, v214, v180, 0
  v_dot2_f32_bf16 v223, v215, v180, 0
  v_dot2_f32_bf16 v224, v216, v180, 0
  v_dot2_f32_bf16 v225, v217, v180, 0
  v_dot2_f32_bf16 v226, v218, v180, 0
  v_dot2_f32_bf16 v227, v219, v180, 0
  v_dot2_f32_bf16 v228, v220, v180, 0
  v_dot2_f32_bf16 v229, v221, v180, 0
  v_lshlrev_b32 v230, 16, v63
  v_lshlrev_b32 v231, 16, v67
  v_lshlrev_b32 v232, 16, v71
  v_lshlrev_b32 v233, 16, v75
  v_lshlrev_b32 v234, 16, v79
  v_lshlrev_b32 v235, 16, v83
  v_lshlrev_b32 v236, 16, v87
  v_lshlrev_b32 v237, 16, v91
  v_dot2c_f32_bf16 v222, v212, v181
  v_dot2c_f32_bf16 v223, v213, v181
  v_dot2c_f32_bf16 v224, v214, v181
  v_dot2c_f32_bf16 v225, v215, v181
  v_dot2c_f32_bf16 v226, v216, v181
  v_dot2c_f32_bf16 v227, v217, v181
  v_dot2c_f32_bf16 v228, v218, v181
  v_dot2c_f32_bf16_e64 v229, v219, v181
  s_waitcnt lgkmcnt(0)
  buffer_store_dwordx4 v[250:253], v12, s[16:19], s84 offen sc1
  s_add_u32 s84, s84, 4096
  v_mul_f32 v222, v222, v230
  v_mul_f32 v223, v223, v231
  v_mul_f32 v224, v224, v232
  v_mul_f32 v225, v225, v233
  v_mul_f32 v226, v226, v234
  v_mul_f32 v227, v227, v235
  v_mul_f32 v228, v228, v236
  v_mul_f32 v229, v229, v237
  v_cvt_pk_bf16_f32 v238, v229, v228
  v_cvt_pk_bf16_f32 v239, v227, v226
  v_cvt_pk_bf16_f32 v240, v225, v224
  v_cvt_pk_bf16_f32 v241, v223, v222
  ds_write_b128 v3, v[238:241] offset:0
  ds_read_b128 v[246:249], v10 offset:0
  v_perm_b32 v212, v19, v23, s75
  v_perm_b32 v213, v23, v27, s75
  v_perm_b32 v214, v27, v31, s75
  v_perm_b32 v215, v31, v35, s75
  v_perm_b32 v216, v35, v39, s75
  v_perm_b32 v217, v39, v43, s75
  v_perm_b32 v218, v43, v47, s75
  v_perm_b32 v219, v47, v51, s75
  v_perm_b32 v220, v51, v55, s75
  v_perm_b32 v221, v55, v59, s75
  v_dot2_f32_bf16 v222, v214, v182, 0
  v_dot2_f32_bf16 v223, v215, v182, 0
  v_dot2_f32_bf16 v224, v216, v182, 0
  v_dot2_f32_bf16 v225, v217, v182, 0
  v_dot2_f32_bf16 v226, v218, v182, 0
  v_dot2_f32_bf16 v227, v219, v182, 0
  v_dot2_f32_bf16 v228, v220, v182, 0
  v_dot2_f32_bf16 v229, v221, v182, 0
  v_and_b32 v230, 0xffff0000, v63
  v_and_b32 v231, 0xffff0000, v67
  v_and_b32 v232, 0xffff0000, v71
  v_and_b32 v233, 0xffff0000, v75
  v_and_b32 v234, 0xffff0000, v79
  v_and_b32 v235, 0xffff0000, v83
  v_and_b32 v236, 0xffff0000, v87
  v_and_b32 v237, 0xffff0000, v91
  v_dot2c_f32_bf16 v222, v212, v183
  v_dot2c_f32_bf16 v223, v213, v183
  v_dot2c_f32_bf16 v224, v214, v183
  v_dot2c_f32_bf16 v225, v215, v183
  v_dot2c_f32_bf16 v226, v216, v183
  v_dot2c_f32_bf16 v227, v217, v183
  v_dot2c_f32_bf16 v228, v218, v183
  v_dot2c_f32_bf16_e64 v229, v219, v183
  s_waitcnt lgkmcnt(0)
  buffer_store_dwordx4 v[246:249], v12, s[16:19], s84 offen sc1
  s_add_u32 s84, s84, 4096
  buffer_load_dwordx4 v[184:187], v206, s[28:31], s72 offen offset:2048
  buffer_load_dwordx4 v[188:191], v206, s[28:31], s72 offen offset:2064
  buffer_load_dwordx4 v[192:195], v206, s[28:31], s72 offen offset:2080
  buffer_load_dwordx4 v[196:199], v206, s[28:31], s72 offen offset:2096
  buffer_load_dwordx4 v[92:95], v200, s[20:23], 0 offen offset:512 nt
  buffer_load_dwordx4 v[96:99], v200, s[20:23], 0 offen offset:2560 nt
  buffer_load_dwordx4 v[100:103], v201, s[20:23], 0 offen offset:512 nt
  buffer_load_dwordx4 v[104:107], v202, s[20:23], 0 offen offset:512 nt
  buffer_load_dwordx4 v[108:111], v202, s[20:23], 0 offen offset:2560 nt
  buffer_load_dwordx4 v[112:115], v203, s[20:23], 0 offen offset:512 nt
  buffer_load_dwordx4 v[116:119], v203, s[20:23], 0 offen offset:2560 nt
  buffer_load_dwordx4 v[120:123], v204, s[20:23], 0 offen offset:512 nt
  buffer_load_dwordx4 v[124:127], v204, s[20:23], 0 offen offset:2560 nt
  buffer_load_dwordx4 v[128:131], v205, s[20:23], 0 offen offset:512 nt
  buffer_load_dwordx4 v[132:135], v205, s[20:23], 0 offen offset:2560 nt
  buffer_load_dwordx4 v[136:139], v202, s[24:27], 0 offen offset:512 nt
  buffer_load_dwordx4 v[140:143], v202, s[24:27], 0 offen offset:2560 nt
  buffer_load_dwordx4 v[144:147], v203, s[24:27], 0 offen offset:512 nt
  buffer_load_dwordx4 v[148:151], v203, s[24:27], 0 offen offset:2560 nt
  buffer_load_dwordx4 v[152:155], v204, s[24:27], 0 offen offset:512 nt
  buffer_load_dwordx4 v[156:159], v204, s[24:27], 0 offen offset:2560 nt
  buffer_load_dwordx4 v[160:163], v205, s[24:27], 0 offen offset:512 nt
  buffer_load_dwordx4 v[164:167], v205, s[24:27], 0 offen offset:2560 nt
  v_mul_f32 v222, v222, v230
  v_mul_f32 v223, v223, v231
  v_mul_f32 v224, v224, v232
  v_mul_f32 v225, v225, v233
  v_mul_f32 v226, v226, v234
  v_mul_f32 v227, v227, v235
  v_mul_f32 v228, v228, v236
  v_mul_f32 v229, v229, v237
  v_cvt_pk_bf16_f32 v242, v229, v228
  v_cvt_pk_bf16_f32 v243, v227, v226
  v_cvt_pk_bf16_f32 v244, v225, v224
  v_cvt_pk_bf16_f32 v245, v223, v222
  ds_write_b128 v3, v[242:245] offset:1024
  ds_read_b128 v[250:253], v10 offset:1024
  s_waitcnt lgkmcnt(0)
  buffer_store_dwordx4 v[250:253], v12, s[16:19], s84 offen sc1
  s_add_u32 s84, s84, 233472
  s_cmp_ge_u32 s61, 2
  s_cbranch_scc1 parallel_sum__ssm_conv_h3__mixer_gmlp__prompt_kernel_kvend
  s_waitcnt vmcnt(55)
  v_accvgpr_read_b32 v168, a168
  v_accvgpr_read_b32 v169, a169
  v_accvgpr_read_b32 v170, a170
  v_accvgpr_read_b32 v171, a171
  s_waitcnt vmcnt(51)
  v_accvgpr_read_b32 v16, a76
  s_waitcnt vmcnt(50)
  v_accvgpr_read_b32 v20, a80
  s_waitcnt vmcnt(49)
  v_accvgpr_read_b32 v24, a84
  s_waitcnt vmcnt(48)
  v_accvgpr_read_b32 v28, a88
  s_waitcnt vmcnt(47)
  v_accvgpr_read_b32 v32, a92
  s_waitcnt vmcnt(46)
  v_accvgpr_read_b32 v36, a96
  s_waitcnt vmcnt(45)
  v_accvgpr_read_b32 v40, a100
  s_waitcnt vmcnt(44)
  v_accvgpr_read_b32 v44, a104
  s_waitcnt vmcnt(43)
  v_accvgpr_read_b32 v48, a108
  s_waitcnt vmcnt(42)
  v_accvgpr_read_b32 v52, a112
  s_waitcnt vmcnt(41)
  v_accvgpr_read_b32 v56, a116
  s_waitcnt vmcnt(40)
  v_accvgpr_read_b32 v60, a120
  s_waitcnt vmcnt(39)
  v_accvgpr_read_b32 v64, a124
  s_waitcnt vmcnt(38)
  v_accvgpr_read_b32 v68, a128
  s_waitcnt vmcnt(37)
  v_accvgpr_read_b32 v72, a132
  s_waitcnt vmcnt(36)
  v_accvgpr_read_b32 v76, a136
  s_waitcnt vmcnt(35)
  v_accvgpr_read_b32 v80, a140
  s_waitcnt vmcnt(34)
  v_accvgpr_read_b32 v84, a144
  s_waitcnt vmcnt(33)
  v_accvgpr_read_b32 v88, a148
  v_perm_b32 v212, v16, v20, s74
  v_perm_b32 v213, v20, v24, s74
  v_perm_b32 v214, v24, v28, s74
  v_perm_b32 v215, v28, v32, s74
  v_perm_b32 v216, v32, v36, s74
  v_perm_b32 v217, v36, v40, s74
  v_perm_b32 v218, v40, v44, s74
  v_perm_b32 v219, v44, v48, s74
  v_perm_b32 v220, v48, v52, s74
  v_perm_b32 v221, v52, v56, s74
  v_dot2_f32_bf16 v222, v214, v168, 0
  v_dot2_f32_bf16 v223, v215, v168, 0
  v_dot2_f32_bf16 v224, v216, v168, 0
  v_dot2_f32_bf16 v225, v217, v168, 0
  v_dot2_f32_bf16 v226, v218, v168, 0
  v_dot2_f32_bf16 v227, v219, v168, 0
  v_dot2_f32_bf16 v228, v220, v168, 0
  v_dot2_f32_bf16 v229, v221, v168, 0
  v_lshlrev_b32 v230, 16, v60
  v_lshlrev_b32 v231, 16, v64
  v_lshlrev_b32 v232, 16, v68
  v_lshlrev_b32 v233, 16, v72
  v_lshlrev_b32 v234, 16, v76
  v_lshlrev_b32 v235, 16, v80
  v_lshlrev_b32 v236, 16, v84
  v_lshlrev_b32 v237, 16, v88
  v_dot2c_f32_bf16 v222, v212, v169
  v_dot2c_f32_bf16 v223, v213, v169
  v_dot2c_f32_bf16 v224, v214, v169
  v_dot2c_f32_bf16 v225, v215, v169
  v_dot2c_f32_bf16 v226, v216, v169
  v_dot2c_f32_bf16 v227, v217, v169
  v_dot2c_f32_bf16 v228, v218, v169
  v_dot2c_f32_bf16 v229, v219, v169
  v_mul_f32 v222, v222, v230
  v_mul_f32 v223, v223, v231
  v_mul_f32 v224, v224, v232
  v_mul_f32 v225, v225, v233
  v_mul_f32 v226, v226, v234
  v_mul_f32 v227, v227, v235
  v_mul_f32 v228, v228, v236
  v_mul_f32_e64 v229, v229, v237
  v_cvt_pk_bf16_f32 v238, v229, v228
  v_cvt_pk_bf16_f32 v239, v227, v226
  v_cvt_pk_bf16_f32 v240, v225, v224
  v_cvt_pk_bf16_f32 v241, v223, v222
  ds_write_b128 v3, v[238:241] offset:0
  ds_read_b128 v[246:249], v10 offset:0
  v_perm_b32 v212, v16, v20, s75
  v_perm_b32 v213, v20, v24, s75
  v_perm_b32 v214, v24, v28, s75
  v_perm_b32 v215, v28, v32, s75
  v_perm_b32 v216, v32, v36, s75
  v_perm_b32 v217, v36, v40, s75
  v_perm_b32 v218, v40, v44, s75
  v_perm_b32 v219, v44, v48, s75
  v_perm_b32 v220, v48, v52, s75
  v_perm_b32 v221, v52, v56, s75
  v_dot2_f32_bf16 v222, v214, v170, 0
  v_dot2_f32_bf16 v223, v215, v170, 0
  v_dot2_f32_bf16 v224, v216, v170, 0
  v_dot2_f32_bf16 v225, v217, v170, 0
  v_dot2_f32_bf16 v226, v218, v170, 0
  v_dot2_f32_bf16 v227, v219, v170, 0
  v_dot2_f32_bf16 v228, v220, v170, 0
  v_dot2_f32_bf16 v229, v221, v170, 0
  v_and_b32 v230, 0xffff0000, v60
  v_and_b32 v231, 0xffff0000, v64
  v_and_b32 v232, 0xffff0000, v68
  v_and_b32 v233, 0xffff0000, v72
  v_and_b32 v234, 0xffff0000, v76
  v_and_b32 v235, 0xffff0000, v80
  v_and_b32 v236, 0xffff0000, v84
  v_and_b32 v237, 0xffff0000, v88
  v_dot2c_f32_bf16 v222, v212, v171
  v_dot2c_f32_bf16 v223, v213, v171
  v_dot2c_f32_bf16 v224, v214, v171
  v_dot2c_f32_bf16 v225, v215, v171
  v_dot2c_f32_bf16 v226, v216, v171
  v_dot2c_f32_bf16 v227, v217, v171
  v_dot2c_f32_bf16 v228, v218, v171
  v_dot2c_f32_bf16_e64 v229, v219, v171
  s_waitcnt lgkmcnt(0)
  buffer_store_dwordx4 v[246:249], v12, s[16:19], s84 offen sc1
  s_add_u32 s84, s84, 4096
  v_mul_f32 v222, v222, v230
  v_mul_f32 v223, v223, v231
  v_mul_f32 v224, v224, v232
  v_mul_f32 v225, v225, v233
  v_mul_f32 v226, v226, v234
  v_mul_f32 v227, v227, v235
  v_mul_f32 v228, v228, v236
  v_mul_f32 v229, v229, v237
  v_cvt_pk_bf16_f32 v242, v229, v228
  v_cvt_pk_bf16_f32 v243, v227, v226
  v_cvt_pk_bf16_f32 v244, v225, v224
  v_cvt_pk_bf16_f32 v245, v223, v222
  ds_write_b128 v3, v[242:245] offset:1024
  ds_read_b128 v[250:253], v10 offset:1024
  v_accvgpr_read_b32 v172, a172
  v_accvgpr_read_b32 v173, a173
  v_accvgpr_read_b32 v174, a174
  v_accvgpr_read_b32 v175, a175
  v_accvgpr_read_b32 v17, a77
  v_accvgpr_read_b32 v21, a81
  v_accvgpr_read_b32 v25, a85
  v_accvgpr_read_b32 v29, a89
  v_accvgpr_read_b32 v33, a93
  v_accvgpr_read_b32 v37, a97
  v_accvgpr_read_b32 v41, a101
  v_accvgpr_read_b32 v45, a105
  v_accvgpr_read_b32 v49, a109
  v_accvgpr_read_b32 v53, a113
  v_accvgpr_read_b32 v57, a117
  v_accvgpr_read_b32 v61, a121
  v_accvgpr_read_b32 v65, a125
  v_accvgpr_read_b32 v69, a129
  v_accvgpr_read_b32 v73, a133
  v_accvgpr_read_b32 v77, a137
  v_accvgpr_read_b32 v81, a141
  v_accvgpr_read_b32 v85, a145
  v_accvgpr_read_b32 v89, a149
  v_perm_b32 v212, v17, v21, s74
  v_perm_b32 v213, v21, v25, s74
  v_perm_b32 v214, v25, v29, s74
  v_perm_b32 v215, v29, v33, s74
  v_perm_b32 v216, v33, v37, s74
  v_perm_b32 v217, v37, v41, s74
  v_perm_b32 v218, v41, v45, s74
  v_perm_b32 v219, v45, v49, s74
  v_perm_b32 v220, v49, v53, s74
  v_perm_b32 v221, v53, v57, s74
  v_dot2_f32_bf16 v222, v214, v172, 0
  v_dot2_f32_bf16 v223, v215, v172, 0
  v_dot2_f32_bf16 v224, v216, v172, 0
  v_dot2_f32_bf16 v225, v217, v172, 0
  v_dot2_f32_bf16 v226, v218, v172, 0
  v_dot2_f32_bf16 v227, v219, v172, 0
  v_dot2_f32_bf16 v228, v220, v172, 0
  v_dot2_f32_bf16 v229, v221, v172, 0
  v_lshlrev_b32 v230, 16, v61
  v_lshlrev_b32 v231, 16, v65
  v_lshlrev_b32 v232, 16, v69
  v_lshlrev_b32 v233, 16, v73
  v_lshlrev_b32 v234, 16, v77
  v_lshlrev_b32 v235, 16, v81
  v_lshlrev_b32 v236, 16, v85
  v_lshlrev_b32 v237, 16, v89
  v_dot2c_f32_bf16 v222, v212, v173
  v_dot2c_f32_bf16 v223, v213, v173
  v_dot2c_f32_bf16 v224, v214, v173
  v_dot2c_f32_bf16 v225, v215, v173
  v_dot2c_f32_bf16 v226, v216, v173
  v_dot2c_f32_bf16 v227, v217, v173
  v_dot2c_f32_bf16 v228, v218, v173
  v_dot2c_f32_bf16_e64 v229, v219, v173
  s_waitcnt lgkmcnt(0)
  buffer_store_dwordx4 v[250:253], v12, s[16:19], s84 offen sc1
  s_add_u32 s84, s84, 4096
  v_mul_f32 v222, v222, v230
  v_mul_f32 v223, v223, v231
  v_mul_f32 v224, v224, v232
  v_mul_f32 v225, v225, v233
  v_mul_f32 v226, v226, v234
  v_mul_f32 v227, v227, v235
  v_mul_f32 v228, v228, v236
  v_mul_f32 v229, v229, v237
  v_cvt_pk_bf16_f32 v238, v229, v228
  v_cvt_pk_bf16_f32 v239, v227, v226
  v_cvt_pk_bf16_f32 v240, v225, v224
  v_cvt_pk_bf16_f32 v241, v223, v222
  ds_write_b128 v3, v[238:241] offset:0
  ds_read_b128 v[246:249], v10 offset:0
  v_perm_b32 v212, v17, v21, s75
  v_perm_b32 v213, v21, v25, s75
  v_perm_b32 v214, v25, v29, s75
  v_perm_b32 v215, v29, v33, s75
  v_perm_b32 v216, v33, v37, s75
  v_perm_b32 v217, v37, v41, s75
  v_perm_b32 v218, v41, v45, s75
  v_perm_b32 v219, v45, v49, s75
  v_perm_b32 v220, v49, v53, s75
  v_perm_b32 v221, v53, v57, s75
  v_dot2_f32_bf16 v222, v214, v174, 0
  v_dot2_f32_bf16 v223, v215, v174, 0
  v_dot2_f32_bf16 v224, v216, v174, 0
  v_dot2_f32_bf16 v225, v217, v174, 0
  v_dot2_f32_bf16 v226, v218, v174, 0
  v_dot2_f32_bf16 v227, v219, v174, 0
  v_dot2_f32_bf16 v228, v220, v174, 0
  v_dot2_f32_bf16 v229, v221, v174, 0
  v_and_b32 v230, 0xffff0000, v61
  v_and_b32 v231, 0xffff0000, v65
  v_and_b32 v232, 0xffff0000, v69
  v_and_b32 v233, 0xffff0000, v73
  v_and_b32 v234, 0xffff0000, v77
  v_and_b32 v235, 0xffff0000, v81
  v_and_b32 v236, 0xffff0000, v85
  v_and_b32 v237, 0xffff0000, v89
  v_dot2c_f32_bf16 v222, v212, v175
  v_dot2c_f32_bf16 v223, v213, v175
  v_dot2c_f32_bf16 v224, v214, v175
  v_dot2c_f32_bf16 v225, v215, v175
  v_dot2c_f32_bf16 v226, v216, v175
  v_dot2c_f32_bf16 v227, v217, v175
  v_dot2c_f32_bf16 v228, v218, v175
  v_dot2c_f32_bf16_e64 v229, v219, v175
  s_waitcnt lgkmcnt(0)
  buffer_store_dwordx4 v[246:249], v12, s[16:19], s84 offen sc1
  s_add_u32 s84, s84, 4096
  v_mul_f32 v222, v222, v230
  v_mul_f32 v223, v223, v231
  v_mul_f32 v224, v224, v232
  v_mul_f32 v225, v225, v233
  v_mul_f32 v226, v226, v234
  v_mul_f32 v227, v227, v235
  v_mul_f32 v228, v228, v236
  v_mul_f32 v229, v229, v237
  v_cvt_pk_bf16_f32 v242, v229, v228
  v_cvt_pk_bf16_f32 v243, v227, v226
  v_cvt_pk_bf16_f32 v244, v225, v224
  v_cvt_pk_bf16_f32 v245, v223, v222
  ds_write_b128 v3, v[242:245] offset:1024
  ds_read_b128 v[250:253], v10 offset:1024
  v_accvgpr_read_b32 v176, a176
  v_accvgpr_read_b32 v177, a177
  v_accvgpr_read_b32 v178, a178
  v_accvgpr_read_b32 v179, a179
  v_accvgpr_read_b32 v18, a78
  v_accvgpr_read_b32 v22, a82
  v_accvgpr_read_b32 v26, a86
  v_accvgpr_read_b32 v30, a90
  v_accvgpr_read_b32 v34, a94
  v_accvgpr_read_b32 v38, a98
  v_accvgpr_read_b32 v42, a102
  v_accvgpr_read_b32 v46, a106
  v_accvgpr_read_b32 v50, a110
  v_accvgpr_read_b32 v54, a114
  v_accvgpr_read_b32 v58, a118
  v_accvgpr_read_b32 v62, a122
  v_accvgpr_read_b32 v66, a126
  v_accvgpr_read_b32 v70, a130
  v_accvgpr_read_b32 v74, a134
  v_accvgpr_read_b32 v78, a138
  v_accvgpr_read_b32 v82, a142
  v_accvgpr_read_b32 v86, a146
  v_accvgpr_read_b32 v90, a150
  v_perm_b32 v212, v18, v22, s74
  v_perm_b32 v213, v22, v26, s74
  v_perm_b32 v214, v26, v30, s74
  v_perm_b32 v215, v30, v34, s74
  v_perm_b32 v216, v34, v38, s74
  v_perm_b32 v217, v38, v42, s74
  v_perm_b32 v218, v42, v46, s74
  v_perm_b32 v219, v46, v50, s74
  v_perm_b32 v220, v50, v54, s74
  v_perm_b32 v221, v54, v58, s74
  v_dot2_f32_bf16 v222, v214, v176, 0
  v_dot2_f32_bf16 v223, v215, v176, 0
  v_dot2_f32_bf16 v224, v216, v176, 0
  v_dot2_f32_bf16 v225, v217, v176, 0
  v_dot2_f32_bf16 v226, v218, v176, 0
  v_dot2_f32_bf16 v227, v219, v176, 0
  v_dot2_f32_bf16 v228, v220, v176, 0
  v_dot2_f32_bf16 v229, v221, v176, 0
  v_lshlrev_b32 v230, 16, v62
  v_lshlrev_b32 v231, 16, v66
  v_lshlrev_b32 v232, 16, v70
  v_lshlrev_b32 v233, 16, v74
  v_lshlrev_b32 v234, 16, v78
  v_lshlrev_b32 v235, 16, v82
  v_lshlrev_b32 v236, 16, v86
  v_lshlrev_b32 v237, 16, v90
  v_dot2c_f32_bf16 v222, v212, v177
  v_dot2c_f32_bf16 v223, v213, v177
  v_dot2c_f32_bf16 v224, v214, v177
  v_dot2c_f32_bf16 v225, v215, v177
  v_dot2c_f32_bf16 v226, v216, v177
  v_dot2c_f32_bf16 v227, v217, v177
  v_dot2c_f32_bf16 v228, v218, v177
  v_dot2c_f32_bf16_e64 v229, v219, v177
  s_waitcnt lgkmcnt(0)
  buffer_store_dwordx4 v[250:253], v12, s[16:19], s84 offen sc1
  s_add_u32 s84, s84, 4096
  v_mul_f32 v222, v222, v230
  v_mul_f32 v223, v223, v231
  v_mul_f32 v224, v224, v232
  v_mul_f32 v225, v225, v233
  v_mul_f32 v226, v226, v234
  v_mul_f32 v227, v227, v235
  v_mul_f32 v228, v228, v236
  v_mul_f32 v229, v229, v237
  v_cvt_pk_bf16_f32 v238, v229, v228
  v_cvt_pk_bf16_f32 v239, v227, v226
  v_cvt_pk_bf16_f32 v240, v225, v224
  v_cvt_pk_bf16_f32 v241, v223, v222
  ds_write_b128 v3, v[238:241] offset:0
  ds_read_b128 v[246:249], v10 offset:0
  v_perm_b32 v212, v18, v22, s75
  v_perm_b32 v213, v22, v26, s75
  v_perm_b32 v214, v26, v30, s75
  v_perm_b32 v215, v30, v34, s75
  v_perm_b32 v216, v34, v38, s75
  v_perm_b32 v217, v38, v42, s75
  v_perm_b32 v218, v42, v46, s75
  v_perm_b32 v219, v46, v50, s75
  v_perm_b32 v220, v50, v54, s75
  v_perm_b32 v221, v54, v58, s75
  v_dot2_f32_bf16 v222, v214, v178, 0
  v_dot2_f32_bf16 v223, v215, v178, 0
  v_dot2_f32_bf16 v224, v216, v178, 0
  v_dot2_f32_bf16 v225, v217, v178, 0
  v_dot2_f32_bf16 v226, v218, v178, 0
  v_dot2_f32_bf16 v227, v219, v178, 0
  v_dot2_f32_bf16 v228, v220, v178, 0
  v_dot2_f32_bf16 v229, v221, v178, 0
  v_and_b32 v230, 0xffff0000, v62
  v_and_b32 v231, 0xffff0000, v66
  v_and_b32 v232, 0xffff0000, v70
  v_and_b32 v233, 0xffff0000, v74
  v_and_b32 v234, 0xffff0000, v78
  v_and_b32 v235, 0xffff0000, v82
  v_and_b32 v236, 0xffff0000, v86
  v_and_b32 v237, 0xffff0000, v90
  v_dot2c_f32_bf16 v222, v212, v179
  v_dot2c_f32_bf16 v223, v213, v179
  v_dot2c_f32_bf16 v224, v214, v179
  v_dot2c_f32_bf16 v225, v215, v179
  v_dot2c_f32_bf16 v226, v216, v179
  v_dot2c_f32_bf16 v227, v217, v179
  v_dot2c_f32_bf16 v228, v218, v179
  v_dot2c_f32_bf16_e64 v229, v219, v179
  s_waitcnt lgkmcnt(0)
  buffer_store_dwordx4 v[246:249], v12, s[16:19], s84 offen sc1
  s_add_u32 s84, s84, 4096
  v_mul_f32 v222, v222, v230
  v_mul_f32 v223, v223, v231
  v_mul_f32 v224, v224, v232
  v_mul_f32 v225, v225, v233
  v_mul_f32 v226, v226, v234
  v_mul_f32 v227, v227, v235
  v_mul_f32 v228, v228, v236
  v_mul_f32 v229, v229, v237
  v_cvt_pk_bf16_f32 v242, v229, v228
  v_cvt_pk_bf16_f32 v243, v227, v226
  v_cvt_pk_bf16_f32 v244, v225, v224
  v_cvt_pk_bf16_f32 v245, v223, v222
  ds_write_b128 v3, v[242:245] offset:1024
  ds_read_b128 v[250:253], v10 offset:1024
  v_accvgpr_read_b32 v180, a180
  v_accvgpr_read_b32 v181, a181
  v_accvgpr_read_b32 v182, a182
  v_accvgpr_read_b32 v183, a183
  v_accvgpr_read_b32 v19, a79
  v_accvgpr_read_b32 v23, a83
  v_accvgpr_read_b32 v27, a87
  v_accvgpr_read_b32 v31, a91
  v_accvgpr_read_b32 v35, a95
  v_accvgpr_read_b32 v39, a99
  v_accvgpr_read_b32 v43, a103
  v_accvgpr_read_b32 v47, a107
  v_accvgpr_read_b32 v51, a111
  v_accvgpr_read_b32 v55, a115
  v_accvgpr_read_b32 v59, a119
  v_accvgpr_read_b32 v63, a123
  v_accvgpr_read_b32 v67, a127
  v_accvgpr_read_b32 v71, a131
  v_accvgpr_read_b32 v75, a135
  v_accvgpr_read_b32 v79, a139
  v_accvgpr_read_b32 v83, a143
  v_accvgpr_read_b32 v87, a147
  v_accvgpr_read_b32 v91, a151
  v_perm_b32 v212, v19, v23, s74
  v_perm_b32 v213, v23, v27, s74
  v_perm_b32 v214, v27, v31, s74
  v_perm_b32 v215, v31, v35, s74
  v_perm_b32 v216, v35, v39, s74
  v_perm_b32 v217, v39, v43, s74
  v_perm_b32 v218, v43, v47, s74
  v_perm_b32 v219, v47, v51, s74
  v_perm_b32 v220, v51, v55, s74
  v_perm_b32 v221, v55, v59, s74
  v_dot2_f32_bf16 v222, v214, v180, 0
  v_dot2_f32_bf16 v223, v215, v180, 0
  v_dot2_f32_bf16 v224, v216, v180, 0
  v_dot2_f32_bf16 v225, v217, v180, 0
  v_dot2_f32_bf16 v226, v218, v180, 0
  v_dot2_f32_bf16 v227, v219, v180, 0
  v_dot2_f32_bf16 v228, v220, v180, 0
  v_dot2_f32_bf16 v229, v221, v180, 0
  v_lshlrev_b32 v230, 16, v63
  v_lshlrev_b32 v231, 16, v67
  v_lshlrev_b32 v232, 16, v71
  v_lshlrev_b32 v233, 16, v75
  v_lshlrev_b32 v234, 16, v79
  v_lshlrev_b32 v235, 16, v83
  v_lshlrev_b32 v236, 16, v87
  v_lshlrev_b32 v237, 16, v91
  v_dot2c_f32_bf16 v222, v212, v181
  v_dot2c_f32_bf16 v223, v213, v181
  v_dot2c_f32_bf16 v224, v214, v181
  v_dot2c_f32_bf16 v225, v215, v181
  v_dot2c_f32_bf16 v226, v216, v181
  v_dot2c_f32_bf16 v227, v217, v181
  v_dot2c_f32_bf16 v228, v218, v181
  v_dot2c_f32_bf16_e64 v229, v219, v181
  s_waitcnt lgkmcnt(0)
  buffer_store_dwordx4 v[250:253], v12, s[16:19], s84 offen sc1
  s_add_u32 s84, s84, 4096
  v_mul_f32 v222, v222, v230
  v_mul_f32 v223, v223, v231
  v_mul_f32 v224, v224, v232
  v_mul_f32 v225, v225, v233
  v_mul_f32 v226, v226, v234
  v_mul_f32 v227, v227, v235
  v_mul_f32 v228, v228, v236
  v_mul_f32 v229, v229, v237
  v_cvt_pk_bf16_f32 v238, v229, v228
  v_cvt_pk_bf16_f32 v239, v227, v226
  v_cvt_pk_bf16_f32 v240, v225, v224
  v_cvt_pk_bf16_f32 v241, v223, v222
  ds_write_b128 v3, v[238:241] offset:0
  ds_read_b128 v[246:249], v10 offset:0
  v_perm_b32 v212, v19, v23, s75
  v_perm_b32 v213, v23, v27, s75
  v_perm_b32 v214, v27, v31, s75
  v_perm_b32 v215, v31, v35, s75
  v_perm_b32 v216, v35, v39, s75
  v_perm_b32 v217, v39, v43, s75
  v_perm_b32 v218, v43, v47, s75
  v_perm_b32 v219, v47, v51, s75
  v_perm_b32 v220, v51, v55, s75
  v_perm_b32 v221, v55, v59, s75
  v_dot2_f32_bf16 v222, v214, v182, 0
  v_dot2_f32_bf16 v223, v215, v182, 0
  v_dot2_f32_bf16 v224, v216, v182, 0
  v_dot2_f32_bf16 v225, v217, v182, 0
  v_dot2_f32_bf16 v226, v218, v182, 0
  v_dot2_f32_bf16 v227, v219, v182, 0
  v_dot2_f32_bf16 v228, v220, v182, 0
  v_dot2_f32_bf16 v229, v221, v182, 0
  v_and_b32 v230, 0xffff0000, v63
  v_and_b32 v231, 0xffff0000, v67
  v_and_b32 v232, 0xffff0000, v71
  v_and_b32 v233, 0xffff0000, v75
  v_and_b32 v234, 0xffff0000, v79
  v_and_b32 v235, 0xffff0000, v83
  v_and_b32 v236, 0xffff0000, v87
  v_and_b32 v237, 0xffff0000, v91
  v_dot2c_f32_bf16 v222, v212, v183
  v_dot2c_f32_bf16 v223, v213, v183
  v_dot2c_f32_bf16 v224, v214, v183
  v_dot2c_f32_bf16 v225, v215, v183
  v_dot2c_f32_bf16 v226, v216, v183
  v_dot2c_f32_bf16 v227, v217, v183
  v_dot2c_f32_bf16 v228, v218, v183
  v_dot2c_f32_bf16_e64 v229, v219, v183
  s_waitcnt lgkmcnt(0)
  buffer_store_dwordx4 v[246:249], v12, s[16:19], s84 offen sc1
  s_add_u32 s84, s84, 4096
  v_mul_f32 v222, v222, v230
  v_mul_f32 v223, v223, v231
  v_mul_f32 v224, v224, v232
  v_mul_f32 v225, v225, v233
  v_mul_f32 v226, v226, v234
  v_mul_f32 v227, v227, v235
  v_mul_f32 v228, v228, v236
  v_mul_f32 v229, v229, v237
  v_cvt_pk_bf16_f32 v242, v229, v228
  v_cvt_pk_bf16_f32 v243, v227, v226
  v_cvt_pk_bf16_f32 v244, v225, v224
  v_cvt_pk_bf16_f32 v245, v223, v222
  ds_write_b128 v3, v[242:245] offset:1024
  ds_read_b128 v[250:253], v10 offset:1024
  s_waitcnt vmcnt(25)
  v_perm_b32 v212, v92, v96, s74
  s_waitcnt vmcnt(24)
  v_perm_b32 v213, v96, v100, s74
  s_waitcnt vmcnt(23)
  v_perm_b32 v214, v100, v104, s74
  s_waitcnt vmcnt(22)
  v_perm_b32 v215, v104, v108, s74
  s_waitcnt vmcnt(21)
  v_perm_b32 v216, v108, v112, s74
  s_waitcnt vmcnt(20)
  v_perm_b32 v217, v112, v116, s74
  s_waitcnt vmcnt(19)
  v_perm_b32 v218, v116, v120, s74
  s_waitcnt vmcnt(18)
  v_perm_b32 v219, v120, v124, s74
  s_waitcnt vmcnt(17)
  v_perm_b32 v220, v124, v128, s74
  s_waitcnt vmcnt(16)
  v_perm_b32 v221, v128, v132, s74
  v_dot2_f32_bf16 v222, v214, v184, 0
  v_dot2_f32_bf16 v223, v215, v184, 0
  v_dot2_f32_bf16 v224, v216, v184, 0
  v_dot2_f32_bf16 v225, v217, v184, 0
  v_dot2_f32_bf16 v226, v218, v184, 0
  v_dot2_f32_bf16 v227, v219, v184, 0
  v_dot2_f32_bf16 v228, v220, v184, 0
  v_dot2_f32_bf16 v229, v221, v184, 0
  s_waitcnt vmcnt(15)
  v_lshlrev_b32 v230, 16, v136
  s_waitcnt vmcnt(14)
  v_lshlrev_b32 v231, 16, v140
  s_waitcnt vmcnt(13)
  v_lshlrev_b32 v232, 16, v144
  s_waitcnt vmcnt(12)
  v_lshlrev_b32 v233, 16, v148
  s_waitcnt vmcnt(11)
  v_lshlrev_b32 v234, 16, v152
  s_waitcnt vmcnt(10)
  v_lshlrev_b32 v235, 16, v156
  s_waitcnt vmcnt(9)
  v_lshlrev_b32 v236, 16, v160
  s_waitcnt vmcnt(8)
  v_lshlrev_b32 v237, 16, v164
  v_dot2c_f32_bf16 v222, v212, v185
  v_dot2c_f32_bf16 v223, v213, v185
  v_dot2c_f32_bf16 v224, v214, v185
  v_dot2c_f32_bf16 v225, v215, v185
  v_dot2c_f32_bf16 v226, v216, v185
  v_dot2c_f32_bf16 v227, v217, v185
  v_dot2c_f32_bf16 v228, v218, v185
  v_dot2c_f32_bf16_e64 v229, v219, v185
  s_waitcnt lgkmcnt(0)
  buffer_store_dwordx4 v[250:253], v12, s[16:19], s84 offen sc1
  s_add_u32 s84, s84, 233472
  v_mul_f32 v222, v222, v230
  v_mul_f32 v223, v223, v231
  v_mul_f32 v224, v224, v232
  v_mul_f32 v225, v225, v233
  v_mul_f32 v226, v226, v234
  v_mul_f32 v227, v227, v235
  v_mul_f32 v228, v228, v236
  v_mul_f32 v229, v229, v237
  v_cvt_pk_bf16_f32 v238, v229, v228
  v_cvt_pk_bf16_f32 v239, v227, v226
  v_cvt_pk_bf16_f32 v240, v225, v224
  v_cvt_pk_bf16_f32 v241, v223, v222
  ds_write_b128 v3, v[238:241] offset:0
  ds_read_b128 v[246:249], v10 offset:0
  v_perm_b32 v212, v92, v96, s75
  v_perm_b32 v213, v96, v100, s75
  v_perm_b32 v214, v100, v104, s75
  v_perm_b32 v215, v104, v108, s75
  v_perm_b32 v216, v108, v112, s75
  v_perm_b32 v217, v112, v116, s75
  v_perm_b32 v218, v116, v120, s75
  v_perm_b32 v219, v120, v124, s75
  v_perm_b32 v220, v124, v128, s75
  v_perm_b32 v221, v128, v132, s75
  v_dot2_f32_bf16 v222, v214, v186, 0
  v_dot2_f32_bf16 v223, v215, v186, 0
  v_dot2_f32_bf16 v224, v216, v186, 0
  v_dot2_f32_bf16 v225, v217, v186, 0
  v_dot2_f32_bf16 v226, v218, v186, 0
  v_dot2_f32_bf16 v227, v219, v186, 0
  v_dot2_f32_bf16 v228, v220, v186, 0
  v_dot2_f32_bf16 v229, v221, v186, 0
  v_and_b32 v230, 0xffff0000, v136
  v_and_b32 v231, 0xffff0000, v140
  v_and_b32 v232, 0xffff0000, v144
  v_and_b32 v233, 0xffff0000, v148
  v_and_b32 v234, 0xffff0000, v152
  v_and_b32 v235, 0xffff0000, v156
  v_and_b32 v236, 0xffff0000, v160
  v_and_b32 v237, 0xffff0000, v164
  v_dot2c_f32_bf16 v222, v212, v187
  v_dot2c_f32_bf16 v223, v213, v187
  v_dot2c_f32_bf16 v224, v214, v187
  v_dot2c_f32_bf16 v225, v215, v187
  v_dot2c_f32_bf16 v226, v216, v187
  v_dot2c_f32_bf16 v227, v217, v187
  v_dot2c_f32_bf16 v228, v218, v187
  v_dot2c_f32_bf16_e64 v229, v219, v187
  s_waitcnt lgkmcnt(0)
  buffer_store_dwordx4 v[246:249], v12, s[16:19], s84 offen sc1
  s_add_u32 s84, s84, 4096
  v_mul_f32 v222, v222, v230
  v_mul_f32 v223, v223, v231
  v_mul_f32 v224, v224, v232
  v_mul_f32 v225, v225, v233
  v_mul_f32 v226, v226, v234
  v_mul_f32 v227, v227, v235
  v_mul_f32 v228, v228, v236
  v_mul_f32 v229, v229, v237
  v_cvt_pk_bf16_f32 v242, v229, v228
  v_cvt_pk_bf16_f32 v243, v227, v226
  v_cvt_pk_bf16_f32 v244, v225, v224
  v_cvt_pk_bf16_f32 v245, v223, v222
  ds_write_b128 v3, v[242:245] offset:1024
  ds_read_b128 v[250:253], v10 offset:1024
  v_perm_b32 v212, v93, v97, s74
  v_perm_b32 v213, v97, v101, s74
  v_perm_b32 v214, v101, v105, s74
  v_perm_b32 v215, v105, v109, s74
  v_perm_b32 v216, v109, v113, s74
  v_perm_b32 v217, v113, v117, s74
  v_perm_b32 v218, v117, v121, s74
  v_perm_b32 v219, v121, v125, s74
  v_perm_b32 v220, v125, v129, s74
  v_perm_b32 v221, v129, v133, s74
  v_dot2_f32_bf16 v222, v214, v188, 0
  v_dot2_f32_bf16 v223, v215, v188, 0
  v_dot2_f32_bf16 v224, v216, v188, 0
  v_dot2_f32_bf16 v225, v217, v188, 0
  v_dot2_f32_bf16 v226, v218, v188, 0
  v_dot2_f32_bf16 v227, v219, v188, 0
  v_dot2_f32_bf16 v228, v220, v188, 0
  v_dot2_f32_bf16 v229, v221, v188, 0
  v_lshlrev_b32 v230, 16, v137
  v_lshlrev_b32 v231, 16, v141
  v_lshlrev_b32 v232, 16, v145
  v_lshlrev_b32 v233, 16, v149
  v_lshlrev_b32 v234, 16, v153
  v_lshlrev_b32 v235, 16, v157
  v_lshlrev_b32 v236, 16, v161
  v_lshlrev_b32 v237, 16, v165
  v_dot2c_f32_bf16 v222, v212, v189
  v_dot2c_f32_bf16 v223, v213, v189
  v_dot2c_f32_bf16 v224, v214, v189
  v_dot2c_f32_bf16 v225, v215, v189
  v_dot2c_f32_bf16 v226, v216, v189
  v_dot2c_f32_bf16 v227, v217, v189
  v_dot2c_f32_bf16 v228, v218, v189
  v_dot2c_f32_bf16_e64 v229, v219, v189
  s_waitcnt lgkmcnt(0)
  buffer_store_dwordx4 v[250:253], v12, s[16:19], s84 offen sc1
  s_add_u32 s84, s84, 4096
  v_mul_f32 v222, v222, v230
  v_mul_f32 v223, v223, v231
  v_mul_f32 v224, v224, v232
  v_mul_f32 v225, v225, v233
  v_mul_f32 v226, v226, v234
  v_mul_f32 v227, v227, v235
  v_mul_f32 v228, v228, v236
  v_mul_f32 v229, v229, v237
  v_cvt_pk_bf16_f32 v238, v229, v228
  v_cvt_pk_bf16_f32 v239, v227, v226
  v_cvt_pk_bf16_f32 v240, v225, v224
  v_cvt_pk_bf16_f32 v241, v223, v222
  ds_write_b128 v3, v[238:241] offset:0
  ds_read_b128 v[246:249], v10 offset:0
  v_perm_b32 v212, v93, v97, s75
  v_perm_b32 v213, v97, v101, s75
  v_perm_b32 v214, v101, v105, s75
  v_perm_b32 v215, v105, v109, s75
  v_perm_b32 v216, v109, v113, s75
  v_perm_b32 v217, v113, v117, s75
  v_perm_b32 v218, v117, v121, s75
  v_perm_b32 v219, v121, v125, s75
  v_perm_b32 v220, v125, v129, s75
  v_perm_b32 v221, v129, v133, s75
  v_dot2_f32_bf16 v222, v214, v190, 0
  v_dot2_f32_bf16 v223, v215, v190, 0
  v_dot2_f32_bf16 v224, v216, v190, 0
  v_dot2_f32_bf16 v225, v217, v190, 0
  v_dot2_f32_bf16 v226, v218, v190, 0
  v_dot2_f32_bf16 v227, v219, v190, 0
  v_dot2_f32_bf16 v228, v220, v190, 0
  v_dot2_f32_bf16 v229, v221, v190, 0
  v_and_b32 v230, 0xffff0000, v137
  v_and_b32 v231, 0xffff0000, v141
  v_and_b32 v232, 0xffff0000, v145
  v_and_b32 v233, 0xffff0000, v149
  v_and_b32 v234, 0xffff0000, v153
  v_and_b32 v235, 0xffff0000, v157
  v_and_b32 v236, 0xffff0000, v161
  v_and_b32 v237, 0xffff0000, v165
  v_dot2c_f32_bf16 v222, v212, v191
  v_dot2c_f32_bf16 v223, v213, v191
  v_dot2c_f32_bf16 v224, v214, v191
  v_dot2c_f32_bf16 v225, v215, v191
  v_dot2c_f32_bf16 v226, v216, v191
  v_dot2c_f32_bf16 v227, v217, v191
  v_dot2c_f32_bf16 v228, v218, v191
  v_dot2c_f32_bf16_e64 v229, v219, v191
  s_waitcnt lgkmcnt(0)
  buffer_store_dwordx4 v[246:249], v12, s[16:19], s84 offen sc1
  s_add_u32 s84, s84, 4096
  v_mul_f32 v222, v222, v230
  v_mul_f32 v223, v223, v231
  v_mul_f32 v224, v224, v232
  v_mul_f32 v225, v225, v233
  v_mul_f32 v226, v226, v234
  v_mul_f32 v227, v227, v235
  v_mul_f32 v228, v228, v236
  v_mul_f32 v229, v229, v237
  v_cvt_pk_bf16_f32 v242, v229, v228
  v_cvt_pk_bf16_f32 v243, v227, v226
  v_cvt_pk_bf16_f32 v244, v225, v224
  v_cvt_pk_bf16_f32 v245, v223, v222
  ds_write_b128 v3, v[242:245] offset:1024
  ds_read_b128 v[250:253], v10 offset:1024
  v_perm_b32 v212, v94, v98, s74
  v_perm_b32 v213, v98, v102, s74
  v_perm_b32 v214, v102, v106, s74
  v_perm_b32 v215, v106, v110, s74
  v_perm_b32 v216, v110, v114, s74
  v_perm_b32 v217, v114, v118, s74
  v_perm_b32 v218, v118, v122, s74
  v_perm_b32 v219, v122, v126, s74
  v_perm_b32 v220, v126, v130, s74
  v_perm_b32 v221, v130, v134, s74
  v_dot2_f32_bf16 v222, v214, v192, 0
  v_dot2_f32_bf16 v223, v215, v192, 0
  v_dot2_f32_bf16 v224, v216, v192, 0
  v_dot2_f32_bf16 v225, v217, v192, 0
  v_dot2_f32_bf16 v226, v218, v192, 0
  v_dot2_f32_bf16 v227, v219, v192, 0
  v_dot2_f32_bf16 v228, v220, v192, 0
  v_dot2_f32_bf16 v229, v221, v192, 0
  v_lshlrev_b32 v230, 16, v138
  v_lshlrev_b32 v231, 16, v142
  v_lshlrev_b32 v232, 16, v146
  v_lshlrev_b32 v233, 16, v150
  v_lshlrev_b32 v234, 16, v154
  v_lshlrev_b32 v235, 16, v158
  v_lshlrev_b32 v236, 16, v162
  v_lshlrev_b32 v237, 16, v166
  v_dot2c_f32_bf16 v222, v212, v193
  v_dot2c_f32_bf16 v223, v213, v193
  v_dot2c_f32_bf16 v224, v214, v193
  v_dot2c_f32_bf16 v225, v215, v193
  v_dot2c_f32_bf16 v226, v216, v193
  v_dot2c_f32_bf16 v227, v217, v193
  v_dot2c_f32_bf16 v228, v218, v193
  v_dot2c_f32_bf16_e64 v229, v219, v193
  s_waitcnt lgkmcnt(0)
  buffer_store_dwordx4 v[250:253], v12, s[16:19], s84 offen sc1
  s_add_u32 s84, s84, 4096
  v_mul_f32 v222, v222, v230
  v_mul_f32 v223, v223, v231
  v_mul_f32 v224, v224, v232
  v_mul_f32 v225, v225, v233
  v_mul_f32 v226, v226, v234
  v_mul_f32 v227, v227, v235
  v_mul_f32 v228, v228, v236
  v_mul_f32 v229, v229, v237
  v_cvt_pk_bf16_f32 v238, v229, v228
  v_cvt_pk_bf16_f32 v239, v227, v226
  v_cvt_pk_bf16_f32 v240, v225, v224
  v_cvt_pk_bf16_f32 v241, v223, v222
  ds_write_b128 v3, v[238:241] offset:0
  ds_read_b128 v[246:249], v10 offset:0
  v_perm_b32 v212, v94, v98, s75
  v_perm_b32 v213, v98, v102, s75
  v_perm_b32 v214, v102, v106, s75
  v_perm_b32 v215, v106, v110, s75
  v_perm_b32 v216, v110, v114, s75
  v_perm_b32 v217, v114, v118, s75
  v_perm_b32 v218, v118, v122, s75
  v_perm_b32 v219, v122, v126, s75
  v_perm_b32 v220, v126, v130, s75
  v_perm_b32 v221, v130, v134, s75
  v_dot2_f32_bf16 v222, v214, v194, 0
  v_dot2_f32_bf16 v223, v215, v194, 0
  v_dot2_f32_bf16 v224, v216, v194, 0
  v_dot2_f32_bf16 v225, v217, v194, 0
  v_dot2_f32_bf16 v226, v218, v194, 0
  v_dot2_f32_bf16 v227, v219, v194, 0
  v_dot2_f32_bf16 v228, v220, v194, 0
  v_dot2_f32_bf16 v229, v221, v194, 0
  v_and_b32 v230, 0xffff0000, v138
  v_and_b32 v231, 0xffff0000, v142
  v_and_b32 v232, 0xffff0000, v146
  v_and_b32 v233, 0xffff0000, v150
  v_and_b32 v234, 0xffff0000, v154
  v_and_b32 v235, 0xffff0000, v158
  v_and_b32 v236, 0xffff0000, v162
  v_and_b32 v237, 0xffff0000, v166
  v_dot2c_f32_bf16 v222, v212, v195
  v_dot2c_f32_bf16 v223, v213, v195
  v_dot2c_f32_bf16 v224, v214, v195
  v_dot2c_f32_bf16 v225, v215, v195
  v_dot2c_f32_bf16 v226, v216, v195
  v_dot2c_f32_bf16 v227, v217, v195
  v_dot2c_f32_bf16 v228, v218, v195
  v_dot2c_f32_bf16_e64 v229, v219, v195
  s_waitcnt lgkmcnt(0)
  buffer_store_dwordx4 v[246:249], v12, s[16:19], s84 offen sc1
  s_add_u32 s84, s84, 4096
  v_mul_f32 v222, v222, v230
  v_mul_f32 v223, v223, v231
  v_mul_f32 v224, v224, v232
  v_mul_f32 v225, v225, v233
  v_mul_f32 v226, v226, v234
  v_mul_f32 v227, v227, v235
  v_mul_f32 v228, v228, v236
  v_mul_f32 v229, v229, v237
  v_cvt_pk_bf16_f32 v242, v229, v228
  v_cvt_pk_bf16_f32 v243, v227, v226
  v_cvt_pk_bf16_f32 v244, v225, v224
  v_cvt_pk_bf16_f32 v245, v223, v222
  ds_write_b128 v3, v[242:245] offset:1024
  ds_read_b128 v[250:253], v10 offset:1024
  v_perm_b32 v212, v95, v99, s74
  v_perm_b32 v213, v99, v103, s74
  v_perm_b32 v214, v103, v107, s74
  v_perm_b32 v215, v107, v111, s74
  v_perm_b32 v216, v111, v115, s74
  v_perm_b32 v217, v115, v119, s74
  v_perm_b32 v218, v119, v123, s74
  v_perm_b32 v219, v123, v127, s74
  v_perm_b32 v220, v127, v131, s74
  v_perm_b32 v221, v131, v135, s74
  v_dot2_f32_bf16 v222, v214, v196, 0
  v_dot2_f32_bf16 v223, v215, v196, 0
  v_dot2_f32_bf16 v224, v216, v196, 0
  v_dot2_f32_bf16 v225, v217, v196, 0
  v_dot2_f32_bf16 v226, v218, v196, 0
  v_dot2_f32_bf16 v227, v219, v196, 0
  v_dot2_f32_bf16 v228, v220, v196, 0
  v_dot2_f32_bf16 v229, v221, v196, 0
  v_lshlrev_b32 v230, 16, v139
  v_lshlrev_b32 v231, 16, v143
  v_lshlrev_b32 v232, 16, v147
  v_lshlrev_b32 v233, 16, v151
  v_lshlrev_b32 v234, 16, v155
  v_lshlrev_b32 v235, 16, v159
  v_lshlrev_b32 v236, 16, v163
  v_lshlrev_b32 v237, 16, v167
  v_dot2c_f32_bf16 v222, v212, v197
  v_dot2c_f32_bf16 v223, v213, v197
  v_dot2c_f32_bf16 v224, v214, v197
  v_dot2c_f32_bf16 v225, v215, v197
  v_dot2c_f32_bf16 v226, v216, v197
  v_dot2c_f32_bf16 v227, v217, v197
  v_dot2c_f32_bf16 v228, v218, v197
  v_dot2c_f32_bf16_e64 v229, v219, v197
  s_waitcnt lgkmcnt(0)
  buffer_store_dwordx4 v[250:253], v12, s[16:19], s84 offen sc1
  s_add_u32 s84, s84, 4096
  v_mul_f32 v222, v222, v230
  v_mul_f32 v223, v223, v231
  v_mul_f32 v224, v224, v232
  v_mul_f32 v225, v225, v233
  v_mul_f32 v226, v226, v234
  v_mul_f32 v227, v227, v235
  v_mul_f32 v228, v228, v236
  v_mul_f32 v229, v229, v237
  v_cvt_pk_bf16_f32 v238, v229, v228
  v_cvt_pk_bf16_f32 v239, v227, v226
  v_cvt_pk_bf16_f32 v240, v225, v224
  v_cvt_pk_bf16_f32 v241, v223, v222
  ds_write_b128 v3, v[238:241] offset:0
  ds_read_b128 v[246:249], v10 offset:0
  v_perm_b32 v212, v95, v99, s75
  v_perm_b32 v213, v99, v103, s75
  v_perm_b32 v214, v103, v107, s75
  v_perm_b32 v215, v107, v111, s75
  v_perm_b32 v216, v111, v115, s75
  v_perm_b32 v217, v115, v119, s75
  v_perm_b32 v218, v119, v123, s75
  v_perm_b32 v219, v123, v127, s75
  v_perm_b32 v220, v127, v131, s75
  v_perm_b32 v221, v131, v135, s75
  v_dot2_f32_bf16 v222, v214, v198, 0
  v_dot2_f32_bf16 v223, v215, v198, 0
  v_dot2_f32_bf16 v224, v216, v198, 0
  v_dot2_f32_bf16 v225, v217, v198, 0
  v_dot2_f32_bf16 v226, v218, v198, 0
  v_dot2_f32_bf16 v227, v219, v198, 0
  v_dot2_f32_bf16 v228, v220, v198, 0
  v_dot2_f32_bf16 v229, v221, v198, 0
  v_and_b32 v230, 0xffff0000, v139
  v_and_b32 v231, 0xffff0000, v143
  v_and_b32 v232, 0xffff0000, v147
  v_and_b32 v233, 0xffff0000, v151
  v_and_b32 v234, 0xffff0000, v155
  v_and_b32 v235, 0xffff0000, v159
  v_and_b32 v236, 0xffff0000, v163
  v_and_b32 v237, 0xffff0000, v167
  v_dot2c_f32_bf16 v222, v212, v199
  v_dot2c_f32_bf16 v223, v213, v199
  v_dot2c_f32_bf16 v224, v214, v199
  v_dot2c_f32_bf16 v225, v215, v199
  v_dot2c_f32_bf16 v226, v216, v199
  v_dot2c_f32_bf16 v227, v217, v199
  v_dot2c_f32_bf16 v228, v218, v199
  v_dot2c_f32_bf16_e64 v229, v219, v199
  s_waitcnt lgkmcnt(0)
  buffer_store_dwordx4 v[246:249], v12, s[16:19], s84 offen sc1
  s_add_u32 s84, s84, 4096
  v_mul_f32 v222, v222, v230
  v_mul_f32 v223, v223, v231
  v_mul_f32 v224, v224, v232
  v_mul_f32 v225, v225, v233
  v_mul_f32 v226, v226, v234
  v_mul_f32 v227, v227, v235
  v_mul_f32 v228, v228, v236
  v_mul_f32 v229, v229, v237
  v_cvt_pk_bf16_f32 v242, v229, v228
  v_cvt_pk_bf16_f32 v243, v227, v226
  v_cvt_pk_bf16_f32 v244, v225, v224
  v_cvt_pk_bf16_f32 v245, v223, v222
  ds_write_b128 v3, v[242:245] offset:1024
  ds_read_b128 v[250:253], v10 offset:1024
  s_waitcnt lgkmcnt(0)
  buffer_store_dwordx4 v[250:253], v12, s[16:19], s84 offen sc1
  s_add_u32 s84, s84, 233472
parallel_sum__ssm_conv_h3__mixer_gmlp__prompt_kernel_kvend:
  v_mul_u32_u24 v4, 4096, v0
  s_waitcnt vmcnt(0)
  s_mov_b32 exec_lo, s80
  s_mov_b32 exec_hi, 0
  buffer_store_dword v13, v4, s[16:19], s70 offen sc1
  s_mov_b64 exec, -1
  v_lshrrev_b32 v4, 3, v0
  v_lshlrev_b32 v4, 11, v4
  v_and_b32 v5, 7, v0
  v_lshl_add_u32 v4, v5, 7, v4
  v_lshlrev_b32_e64 v5, 7, v0
  s_and_b32 s4, s61, 1
  s_lshl_b32 s4, s4, 2
  s_add_u32 s4, s4, s3
  s_lshr_b32 s5, s60, 1
  s_mul_i32 s5, s5, 917504
  s_mul_i32 s6, s4, 114688
  s_add_u32 s5, s5, s6
  s_and_b32 s6, s60, 1
  s_lshl_b32 s6, s6, 10
  s_add_u32 s5, s5, s6
  s_lshl_b32 s4, s4, 19
  s_lshl_b32 s6, s60, 14
  s_add_u32 s4, s4, s6
  s_barrier
  s_cmp_ge_u32 s61, 2
  s_cbranch_scc1 parallel_sum__ssm_conv_h3__mixer_gmlp__prompt_kernel_pfc
  buffer_load_dword v100, v4, s[48:51], s5 offen
  s_add_u32 s5, s5, 16384
  buffer_load_dword v100, v4, s[48:51], s5 offen
  s_add_u32 s5, s5, 16384
  buffer_load_dword v100, v4, s[48:51], s5 offen
  s_add_u32 s5, s5, 16384
  buffer_load_dword v100, v4, s[48:51], s5 offen
  s_add_u32 s5, s5, 16384
  s_branch parallel_sum__ssm_conv_h3__mixer_gmlp__prompt_kernel_pfe
parallel_sum__ssm_conv_h3__mixer_gmlp__prompt_kernel_pfc:
  s_add_u32 s5, s5, 65536
  buffer_load_dword v100, v4, s[48:51], s5 offen
  s_add_u32 s5, s5, 16384
  buffer_load_dword v100, v4, s[48:51], s5 offen
  s_add_u32 s5, s5, 16384
  buffer_load_dword v100, v4, s[48:51], s5 offen
  s_add_u32 s5, s5, 16384
parallel_sum__ssm_conv_h3__mixer_gmlp__prompt_kernel_pfe:
  s_and_b32 s4, s2, 7
  s_lshr_b32 s5, s2, 3
  s_lshr_b32 s95, s4, 1
  s_lshl_b32 s95, s95, 3
  s_lshr_b32 s6, s5, 2
  s_add_u32 s95, s95, s6
  s_and_b32 s7, s4, 1
  s_lshl_b32 s7, s7, 2
  s_and_b32 s6, s5, 3
  s_add_u32 s7, s7, s6
  s_xor_b32 s7, s7, 1
  s_lshl_b32 s96, s7, 8
  s_lshl_b32 s6, s3, 6
  s_add_u32 s96, s96, s6
  s_add_u32 s6, s95, 2
  s_and_b32 s6, s6, 7
  s_and_b32 s97, s95, 24
  s_add_u32 s97, s97, s6
  s_add_u32 s97, s97, s7
  s_cmp_ge_u32 s97, 28
  s_cselect_b32 s6, 28, 0
  s_sub_u32 s97, s97, s6
  s_cmp_ge_u32 s97, 14
  s_cselect_b32 s6, 14, 0
  s_sub_u32 s97, s97, s6
  v_lshrrev_b32 v7, 2, v1
  v_lshlrev_b32 v8, 6, v7
  v_bfe_u32 v9, v1, 1, 1
  v_lshl_add_u32 v8, v9, 4, v8
  v_and_b32_e64 v9, 1, v1
  v_lshl_add_u32 v209, v9, 2, v8
  s_lshl_b32 s72, s97, 18
  s_mul_i32 s88, s2, 4096
  s_lshl_b32 s4, s3, 7
  s_add_u32 s88, s88, s4
  s_add_u32 s88, s88, 1314304
  s_lshl_b32 s4, s2, 2
  s_add_u32 s4, s4, s3
  s_lshl_b32 s71, s4, 12
  s_mul_i32 s75, s4, 4096
  s_add_u32 s75, s75, 33554432
  s_add_u32 s86, s71, 5242880
  s_lshr_b32 s94, s4, 5
  s_mul_i32 s94, s94, 4096
  s_and_b32 s98, s4, 31
  s_lshl_b32 s98, s98, 4
  s_add_u32 s98, s98, s94
  s_add_u32 s98, s98, 1835008
  s_add_u32 s94, s94, 1572864
  v_mov_b32 v9, 0
  s_lshl_b32 s87, s95, 17
  s_mul_i32 s91, s95, 4096
  s_add_u32 s91, s91, 1310720
  s_lshr_b32 s99, s96, 6
  s_mul_i32 s99, s99, 4096
  s_add_u32 s99, s99, 1835008
  s_lshl_b32 s100, s96, 11
  s_lshl_b32 s5, s95, 7
  s_add_u32 s100, s100, s5
  s_add_u32 s100, s100, 5242880
  s_lshl_b32 s60, s95, 1
  s_and_b32 s5, s3, 1
  s_add_u32 s60, s60, s5
  s_lshl_b32 s60, s60, 8
  s_lshl_b32 s63, s3, 12
  s_lshl_b32 s90, s97, 14
  s_mul_i32 s4, s95, 229376
  s_add_u32 s4, s4, s63
  s_add_u32 s4, s4, 25165824
  v_add_u32 v12, s4, v208
  s_add_u32 s85, s68, 11808
  s_lshl_b32 s84, s3, 13
  s_add_u32 s84, s84, 65536
  v_add_u32 v250, s85, v208
  v_add_u32_e64 v251, s68, v208
  s_and_b32 s5, s3, 1
  s_lshl_b32 s4, s5, 17
  s_andn2_b32 s6, s96, 127
  s_add_u32 s4, s4, s6
  v_lshrrev_b32 v4, 3, v0
  v_lshlrev_b32 v4, 11, v4
  v_and_b32 v5, 7, v0
  v_lshlrev_b32 v6, 1, v2
  v_xor_b32 v6, v5, v6
  v_lshlrev_b32_e64 v6, 4, v6
  v_add3_u32 v244, v4, v6, s4
  v_add_u32 v245, 15360, v244
  v_add_u32 v246, 30720, v244
  v_add_u32 v247, 46080, v244
  v_lshlrev_b32_e64 v4, 2, v2
  v_bfe_u32 v6, v0, 2, 2
  v_add_u32_e64 v4, v4, v6
  v_bfe_u32 v6, v4, 1, 2
  v_lshlrev_b32_e64 v4, 7, v4
  v_lshl_add_u32 v4, v6, 5, v4
  v_and_b32_e64 v5, 3, v0
  v_lshl_add_u32 v4, v5, 3, v4
  v_add_u32 v240, s68, v4
  v_xor_b32 v241, 32, v240
  v_xor_b32_e64 v242, 64, v240
  v_xor_b32 v243, 96, v240
  s_sub_u32 s4, s63, s68
  v_add_u32 v232, s4, v240
  v_add_u32 v233, s4, v241
  v_add_u32 v234, s4, v242
  v_add_u32 v235, s4, v243
  s_sub_u32 s4, s84, s68
  v_add_u32 v228, s4, v240
  v_add_u32 v229, s4, v241
  v_add_u32 v230, s4, v242
  v_add_u32 v231, s4, v243
  s_mul_i32 s4, s5, 10240
  v_add_u32_e64 v248, s4, v208
  s_mul_i32 s4, s5, 6144
  v_add_u32 v249, s4, v208
  v_lshlrev_b32 v3, 5, v1
  v_lshl_add_u32 v8, v2, 4, v3
  v_add_u32_e64 v8, s85, v8
  v_lshl_add_u32 v3, v2, 3, v3
  s_add_u32 s4, s68, 504
  v_sub_u32 v11, s4, v3
  v_add_u32 v3, s85, v3
  v_sub_u32 v4, 1807, v1
  v_lshrrev_b32 v4, 1, v4
  v_lshlrev_b32 v4, 2, v4
  v_lshl_add_u32 v4, v2, 4, v4
  v_and_b32_e64 v5, 1, v1
  v_mul_u32_u24 v5, 4160, v5
  v_sub_u32_e64 v4, v4, v5
  s_add_u32 s4, s68, 3648
  v_add_u32_e64 v4, s4, v4
  v_subrev_u32 v5, 1024, v4
  v_subrev_u32 v6, 2048, v4
  v_subrev_u32 v7, 3072, v4
  v_and_b32 v254, 31, v0
  v_lshlrev_b32 v254, 4, v254
  s_add_u32 m0, s85, 480
  s_nop 0
  buffer_load_dwordx4 v208, s[32:35], s71 offen offset:0 nt lds
  buffer_load_dwordx4 v208, s[32:35], s71 offen offset:1024 nt lds
  buffer_load_dwordx4 v208, s[32:35], s71 offen offset:2048 nt lds
  buffer_load_dwordx4 v208, s[32:35], s71 offen offset:3072 nt lds
  s_lshr_b32 s7, s71, 11
  buffer_load_ushort v9, v9, s[36:39], s7 offen
  buffer_load_dword v255, v254, s[16:19], s94 offen sc1
  s_add_u32 m0, s63, 0
  s_add_u32 s73, s72, 0x10000
  buffer_load_dwordx4 v244, s[48:51], s72 offen offset:0 lds
  buffer_load_dwordx4 v245, s[48:51], s72 offen offset:1024 lds
  buffer_load_dwordx4 v246, s[48:51], s72 offen offset:2048 lds
  buffer_load_dwordx4 v247, s[48:51], s72 offen offset:3072 lds
  s_add_u32 m0, s63, 16384
  s_nop 0
  buffer_load_dwordx4 v244, s[48:51], s73 offen offset:0 lds
  buffer_load_dwordx4 v245, s[48:51], s73 offen offset:1024 lds
  buffer_load_dwordx4 v246, s[48:51], s73 offen offset:2048 lds
  buffer_load_dwordx4 v247, s[48:51], s73 offen offset:3072 lds
  s_add_u32 s72, s72, 0x40000
  s_cmp_eq_u32 s72, 0x380000
  s_cselect_b32 s72, 0, s72
  s_add_u32 m0, s63, 32768
  s_add_u32 s73, s72, 0x10000
  buffer_load_dwordx4 v244, s[48:51], s72 offen offset:0 lds
  buffer_load_dwordx4 v245, s[48:51], s72 offen offset:1024 lds
  buffer_load_dwordx4 v246, s[48:51], s72 offen offset:2048 lds
  buffer_load_dwordx4 v247, s[48:51], s72 offen offset:3072 lds
  s_add_u32 m0, s63, 49152
  s_nop 0
  buffer_load_dwordx4 v244, s[48:51], s73 offen offset:0 lds
  buffer_load_dwordx4 v245, s[48:51], s73 offen offset:1024 lds
  buffer_load_dwordx4 v246, s[48:51], s73 offen offset:2048 lds
  buffer_load_dwordx4 v247, s[48:51], s73 offen offset:3072 lds
  s_add_u32 s72, s72, 0x40000
  s_cmp_eq_u32 s72, 0x380000
  s_cselect_b32 s72, 0, s72
  s_add_u32 m0, s84, 0
  s_add_u32 s73, s72, 0x10000
  buffer_load_dwordx4 v244, s[48:51], s72 offen offset:0 lds
  buffer_load_dwordx4 v245, s[48:51], s72 offen offset:1024 lds
  buffer_load_dwordx4 v246, s[48:51], s72 offen offset:2048 lds
  buffer_load_dwordx4 v247, s[48:51], s72 offen offset:3072 lds
  s_add_u32 m0, s84, 4096
  s_nop 0
  buffer_load_dwordx4 v244, s[48:51], s73 offen offset:0 lds
  buffer_load_dwordx4 v245, s[48:51], s73 offen offset:1024 lds
  buffer_load_dwordx4 v246, s[48:51], s73 offen offset:2048 lds
  buffer_load_dwordx4 v247, s[48:51], s73 offen offset:3072 lds
  s_add_u32 s72, s72, 0x40000
  s_cmp_eq_u32 s72, 0x380000
  s_cselect_b32 s72, 0, s72
  v_mov_b32 v236, 0
  v_mov_b32 v237, 0
  v_mov_b32 v238, 0
  v_mov_b32 v239, 0
  s_waitcnt vmcnt(24)
  v_cmp_ne_u32_e64 vcc, s64, v255
  s_cbranch_vccnz parallel_sum__ssm_conv_h3__mixer_gmlp__prompt_kernel_ug_slow
parallel_sum__ssm_conv_h3__mixer_gmlp__prompt_kernel_ug_ok:
  s_mov_b32 m0, s68
  s_nop 0
  buffer_load_dwordx4 v208, s[16:19], s75 offen offset:0 sc1 nt lds
  buffer_load_dwordx4 v208, s[16:19], s75 offen offset:1024 sc1 nt lds
  buffer_load_dwordx4 v208, s[16:19], s75 offen offset:2048 sc1 nt lds
  buffer_load_dwordx4 v208, s[16:19], s75 offen offset:3072 sc1 nt lds
  v_lshl_add_u32 v10, v0, 3, s68
  ds_write_b64 v10, v[236:237] offset:4096
  ds_write_b64 v10, v[236:237] offset:8256
  ds_write_b64 v10, v[236:237] offset:11776
  s_waitcnt vmcnt(24)
  ds_read_b64_tr_b16 a[0:1], v232 offset:0
  ds_read_b64_tr_b16 a[2:3], v232 offset:2048
  ds_read_b64_tr_b16 a[4:5], v233 offset:0
  ds_read_b64_tr_b16 a[6:7], v233 offset:2048
  ds_read_b64_tr_b16 a[8:9], v234 offset:0
  ds_read_b64_tr_b16 a[10:11], v234 offset:2048
  ds_read_b64_tr_b16 a[12:13], v235 offset:0
  ds_read_b64_tr_b16 a[14:15], v235 offset:2048
  s_waitcnt vmcnt(20)
  ds_read_b64_tr_b16 a[16:17], v232 offset:16384
  ds_read_b64_tr_b16 a[18:19], v232 offset:18432
  ds_read_b64_tr_b16 a[20:21], v233 offset:16384
  ds_read_b64_tr_b16 a[22:23], v233 offset:18432
  ds_read_b64_tr_b16 a[24:25], v234 offset:16384
  ds_read_b64_tr_b16 a[26:27], v234 offset:18432
  ds_read_b64_tr_b16 a[28:29], v235 offset:16384
  ds_read_b64_tr_b16 a[30:31], v235 offset:18432
  s_waitcnt lgkmcnt(8)
  s_add_u32 m0, s63, 0
  s_add_u32 s73, s72, 0x10000
  buffer_load_dwordx4 v244, s[48:51], s72 offen offset:0 lds
  buffer_load_dwordx4 v245, s[48:51], s72 offen offset:1024 lds
  buffer_load_dwordx4 v246, s[48:51], s72 offen offset:2048 lds
  buffer_load_dwordx4 v247, s[48:51], s72 offen offset:3072 lds
  s_waitcnt lgkmcnt(0)
  s_add_u32 m0, s63, 16384
  s_nop 0
  buffer_load_dwordx4 v244, s[48:51], s73 offen offset:0 lds
  buffer_load_dwordx4 v245, s[48:51], s73 offen offset:1024 lds
  buffer_load_dwordx4 v246, s[48:51], s73 offen offset:2048 lds
  buffer_load_dwordx4 v247, s[48:51], s73 offen offset:3072 lds
  s_add_u32 s72, s72, 0x40000
  s_cmp_eq_u32 s72, 0x380000
  s_cselect_b32 s72, 0, s72
  s_waitcnt vmcnt(24)
  ds_read_b64_tr_b16 a[32:33], v232 offset:32768
  ds_read_b64_tr_b16 a[34:35], v232 offset:34816
  ds_read_b64_tr_b16 a[36:37], v233 offset:32768
  ds_read_b64_tr_b16 a[38:39], v233 offset:34816
  ds_read_b64_tr_b16 a[40:41], v234 offset:32768
  ds_read_b64_tr_b16 a[42:43], v234 offset:34816
  ds_read_b64_tr_b16 a[44:45], v235 offset:32768
  ds_read_b64_tr_b16 a[46:47], v235 offset:34816
  s_waitcnt vmcnt(20)
  ds_read_b64_tr_b16 a[48:49], v232 offset:49152
  ds_read_b64_tr_b16 a[50:51], v232 offset:51200
  ds_read_b64_tr_b16 a[52:53], v233 offset:49152
  ds_read_b64_tr_b16 a[54:55], v233 offset:51200
  ds_read_b64_tr_b16 a[56:57], v234 offset:49152
  ds_read_b64_tr_b16 a[58:59], v234 offset:51200
  ds_read_b64_tr_b16 a[60:61], v235 offset:49152
  ds_read_b64_tr_b16 a[62:63], v235 offset:51200
  s_waitcnt lgkmcnt(8)
  s_add_u32 m0, s63, 32768
  s_add_u32 s73, s72, 0x10000
  buffer_load_dwordx4 v244, s[48:51], s72 offen offset:0 lds
  buffer_load_dwordx4 v245, s[48:51], s72 offen offset:1024 lds
  buffer_load_dwordx4 v246, s[48:51], s72 offen offset:2048 lds
  buffer_load_dwordx4 v247, s[48:51], s72 offen offset:3072 lds
  s_waitcnt lgkmcnt(0)
  s_add_u32 m0, s63, 49152
  s_nop 0
  buffer_load_dwordx4 v244, s[48:51], s73 offen offset:0 lds
  buffer_load_dwordx4 v245, s[48:51], s73 offen offset:1024 lds
  buffer_load_dwordx4 v246, s[48:51], s73 offen offset:2048 lds
  buffer_load_dwordx4 v247, s[48:51], s73 offen offset:3072 lds
  s_add_u32 s72, s72, 0x40000
  s_cmp_eq_u32 s72, 0x380000
  s_cselect_b32 s72, 0, s72
  s_waitcnt vmcnt(16)
  ds_read_b128 v[144:147], v251 offset:0
  ds_read_b32 v148, v251 offset:16
  ds_read_b128 v[152:155], v251 offset:1024
  ds_read_b32 v156, v251 offset:1040
  ds_read_b128 v[160:163], v251 offset:2048
  ds_read_b32 v164, v251 offset:2064
  ds_read_b128 v[168:171], v251 offset:3072
  ds_read_b32 v172, v251 offset:3088
  s_waitcnt lgkmcnt(7)
  v_alignbit_b32 v144, v145, v144, 16
  v_alignbit_b32 v145, v146, v145, 16
  v_alignbit_b32 v146, v147, v146, 16
  s_waitcnt lgkmcnt(6)
  v_alignbit_b32 v147, v148, v147, 16
  ds_write_b128 v251, v[144:147] offset:4160
  s_waitcnt lgkmcnt(6)
  v_alignbit_b32 v152, v153, v152, 16
  v_alignbit_b32 v153, v154, v153, 16
  v_alignbit_b32 v154, v155, v154, 16
  s_waitcnt lgkmcnt(5)
  v_alignbit_b32 v155, v156, v155, 16
  ds_write_b128 v251, v[152:155] offset:5184
  s_waitcnt lgkmcnt(5)
  v_alignbit_b32 v160, v161, v160, 16
  v_alignbit_b32 v161, v162, v161, 16
  v_alignbit_b32 v162, v163, v162, 16
  s_waitcnt lgkmcnt(4)
  v_alignbit_b32 v163, v164, v163, 16
  ds_write_b128 v251, v[160:163] offset:6208
  s_waitcnt lgkmcnt(4)
  v_alignbit_b32 v168, v169, v168, 16
  v_alignbit_b32 v169, v170, v169, 16
  v_alignbit_b32 v170, v171, v170, 16
  s_waitcnt lgkmcnt(3)
  v_alignbit_b32 v171, v172, v171, 16
  ds_write_b128 v251, v[168:171] offset:7232
  ds_read2_b32 v[176:177], v4 offset0:128 offset1:129
  ds_read2_b32 v[178:179], v4 offset0:130 offset1:131
  ds_read2_b32 v[180:181], v4 offset0:0 offset1:1
  ds_read2_b32 v[182:183], v4 offset0:2 offset1:3
  ds_read2_b32 v[184:185], v5 offset0:128 offset1:129
  ds_read2_b32 v[186:187], v5 offset0:130 offset1:131
  ds_read2_b32 v[188:189], v5 offset0:0 offset1:1
  ds_read2_b32 v[190:191], v5 offset0:2 offset1:3
  ds_read2_b32 v[192:193], v6 offset0:128 offset1:129
  ds_read2_b32 v[194:195], v6 offset0:130 offset1:131
  ds_read2_b32 v[196:197], v6 offset0:0 offset1:1
  ds_read2_b32 v[198:199], v6 offset0:2 offset1:3
  ds_read2_b32 v[200:201], v7 offset0:128 offset1:129
  ds_read2_b32 v[202:203], v7 offset0:130 offset1:131
  ds_read2_b32 v[204:205], v7 offset0:0 offset1:1
  ds_read2_b32 v[206:207], v7 offset0:2 offset1:3
  ds_read_b128 v[144:147], v8 offset:0
  ds_read_b128 v[148:151], v8 offset:512
  ds_read_b128 v[152:155], v8 offset:1024
  ds_read_b128 v[156:159], v8 offset:1536
  ds_read_b128 v[160:163], v8 offset:2048
  ds_read_b128 v[164:167], v8 offset:2560
  ds_read_b128 v[168:171], v8 offset:3072
  ds_read_b128 v[172:175], v8 offset:3584
  s_waitcnt vmcnt(0) lgkmcnt(0)
  s_branch parallel_sum__ssm_conv_h3__mixer_gmlp__prompt_kernel_join
parallel_sum__ssm_conv_h3__mixer_gmlp__prompt_kernel_last:
.section .rodata,"a"
.p2align 6
.amdhsa_kernel parallel_sum__ssm_conv_h3__mixer_gmlp__prompt_kernel
  .amdhsa_next_free_vgpr 512
  .amdhsa_next_free_sgpr 102
  .amdhsa_accum_offset 256
  .amdhsa_group_segment_fixed_size 0
  .amdhsa_kernarg_size 112
  .amdhsa_user_sgpr_count 2
  .amdhsa_user_sgpr_kernarg_segment_ptr 1
  .amdhsa_system_sgpr_workgroup_id_x 1
.end_amdhsa_kernel
```
